```python
import torch

def _softmax(x, axis=-1):
    return torch.softmax(x, dim=axis)
def _gelu(x):
    return torch.nn.functional.gelu(x, approximate="tanh")
def _silu(x):
    return torch.nn.functional.silu(x)
def _sigmoid(x):
    return torch.sigmoid(x)
def _layernorm(x, axis=-1, eps=1e-5):
    m = x.mean(dim=axis, keepdim=True)
    v = x.var(dim=axis, keepdim=True, unbiased=False)
    return (x - m) / torch.sqrt(v + eps)
def _scatter_add(tgt, idx, src, axis=0):
    return tgt.clone().index_add_(axis, idx, src)
def _segment_sum(src, seg, n):
    out = torch.zeros((n,) + src.shape[1:], dtype=src.dtype)
    return out.index_add_(0, seg, src)
def _pad(x, pw):
    flat = tuple(v for pair in reversed(pw) for v in pair)
    return torch.nn.functional.pad(x, flat)

kernel_name = 'standalone__window_attn_swin__vision'

def setup_inputs():

    _w = (lambda a: (lambda t: t.to(torch.bfloat16) if t.is_floating_point() else t)(torch.as_tensor(a)))
    H = W = 256
    C = 384
    ws = 8
    nh = 4
    shift = ws // 2
    coords = torch.stack(torch.meshgrid(torch.arange(ws), torch.arange(ws), indexing='ij'), 0).reshape(2, -1)
    rel = coords[:, :, None] - coords[:, None, :]
    rel[0] += ws - 1
    rel[1] += ws - 1
    rel[0] *= 2 * ws - 1
    rp_idx = rel.sum(0).to(torch.int64)
    img_mask = torch.zeros((1, H, W, 1), dtype=float)
    cnt = 0
    for hs in (slice(0, H - ws), slice(H - ws, H - shift), slice(H - shift, H)):
        for vs in (slice(0, W - ws), slice(W - ws, W - shift), slice(W - shift, W)):
            img_mask[:, hs, vs, :] = cnt
            cnt += 1
    mw = img_mask.reshape(1, H // ws, ws, W // ws, ws, 1).permute(0, 1, 3, 2, 4, 5).reshape(-1, ws * ws)
    am = mw[:, :, None] - mw[:, None, :]
    attn_mask = torch.where(am != 0, -100.0, 0.0).to(float)
    return {
        "x": _w((lambda *s: torch.randn(*s, dtype=torch.bfloat16) * 1.6)(1, H, W, C)),
        "wqkv": _w((lambda *s: torch.randn(*s, dtype=torch.bfloat16) * 1.6)(C, 3 * C) * 0.02),
        "wo": _w((lambda *s: torch.randn(*s, dtype=torch.bfloat16) * 0.05)(C, C) * 0.02),
        "rpb": _w((lambda *s: torch.randn(*s, dtype=torch.bfloat16) * 0.2)((2 * ws - 1) * (2 * ws - 1), nh)),
        "rp_idx": _w(rp_idx),
        "attn_mask": _w(attn_mask),
    }

def reference(x, wqkv, wo, rpb, rp_idx, attn_mask):
    B, H, W, C = x.shape
    N = rp_idx.shape[0]
    ws = int(round(N ** 0.5))
    nh = rpb.shape[-1]
    hd = C // nh
    shift = ws // 2
    xs = torch.roll(x, (-shift, -shift), (1, 2))
    nWh = H // ws
    nWw = W // ws
    xw = (lambda x, *d: x.permute(*d))(xs.reshape(B, nWh, ws, nWw, ws, C), 0, 1, 3, 2, 4, 5).reshape(B * nWh * nWw, N, C)
    qkv = (lambda x, *d: x.permute(*d))(torch.einsum('wnc,cd->wnd', xw, wqkv).reshape(-1, N, 3, nh, hd), 2, 0, 3, 1, 4)
    q, k, v = qkv[0], qkv[1], qkv[2]
    attn = torch.einsum('whid,whjd->whij', q, k) * (hd ** -0.5)
    bias = (lambda x, *d: x.permute(*d))(rpb[rp_idx.reshape(-1)].reshape(N, N, nh), 2, 0, 1)
    attn = attn + bias[None, :, :, :]
    attn = (attn.reshape(B, nWh * nWw, nh, N, N) + attn_mask[None, :, None, :, :]).reshape(-1, nh, N, N)
    attn = _softmax(attn, axis=-1)
    out = (lambda x, *d: x.permute(*d))(torch.einsum('whij,whjd->whid', attn, v), 0, 2, 1, 3).reshape(-1, N, C)
    out = torch.einsum('wnc,cd->wnd', out, wo)
    out = (lambda x, *d: x.permute(*d))(out.reshape(B, nWh, nWw, ws, ws, C), 0, 1, 3, 2, 4, 5).reshape(B, H, W, C)
    return torch.roll(out, (shift, shift), (1, 2))
```

```asm
; @launch grid=(256,1,1) block=(256,1,1) lds=163840
.amdgcn_target "amdgcn-amd-amdhsa--gfx950"
.text
.p2align 12
L_top:
.globl standalone__window_attn_swin__vision_kernel
.p2align 8
.type standalone__window_attn_swin__vision_kernel,@function
standalone__window_attn_swin__vision_kernel:
    s_cmp_ge_u32 s2, 256
    s_cbranch_scc1 L_end
    s_mov_b64 vcc, 0
    s_load_dwordx4 s[40:43], s[0:1], 0
    s_load_dwordx2 s[44:45], s[0:1], 16
    s_load_dwordx2 s[52:53], s[0:1], 24
    s_load_dwordx2 s[56:57], s[0:1], 48
    v_lshrrev_b32 v255, 6, v0
    v_and_b32 v254, 63, v0
    v_readfirstlane_b32 s28, v255
    v_lshrrev_b32 v253, 3, v254
    v_lshrrev_b32 v252, 4, v254
    v_and_b32 v251, 7, v254
    v_xor_b32 v255, v251, v252
    v_lshrrev_b32 v250, 2, v253
    v_and_b32 v249, 3, v253
    v_lshl_add_u32 v248, v250, 3, v249
    v_bfe_u32 v251, v254, 1, 2
    v_xor_b32 v247, v251, v252
    v_and_b32 v246, 1, v254
    v_lshlrev_b32 v250, 4, v246
    v_lshl_add_u32 v249, v247, 5, v250
    s_lshl_b32 s29, s28, 10
    s_lshl_b32 s37, s2, 2
    s_add_u32 s37, s37, s28
    s_lshr_b32 s38, s37, 5
    s_and_b32 s39, s37, 31
    s_lshl_b32 s33, s38, 3
    s_add_u32 s33, s33, 4
    s_lshl_b32 s34, s39, 3
    s_add_u32 s34, s34, 4
    s_cmp_eq_u32 s38, 31
    s_cselect_b32 s35, -1, 0
    s_cmp_eq_u32 s39, 31
    s_cselect_b32 s36, -1, 0
    s_lshl_b32 s100, s28, 13
    s_add_u32 s100, s100, 65536
    s_and_b32 s46, s28, 1
    s_lshl_b32 s46, s46, 4
    s_lshr_b32 s47, s28, 1
    s_lshl_b32 s47, s47, 2
    s_add_u32 s46, s46, s47
    v_add_u32 v251, s46, v248
    v_mul_u32_u24 v250, 2304, v251
    v_add_u32 v247, v250, v249
    v_add_u32 v246, s34, v253
    v_and_b32 v248, 255, v246
    v_mul_u32_u24 v251, 768, v248
    v_lshl_add_u32 v250, v255, 4, v251
    v_xor_b32 v253, 64, v250
    s_add_u32 s38, s33, 0
    s_and_b32 s38, s38, 255
    s_mul_i32 s92, s38, 196608
    s_add_u32 s38, s33, 1
    s_and_b32 s38, s38, 255
    s_mul_i32 s93, s38, 196608
    s_add_u32 s38, s33, 2
    s_and_b32 s38, s38, 255
    s_mul_i32 s94, s38, 196608
    s_add_u32 s38, s33, 3
    s_and_b32 s38, s38, 255
    s_mul_i32 s95, s38, 196608
    s_add_u32 s38, s33, 4
    s_and_b32 s38, s38, 255
    s_mul_i32 s96, s38, 196608
    s_add_u32 s38, s33, 5
    s_and_b32 s38, s38, 255
    s_mul_i32 s97, s38, 196608
    s_add_u32 s38, s33, 6
    s_and_b32 s38, s38, 255
    s_mul_i32 s98, s38, 196608
    s_add_u32 s38, s33, 7
    s_and_b32 s38, s38, 255
    s_mul_i32 s99, s38, 196608
    s_waitcnt lgkmcnt(0)
    s_mov_b32 s4, s42
    s_mov_b32 s5, s43
    s_mov_b32 s42, 50331648
    s_mov_b32 s43, 0x20000
    s_add_u32 s6, s4, 73728
    s_addc_u32 s7, s5, 0
    s_add_u32 m0, s100, 0
    s_nop 0
    buffer_load_dwordx4 v250, s[40:43], s92 offen nt lds
    s_add_u32 m0, s29, 7424
    s_nop 0
    global_load_lds_dwordx4 v247, s[4:5] offset:768
    s_add_u32 m0, s100, 1024
    s_nop 0
    buffer_load_dwordx4 v253, s[40:43], s93 offen nt lds
    s_add_u32 m0, s29, 11392
    s_nop 0
    global_load_lds_dwordx4 v247, s[4:5] offset:896
    s_add_u32 m0, s100, 2048
    s_nop 0
    buffer_load_dwordx4 v250, s[40:43], s94 offen nt lds
    s_add_u32 m0, s29, 0
    s_nop 0
    global_load_lds_dwordx4 v247, s[4:5]
    s_add_u32 m0, s100, 3072
    s_nop 0
    buffer_load_dwordx4 v253, s[40:43], s95 offen nt lds
    s_add_u32 m0, s29, 3968
    s_nop 0
    global_load_lds_dwordx4 v247, s[4:5] offset:128
    s_add_u32 m0, s100, 4096
    s_nop 0
    buffer_load_dwordx4 v250, s[40:43], s96 offen nt lds
    s_add_u32 m0, s29, 23808
    s_nop 0
    global_load_lds_dwordx4 v247, s[6:7] offset:768
    s_add_u32 m0, s100, 5120
    s_nop 0
    buffer_load_dwordx4 v253, s[40:43], s97 offen nt lds
    s_add_u32 m0, s29, 27776
    s_nop 0
    global_load_lds_dwordx4 v247, s[6:7] offset:896
    s_add_u32 m0, s100, 6144
    s_nop 0
    buffer_load_dwordx4 v250, s[40:43], s98 offen nt lds
    s_add_u32 m0, s29, 16384
    s_nop 0
    global_load_lds_dwordx4 v247, s[6:7]
    s_add_u32 m0, s100, 7168
    s_nop 0
    buffer_load_dwordx4 v253, s[40:43], s99 offen nt lds
    s_add_u32 m0, s29, 20352
    s_nop 0
    global_load_lds_dwordx4 v247, s[6:7] offset:128
    s_add_u32 s8, s4, 147456
    s_addc_u32 s9, s5, 0
    s_add_u32 s10, s4, 221184
    s_addc_u32 s11, s5, 0
    s_add_u32 s12, s4, 294912
    s_addc_u32 s13, s5, 0
    s_add_u32 s14, s4, 368640
    s_addc_u32 s15, s5, 0
    s_add_u32 s16, s4, 442368
    s_addc_u32 s17, s5, 0
    s_add_u32 s18, s4, 516096
    s_addc_u32 s19, s5, 0
    s_add_u32 s20, s4, 589824
    s_addc_u32 s21, s5, 0
    s_add_u32 s22, s4, 663552
    s_addc_u32 s23, s5, 0
    s_add_u32 s24, s4, 737280
    s_addc_u32 s25, s5, 0
    s_add_u32 s26, s4, 811008
    s_addc_u32 s27, s5, 0
    s_mov_b32 s54, 1800
    s_mov_b32 s55, 0x20000
    s_mov_b32 s58, 50331648
    s_mov_b32 s59, 0x20000
    s_mov_b32 s31, 0x3e16c740
    s_mov_b32 s32, 0xbe16c740
    s_getpc_b64 s[50:51]
L_pc:
    s_lshr_b32 s30, s2, 3
    s_lshl_b32 s30, s30, 2
    s_add_u32 s30, s30, s28
    v_min_u32 v255, 5, v254
    s_mul_i32 s46, s30, 6
    v_add_u32 v251, s46, v255
    v_lshlrev_b32 v249, 7, v251
    v_min_u32 v248, 11, v254
    v_subrev_u32 v246, 6, v248
    s_add_u32 s47, s28, 1
    s_lshl_b32 s47, s47, 12
    s_sub_u32 s47, s47, L_pc - L_top
    v_lshlrev_b32 v255, 14, v246
    v_add_u32 v251, s47, v255
    v_ashrrev_i32 v248, 31, v246
    v_bfi_b32 v245, v248, v249, v251
    v_min_u32 v244, L_code_end - L_pc - 4, v245
    v_and_b32 v255, 0xfffffffc, v244
    global_load_dword v246, v255, s[50:51]
    v_min_u32 v251, 11, v254
    v_lshrrev_b32 v249, 2, v251
    s_mul_i32 s46, s30, 6912
    v_mul_u32_u24 v255, 2304, v249
    v_and_b32 v248, 1, v251
    v_bfe_u32 v245, v251, 1, 1
    v_mul_u32_u24 v244, 768, v245
    v_lshl_add_u32 v249, v248, 7, v244
    v_add_u32 v243, v255, v249
    v_add_u32 v251, s46, v243
    global_load_dword v245, v251, s[4:5]
    s_add_u32 m0, s100, 32640
    s_nop 0
    buffer_load_dwordx4 v250, s[40:43], s92 offen offset:128 nt lds
    s_add_u32 m0, s100, 33664
    s_nop 0
    buffer_load_dwordx4 v253, s[40:43], s93 offen offset:128 nt lds
    s_add_u32 m0, s100, 34688
    s_nop 0
    buffer_load_dwordx4 v250, s[40:43], s94 offen offset:128 nt lds
    s_add_u32 m0, s100, 35712
    s_nop 0
    buffer_load_dwordx4 v253, s[40:43], s95 offen offset:128 nt lds
    s_add_u32 m0, s100, 36736
    s_nop 0
    buffer_load_dwordx4 v250, s[40:43], s96 offen offset:128 nt lds
    s_add_u32 m0, s100, 37760
    s_nop 0
    buffer_load_dwordx4 v253, s[40:43], s97 offen offset:128 nt lds
    s_add_u32 m0, s100, 38784
    s_nop 0
    buffer_load_dwordx4 v250, s[40:43], s98 offen offset:128 nt lds
    s_add_u32 m0, s100, 39808
    s_nop 0
    buffer_load_dwordx4 v253, s[40:43], s99 offen offset:128 nt lds
    v_bfe_u32 v255, v254, 2, 2
    v_and_b32 v251, 3, v254
    v_lshl_add_u32 v249, v252, 2, v255
    v_bfe_u32 v248, v249, 1, 2
    v_lshlrev_b32 v244, 7, v249
    v_lshl_add_u32 v243, v248, 5, v244
    v_lshl_add_u32 v255, v251, 3, v243
    v_and_b32 v242, 15, v254
    v_lshrrev_b32 v249, 1, v242
    v_xor_b32 v248, v252, v249
    v_lshlrev_b32 v251, 7, v242
    v_lshl_add_u32 v254, v248, 4, v251
    v_add_u32 v244, s100, v254
    v_xor_b32 v252, 64, v244
    s_waitcnt vmcnt(11)
    ds_read_b128 a[0:3], v244 offset:0
    ds_read_b128 a[48:51], v244 offset:2048
    ds_read_b128 a[96:99], v244 offset:4096
    ds_read_b128 a[144:147], v244 offset:6144
    ds_read_b128 a[4:7], v252 offset:0
    ds_read_b128 a[52:55], v252 offset:2048
    ds_read_b128 a[100:103], v252 offset:4096
    ds_read_b128 a[148:151], v252 offset:6144
    s_waitcnt vmcnt(10) lgkmcnt(0)
    s_barrier
    v_xor_b32 v254, 0, v255
    ds_read_b64_tr_b16 v[4:5], v254 offset:8192
    ds_read_b64_tr_b16 v[6:7], v254 offset:10240
    ds_read_b64_tr_b16 v[8:9], v254 offset:24576
    ds_read_b64_tr_b16 v[10:11], v254 offset:26624
    v_xor_b32 v251, 32, v255
    ds_read_b64_tr_b16 v[12:13], v251 offset:8192
    ds_read_b64_tr_b16 v[14:15], v251 offset:10240
    ds_read_b64_tr_b16 v[16:17], v251 offset:24576
    ds_read_b64_tr_b16 v[18:19], v251 offset:26624
    s_waitcnt lgkmcnt(0)
    v_mfma_f32_16x16x32_bf16 v[20:23], v[4:7], a[0:3], 0
    v_xor_b32 v249, 64, v255
    ds_read_b64_tr_b16 v[24:25], v249 offset:8192
    v_mfma_f32_16x16x32_bf16 v[20:23], v[8:11], a[4:7], v[20:23]
    ds_read_b64_tr_b16 v[26:27], v249 offset:10240
    v_xor_b32 v248, 96, v255
    v_mfma_f32_16x16x32_bf16 v[28:31], v[8:11], a[52:55], 0
    ds_read_b64_tr_b16 v[32:33], v249 offset:24576
    v_mfma_f32_16x16x32_bf16 v[28:31], v[4:7], a[48:51], v[28:31]
    ds_read_b64_tr_b16 v[34:35], v249 offset:26624
    v_mfma_f32_16x16x32_bf16 v[36:39], v[4:7], a[96:99], 0
    ds_read_b64_tr_b16 v[40:41], v248 offset:8192
    v_mfma_f32_16x16x32_bf16 v[36:39], v[8:11], a[100:103], v[36:39]
    ds_read_b64_tr_b16 v[42:43], v248 offset:10240
    v_mfma_f32_16x16x32_bf16 v[44:47], v[8:11], a[148:151], 0
    ds_read_b64_tr_b16 v[48:49], v248 offset:24576
    v_mfma_f32_16x16x32_bf16 v[44:47], v[4:7], a[144:147], v[44:47]
    s_add_u32 m0, s29, 40192
    ds_read_b64_tr_b16 v[50:51], v248 offset:26624
    v_mfma_f32_16x16x32_bf16 v[8:11], v[12:15], a[0:3], 0
    global_load_lds_dwordx4 v247, s[8:9] offset:768
    v_mfma_f32_16x16x32_bf16 v[8:11], v[16:19], a[4:7], v[8:11]
    s_add_u32 m0, s29, 44160
    v_mfma_f32_16x16x32_bf16 v[4:7], v[16:19], a[52:55], 0
    global_load_lds_dwordx4 v247, s[8:9] offset:896
    v_mfma_f32_16x16x32_bf16 v[4:7], v[12:15], a[48:51], v[4:7]
    s_add_u32 m0, s29, 32768
    v_mfma_f32_16x16x32_bf16 v[52:55], v[12:15], a[96:99], 0
    global_load_lds_dwordx4 v247, s[8:9]
    v_mfma_f32_16x16x32_bf16 v[52:55], v[16:19], a[100:103], v[52:55]
    s_add_u32 m0, s29, 36736
    v_mfma_f32_16x16x32_bf16 v[56:59], v[16:19], a[148:151], 0
    global_load_lds_dwordx4 v247, s[8:9] offset:128
    v_mfma_f32_16x16x32_bf16 v[56:59], v[12:15], a[144:147], v[56:59]
    s_waitcnt vmcnt(13) lgkmcnt(0)
    s_mov_b64 vcc, -1
    s_cmp_eq_u32 s28, 0
    s_cbranch_scc1 G_1
    s_cmp_eq_u32 s28, 1
    s_cbranch_scc1 G_2
    s_cmp_eq_u32 s28, 2
    s_cbranch_scc1 G_3
    s_branch G_4
R_ret0:
    s_mov_b64 vcc, 0
    v_mfma_f32_16x16x32_bf16 v[16:19], v[24:27], a[0:3], 0
    ds_read_b64_tr_b16 v[12:13], v254 offset:12288
    v_mfma_f32_16x16x32_bf16 v[16:19], v[32:35], a[4:7], v[16:19]
    ds_read_b64_tr_b16 v[14:15], v254 offset:14336
    v_mfma_f32_16x16x32_bf16 v[60:63], v[32:35], a[52:55], 0
    ds_read_b64_tr_b16 v[64:65], v254 offset:28672
    v_mfma_f32_16x16x32_bf16 v[60:63], v[24:27], a[48:51], v[60:63]
    ds_read_b64_tr_b16 v[66:67], v254 offset:30720
    v_mfma_f32_16x16x32_bf16 v[68:71], v[24:27], a[96:99], 0
    ds_read_b64_tr_b16 v[72:73], v251 offset:12288
    v_mfma_f32_16x16x32_bf16 v[68:71], v[32:35], a[100:103], v[68:71]
    ds_read_b64_tr_b16 v[74:75], v251 offset:14336
    v_mfma_f32_16x16x32_bf16 v[76:79], v[32:35], a[148:151], 0
    ds_read_b64_tr_b16 v[80:81], v251 offset:28672
    v_mfma_f32_16x16x32_bf16 v[76:79], v[24:27], a[144:147], v[76:79]
    s_add_u32 m0, s29, 56576
    ds_read_b64_tr_b16 v[82:83], v251 offset:30720
    v_mfma_f32_16x16x32_bf16 v[32:35], v[40:43], a[0:3], 0
    global_load_lds_dwordx4 v247, s[10:11] offset:768
    v_mfma_f32_16x16x32_bf16 v[32:35], v[48:51], a[4:7], v[32:35]
    s_add_u32 m0, s29, 60544
    v_mfma_f32_16x16x32_bf16 v[24:27], v[48:51], a[52:55], 0
    global_load_lds_dwordx4 v247, s[10:11] offset:896
    v_mfma_f32_16x16x32_bf16 v[24:27], v[40:43], a[48:51], v[24:27]
    s_add_u32 m0, s29, 49152
    v_mfma_f32_16x16x32_bf16 v[84:87], v[40:43], a[96:99], 0
    global_load_lds_dwordx4 v247, s[10:11]
    v_mfma_f32_16x16x32_bf16 v[84:87], v[48:51], a[100:103], v[84:87]
    s_add_u32 m0, s29, 53120
    v_mfma_f32_16x16x32_bf16 v[88:91], v[48:51], a[148:151], 0
    global_load_lds_dwordx4 v247, s[10:11] offset:128
    v_mfma_f32_16x16x32_bf16 v[88:91], v[40:43], a[144:147], v[88:91]
    s_waitcnt lgkmcnt(0)
    v_mfma_f32_16x16x32_bf16 v[48:51], v[12:15], a[0:3], 0
    ds_read_b64_tr_b16 v[92:93], v249 offset:12288
    v_mfma_f32_16x16x32_bf16 v[48:51], v[64:67], a[4:7], v[48:51]
    ds_read_b64_tr_b16 v[94:95], v249 offset:14336
    v_mfma_f32_16x16x32_bf16 v[40:43], v[64:67], a[52:55], 0
    ds_read_b64_tr_b16 v[96:97], v249 offset:28672
    v_mfma_f32_16x16x32_bf16 v[40:43], v[12:15], a[48:51], v[40:43]
    ds_read_b64_tr_b16 v[98:99], v249 offset:30720
    v_mfma_f32_16x16x32_bf16 v[100:103], v[12:15], a[96:99], 0
    ds_read_b64_tr_b16 v[104:105], v248 offset:12288
    v_mfma_f32_16x16x32_bf16 v[100:103], v[64:67], a[100:103], v[100:103]
    ds_read_b64_tr_b16 v[106:107], v248 offset:14336
    v_mfma_f32_16x16x32_bf16 v[108:111], v[64:67], a[148:151], 0
    ds_read_b64_tr_b16 v[112:113], v248 offset:28672
    v_mfma_f32_16x16x32_bf16 v[108:111], v[12:15], a[144:147], v[108:111]
    s_add_u32 m0, s100, 65280
    ds_read_b64_tr_b16 v[114:115], v248 offset:30720
    v_mfma_f32_16x16x32_bf16 v[64:67], v[72:75], a[0:3], 0
    buffer_load_dwordx4 v250, s[40:43], s92 offen offset:256 nt lds
    v_mfma_f32_16x16x32_bf16 v[64:67], v[80:83], a[4:7], v[64:67]
    s_add_u32 m0, s100, 66304
    v_mfma_f32_16x16x32_bf16 v[12:15], v[80:83], a[52:55], 0
    buffer_load_dwordx4 v253, s[40:43], s93 offen offset:256 nt lds
    v_mfma_f32_16x16x32_bf16 v[12:15], v[72:75], a[48:51], v[12:15]
    s_add_u32 m0, s100, 67328
    v_mfma_f32_16x16x32_bf16 v[116:119], v[72:75], a[96:99], 0
    buffer_load_dwordx4 v250, s[40:43], s94 offen offset:256 nt lds
    v_mfma_f32_16x16x32_bf16 v[116:119], v[80:83], a[100:103], v[116:119]
    s_add_u32 m0, s100, 68352
    v_mfma_f32_16x16x32_bf16 v[120:123], v[80:83], a[148:151], 0
    buffer_load_dwordx4 v253, s[40:43], s95 offen offset:256 nt lds
    v_mfma_f32_16x16x32_bf16 v[120:123], v[72:75], a[144:147], v[120:123]
    s_waitcnt lgkmcnt(0)
    v_mfma_f32_16x16x32_bf16 a[192:195], v[92:95], a[0:3], 0
    ds_read_b64_tr_b16 v[80:81], v254 offset:0
    v_mfma_f32_16x16x32_bf16 a[192:195], v[96:99], a[4:7], a[192:195]
    ds_read_b64_tr_b16 v[82:83], v254 offset:2048
    v_mfma_f32_16x16x32_bf16 a[196:199], v[96:99], a[52:55], 0
    ds_read_b64_tr_b16 v[72:73], v254 offset:16384
    v_mfma_f32_16x16x32_bf16 a[196:199], v[92:95], a[48:51], a[196:199]
    ds_read_b64_tr_b16 v[74:75], v254 offset:18432
    v_mfma_f32_16x16x32_bf16 a[200:203], v[92:95], a[96:99], 0
    ds_read_b64_tr_b16 v[124:125], v251 offset:0
    v_mfma_f32_16x16x32_bf16 a[200:203], v[96:99], a[100:103], a[200:203]
    ds_read_b64_tr_b16 v[126:127], v251 offset:2048
    v_mfma_f32_16x16x32_bf16 a[204:207], v[96:99], a[148:151], 0
    ds_read_b64_tr_b16 v[128:129], v251 offset:16384
    v_mfma_f32_16x16x32_bf16 a[204:207], v[92:95], a[144:147], a[204:207]
    s_add_u32 m0, s100, 69376
    ds_read_b64_tr_b16 v[130:131], v251 offset:18432
    v_mfma_f32_16x16x32_bf16 a[208:211], v[104:107], a[0:3], 0
    buffer_load_dwordx4 v250, s[40:43], s96 offen offset:256 nt lds
    v_mfma_f32_16x16x32_bf16 a[208:211], v[112:115], a[4:7], a[208:211]
    s_add_u32 m0, s100, 70400
    v_mfma_f32_16x16x32_bf16 a[212:215], v[112:115], a[52:55], 0
    buffer_load_dwordx4 v253, s[40:43], s97 offen offset:256 nt lds
    v_mfma_f32_16x16x32_bf16 a[212:215], v[104:107], a[48:51], a[212:215]
    s_add_u32 m0, s100, 71424
    v_add_u32 v243, 32768, v244
    v_mfma_f32_16x16x32_bf16 a[216:219], v[104:107], a[96:99], 0
    buffer_load_dwordx4 v250, s[40:43], s98 offen offset:256 nt lds
    v_mfma_f32_16x16x32_bf16 a[216:219], v[112:115], a[100:103], a[216:219]
    s_add_u32 m0, s100, 72448
    v_mfma_f32_16x16x32_bf16 a[220:223], v[112:115], a[148:151], 0
    buffer_load_dwordx4 v253, s[40:43], s99 offen offset:256 nt lds
    v_mfma_f32_16x16x32_bf16 a[220:223], v[104:107], a[144:147], a[220:223]
    s_waitcnt lgkmcnt(0)
    v_mfma_f32_16x16x32_bf16 v[92:95], v[80:83], a[0:3], 0
    ds_read_b64_tr_b16 v[96:97], v249 offset:0
    v_mfma_f32_16x16x32_bf16 v[92:95], v[72:75], a[4:7], v[92:95]
    ds_read_b64_tr_b16 v[98:99], v249 offset:2048
    v_mfma_f32_16x16x32_bf16 v[104:107], v[72:75], a[52:55], 0
    ds_read_b64_tr_b16 v[112:113], v249 offset:16384
    v_mfma_f32_16x16x32_bf16 v[104:107], v[80:83], a[48:51], v[104:107]
    ds_read_b64_tr_b16 v[114:115], v249 offset:18432
    v_mfma_f32_16x16x32_bf16 v[132:135], v[80:83], a[96:99], 0
    ds_read_b64_tr_b16 v[136:137], v248 offset:0
    v_mfma_f32_16x16x32_bf16 v[132:135], v[72:75], a[100:103], v[132:135]
    ds_read_b64_tr_b16 v[138:139], v248 offset:2048
    v_mfma_f32_16x16x32_bf16 v[140:143], v[72:75], a[148:151], 0
    ds_read_b64_tr_b16 v[144:145], v248 offset:16384
    v_mfma_f32_16x16x32_bf16 v[140:143], v[80:83], a[144:147], v[140:143]
    ds_read_b64_tr_b16 v[146:147], v248 offset:18432
    s_waitcnt vmcnt(16)
    v_mfma_f32_16x16x32_bf16 v[72:75], v[124:127], a[0:3], 0
    ds_read_b128 a[8:11], v243 offset:0
    v_mfma_f32_16x16x32_bf16 v[72:75], v[128:131], a[4:7], v[72:75]
    ds_read_b128 a[56:59], v243 offset:2048
    v_mfma_f32_16x16x32_bf16 v[80:83], v[128:131], a[52:55], 0
    ds_read_b128 a[104:107], v243 offset:4096
    v_mfma_f32_16x16x32_bf16 v[80:83], v[124:127], a[48:51], v[80:83]
    ds_read_b128 a[152:155], v243 offset:6144
    v_mfma_f32_16x16x32_bf16 v[148:151], v[124:127], a[96:99], 0
    v_add_u32 v242, 32768, v252
    v_mfma_f32_16x16x32_bf16 v[148:151], v[128:131], a[100:103], v[148:151]
    v_mfma_f32_16x16x32_bf16 v[152:155], v[128:131], a[148:151], 0
    v_mfma_f32_16x16x32_bf16 v[152:155], v[124:127], a[144:147], v[152:155]
    s_waitcnt lgkmcnt(4)
    v_mfma_f32_16x16x32_bf16 v[156:159], v[96:99], a[0:3], 0
    ds_read_b64_tr_b16 v[128:129], v254 offset:4096
    v_mfma_f32_16x16x32_bf16 v[156:159], v[112:115], a[4:7], v[156:159]
    ds_read_b64_tr_b16 v[130:131], v254 offset:6144
    v_mfma_f32_16x16x32_bf16 v[124:127], v[112:115], a[52:55], 0
    ds_read_b64_tr_b16 v[160:161], v254 offset:20480
    v_mfma_f32_16x16x32_bf16 v[124:127], v[96:99], a[48:51], v[124:127]
    ds_read_b64_tr_b16 v[162:163], v254 offset:22528
    v_mfma_f32_16x16x32_bf16 v[164:167], v[96:99], a[96:99], 0
    ds_read_b64_tr_b16 v[168:169], v251 offset:4096
    v_mfma_f32_16x16x32_bf16 v[164:167], v[112:115], a[100:103], v[164:167]
    ds_read_b64_tr_b16 v[170:171], v251 offset:6144
    v_mfma_f32_16x16x32_bf16 v[172:175], v[112:115], a[148:151], 0
    ds_read_b64_tr_b16 v[176:177], v251 offset:20480
    v_mfma_f32_16x16x32_bf16 v[172:175], v[96:99], a[144:147], v[172:175]
    ds_read_b64_tr_b16 v[178:179], v251 offset:22528
    v_mfma_f32_16x16x32_bf16 v[112:115], v[136:139], a[0:3], 0
    ds_read_b128 a[12:15], v242 offset:0
    v_mfma_f32_16x16x32_bf16 v[112:115], v[144:147], a[4:7], v[112:115]
    ds_read_b128 a[60:63], v242 offset:2048
    v_mfma_f32_16x16x32_bf16 v[96:99], v[144:147], a[52:55], 0
    ds_read_b128 a[108:111], v242 offset:4096
    v_mfma_f32_16x16x32_bf16 v[96:99], v[136:139], a[48:51], v[96:99]
    ds_read_b128 a[156:159], v242 offset:6144
    v_mfma_f32_16x16x32_bf16 v[180:183], v[136:139], a[96:99], 0
    v_mfma_f32_16x16x32_bf16 v[180:183], v[144:147], a[100:103], v[180:183]
    v_mfma_f32_16x16x32_bf16 v[184:187], v[144:147], a[148:151], 0
    v_mfma_f32_16x16x32_bf16 v[184:187], v[136:139], a[144:147], v[184:187]
    s_waitcnt lgkmcnt(4)
    v_mfma_f32_16x16x32_bf16 v[188:191], v[128:131], a[0:3], 0
    ds_read_b64_tr_b16 v[144:145], v249 offset:4096
    v_mfma_f32_16x16x32_bf16 v[188:191], v[160:163], a[4:7], v[188:191]
    ds_read_b64_tr_b16 v[146:147], v249 offset:6144
    v_mfma_f32_16x16x32_bf16 v[136:139], v[160:163], a[52:55], 0
    ds_read_b64_tr_b16 v[192:193], v249 offset:20480
    v_mfma_f32_16x16x32_bf16 v[136:139], v[128:131], a[48:51], v[136:139]
    ds_read_b64_tr_b16 v[194:195], v249 offset:22528
    v_mfma_f32_16x16x32_bf16 v[196:199], v[128:131], a[96:99], 0
    ds_read_b64_tr_b16 v[200:201], v248 offset:4096
    v_mfma_f32_16x16x32_bf16 v[196:199], v[160:163], a[100:103], v[196:199]
    ds_read_b64_tr_b16 v[202:203], v248 offset:6144
    v_mfma_f32_16x16x32_bf16 v[204:207], v[160:163], a[148:151], 0
    ds_read_b64_tr_b16 v[208:209], v248 offset:20480
    v_mfma_f32_16x16x32_bf16 v[204:207], v[128:131], a[144:147], v[204:207]
    ds_read_b64_tr_b16 v[210:211], v248 offset:22528
    v_mfma_f32_16x16x32_bf16 v[160:163], v[168:171], a[0:3], 0
    v_mfma_f32_16x16x32_bf16 v[160:163], v[176:179], a[4:7], v[160:163]
    v_mfma_f32_16x16x32_bf16 v[128:131], v[176:179], a[52:55], 0
    v_xor_b32 v254, 32768, v255
    v_xor_b32 v251, 32800, v255
    v_mfma_f32_16x16x32_bf16 v[128:131], v[168:171], a[48:51], v[128:131]
    v_mfma_f32_16x16x32_bf16 v[212:215], v[168:171], a[96:99], 0
    v_mfma_f32_16x16x32_bf16 v[212:215], v[176:179], a[100:103], v[212:215]
    v_mfma_f32_16x16x32_bf16 v[216:219], v[176:179], a[148:151], 0
    v_mfma_f32_16x16x32_bf16 v[216:219], v[168:171], a[144:147], v[216:219]
    s_waitcnt vmcnt(8) lgkmcnt(0)
    s_barrier
    v_mfma_f32_16x16x32_bf16 a[224:227], v[144:147], a[0:3], 0
    ds_read_b64_tr_b16 v[168:169], v254 offset:8192
    v_mfma_f32_16x16x32_bf16 a[224:227], v[192:195], a[4:7], a[224:227]
    ds_read_b64_tr_b16 v[170:171], v254 offset:10240
    v_mfma_f32_16x16x32_bf16 a[228:231], v[192:195], a[52:55], 0
    ds_read_b64_tr_b16 v[176:177], v254 offset:24576
    v_mfma_f32_16x16x32_bf16 a[228:231], v[144:147], a[48:51], a[228:231]
    ds_read_b64_tr_b16 v[178:179], v254 offset:26624
G_1:
    s_cbranch_vccnz G_5
    v_mfma_f32_16x16x32_bf16 a[232:235], v[144:147], a[96:99], 0
    ds_read_b64_tr_b16 v[220:221], v251 offset:8192
    v_mfma_f32_16x16x32_bf16 a[232:235], v[192:195], a[100:103], a[232:235]
    ds_read_b64_tr_b16 v[222:223], v251 offset:10240
    v_mfma_f32_16x16x32_bf16 a[236:239], v[192:195], a[148:151], 0
    ds_read_b64_tr_b16 v[224:225], v251 offset:24576
    v_mfma_f32_16x16x32_bf16 a[236:239], v[144:147], a[144:147], a[236:239]
    s_add_u32 m0, s29, 7424
    ds_read_b64_tr_b16 v[226:227], v251 offset:26624
    v_mfma_f32_16x16x32_bf16 a[240:243], v[200:203], a[0:3], 0
    global_load_lds_dwordx4 v247, s[12:13] offset:768
    v_mfma_f32_16x16x32_bf16 a[240:243], v[208:211], a[4:7], a[240:243]
    s_add_u32 m0, s29, 11392
    v_mfma_f32_16x16x32_bf16 a[244:247], v[208:211], a[52:55], 0
    global_load_lds_dwordx4 v247, s[12:13] offset:896
    v_mfma_f32_16x16x32_bf16 a[244:247], v[200:203], a[48:51], a[244:247]
    s_add_u32 m0, s29, 0
    v_xor_b32 v249, 32832, v255
    v_xor_b32 v248, 32864, v255
    v_mfma_f32_16x16x32_bf16 a[248:251], v[200:203], a[96:99], 0
    global_load_lds_dwordx4 v247, s[12:13]
    v_mfma_f32_16x16x32_bf16 a[248:251], v[208:211], a[100:103], a[248:251]
    s_add_u32 m0, s29, 3968
    v_mfma_f32_16x16x32_bf16 a[252:255], v[208:211], a[148:151], 0
    global_load_lds_dwordx4 v247, s[12:13] offset:128
    v_mfma_f32_16x16x32_bf16 a[252:255], v[200:203], a[144:147], a[252:255]
    s_waitcnt lgkmcnt(0)
    v_mfma_f32_16x16x32_bf16 v[20:23], v[168:171], a[8:11], v[20:23]
    ds_read_b64_tr_b16 v[144:145], v249 offset:8192
    v_mfma_f32_16x16x32_bf16 v[20:23], v[176:179], a[12:15], v[20:23]
    ds_read_b64_tr_b16 v[146:147], v249 offset:10240
    v_mfma_f32_16x16x32_bf16 v[28:31], v[176:179], a[60:63], v[28:31]
    ds_read_b64_tr_b16 v[192:193], v249 offset:24576
    v_mfma_f32_16x16x32_bf16 v[28:31], v[168:171], a[56:59], v[28:31]
    ds_read_b64_tr_b16 v[194:195], v249 offset:26624
    v_mfma_f32_16x16x32_bf16 v[36:39], v[168:171], a[104:107], v[36:39]
    ds_read_b64_tr_b16 v[200:201], v248 offset:8192
    v_mfma_f32_16x16x32_bf16 v[36:39], v[176:179], a[108:111], v[36:39]
    ds_read_b64_tr_b16 v[202:203], v248 offset:10240
    v_mfma_f32_16x16x32_bf16 v[44:47], v[176:179], a[156:159], v[44:47]
    ds_read_b64_tr_b16 v[208:209], v248 offset:24576
    v_mfma_f32_16x16x32_bf16 v[44:47], v[168:171], a[152:155], v[44:47]
    s_add_u32 m0, s29, 23808
    ds_read_b64_tr_b16 v[210:211], v248 offset:26624
    v_mfma_f32_16x16x32_bf16 v[8:11], v[220:223], a[8:11], v[8:11]
    global_load_lds_dwordx4 v247, s[14:15] offset:768
    v_mfma_f32_16x16x32_bf16 v[8:11], v[224:227], a[12:15], v[8:11]
    s_add_u32 m0, s29, 27776
    v_mfma_f32_16x16x32_bf16 v[4:7], v[224:227], a[60:63], v[4:7]
    global_load_lds_dwordx4 v247, s[14:15] offset:896
    v_mfma_f32_16x16x32_bf16 v[4:7], v[220:223], a[56:59], v[4:7]
    s_add_u32 m0, s29, 16384
    v_mfma_f32_16x16x32_bf16 v[52:55], v[220:223], a[104:107], v[52:55]
    global_load_lds_dwordx4 v247, s[14:15]
    v_mfma_f32_16x16x32_bf16 v[52:55], v[224:227], a[108:111], v[52:55]
    s_add_u32 m0, s29, 20352
    v_mfma_f32_16x16x32_bf16 v[56:59], v[224:227], a[156:159], v[56:59]
    global_load_lds_dwordx4 v247, s[14:15] offset:128
    v_mfma_f32_16x16x32_bf16 v[56:59], v[220:223], a[152:155], v[56:59]
    s_waitcnt lgkmcnt(0)
    v_mfma_f32_16x16x32_bf16 v[16:19], v[144:147], a[8:11], v[16:19]
    ds_read_b64_tr_b16 v[168:169], v254 offset:12288
    v_mfma_f32_16x16x32_bf16 v[16:19], v[192:195], a[12:15], v[16:19]
    ds_read_b64_tr_b16 v[170:171], v254 offset:14336
    v_mfma_f32_16x16x32_bf16 v[60:63], v[192:195], a[60:63], v[60:63]
    ds_read_b64_tr_b16 v[176:177], v254 offset:28672
    v_mfma_f32_16x16x32_bf16 v[60:63], v[144:147], a[56:59], v[60:63]
    ds_read_b64_tr_b16 v[178:179], v254 offset:30720
    v_mfma_f32_16x16x32_bf16 v[68:71], v[144:147], a[104:107], v[68:71]
    ds_read_b64_tr_b16 v[220:221], v251 offset:12288
    v_mfma_f32_16x16x32_bf16 v[68:71], v[192:195], a[108:111], v[68:71]
    ds_read_b64_tr_b16 v[222:223], v251 offset:14336
    v_mfma_f32_16x16x32_bf16 v[76:79], v[192:195], a[156:159], v[76:79]
    ds_read_b64_tr_b16 v[224:225], v251 offset:28672
    v_mfma_f32_16x16x32_bf16 v[76:79], v[144:147], a[152:155], v[76:79]
    s_sub_u32 m0, s100, 384
    ds_read_b64_tr_b16 v[226:227], v251 offset:30720
    v_mfma_f32_16x16x32_bf16 v[32:35], v[200:203], a[8:11], v[32:35]
    buffer_load_dwordx4 v250, s[40:43], s92 offen offset:384 nt lds
    v_mfma_f32_16x16x32_bf16 v[32:35], v[208:211], a[12:15], v[32:35]
    s_add_u32 m0, s100, 640
    v_mfma_f32_16x16x32_bf16 v[24:27], v[208:211], a[60:63], v[24:27]
    buffer_load_dwordx4 v253, s[40:43], s93 offen offset:384 nt lds
    v_mfma_f32_16x16x32_bf16 v[24:27], v[200:203], a[56:59], v[24:27]
    s_add_u32 m0, s100, 1664
    v_mfma_f32_16x16x32_bf16 v[84:87], v[200:203], a[104:107], v[84:87]
    buffer_load_dwordx4 v250, s[40:43], s94 offen offset:384 nt lds
    v_mfma_f32_16x16x32_bf16 v[84:87], v[208:211], a[108:111], v[84:87]
    s_add_u32 m0, s100, 2688
    v_mfma_f32_16x16x32_bf16 v[88:91], v[208:211], a[156:159], v[88:91]
    buffer_load_dwordx4 v253, s[40:43], s95 offen offset:384 nt lds
    v_mfma_f32_16x16x32_bf16 v[88:91], v[200:203], a[152:155], v[88:91]
    s_waitcnt lgkmcnt(0)
    v_mfma_f32_16x16x32_bf16 v[48:51], v[168:171], a[8:11], v[48:51]
    ds_read_b64_tr_b16 v[144:145], v249 offset:12288
    v_mfma_f32_16x16x32_bf16 v[48:51], v[176:179], a[12:15], v[48:51]
    ds_read_b64_tr_b16 v[146:147], v249 offset:14336
    v_mfma_f32_16x16x32_bf16 v[40:43], v[176:179], a[60:63], v[40:43]
    ds_read_b64_tr_b16 v[192:193], v249 offset:28672
    v_mfma_f32_16x16x32_bf16 v[40:43], v[168:171], a[56:59], v[40:43]
    ds_read_b64_tr_b16 v[194:195], v249 offset:30720
    v_mfma_f32_16x16x32_bf16 v[100:103], v[168:171], a[104:107], v[100:103]
    ds_read_b64_tr_b16 v[200:201], v248 offset:12288
    v_mfma_f32_16x16x32_bf16 v[100:103], v[176:179], a[108:111], v[100:103]
    ds_read_b64_tr_b16 v[202:203], v248 offset:14336
    v_mfma_f32_16x16x32_bf16 v[108:111], v[176:179], a[156:159], v[108:111]
    ds_read_b64_tr_b16 v[208:209], v248 offset:28672
    v_mfma_f32_16x16x32_bf16 v[108:111], v[168:171], a[152:155], v[108:111]
    s_add_u32 m0, s100, 3712
    ds_read_b64_tr_b16 v[210:211], v248 offset:30720
    v_mfma_f32_16x16x32_bf16 v[64:67], v[220:223], a[8:11], v[64:67]
    buffer_load_dwordx4 v250, s[40:43], s96 offen offset:384 nt lds
    v_mfma_f32_16x16x32_bf16 v[64:67], v[224:227], a[12:15], v[64:67]
    s_add_u32 m0, s100, 4736
    v_mfma_f32_16x16x32_bf16 v[12:15], v[224:227], a[60:63], v[12:15]
    buffer_load_dwordx4 v253, s[40:43], s97 offen offset:384 nt lds
    v_mfma_f32_16x16x32_bf16 v[12:15], v[220:223], a[56:59], v[12:15]
    s_add_u32 m0, s100, 5760
    v_mfma_f32_16x16x32_bf16 v[116:119], v[220:223], a[104:107], v[116:119]
    buffer_load_dwordx4 v250, s[40:43], s98 offen offset:384 nt lds
    v_mfma_f32_16x16x32_bf16 v[116:119], v[224:227], a[108:111], v[116:119]
    s_add_u32 m0, s100, 6784
    v_mfma_f32_16x16x32_bf16 v[120:123], v[224:227], a[156:159], v[120:123]
    buffer_load_dwordx4 v253, s[40:43], s99 offen offset:384 nt lds
    v_mfma_f32_16x16x32_bf16 v[120:123], v[220:223], a[152:155], v[120:123]
    s_waitcnt lgkmcnt(0)
    v_mfma_f32_16x16x32_bf16 a[192:195], v[144:147], a[8:11], a[192:195]
    ds_read_b64_tr_b16 v[168:169], v254 offset:0
    v_mfma_f32_16x16x32_bf16 a[192:195], v[192:195], a[12:15], a[192:195]
    ds_read_b64_tr_b16 v[170:171], v254 offset:2048
    v_mfma_f32_16x16x32_bf16 a[196:199], v[192:195], a[60:63], a[196:199]
    ds_read_b64_tr_b16 v[176:177], v254 offset:16384
    v_mfma_f32_16x16x32_bf16 a[196:199], v[144:147], a[56:59], a[196:199]
    ds_read_b64_tr_b16 v[178:179], v254 offset:18432
    v_mfma_f32_16x16x32_bf16 a[200:203], v[144:147], a[104:107], a[200:203]
    ds_read_b64_tr_b16 v[220:221], v251 offset:0
    v_mfma_f32_16x16x32_bf16 a[200:203], v[192:195], a[108:111], a[200:203]
    ds_read_b64_tr_b16 v[222:223], v251 offset:2048
    v_mfma_f32_16x16x32_bf16 a[204:207], v[192:195], a[156:159], a[204:207]
    ds_read_b64_tr_b16 v[224:225], v251 offset:16384
    v_mfma_f32_16x16x32_bf16 a[204:207], v[144:147], a[152:155], a[204:207]
    ds_read_b64_tr_b16 v[226:227], v251 offset:18432
    v_mfma_f32_16x16x32_bf16 a[208:211], v[200:203], a[8:11], a[208:211]
    v_mfma_f32_16x16x32_bf16 a[208:211], v[208:211], a[12:15], a[208:211]
    v_mfma_f32_16x16x32_bf16 a[212:215], v[208:211], a[60:63], a[212:215]
    v_mfma_f32_16x16x32_bf16 a[212:215], v[200:203], a[56:59], a[212:215]
    v_add_u32 v243, 65536, v244
    v_mfma_f32_16x16x32_bf16 a[216:219], v[200:203], a[104:107], a[216:219]
    v_mfma_f32_16x16x32_bf16 a[216:219], v[208:211], a[108:111], a[216:219]
    v_mfma_f32_16x16x32_bf16 a[220:223], v[208:211], a[156:159], a[220:223]
    v_mfma_f32_16x16x32_bf16 a[220:223], v[200:203], a[152:155], a[220:223]
    s_waitcnt lgkmcnt(0)
    v_mfma_f32_16x16x32_bf16 v[92:95], v[168:171], a[8:11], v[92:95]
    ds_read_b64_tr_b16 v[144:145], v249 offset:0
    v_mfma_f32_16x16x32_bf16 v[92:95], v[176:179], a[12:15], v[92:95]
    ds_read_b64_tr_b16 v[146:147], v249 offset:2048
    v_mfma_f32_16x16x32_bf16 v[104:107], v[176:179], a[60:63], v[104:107]
    ds_read_b64_tr_b16 v[192:193], v249 offset:16384
    v_mfma_f32_16x16x32_bf16 v[104:107], v[168:171], a[56:59], v[104:107]
    ds_read_b64_tr_b16 v[194:195], v249 offset:18432
    v_mfma_f32_16x16x32_bf16 v[132:135], v[168:171], a[104:107], v[132:135]
    ds_read_b64_tr_b16 v[200:201], v248 offset:0
    v_mfma_f32_16x16x32_bf16 v[132:135], v[176:179], a[108:111], v[132:135]
    ds_read_b64_tr_b16 v[202:203], v248 offset:2048
    v_mfma_f32_16x16x32_bf16 v[140:143], v[176:179], a[156:159], v[140:143]
    ds_read_b64_tr_b16 v[208:209], v248 offset:16384
    v_mfma_f32_16x16x32_bf16 v[140:143], v[168:171], a[152:155], v[140:143]
    ds_read_b64_tr_b16 v[210:211], v248 offset:18432
    s_waitcnt vmcnt(16)
    v_mfma_f32_16x16x32_bf16 v[72:75], v[220:223], a[8:11], v[72:75]
    ds_read_b128 a[16:19], v243 offset:0
    v_mfma_f32_16x16x32_bf16 v[72:75], v[224:227], a[12:15], v[72:75]
    ds_read_b128 a[64:67], v243 offset:2048
    v_mfma_f32_16x16x32_bf16 v[80:83], v[224:227], a[60:63], v[80:83]
    ds_read_b128 a[112:115], v243 offset:4096
    v_mfma_f32_16x16x32_bf16 v[80:83], v[220:223], a[56:59], v[80:83]
    ds_read_b128 a[160:163], v243 offset:6144
    v_mfma_f32_16x16x32_bf16 v[148:151], v[220:223], a[104:107], v[148:151]
    v_add_u32 v242, 65536, v252
    v_mfma_f32_16x16x32_bf16 v[148:151], v[224:227], a[108:111], v[148:151]
    v_mfma_f32_16x16x32_bf16 v[152:155], v[224:227], a[156:159], v[152:155]
    v_mfma_f32_16x16x32_bf16 v[152:155], v[220:223], a[152:155], v[152:155]
    s_waitcnt lgkmcnt(4)
    v_mfma_f32_16x16x32_bf16 v[156:159], v[144:147], a[8:11], v[156:159]
    ds_read_b64_tr_b16 v[168:169], v254 offset:4096
    v_mfma_f32_16x16x32_bf16 v[156:159], v[192:195], a[12:15], v[156:159]
    ds_read_b64_tr_b16 v[170:171], v254 offset:6144
    v_mfma_f32_16x16x32_bf16 v[124:127], v[192:195], a[60:63], v[124:127]
    ds_read_b64_tr_b16 v[176:177], v254 offset:20480
    v_mfma_f32_16x16x32_bf16 v[124:127], v[144:147], a[56:59], v[124:127]
    ds_read_b64_tr_b16 v[178:179], v254 offset:22528
    v_mfma_f32_16x16x32_bf16 v[164:167], v[144:147], a[104:107], v[164:167]
    ds_read_b64_tr_b16 v[220:221], v251 offset:4096
    v_mfma_f32_16x16x32_bf16 v[164:167], v[192:195], a[108:111], v[164:167]
    ds_read_b64_tr_b16 v[222:223], v251 offset:6144
    v_mfma_f32_16x16x32_bf16 v[172:175], v[192:195], a[156:159], v[172:175]
    ds_read_b64_tr_b16 v[224:225], v251 offset:20480
    v_mfma_f32_16x16x32_bf16 v[172:175], v[144:147], a[152:155], v[172:175]
    ds_read_b64_tr_b16 v[226:227], v251 offset:22528
    v_mfma_f32_16x16x32_bf16 v[112:115], v[200:203], a[8:11], v[112:115]
    ds_read_b128 a[20:23], v242 offset:0
    v_mfma_f32_16x16x32_bf16 v[112:115], v[208:211], a[12:15], v[112:115]
    ds_read_b128 a[68:71], v242 offset:2048
    v_mfma_f32_16x16x32_bf16 v[96:99], v[208:211], a[60:63], v[96:99]
    ds_read_b128 a[116:119], v242 offset:4096
    v_mfma_f32_16x16x32_bf16 v[96:99], v[200:203], a[56:59], v[96:99]
    ds_read_b128 a[164:167], v242 offset:6144
    v_mfma_f32_16x16x32_bf16 v[180:183], v[200:203], a[104:107], v[180:183]
    v_mfma_f32_16x16x32_bf16 v[180:183], v[208:211], a[108:111], v[180:183]
    v_mfma_f32_16x16x32_bf16 v[184:187], v[208:211], a[156:159], v[184:187]
    v_mfma_f32_16x16x32_bf16 v[184:187], v[200:203], a[152:155], v[184:187]
    s_waitcnt lgkmcnt(4)
    v_mfma_f32_16x16x32_bf16 v[188:191], v[168:171], a[8:11], v[188:191]
    ds_read_b64_tr_b16 v[144:145], v249 offset:4096
    v_mfma_f32_16x16x32_bf16 v[188:191], v[176:179], a[12:15], v[188:191]
    ds_read_b64_tr_b16 v[146:147], v249 offset:6144
    v_mfma_f32_16x16x32_bf16 v[136:139], v[176:179], a[60:63], v[136:139]
    ds_read_b64_tr_b16 v[192:193], v249 offset:20480
    v_mfma_f32_16x16x32_bf16 v[136:139], v[168:171], a[56:59], v[136:139]
    ds_read_b64_tr_b16 v[194:195], v249 offset:22528
    v_mfma_f32_16x16x32_bf16 v[196:199], v[168:171], a[104:107], v[196:199]
    ds_read_b64_tr_b16 v[200:201], v248 offset:4096
    v_mfma_f32_16x16x32_bf16 v[196:199], v[176:179], a[108:111], v[196:199]
    ds_read_b64_tr_b16 v[202:203], v248 offset:6144
    v_mfma_f32_16x16x32_bf16 v[204:207], v[176:179], a[156:159], v[204:207]
    ds_read_b64_tr_b16 v[208:209], v248 offset:20480
    v_mfma_f32_16x16x32_bf16 v[204:207], v[168:171], a[152:155], v[204:207]
    ds_read_b64_tr_b16 v[210:211], v248 offset:22528
    v_mfma_f32_16x16x32_bf16 v[160:163], v[220:223], a[8:11], v[160:163]
    v_mfma_f32_16x16x32_bf16 v[160:163], v[224:227], a[12:15], v[160:163]
    v_mfma_f32_16x16x32_bf16 v[128:131], v[224:227], a[60:63], v[128:131]
    v_xor_b32 v254, 0, v255
    v_xor_b32 v251, 32, v255
    v_mfma_f32_16x16x32_bf16 v[128:131], v[220:223], a[56:59], v[128:131]
    v_mfma_f32_16x16x32_bf16 v[212:215], v[220:223], a[104:107], v[212:215]
    v_mfma_f32_16x16x32_bf16 v[212:215], v[224:227], a[108:111], v[212:215]
    v_mfma_f32_16x16x32_bf16 v[216:219], v[224:227], a[156:159], v[216:219]
    v_mfma_f32_16x16x32_bf16 v[216:219], v[220:223], a[152:155], v[216:219]
    s_waitcnt vmcnt(8) lgkmcnt(0)
    s_barrier
    v_mfma_f32_16x16x32_bf16 a[224:227], v[144:147], a[8:11], a[224:227]
    ds_read_b64_tr_b16 v[168:169], v254 offset:8192
    v_mfma_f32_16x16x32_bf16 a[224:227], v[192:195], a[12:15], a[224:227]
    ds_read_b64_tr_b16 v[170:171], v254 offset:10240
    v_mfma_f32_16x16x32_bf16 a[228:231], v[192:195], a[60:63], a[228:231]
    ds_read_b64_tr_b16 v[176:177], v254 offset:24576
    v_mfma_f32_16x16x32_bf16 a[228:231], v[144:147], a[56:59], a[228:231]
    ds_read_b64_tr_b16 v[178:179], v254 offset:26624
    v_mfma_f32_16x16x32_bf16 a[232:235], v[144:147], a[104:107], a[232:235]
    ds_read_b64_tr_b16 v[220:221], v251 offset:8192
    v_mfma_f32_16x16x32_bf16 a[232:235], v[192:195], a[108:111], a[232:235]
    ds_read_b64_tr_b16 v[222:223], v251 offset:10240
    v_mfma_f32_16x16x32_bf16 a[236:239], v[192:195], a[156:159], a[236:239]
    ds_read_b64_tr_b16 v[224:225], v251 offset:24576
    v_mfma_f32_16x16x32_bf16 a[236:239], v[144:147], a[152:155], a[236:239]
    s_add_u32 m0, s29, 40192
    ds_read_b64_tr_b16 v[226:227], v251 offset:26624
    v_mfma_f32_16x16x32_bf16 a[240:243], v[200:203], a[8:11], a[240:243]
    global_load_lds_dwordx4 v247, s[16:17] offset:768
    v_mfma_f32_16x16x32_bf16 a[240:243], v[208:211], a[12:15], a[240:243]
    s_add_u32 m0, s29, 44160
    v_mfma_f32_16x16x32_bf16 a[244:247], v[208:211], a[60:63], a[244:247]
    global_load_lds_dwordx4 v247, s[16:17] offset:896
    v_mfma_f32_16x16x32_bf16 a[244:247], v[200:203], a[56:59], a[244:247]
    s_add_u32 m0, s29, 32768
    v_xor_b32 v249, 64, v255
    v_xor_b32 v248, 96, v255
    v_mfma_f32_16x16x32_bf16 a[248:251], v[200:203], a[104:107], a[248:251]
    global_load_lds_dwordx4 v247, s[16:17]
    v_mfma_f32_16x16x32_bf16 a[248:251], v[208:211], a[108:111], a[248:251]
    s_add_u32 m0, s29, 36736
    v_mfma_f32_16x16x32_bf16 a[252:255], v[208:211], a[156:159], a[252:255]
    global_load_lds_dwordx4 v247, s[16:17] offset:128
    v_mfma_f32_16x16x32_bf16 a[252:255], v[200:203], a[152:155], a[252:255]
    s_waitcnt lgkmcnt(0)
    v_mfma_f32_16x16x32_bf16 v[20:23], v[168:171], a[16:19], v[20:23]
    ds_read_b64_tr_b16 v[144:145], v249 offset:8192
    v_mfma_f32_16x16x32_bf16 v[20:23], v[176:179], a[20:23], v[20:23]
    ds_read_b64_tr_b16 v[146:147], v249 offset:10240
    v_mfma_f32_16x16x32_bf16 v[28:31], v[176:179], a[68:71], v[28:31]
    ds_read_b64_tr_b16 v[192:193], v249 offset:24576
    v_mfma_f32_16x16x32_bf16 v[28:31], v[168:171], a[64:67], v[28:31]
    ds_read_b64_tr_b16 v[194:195], v249 offset:26624
    v_mfma_f32_16x16x32_bf16 v[36:39], v[168:171], a[112:115], v[36:39]
    ds_read_b64_tr_b16 v[200:201], v248 offset:8192
    v_mfma_f32_16x16x32_bf16 v[36:39], v[176:179], a[116:119], v[36:39]
    ds_read_b64_tr_b16 v[202:203], v248 offset:10240
    v_mfma_f32_16x16x32_bf16 v[44:47], v[176:179], a[164:167], v[44:47]
    ds_read_b64_tr_b16 v[208:209], v248 offset:24576
    v_mfma_f32_16x16x32_bf16 v[44:47], v[168:171], a[160:163], v[44:47]
    s_add_u32 m0, s29, 56576
    ds_read_b64_tr_b16 v[210:211], v248 offset:26624
    v_mfma_f32_16x16x32_bf16 v[8:11], v[220:223], a[16:19], v[8:11]
    global_load_lds_dwordx4 v247, s[18:19] offset:768
    v_mfma_f32_16x16x32_bf16 v[8:11], v[224:227], a[20:23], v[8:11]
    s_add_u32 m0, s29, 60544
    v_mfma_f32_16x16x32_bf16 v[4:7], v[224:227], a[68:71], v[4:7]
    global_load_lds_dwordx4 v247, s[18:19] offset:896
    v_mfma_f32_16x16x32_bf16 v[4:7], v[220:223], a[64:67], v[4:7]
    s_add_u32 m0, s29, 49152
    v_mfma_f32_16x16x32_bf16 v[52:55], v[220:223], a[112:115], v[52:55]
    global_load_lds_dwordx4 v247, s[18:19]
    v_mfma_f32_16x16x32_bf16 v[52:55], v[224:227], a[116:119], v[52:55]
    s_add_u32 m0, s29, 53120
    v_mfma_f32_16x16x32_bf16 v[56:59], v[224:227], a[164:167], v[56:59]
    global_load_lds_dwordx4 v247, s[18:19] offset:128
    v_mfma_f32_16x16x32_bf16 v[56:59], v[220:223], a[160:163], v[56:59]
    s_waitcnt lgkmcnt(0)
    v_mfma_f32_16x16x32_bf16 v[16:19], v[144:147], a[16:19], v[16:19]
    ds_read_b64_tr_b16 v[168:169], v254 offset:12288
    v_mfma_f32_16x16x32_bf16 v[16:19], v[192:195], a[20:23], v[16:19]
    ds_read_b64_tr_b16 v[170:171], v254 offset:14336
    v_mfma_f32_16x16x32_bf16 v[60:63], v[192:195], a[68:71], v[60:63]
    ds_read_b64_tr_b16 v[176:177], v254 offset:28672
    v_mfma_f32_16x16x32_bf16 v[60:63], v[144:147], a[64:67], v[60:63]
    ds_read_b64_tr_b16 v[178:179], v254 offset:30720
    v_mfma_f32_16x16x32_bf16 v[68:71], v[144:147], a[112:115], v[68:71]
    ds_read_b64_tr_b16 v[220:221], v251 offset:12288
    v_mfma_f32_16x16x32_bf16 v[68:71], v[192:195], a[116:119], v[68:71]
    ds_read_b64_tr_b16 v[222:223], v251 offset:14336
    v_mfma_f32_16x16x32_bf16 v[76:79], v[192:195], a[164:167], v[76:79]
    ds_read_b64_tr_b16 v[224:225], v251 offset:28672
    v_mfma_f32_16x16x32_bf16 v[76:79], v[144:147], a[160:163], v[76:79]
    s_add_u32 m0, s100, 32256
    ds_read_b64_tr_b16 v[226:227], v251 offset:30720
    v_mfma_f32_16x16x32_bf16 v[32:35], v[200:203], a[16:19], v[32:35]
    buffer_load_dwordx4 v250, s[40:43], s92 offen offset:512 nt lds
    v_mfma_f32_16x16x32_bf16 v[32:35], v[208:211], a[20:23], v[32:35]
    s_add_u32 m0, s100, 33280
    v_mfma_f32_16x16x32_bf16 v[24:27], v[208:211], a[68:71], v[24:27]
    buffer_load_dwordx4 v253, s[40:43], s93 offen offset:512 nt lds
    v_mfma_f32_16x16x32_bf16 v[24:27], v[200:203], a[64:67], v[24:27]
    s_add_u32 m0, s100, 34304
    v_mfma_f32_16x16x32_bf16 v[84:87], v[200:203], a[112:115], v[84:87]
    buffer_load_dwordx4 v250, s[40:43], s94 offen offset:512 nt lds
    v_mfma_f32_16x16x32_bf16 v[84:87], v[208:211], a[116:119], v[84:87]
    s_add_u32 m0, s100, 35328
    v_mfma_f32_16x16x32_bf16 v[88:91], v[208:211], a[164:167], v[88:91]
    buffer_load_dwordx4 v253, s[40:43], s95 offen offset:512 nt lds
    v_mfma_f32_16x16x32_bf16 v[88:91], v[200:203], a[160:163], v[88:91]
    s_waitcnt lgkmcnt(0)
    v_mfma_f32_16x16x32_bf16 v[48:51], v[168:171], a[16:19], v[48:51]
    ds_read_b64_tr_b16 v[144:145], v249 offset:12288
    v_mfma_f32_16x16x32_bf16 v[48:51], v[176:179], a[20:23], v[48:51]
    ds_read_b64_tr_b16 v[146:147], v249 offset:14336
    v_mfma_f32_16x16x32_bf16 v[40:43], v[176:179], a[68:71], v[40:43]
    ds_read_b64_tr_b16 v[192:193], v249 offset:28672
    v_mfma_f32_16x16x32_bf16 v[40:43], v[168:171], a[64:67], v[40:43]
    ds_read_b64_tr_b16 v[194:195], v249 offset:30720
    v_mfma_f32_16x16x32_bf16 v[100:103], v[168:171], a[112:115], v[100:103]
    ds_read_b64_tr_b16 v[200:201], v248 offset:12288
    v_mfma_f32_16x16x32_bf16 v[100:103], v[176:179], a[116:119], v[100:103]
    ds_read_b64_tr_b16 v[202:203], v248 offset:14336
    v_mfma_f32_16x16x32_bf16 v[108:111], v[176:179], a[164:167], v[108:111]
    ds_read_b64_tr_b16 v[208:209], v248 offset:28672
    v_mfma_f32_16x16x32_bf16 v[108:111], v[168:171], a[160:163], v[108:111]
    s_add_u32 m0, s100, 36352
    ds_read_b64_tr_b16 v[210:211], v248 offset:30720
    v_mfma_f32_16x16x32_bf16 v[64:67], v[220:223], a[16:19], v[64:67]
    buffer_load_dwordx4 v250, s[40:43], s96 offen offset:512 nt lds
    v_mfma_f32_16x16x32_bf16 v[64:67], v[224:227], a[20:23], v[64:67]
    s_add_u32 m0, s100, 37376
    v_mfma_f32_16x16x32_bf16 v[12:15], v[224:227], a[68:71], v[12:15]
    buffer_load_dwordx4 v253, s[40:43], s97 offen offset:512 nt lds
    v_mfma_f32_16x16x32_bf16 v[12:15], v[220:223], a[64:67], v[12:15]
    s_add_u32 m0, s100, 38400
    v_mfma_f32_16x16x32_bf16 v[116:119], v[220:223], a[112:115], v[116:119]
    buffer_load_dwordx4 v250, s[40:43], s98 offen offset:512 nt lds
    v_mfma_f32_16x16x32_bf16 v[116:119], v[224:227], a[116:119], v[116:119]
    s_add_u32 m0, s100, 39424
    v_mfma_f32_16x16x32_bf16 v[120:123], v[224:227], a[164:167], v[120:123]
    buffer_load_dwordx4 v253, s[40:43], s99 offen offset:512 nt lds
    v_mfma_f32_16x16x32_bf16 v[120:123], v[220:223], a[160:163], v[120:123]
    s_waitcnt lgkmcnt(0)
    v_mfma_f32_16x16x32_bf16 a[192:195], v[144:147], a[16:19], a[192:195]
    ds_read_b64_tr_b16 v[168:169], v254 offset:0
    v_mfma_f32_16x16x32_bf16 a[192:195], v[192:195], a[20:23], a[192:195]
    ds_read_b64_tr_b16 v[170:171], v254 offset:2048
    v_mfma_f32_16x16x32_bf16 a[196:199], v[192:195], a[68:71], a[196:199]
    ds_read_b64_tr_b16 v[176:177], v254 offset:16384
    v_mfma_f32_16x16x32_bf16 a[196:199], v[144:147], a[64:67], a[196:199]
    ds_read_b64_tr_b16 v[178:179], v254 offset:18432
    v_mfma_f32_16x16x32_bf16 a[200:203], v[144:147], a[112:115], a[200:203]
    ds_read_b64_tr_b16 v[220:221], v251 offset:0
    v_mfma_f32_16x16x32_bf16 a[200:203], v[192:195], a[116:119], a[200:203]
    ds_read_b64_tr_b16 v[222:223], v251 offset:2048
    v_mfma_f32_16x16x32_bf16 a[204:207], v[192:195], a[164:167], a[204:207]
    ds_read_b64_tr_b16 v[224:225], v251 offset:16384
    v_mfma_f32_16x16x32_bf16 a[204:207], v[144:147], a[160:163], a[204:207]
    ds_read_b64_tr_b16 v[226:227], v251 offset:18432
    v_mfma_f32_16x16x32_bf16 a[208:211], v[200:203], a[16:19], a[208:211]
    v_mfma_f32_16x16x32_bf16 a[208:211], v[208:211], a[20:23], a[208:211]
    v_mfma_f32_16x16x32_bf16 a[212:215], v[208:211], a[68:71], a[212:215]
    v_mfma_f32_16x16x32_bf16 a[212:215], v[200:203], a[64:67], a[212:215]
    v_mfma_f32_16x16x32_bf16 a[216:219], v[200:203], a[112:115], a[216:219]
    v_mfma_f32_16x16x32_bf16 a[216:219], v[208:211], a[116:119], a[216:219]
    v_mfma_f32_16x16x32_bf16 a[220:223], v[208:211], a[164:167], a[220:223]
    v_mfma_f32_16x16x32_bf16 a[220:223], v[200:203], a[160:163], a[220:223]
    s_waitcnt lgkmcnt(0)
    v_mfma_f32_16x16x32_bf16 v[92:95], v[168:171], a[16:19], v[92:95]
    ds_read_b64_tr_b16 v[144:145], v249 offset:0
    v_mfma_f32_16x16x32_bf16 v[92:95], v[176:179], a[20:23], v[92:95]
    ds_read_b64_tr_b16 v[146:147], v249 offset:2048
    v_mfma_f32_16x16x32_bf16 v[104:107], v[176:179], a[68:71], v[104:107]
    ds_read_b64_tr_b16 v[192:193], v249 offset:16384
    v_mfma_f32_16x16x32_bf16 v[104:107], v[168:171], a[64:67], v[104:107]
    ds_read_b64_tr_b16 v[194:195], v249 offset:18432
    v_mfma_f32_16x16x32_bf16 v[132:135], v[168:171], a[112:115], v[132:135]
    ds_read_b64_tr_b16 v[200:201], v248 offset:0
    v_mfma_f32_16x16x32_bf16 v[132:135], v[176:179], a[116:119], v[132:135]
    ds_read_b64_tr_b16 v[202:203], v248 offset:2048
    v_mfma_f32_16x16x32_bf16 v[140:143], v[176:179], a[164:167], v[140:143]
    ds_read_b64_tr_b16 v[208:209], v248 offset:16384
    v_mfma_f32_16x16x32_bf16 v[140:143], v[168:171], a[160:163], v[140:143]
    ds_read_b64_tr_b16 v[210:211], v248 offset:18432
    s_waitcnt vmcnt(16)
    v_mfma_f32_16x16x32_bf16 v[72:75], v[220:223], a[16:19], v[72:75]
    ds_read_b128 a[24:27], v244 offset:0
    v_mfma_f32_16x16x32_bf16 v[72:75], v[224:227], a[20:23], v[72:75]
    ds_read_b128 a[72:75], v244 offset:2048
    v_mfma_f32_16x16x32_bf16 v[80:83], v[224:227], a[68:71], v[80:83]
    ds_read_b128 a[120:123], v244 offset:4096
    v_mfma_f32_16x16x32_bf16 v[80:83], v[220:223], a[64:67], v[80:83]
    ds_read_b128 a[168:171], v244 offset:6144
    v_mfma_f32_16x16x32_bf16 v[148:151], v[220:223], a[112:115], v[148:151]
    v_mfma_f32_16x16x32_bf16 v[148:151], v[224:227], a[116:119], v[148:151]
    v_mfma_f32_16x16x32_bf16 v[152:155], v[224:227], a[164:167], v[152:155]
    v_mfma_f32_16x16x32_bf16 v[152:155], v[220:223], a[160:163], v[152:155]
    s_waitcnt lgkmcnt(4)
    v_mfma_f32_16x16x32_bf16 v[156:159], v[144:147], a[16:19], v[156:159]
    ds_read_b64_tr_b16 v[168:169], v254 offset:4096
    v_mfma_f32_16x16x32_bf16 v[156:159], v[192:195], a[20:23], v[156:159]
    ds_read_b64_tr_b16 v[170:171], v254 offset:6144
    v_mfma_f32_16x16x32_bf16 v[124:127], v[192:195], a[68:71], v[124:127]
    ds_read_b64_tr_b16 v[176:177], v254 offset:20480
    v_mfma_f32_16x16x32_bf16 v[124:127], v[144:147], a[64:67], v[124:127]
    ds_read_b64_tr_b16 v[178:179], v254 offset:22528
    v_mfma_f32_16x16x32_bf16 v[164:167], v[144:147], a[112:115], v[164:167]
    ds_read_b64_tr_b16 v[220:221], v251 offset:4096
    v_mfma_f32_16x16x32_bf16 v[164:167], v[192:195], a[116:119], v[164:167]
    ds_read_b64_tr_b16 v[222:223], v251 offset:6144
    v_mfma_f32_16x16x32_bf16 v[172:175], v[192:195], a[164:167], v[172:175]
    ds_read_b64_tr_b16 v[224:225], v251 offset:20480
    v_mfma_f32_16x16x32_bf16 v[172:175], v[144:147], a[160:163], v[172:175]
    ds_read_b64_tr_b16 v[226:227], v251 offset:22528
    v_mfma_f32_16x16x32_bf16 v[112:115], v[200:203], a[16:19], v[112:115]
    ds_read_b128 a[28:31], v252 offset:0
    v_mfma_f32_16x16x32_bf16 v[112:115], v[208:211], a[20:23], v[112:115]
    ds_read_b128 a[76:79], v252 offset:2048
    v_mfma_f32_16x16x32_bf16 v[96:99], v[208:211], a[68:71], v[96:99]
    ds_read_b128 a[124:127], v252 offset:4096
    v_mfma_f32_16x16x32_bf16 v[96:99], v[200:203], a[64:67], v[96:99]
    ds_read_b128 a[172:175], v252 offset:6144
    v_mfma_f32_16x16x32_bf16 v[180:183], v[200:203], a[112:115], v[180:183]
    v_mfma_f32_16x16x32_bf16 v[180:183], v[208:211], a[116:119], v[180:183]
    v_mfma_f32_16x16x32_bf16 v[184:187], v[208:211], a[164:167], v[184:187]
    v_mfma_f32_16x16x32_bf16 v[184:187], v[200:203], a[160:163], v[184:187]
    s_waitcnt lgkmcnt(4)
    v_mfma_f32_16x16x32_bf16 v[188:191], v[168:171], a[16:19], v[188:191]
    ds_read_b64_tr_b16 v[144:145], v249 offset:4096
    v_mfma_f32_16x16x32_bf16 v[188:191], v[176:179], a[20:23], v[188:191]
    ds_read_b64_tr_b16 v[146:147], v249 offset:6144
    v_mfma_f32_16x16x32_bf16 v[136:139], v[176:179], a[68:71], v[136:139]
    ds_read_b64_tr_b16 v[192:193], v249 offset:20480
    v_mfma_f32_16x16x32_bf16 v[136:139], v[168:171], a[64:67], v[136:139]
    ds_read_b64_tr_b16 v[194:195], v249 offset:22528
    v_mfma_f32_16x16x32_bf16 v[196:199], v[168:171], a[112:115], v[196:199]
    ds_read_b64_tr_b16 v[200:201], v248 offset:4096
    v_mfma_f32_16x16x32_bf16 v[196:199], v[176:179], a[116:119], v[196:199]
    ds_read_b64_tr_b16 v[202:203], v248 offset:6144
    v_mfma_f32_16x16x32_bf16 v[204:207], v[176:179], a[164:167], v[204:207]
    ds_read_b64_tr_b16 v[208:209], v248 offset:20480
    v_mfma_f32_16x16x32_bf16 v[204:207], v[168:171], a[160:163], v[204:207]
    ds_read_b64_tr_b16 v[210:211], v248 offset:22528
    v_mfma_f32_16x16x32_bf16 v[160:163], v[220:223], a[16:19], v[160:163]
    v_mfma_f32_16x16x32_bf16 v[160:163], v[224:227], a[20:23], v[160:163]
    v_mfma_f32_16x16x32_bf16 v[128:131], v[224:227], a[68:71], v[128:131]
    v_xor_b32 v254, 32768, v255
    v_xor_b32 v251, 32800, v255
    v_mfma_f32_16x16x32_bf16 v[128:131], v[220:223], a[64:67], v[128:131]
    v_mfma_f32_16x16x32_bf16 v[212:215], v[220:223], a[112:115], v[212:215]
    v_mfma_f32_16x16x32_bf16 v[212:215], v[224:227], a[116:119], v[212:215]
    v_mfma_f32_16x16x32_bf16 v[216:219], v[224:227], a[164:167], v[216:219]
    v_mfma_f32_16x16x32_bf16 v[216:219], v[220:223], a[160:163], v[216:219]
    s_waitcnt vmcnt(8) lgkmcnt(0)
    s_barrier
    v_mfma_f32_16x16x32_bf16 a[224:227], v[144:147], a[16:19], a[224:227]
    ds_read_b64_tr_b16 v[168:169], v254 offset:8192
    v_mfma_f32_16x16x32_bf16 a[224:227], v[192:195], a[20:23], a[224:227]
    ds_read_b64_tr_b16 v[170:171], v254 offset:10240
    v_mfma_f32_16x16x32_bf16 a[228:231], v[192:195], a[68:71], a[228:231]
    ds_read_b64_tr_b16 v[176:177], v254 offset:24576
    v_mfma_f32_16x16x32_bf16 a[228:231], v[144:147], a[64:67], a[228:231]
    ds_read_b64_tr_b16 v[178:179], v254 offset:26624
    v_mfma_f32_16x16x32_bf16 a[232:235], v[144:147], a[112:115], a[232:235]
    ds_read_b64_tr_b16 v[220:221], v251 offset:8192
    v_mfma_f32_16x16x32_bf16 a[232:235], v[192:195], a[116:119], a[232:235]
    ds_read_b64_tr_b16 v[222:223], v251 offset:10240
    v_mfma_f32_16x16x32_bf16 a[236:239], v[192:195], a[164:167], a[236:239]
    ds_read_b64_tr_b16 v[224:225], v251 offset:24576
    v_mfma_f32_16x16x32_bf16 a[236:239], v[144:147], a[160:163], a[236:239]
    s_add_u32 m0, s29, 7424
    ds_read_b64_tr_b16 v[226:227], v251 offset:26624
    v_mfma_f32_16x16x32_bf16 a[240:243], v[200:203], a[16:19], a[240:243]
    global_load_lds_dwordx4 v247, s[20:21] offset:768
    v_mfma_f32_16x16x32_bf16 a[240:243], v[208:211], a[20:23], a[240:243]
    s_add_u32 m0, s29, 11392
    v_mfma_f32_16x16x32_bf16 a[244:247], v[208:211], a[68:71], a[244:247]
    global_load_lds_dwordx4 v247, s[20:21] offset:896
    v_mfma_f32_16x16x32_bf16 a[244:247], v[200:203], a[64:67], a[244:247]
    s_add_u32 m0, s29, 0
    v_xor_b32 v249, 32832, v255
    v_xor_b32 v248, 32864, v255
    v_mfma_f32_16x16x32_bf16 a[248:251], v[200:203], a[112:115], a[248:251]
    global_load_lds_dwordx4 v247, s[20:21]
    v_mfma_f32_16x16x32_bf16 a[248:251], v[208:211], a[116:119], a[248:251]
    s_add_u32 m0, s29, 3968
    v_mfma_f32_16x16x32_bf16 a[252:255], v[208:211], a[164:167], a[252:255]
    global_load_lds_dwordx4 v247, s[20:21] offset:128
    v_mfma_f32_16x16x32_bf16 a[252:255], v[200:203], a[160:163], a[252:255]
    s_waitcnt lgkmcnt(0)
    v_mbcnt_lo_u32_b32 v246, -1, 0
    v_mbcnt_hi_u32_b32 v245, -1, v246
    v_mfma_f32_16x16x32_bf16 v[20:23], v[168:171], a[24:27], v[20:23]
G_2:
    s_cbranch_vccnz G_6
    ds_read_b64_tr_b16 v[144:145], v249 offset:8192
    v_bfe_u32 v243, v245, 3, 1
    v_mfma_f32_16x16x32_bf16 v[20:23], v[176:179], a[28:31], v[20:23]
    ds_read_b64_tr_b16 v[146:147], v249 offset:10240
    v_lshrrev_b32 v246, 5, v245
    v_mfma_f32_16x16x32_bf16 v[28:31], v[176:179], a[76:79], v[28:31]
    ds_read_b64_tr_b16 v[192:193], v249 offset:24576
    v_and_b32 v242, 3, v245
    v_mfma_f32_16x16x32_bf16 v[28:31], v[168:171], a[72:75], v[28:31]
    ds_read_b64_tr_b16 v[194:195], v249 offset:26624
    v_bfe_u32 v241, v245, 4, 1
    v_mfma_f32_16x16x32_bf16 v[36:39], v[168:171], a[120:123], v[36:39]
    ds_read_b64_tr_b16 v[200:201], v248 offset:8192
    v_bfe_u32 v240, v245, 2, 1
    v_mfma_f32_16x16x32_bf16 v[36:39], v[176:179], a[124:127], v[36:39]
    ds_read_b64_tr_b16 v[202:203], v248 offset:10240
    v_sub_u32 v239, v246, v243
    v_mfma_f32_16x16x32_bf16 v[44:47], v[176:179], a[172:175], v[44:47]
    ds_read_b64_tr_b16 v[208:209], v248 offset:24576
    v_sub_u32 v245, 3, v242
    v_mfma_f32_16x16x32_bf16 v[44:47], v[168:171], a[168:171], v[44:47]
    s_add_u32 m0, s29, 23808
    ds_read_b64_tr_b16 v[210:211], v248 offset:26624
    v_sub_u32 v246, v241, v240
    v_mfma_f32_16x16x32_bf16 v[8:11], v[220:223], a[24:27], v[8:11]
    global_load_lds_dwordx4 v247, s[22:23] offset:768
    v_mfma_f32_16x16x32_bf16 v[8:11], v[224:227], a[28:31], v[8:11]
    s_add_u32 m0, s29, 27776
    v_lshlrev_b32 v243, 6, v239
    v_lshl_add_u32 v242, v246, 4, v243
    v_mfma_f32_16x16x32_bf16 v[4:7], v[224:227], a[76:79], v[4:7]
    global_load_lds_dwordx4 v247, s[22:23] offset:896
    v_mfma_f32_16x16x32_bf16 v[4:7], v[220:223], a[72:75], v[4:7]
    s_add_u32 m0, s29, 16384
    v_mul_u32_u24 v246, 960, v245
    v_add_u32 v243, v246, v242
    v_mfma_f32_16x16x32_bf16 v[52:55], v[220:223], a[120:123], v[52:55]
    global_load_lds_dwordx4 v247, s[22:23]
    v_mfma_f32_16x16x32_bf16 v[52:55], v[224:227], a[124:127], v[52:55]
    s_add_u32 m0, s29, 20352
    v_add_u32 v246, 96, v243
    v_mfma_f32_16x16x32_bf16 v[56:59], v[224:227], a[172:175], v[56:59]
    global_load_lds_dwordx4 v247, s[22:23] offset:128
    v_mfma_f32_16x16x32_bf16 v[56:59], v[220:223], a[168:171], v[56:59]
    s_waitcnt lgkmcnt(0)
    v_mfma_f32_16x16x32_bf16 v[16:19], v[144:147], a[24:27], v[16:19]
    ds_read_b64_tr_b16 v[168:169], v254 offset:12288
    v_mfma_f32_16x16x32_bf16 v[16:19], v[192:195], a[28:31], v[16:19]
    ds_read_b64_tr_b16 v[170:171], v254 offset:14336
    v_mfma_f32_16x16x32_bf16 v[60:63], v[192:195], a[76:79], v[60:63]
    ds_read_b64_tr_b16 v[176:177], v254 offset:28672
    v_mfma_f32_16x16x32_bf16 v[60:63], v[144:147], a[72:75], v[60:63]
    ds_read_b64_tr_b16 v[178:179], v254 offset:30720
    v_mfma_f32_16x16x32_bf16 v[68:71], v[144:147], a[120:123], v[68:71]
    ds_read_b64_tr_b16 v[220:221], v251 offset:12288
    v_mfma_f32_16x16x32_bf16 v[68:71], v[192:195], a[124:127], v[68:71]
    ds_read_b64_tr_b16 v[222:223], v251 offset:14336
    v_mfma_f32_16x16x32_bf16 v[76:79], v[192:195], a[172:175], v[76:79]
    ds_read_b64_tr_b16 v[224:225], v251 offset:28672
    v_mfma_f32_16x16x32_bf16 v[76:79], v[144:147], a[168:171], v[76:79]
    s_add_u32 m0, s100, 64896
    ds_read_b64_tr_b16 v[226:227], v251 offset:30720
    v_mfma_f32_16x16x32_bf16 v[32:35], v[200:203], a[24:27], v[32:35]
    buffer_load_dwordx4 v250, s[40:43], s92 offen offset:640 nt lds
    v_mfma_f32_16x16x32_bf16 v[32:35], v[208:211], a[28:31], v[32:35]
    s_add_u32 m0, s100, 65920
    v_mfma_f32_16x16x32_bf16 v[24:27], v[208:211], a[76:79], v[24:27]
    buffer_load_dwordx4 v253, s[40:43], s93 offen offset:640 nt lds
    v_mfma_f32_16x16x32_bf16 v[24:27], v[200:203], a[72:75], v[24:27]
    s_add_u32 m0, s100, 66944
    v_mfma_f32_16x16x32_bf16 v[84:87], v[200:203], a[120:123], v[84:87]
    buffer_load_dwordx4 v250, s[40:43], s94 offen offset:640 nt lds
    v_mfma_f32_16x16x32_bf16 v[84:87], v[208:211], a[124:127], v[84:87]
    s_add_u32 m0, s100, 67968
    v_mfma_f32_16x16x32_bf16 v[88:91], v[208:211], a[172:175], v[88:91]
    buffer_load_dwordx4 v253, s[40:43], s95 offen offset:640 nt lds
    v_mfma_f32_16x16x32_bf16 v[88:91], v[200:203], a[168:171], v[88:91]
    s_waitcnt lgkmcnt(0)
    v_mfma_f32_16x16x32_bf16 v[48:51], v[168:171], a[24:27], v[48:51]
    ds_read_b64_tr_b16 v[144:145], v249 offset:12288
    v_mfma_f32_16x16x32_bf16 v[48:51], v[176:179], a[28:31], v[48:51]
    ds_read_b64_tr_b16 v[146:147], v249 offset:14336
    v_mfma_f32_16x16x32_bf16 v[40:43], v[176:179], a[76:79], v[40:43]
    ds_read_b64_tr_b16 v[192:193], v249 offset:28672
    v_mfma_f32_16x16x32_bf16 v[40:43], v[168:171], a[72:75], v[40:43]
    ds_read_b64_tr_b16 v[194:195], v249 offset:30720
    v_mfma_f32_16x16x32_bf16 v[100:103], v[168:171], a[120:123], v[100:103]
    ds_read_b64_tr_b16 v[200:201], v248 offset:12288
    v_mfma_f32_16x16x32_bf16 v[100:103], v[176:179], a[124:127], v[100:103]
    ds_read_b64_tr_b16 v[202:203], v248 offset:14336
    v_mfma_f32_16x16x32_bf16 v[108:111], v[176:179], a[172:175], v[108:111]
    ds_read_b64_tr_b16 v[208:209], v248 offset:28672
    v_mfma_f32_16x16x32_bf16 v[108:111], v[168:171], a[168:171], v[108:111]
    s_add_u32 m0, s100, 68992
    ds_read_b64_tr_b16 v[210:211], v248 offset:30720
    v_mfma_f32_16x16x32_bf16 v[64:67], v[220:223], a[24:27], v[64:67]
    buffer_load_dwordx4 v250, s[40:43], s96 offen offset:640 nt lds
    v_mfma_f32_16x16x32_bf16 v[64:67], v[224:227], a[28:31], v[64:67]
    s_add_u32 m0, s100, 70016
    v_mfma_f32_16x16x32_bf16 v[12:15], v[224:227], a[76:79], v[12:15]
    buffer_load_dwordx4 v253, s[40:43], s97 offen offset:640 nt lds
    v_mfma_f32_16x16x32_bf16 v[12:15], v[220:223], a[72:75], v[12:15]
    s_add_u32 m0, s100, 71040
    v_mfma_f32_16x16x32_bf16 v[116:119], v[220:223], a[120:123], v[116:119]
    buffer_load_dwordx4 v250, s[40:43], s98 offen offset:640 nt lds
    v_mfma_f32_16x16x32_bf16 v[116:119], v[224:227], a[124:127], v[116:119]
    s_add_u32 m0, s100, 72064
    v_mfma_f32_16x16x32_bf16 v[120:123], v[224:227], a[172:175], v[120:123]
    buffer_load_dwordx4 v253, s[40:43], s99 offen offset:640 nt lds
    v_mfma_f32_16x16x32_bf16 v[120:123], v[220:223], a[168:171], v[120:123]
    s_waitcnt lgkmcnt(0)
    v_mfma_f32_16x16x32_bf16 a[192:195], v[144:147], a[24:27], a[192:195]
    ds_read_b64_tr_b16 v[168:169], v254 offset:0
    v_mfma_f32_16x16x32_bf16 a[192:195], v[192:195], a[28:31], a[192:195]
    ds_read_b64_tr_b16 v[170:171], v254 offset:2048
    v_mfma_f32_16x16x32_bf16 a[196:199], v[192:195], a[76:79], a[196:199]
    ds_read_b64_tr_b16 v[176:177], v254 offset:16384
    v_mfma_f32_16x16x32_bf16 a[196:199], v[144:147], a[72:75], a[196:199]
    ds_read_b64_tr_b16 v[178:179], v254 offset:18432
    v_mfma_f32_16x16x32_bf16 a[200:203], v[144:147], a[120:123], a[200:203]
    ds_read_b64_tr_b16 v[220:221], v251 offset:0
    v_mfma_f32_16x16x32_bf16 a[200:203], v[192:195], a[124:127], a[200:203]
    ds_read_b64_tr_b16 v[222:223], v251 offset:2048
    v_mfma_f32_16x16x32_bf16 a[204:207], v[192:195], a[172:175], a[204:207]
    ds_read_b64_tr_b16 v[224:225], v251 offset:16384
    v_mfma_f32_16x16x32_bf16 a[204:207], v[144:147], a[168:171], a[204:207]
    ds_read_b64_tr_b16 v[226:227], v251 offset:18432
    v_mfma_f32_16x16x32_bf16 a[208:211], v[200:203], a[24:27], a[208:211]
    v_mfma_f32_16x16x32_bf16 a[208:211], v[208:211], a[28:31], a[208:211]
    v_mfma_f32_16x16x32_bf16 a[212:215], v[208:211], a[76:79], a[212:215]
    v_mfma_f32_16x16x32_bf16 a[212:215], v[200:203], a[72:75], a[212:215]
    v_add_u32 v253, 32768, v244
    v_mfma_f32_16x16x32_bf16 a[216:219], v[200:203], a[120:123], a[216:219]
    v_mfma_f32_16x16x32_bf16 a[216:219], v[208:211], a[124:127], a[216:219]
    v_mfma_f32_16x16x32_bf16 a[220:223], v[208:211], a[172:175], a[220:223]
    v_mfma_f32_16x16x32_bf16 a[220:223], v[200:203], a[168:171], a[220:223]
    s_waitcnt lgkmcnt(0)
    v_mfma_f32_16x16x32_bf16 v[92:95], v[168:171], a[24:27], v[92:95]
    ds_read_b64_tr_b16 v[144:145], v249 offset:0
    v_mfma_f32_16x16x32_bf16 v[92:95], v[176:179], a[28:31], v[92:95]
    ds_read_b64_tr_b16 v[146:147], v249 offset:2048
    v_mfma_f32_16x16x32_bf16 v[104:107], v[176:179], a[76:79], v[104:107]
    ds_read_b64_tr_b16 v[192:193], v249 offset:16384
    v_mfma_f32_16x16x32_bf16 v[104:107], v[168:171], a[72:75], v[104:107]
    ds_read_b64_tr_b16 v[194:195], v249 offset:18432
    v_mfma_f32_16x16x32_bf16 v[132:135], v[168:171], a[120:123], v[132:135]
    ds_read_b64_tr_b16 v[200:201], v248 offset:0
    v_mfma_f32_16x16x32_bf16 v[132:135], v[176:179], a[124:127], v[132:135]
    ds_read_b64_tr_b16 v[202:203], v248 offset:2048
    v_mfma_f32_16x16x32_bf16 v[140:143], v[176:179], a[172:175], v[140:143]
    ds_read_b64_tr_b16 v[208:209], v248 offset:16384
    v_mfma_f32_16x16x32_bf16 v[140:143], v[168:171], a[168:171], v[140:143]
    ds_read_b64_tr_b16 v[210:211], v248 offset:18432
    s_waitcnt vmcnt(16)
    v_mfma_f32_16x16x32_bf16 v[72:75], v[220:223], a[24:27], v[72:75]
    ds_read_b128 a[32:35], v253 offset:0
    v_mfma_f32_16x16x32_bf16 v[72:75], v[224:227], a[28:31], v[72:75]
    ds_read_b128 a[80:83], v253 offset:2048
    v_mfma_f32_16x16x32_bf16 v[80:83], v[224:227], a[76:79], v[80:83]
    ds_read_b128 a[128:131], v253 offset:4096
    v_mfma_f32_16x16x32_bf16 v[80:83], v[220:223], a[72:75], v[80:83]
    ds_read_b128 a[176:179], v253 offset:6144
    v_mfma_f32_16x16x32_bf16 v[148:151], v[220:223], a[120:123], v[148:151]
    v_add_u32 v250, 32768, v252
    v_mfma_f32_16x16x32_bf16 v[148:151], v[224:227], a[124:127], v[148:151]
    v_mfma_f32_16x16x32_bf16 v[152:155], v[224:227], a[172:175], v[152:155]
    v_mfma_f32_16x16x32_bf16 v[152:155], v[220:223], a[168:171], v[152:155]
    s_waitcnt lgkmcnt(4)
    v_mfma_f32_16x16x32_bf16 v[156:159], v[144:147], a[24:27], v[156:159]
    ds_read_b64_tr_b16 v[168:169], v254 offset:4096
    v_mfma_f32_16x16x32_bf16 v[156:159], v[192:195], a[28:31], v[156:159]
    ds_read_b64_tr_b16 v[170:171], v254 offset:6144
    v_mfma_f32_16x16x32_bf16 v[124:127], v[192:195], a[76:79], v[124:127]
    ds_read_b64_tr_b16 v[176:177], v254 offset:20480
    v_mfma_f32_16x16x32_bf16 v[124:127], v[144:147], a[72:75], v[124:127]
    ds_read_b64_tr_b16 v[178:179], v254 offset:22528
    v_mfma_f32_16x16x32_bf16 v[164:167], v[144:147], a[120:123], v[164:167]
    ds_read_b64_tr_b16 v[220:221], v251 offset:4096
    v_mfma_f32_16x16x32_bf16 v[164:167], v[192:195], a[124:127], v[164:167]
    ds_read_b64_tr_b16 v[222:223], v251 offset:6144
    v_mfma_f32_16x16x32_bf16 v[172:175], v[192:195], a[172:175], v[172:175]
    ds_read_b64_tr_b16 v[224:225], v251 offset:20480
    v_mfma_f32_16x16x32_bf16 v[172:175], v[144:147], a[168:171], v[172:175]
    ds_read_b64_tr_b16 v[226:227], v251 offset:22528
    v_mfma_f32_16x16x32_bf16 v[112:115], v[200:203], a[24:27], v[112:115]
    ds_read_b128 a[36:39], v250 offset:0
    v_mfma_f32_16x16x32_bf16 v[112:115], v[208:211], a[28:31], v[112:115]
    ds_read_b128 a[84:87], v250 offset:2048
    v_mfma_f32_16x16x32_bf16 v[96:99], v[208:211], a[76:79], v[96:99]
    ds_read_b128 a[132:135], v250 offset:4096
    v_mfma_f32_16x16x32_bf16 v[96:99], v[200:203], a[72:75], v[96:99]
    ds_read_b128 a[180:183], v250 offset:6144
    v_mfma_f32_16x16x32_bf16 v[180:183], v[200:203], a[120:123], v[180:183]
    v_mfma_f32_16x16x32_bf16 v[180:183], v[208:211], a[124:127], v[180:183]
    v_mfma_f32_16x16x32_bf16 v[184:187], v[208:211], a[172:175], v[184:187]
    v_mfma_f32_16x16x32_bf16 v[184:187], v[200:203], a[168:171], v[184:187]
    s_waitcnt lgkmcnt(4)
    v_mfma_f32_16x16x32_bf16 v[188:191], v[168:171], a[24:27], v[188:191]
    ds_read_b64_tr_b16 v[144:145], v249 offset:4096
    v_mfma_f32_16x16x32_bf16 v[188:191], v[176:179], a[28:31], v[188:191]
    ds_read_b64_tr_b16 v[146:147], v249 offset:6144
    v_mfma_f32_16x16x32_bf16 v[136:139], v[176:179], a[76:79], v[136:139]
    ds_read_b64_tr_b16 v[192:193], v249 offset:20480
    v_mfma_f32_16x16x32_bf16 v[136:139], v[168:171], a[72:75], v[136:139]
    ds_read_b64_tr_b16 v[194:195], v249 offset:22528
    v_mfma_f32_16x16x32_bf16 v[196:199], v[168:171], a[120:123], v[196:199]
    ds_read_b64_tr_b16 v[200:201], v248 offset:4096
    v_mfma_f32_16x16x32_bf16 v[196:199], v[176:179], a[124:127], v[196:199]
    ds_read_b64_tr_b16 v[202:203], v248 offset:6144
    v_mfma_f32_16x16x32_bf16 v[204:207], v[176:179], a[172:175], v[204:207]
    ds_read_b64_tr_b16 v[208:209], v248 offset:20480
    v_mfma_f32_16x16x32_bf16 v[204:207], v[168:171], a[168:171], v[204:207]
    ds_read_b64_tr_b16 v[210:211], v248 offset:22528
    v_mfma_f32_16x16x32_bf16 v[160:163], v[220:223], a[24:27], v[160:163]
    v_mfma_f32_16x16x32_bf16 v[160:163], v[224:227], a[28:31], v[160:163]
    v_mfma_f32_16x16x32_bf16 v[128:131], v[224:227], a[76:79], v[128:131]
    v_xor_b32 v254, 0, v255
    v_xor_b32 v253, 32, v255
    v_mfma_f32_16x16x32_bf16 v[128:131], v[220:223], a[72:75], v[128:131]
    v_mfma_f32_16x16x32_bf16 v[212:215], v[220:223], a[120:123], v[212:215]
    v_mfma_f32_16x16x32_bf16 v[212:215], v[224:227], a[124:127], v[212:215]
    v_mfma_f32_16x16x32_bf16 v[216:219], v[224:227], a[172:175], v[216:219]
    v_mfma_f32_16x16x32_bf16 v[216:219], v[220:223], a[168:171], v[216:219]
    s_waitcnt vmcnt(8) lgkmcnt(0)
    s_barrier
    v_mfma_f32_16x16x32_bf16 a[224:227], v[144:147], a[24:27], a[224:227]
    ds_read_b64_tr_b16 v[168:169], v254 offset:8192
    v_mfma_f32_16x16x32_bf16 a[224:227], v[192:195], a[28:31], a[224:227]
    ds_read_b64_tr_b16 v[170:171], v254 offset:10240
    v_mfma_f32_16x16x32_bf16 a[228:231], v[192:195], a[76:79], a[228:231]
    ds_read_b64_tr_b16 v[176:177], v254 offset:24576
    v_mfma_f32_16x16x32_bf16 a[228:231], v[144:147], a[72:75], a[228:231]
    ds_read_b64_tr_b16 v[178:179], v254 offset:26624
    v_mfma_f32_16x16x32_bf16 a[232:235], v[144:147], a[120:123], a[232:235]
    ds_read_b64_tr_b16 v[220:221], v253 offset:8192
    v_mfma_f32_16x16x32_bf16 a[232:235], v[192:195], a[124:127], a[232:235]
    ds_read_b64_tr_b16 v[222:223], v253 offset:10240
    v_mfma_f32_16x16x32_bf16 a[236:239], v[192:195], a[172:175], a[236:239]
    ds_read_b64_tr_b16 v[224:225], v253 offset:24576
    v_mfma_f32_16x16x32_bf16 a[236:239], v[144:147], a[168:171], a[236:239]
    s_add_u32 m0, s29, 40192
    ds_read_b64_tr_b16 v[226:227], v253 offset:26624
    v_mfma_f32_16x16x32_bf16 a[240:243], v[200:203], a[24:27], a[240:243]
    global_load_lds_dwordx4 v247, s[24:25] offset:768
    v_mfma_f32_16x16x32_bf16 a[240:243], v[208:211], a[28:31], a[240:243]
    s_add_u32 m0, s29, 44160
    v_mfma_f32_16x16x32_bf16 a[244:247], v[208:211], a[76:79], a[244:247]
    global_load_lds_dwordx4 v247, s[24:25] offset:896
    v_mfma_f32_16x16x32_bf16 a[244:247], v[200:203], a[72:75], a[244:247]
    s_add_u32 m0, s29, 32768
    v_xor_b32 v251, 64, v255
    v_xor_b32 v250, 96, v255
    v_mfma_f32_16x16x32_bf16 a[248:251], v[200:203], a[120:123], a[248:251]
    global_load_lds_dwordx4 v247, s[24:25]
    v_mfma_f32_16x16x32_bf16 a[248:251], v[208:211], a[124:127], a[248:251]
    s_add_u32 m0, s29, 36736
    v_mfma_f32_16x16x32_bf16 a[252:255], v[208:211], a[172:175], a[252:255]
    global_load_lds_dwordx4 v247, s[24:25] offset:128
    v_mfma_f32_16x16x32_bf16 a[252:255], v[200:203], a[168:171], a[252:255]
    s_waitcnt lgkmcnt(0)
    v_mfma_f32_16x16x32_bf16 v[20:23], v[168:171], a[32:35], v[20:23]
    ds_read_b64_tr_b16 v[144:145], v251 offset:8192
    v_lshlrev_b32 v249, 3, v0
    v_mfma_f32_16x16x32_bf16 v[20:23], v[176:179], a[36:39], v[20:23]
    ds_read_b64_tr_b16 v[146:147], v251 offset:10240
    v_mfma_f32_16x16x32_bf16 v[28:31], v[176:179], a[84:87], v[28:31]
    ds_read_b64_tr_b16 v[192:193], v251 offset:24576
    v_mfma_f32_16x16x32_bf16 v[28:31], v[168:171], a[80:83], v[28:31]
    ds_read_b64_tr_b16 v[194:195], v251 offset:26624
    v_mfma_f32_16x16x32_bf16 v[36:39], v[168:171], a[128:131], v[36:39]
    ds_read_b64_tr_b16 v[200:201], v250 offset:8192
    v_mfma_f32_16x16x32_bf16 v[36:39], v[176:179], a[132:135], v[36:39]
    ds_read_b64_tr_b16 v[202:203], v250 offset:10240
    v_mfma_f32_16x16x32_bf16 v[44:47], v[176:179], a[180:183], v[44:47]
    ds_read_b64_tr_b16 v[208:209], v250 offset:24576
    v_mfma_f32_16x16x32_bf16 v[44:47], v[168:171], a[176:179], v[44:47]
    s_add_u32 m0, s29, 56576
    ds_read_b64_tr_b16 v[210:211], v250 offset:26624
    v_mfma_f32_16x16x32_bf16 v[8:11], v[220:223], a[32:35], v[8:11]
    global_load_lds_dwordx4 v247, s[26:27] offset:768
    v_mfma_f32_16x16x32_bf16 v[8:11], v[224:227], a[36:39], v[8:11]
    s_add_u32 m0, s29, 60544
    buffer_load_dwordx2 v[242:243], v249, s[52:55], 0 offen
    v_mfma_f32_16x16x32_bf16 v[4:7], v[224:227], a[84:87], v[4:7]
    global_load_lds_dwordx4 v247, s[26:27] offset:896
    v_mfma_f32_16x16x32_bf16 v[4:7], v[220:223], a[80:83], v[4:7]
    s_add_u32 m0, s29, 49152
    v_mfma_f32_16x16x32_bf16 v[52:55], v[220:223], a[128:131], v[52:55]
    global_load_lds_dwordx4 v247, s[26:27]
    v_mfma_f32_16x16x32_bf16 v[52:55], v[224:227], a[132:135], v[52:55]
    s_add_u32 m0, s29, 53120
    v_mfma_f32_16x16x32_bf16 v[56:59], v[224:227], a[180:183], v[56:59]
    global_load_lds_dwordx4 v247, s[26:27] offset:128
    v_mfma_f32_16x16x32_bf16 v[56:59], v[220:223], a[176:179], v[56:59]
    s_waitcnt lgkmcnt(0)
    v_mfma_f32_16x16x32_bf16 v[16:19], v[144:147], a[32:35], v[16:19]
    ds_read_b64_tr_b16 v[168:169], v254 offset:12288
    v_mfma_f32_16x16x32_bf16 v[16:19], v[192:195], a[36:39], v[16:19]
    ds_read_b64_tr_b16 v[170:171], v254 offset:14336
    v_mfma_f32_16x16x32_bf16 v[60:63], v[192:195], a[84:87], v[60:63]
    ds_read_b64_tr_b16 v[176:177], v254 offset:28672
    v_mfma_f32_16x16x32_bf16 v[60:63], v[144:147], a[80:83], v[60:63]
    ds_read_b64_tr_b16 v[178:179], v254 offset:30720
    v_mfma_f32_16x16x32_bf16 v[68:71], v[144:147], a[128:131], v[68:71]
    ds_read_b64_tr_b16 v[220:221], v253 offset:12288
    v_mfma_f32_16x16x32_bf16 v[68:71], v[192:195], a[132:135], v[68:71]
    ds_read_b64_tr_b16 v[222:223], v253 offset:14336
    v_mfma_f32_16x16x32_bf16 v[76:79], v[192:195], a[180:183], v[76:79]
    ds_read_b64_tr_b16 v[224:225], v253 offset:28672
    v_mfma_f32_16x16x32_bf16 v[76:79], v[144:147], a[176:179], v[76:79]
    s_add_u32 m0, s29, 64512
    ds_read_b64_tr_b16 v[226:227], v253 offset:30720
    v_mfma_f32_16x16x32_bf16 v[32:35], v[200:203], a[32:35], v[32:35]
    global_load_lds_dwordx4 v247, s[4:5] offset:1024
    v_mfma_f32_16x16x32_bf16 v[32:35], v[208:211], a[36:39], v[32:35]
    s_add_u32 m0, s29, 68608
    v_mfma_f32_16x16x32_bf16 v[24:27], v[208:211], a[84:87], v[24:27]
    global_load_lds_dwordx4 v247, s[6:7] offset:1024
    v_mfma_f32_16x16x32_bf16 v[24:27], v[200:203], a[80:83], v[24:27]
    s_add_u32 m0, s29, 72704
    v_mfma_f32_16x16x32_bf16 v[84:87], v[200:203], a[128:131], v[84:87]
    global_load_lds_dwordx4 v247, s[8:9] offset:1024
    v_mfma_f32_16x16x32_bf16 v[84:87], v[208:211], a[132:135], v[84:87]
    s_add_u32 m0, s29, 76800
    v_mfma_f32_16x16x32_bf16 v[88:91], v[208:211], a[180:183], v[88:91]
    global_load_lds_dwordx4 v247, s[10:11] offset:1024
    v_mfma_f32_16x16x32_bf16 v[88:91], v[200:203], a[176:179], v[88:91]
    s_waitcnt lgkmcnt(0)
    v_mfma_f32_16x16x32_bf16 v[48:51], v[168:171], a[32:35], v[48:51]
    ds_read_b64_tr_b16 v[144:145], v251 offset:12288
    v_mfma_f32_16x16x32_bf16 v[48:51], v[176:179], a[36:39], v[48:51]
    ds_read_b64_tr_b16 v[146:147], v251 offset:14336
    v_mfma_f32_16x16x32_bf16 v[40:43], v[176:179], a[84:87], v[40:43]
    ds_read_b64_tr_b16 v[192:193], v251 offset:28672
    v_mfma_f32_16x16x32_bf16 v[40:43], v[168:171], a[80:83], v[40:43]
    ds_read_b64_tr_b16 v[194:195], v251 offset:30720
    v_mfma_f32_16x16x32_bf16 v[100:103], v[168:171], a[128:131], v[100:103]
    ds_read_b64_tr_b16 v[200:201], v250 offset:12288
    v_mfma_f32_16x16x32_bf16 v[100:103], v[176:179], a[132:135], v[100:103]
    ds_read_b64_tr_b16 v[202:203], v250 offset:14336
    v_mfma_f32_16x16x32_bf16 v[108:111], v[176:179], a[180:183], v[108:111]
    ds_read_b64_tr_b16 v[208:209], v250 offset:28672
    v_mfma_f32_16x16x32_bf16 v[108:111], v[168:171], a[176:179], v[108:111]
    s_add_u32 m0, s29, 80896
    ds_read_b64_tr_b16 v[210:211], v250 offset:30720
    v_mfma_f32_16x16x32_bf16 v[64:67], v[220:223], a[32:35], v[64:67]
    global_load_lds_dwordx4 v247, s[12:13] offset:1024
    v_mfma_f32_16x16x32_bf16 v[64:67], v[224:227], a[36:39], v[64:67]
    s_add_u32 m0, s29, 84992
    v_mfma_f32_16x16x32_bf16 v[12:15], v[224:227], a[84:87], v[12:15]
    global_load_lds_dwordx4 v247, s[14:15] offset:1024
    v_mfma_f32_16x16x32_bf16 v[12:15], v[220:223], a[80:83], v[12:15]
    s_add_u32 m0, s29, 89088
    v_mfma_f32_16x16x32_bf16 v[116:119], v[220:223], a[128:131], v[116:119]
    global_load_lds_dwordx4 v247, s[16:17] offset:1024
    v_mfma_f32_16x16x32_bf16 v[116:119], v[224:227], a[132:135], v[116:119]
    s_add_u32 m0, s29, 93184
    v_mfma_f32_16x16x32_bf16 v[120:123], v[224:227], a[180:183], v[120:123]
    global_load_lds_dwordx4 v247, s[18:19] offset:1024
    v_mfma_f32_16x16x32_bf16 v[120:123], v[220:223], a[176:179], v[120:123]
    s_waitcnt lgkmcnt(0)
    v_mfma_f32_16x16x32_bf16 a[192:195], v[144:147], a[32:35], a[192:195]
    ds_read_b64_tr_b16 v[168:169], v254 offset:0
    v_mfma_f32_16x16x32_bf16 a[192:195], v[192:195], a[36:39], a[192:195]
    ds_read_b64_tr_b16 v[170:171], v254 offset:2048
    v_mfma_f32_16x16x32_bf16 a[196:199], v[192:195], a[84:87], a[196:199]
    ds_read_b64_tr_b16 v[176:177], v254 offset:16384
    v_mfma_f32_16x16x32_bf16 a[196:199], v[144:147], a[80:83], a[196:199]
    ds_read_b64_tr_b16 v[178:179], v254 offset:18432
    v_mfma_f32_16x16x32_bf16 a[200:203], v[144:147], a[128:131], a[200:203]
    ds_read_b64_tr_b16 v[220:221], v253 offset:0
    v_mfma_f32_16x16x32_bf16 a[200:203], v[192:195], a[132:135], a[200:203]
    ds_read_b64_tr_b16 v[222:223], v253 offset:2048
    v_mfma_f32_16x16x32_bf16 a[204:207], v[192:195], a[180:183], a[204:207]
    ds_read_b64_tr_b16 v[224:225], v253 offset:16384
    v_mfma_f32_16x16x32_bf16 a[204:207], v[144:147], a[176:179], a[204:207]
    s_add_u32 m0, s29, 97280
    ds_read_b64_tr_b16 v[226:227], v253 offset:18432
    v_mfma_f32_16x16x32_bf16 a[208:211], v[200:203], a[32:35], a[208:211]
    global_load_lds_dwordx4 v247, s[20:21] offset:1024
    v_mfma_f32_16x16x32_bf16 a[208:211], v[208:211], a[36:39], a[208:211]
    s_add_u32 m0, s29, 101376
    v_mfma_f32_16x16x32_bf16 a[212:215], v[208:211], a[84:87], a[212:215]
    global_load_lds_dwordx4 v247, s[22:23] offset:1024
    v_mfma_f32_16x16x32_bf16 a[212:215], v[200:203], a[80:83], a[212:215]
    s_add_u32 m0, s29, 105472
    v_add_u32 v249, 65536, v244
    v_mfma_f32_16x16x32_bf16 a[216:219], v[200:203], a[128:131], a[216:219]
    global_load_lds_dwordx4 v247, s[24:25] offset:1024
    v_mfma_f32_16x16x32_bf16 a[216:219], v[208:211], a[132:135], a[216:219]
    s_add_u32 m0, s29, 109568
    v_mfma_f32_16x16x32_bf16 a[220:223], v[208:211], a[180:183], a[220:223]
    global_load_lds_dwordx4 v247, s[26:27] offset:1024
    v_mfma_f32_16x16x32_bf16 a[220:223], v[200:203], a[176:179], a[220:223]
    s_waitcnt lgkmcnt(0)
    v_mfma_f32_16x16x32_bf16 v[92:95], v[168:171], a[32:35], v[92:95]
    ds_read_b64_tr_b16 v[144:145], v251 offset:0
    v_mfma_f32_16x16x32_bf16 v[92:95], v[176:179], a[36:39], v[92:95]
    ds_read_b64_tr_b16 v[146:147], v251 offset:2048
    v_mfma_f32_16x16x32_bf16 v[104:107], v[176:179], a[84:87], v[104:107]
    ds_read_b64_tr_b16 v[192:193], v251 offset:16384
    v_mfma_f32_16x16x32_bf16 v[104:107], v[168:171], a[80:83], v[104:107]
    ds_read_b64_tr_b16 v[194:195], v251 offset:18432
    v_mfma_f32_16x16x32_bf16 v[132:135], v[168:171], a[128:131], v[132:135]
    ds_read_b64_tr_b16 v[200:201], v250 offset:0
    v_mfma_f32_16x16x32_bf16 v[132:135], v[176:179], a[132:135], v[132:135]
    ds_read_b64_tr_b16 v[202:203], v250 offset:2048
    v_mfma_f32_16x16x32_bf16 v[140:143], v[176:179], a[180:183], v[140:143]
    ds_read_b64_tr_b16 v[208:209], v250 offset:16384
    v_mfma_f32_16x16x32_bf16 v[140:143], v[168:171], a[176:179], v[140:143]
    ds_read_b64_tr_b16 v[210:211], v250 offset:18432
    s_waitcnt vmcnt(21)
    v_mfma_f32_16x16x32_bf16 v[72:75], v[220:223], a[32:35], v[72:75]
    ds_read_b128 a[40:43], v249 offset:0
    v_mfma_f32_16x16x32_bf16 v[72:75], v[224:227], a[36:39], v[72:75]
    ds_read_b128 a[88:91], v249 offset:2048
    v_mfma_f32_16x16x32_bf16 v[80:83], v[224:227], a[84:87], v[80:83]
    ds_read_b128 a[136:139], v249 offset:4096
    v_mfma_f32_16x16x32_bf16 v[80:83], v[220:223], a[80:83], v[80:83]
    ds_read_b128 a[184:187], v249 offset:6144
    v_mfma_f32_16x16x32_bf16 v[148:151], v[220:223], a[128:131], v[148:151]
    v_add_u32 v248, 65536, v252
    v_mfma_f32_16x16x32_bf16 v[148:151], v[224:227], a[132:135], v[148:151]
    v_mfma_f32_16x16x32_bf16 v[152:155], v[224:227], a[180:183], v[152:155]
    v_mfma_f32_16x16x32_bf16 v[152:155], v[220:223], a[176:179], v[152:155]
    s_waitcnt lgkmcnt(4)
    v_mfma_f32_16x16x32_bf16 v[156:159], v[144:147], a[32:35], v[156:159]
    ds_read_b64_tr_b16 v[168:169], v254 offset:4096
    v_mfma_f32_16x16x32_bf16 v[156:159], v[192:195], a[36:39], v[156:159]
    ds_read_b64_tr_b16 v[170:171], v254 offset:6144
    v_mfma_f32_16x16x32_bf16 v[124:127], v[192:195], a[84:87], v[124:127]
    ds_read_b64_tr_b16 v[176:177], v254 offset:20480
    v_mfma_f32_16x16x32_bf16 v[124:127], v[144:147], a[80:83], v[124:127]
    ds_read_b64_tr_b16 v[178:179], v254 offset:22528
    v_mfma_f32_16x16x32_bf16 v[164:167], v[144:147], a[128:131], v[164:167]
    ds_read_b64_tr_b16 v[220:221], v253 offset:4096
    v_mfma_f32_16x16x32_bf16 v[164:167], v[192:195], a[132:135], v[164:167]
    ds_read_b64_tr_b16 v[222:223], v253 offset:6144
    v_mfma_f32_16x16x32_bf16 v[172:175], v[192:195], a[180:183], v[172:175]
    ds_read_b64_tr_b16 v[224:225], v253 offset:20480
    v_mfma_f32_16x16x32_bf16 v[172:175], v[144:147], a[176:179], v[172:175]
    ds_read_b64_tr_b16 v[226:227], v253 offset:22528
    v_mfma_f32_16x16x32_bf16 v[112:115], v[200:203], a[32:35], v[112:115]
    ds_read_b128 a[44:47], v248 offset:0
    v_mfma_f32_16x16x32_bf16 v[112:115], v[208:211], a[36:39], v[112:115]
    ds_read_b128 a[92:95], v248 offset:2048
    v_mfma_f32_16x16x32_bf16 v[96:99], v[208:211], a[84:87], v[96:99]
    ds_read_b128 a[140:143], v248 offset:4096
    v_mfma_f32_16x16x32_bf16 v[96:99], v[200:203], a[80:83], v[96:99]
    ds_read_b128 a[188:191], v248 offset:6144
    v_mfma_f32_16x16x32_bf16 v[180:183], v[200:203], a[128:131], v[180:183]
    v_mfma_f32_16x16x32_bf16 v[180:183], v[208:211], a[132:135], v[180:183]
    v_mfma_f32_16x16x32_bf16 v[184:187], v[208:211], a[180:183], v[184:187]
    v_mfma_f32_16x16x32_bf16 v[184:187], v[200:203], a[176:179], v[184:187]
    s_waitcnt lgkmcnt(4)
    v_mfma_f32_16x16x32_bf16 v[188:191], v[168:171], a[32:35], v[188:191]
    ds_read_b64_tr_b16 v[144:145], v251 offset:4096
    v_mfma_f32_16x16x32_bf16 v[188:191], v[176:179], a[36:39], v[188:191]
    ds_read_b64_tr_b16 v[146:147], v251 offset:6144
    v_mfma_f32_16x16x32_bf16 v[136:139], v[176:179], a[84:87], v[136:139]
    ds_read_b64_tr_b16 v[192:193], v251 offset:20480
    v_mfma_f32_16x16x32_bf16 v[136:139], v[168:171], a[80:83], v[136:139]
    ds_read_b64_tr_b16 v[194:195], v251 offset:22528
    v_mfma_f32_16x16x32_bf16 v[196:199], v[168:171], a[128:131], v[196:199]
    ds_read_b64_tr_b16 v[200:201], v250 offset:4096
    v_mfma_f32_16x16x32_bf16 v[196:199], v[176:179], a[132:135], v[196:199]
    ds_read_b64_tr_b16 v[202:203], v250 offset:6144
    v_mfma_f32_16x16x32_bf16 v[204:207], v[176:179], a[180:183], v[204:207]
    ds_read_b64_tr_b16 v[208:209], v250 offset:20480
    v_mfma_f32_16x16x32_bf16 v[204:207], v[168:171], a[176:179], v[204:207]
    ds_read_b64_tr_b16 v[210:211], v250 offset:22528
    v_mfma_f32_16x16x32_bf16 v[160:163], v[220:223], a[32:35], v[160:163]
    v_mfma_f32_16x16x32_bf16 v[160:163], v[224:227], a[36:39], v[160:163]
    v_mfma_f32_16x16x32_bf16 v[128:131], v[224:227], a[84:87], v[128:131]
    v_xor_b32 v254, 32768, v255
    v_xor_b32 v253, 32800, v255
    v_mfma_f32_16x16x32_bf16 v[128:131], v[220:223], a[80:83], v[128:131]
    v_xor_b32 v252, v240, v241
    v_sub_u32 v251, 0, v252
    v_mfma_f32_16x16x32_bf16 v[212:215], v[220:223], a[128:131], v[212:215]
    v_and_b32 v250, s36, v251
    v_or_b32 v249, s35, v250
    v_mfma_f32_16x16x32_bf16 v[212:215], v[224:227], a[132:135], v[212:215]
    v_and_b32 v252, 0xc474f2f0, v250
    v_and_b32 v251, 0xc474f2f0, v249
    v_mfma_f32_16x16x32_bf16 v[216:219], v[224:227], a[180:183], v[216:219]
    v_mul_f32 v248, s31, v252
    v_mul_f32 v250, s31, v251
    v_mfma_f32_16x16x32_bf16 v[216:219], v[220:223], a[176:179], v[216:219]
    s_waitcnt vmcnt(12) lgkmcnt(0)
    s_barrier
    v_mfma_f32_16x16x32_bf16 a[224:227], v[144:147], a[32:35], a[224:227]
    ds_read_b64_tr_b16 v[168:169], v254 offset:8192
    v_mfma_f32_16x16x32_bf16 a[224:227], v[192:195], a[36:39], a[224:227]
    ds_read_b64_tr_b16 v[170:171], v254 offset:10240
    v_mfma_f32_16x16x32_bf16 a[228:231], v[192:195], a[84:87], a[228:231]
    ds_read_b64_tr_b16 v[176:177], v254 offset:24576
    v_mfma_f32_16x16x32_bf16 a[228:231], v[144:147], a[80:83], a[228:231]
    s_mov_b32 s49, 12
    ds_read_b64_tr_b16 v[178:179], v254 offset:26624
    v_mfma_f32_16x16x32_bf16 a[232:235], v[144:147], a[128:131], a[232:235]
    ds_read_b64_tr_b16 v[220:221], v253 offset:8192
    v_mfma_f32_16x16x32_bf16 a[232:235], v[192:195], a[132:135], a[232:235]
    ds_read_b64_tr_b16 v[222:223], v253 offset:10240
    v_mul_u32_u24 v249, 4370, v0
    v_mfma_f32_16x16x32_bf16 a[236:239], v[192:195], a[180:183], a[236:239]
    ds_read_b64_tr_b16 v[224:225], v253 offset:24576
    v_lshrrev_b32 v245, 16, v249
    v_mfma_f32_16x16x32_bf16 a[236:239], v[144:147], a[176:179], a[236:239]
    s_add_u32 m0, s29, 114432
    ds_read_b64_tr_b16 v[226:227], v253 offset:26624
    v_mul_u32_u24 v249, 15, v245
    v_mfma_f32_16x16x32_bf16 a[240:243], v[200:203], a[32:35], a[240:243]
    global_load_lds_dwordx4 v247, s[4:5] offset:256
    v_mfma_f32_16x16x32_bf16 a[240:243], v[208:211], a[36:39], a[240:243]
    s_add_u32 m0, s29, 118528
    v_sub_u32 v244, v0, v249
    v_lshl_add_u32 v241, v245, 4, v244
    v_mfma_f32_16x16x32_bf16 a[244:247], v[208:211], a[84:87], a[244:247]
    global_load_lds_dwordx4 v247, s[6:7] offset:256
    v_mfma_f32_16x16x32_bf16 a[244:247], v[200:203], a[80:83], a[244:247]
    s_add_u32 m0, s29, 122624
    v_xor_b32 v249, 32832, v255
    v_xor_b32 v245, 32864, v255
    v_mfma_f32_16x16x32_bf16 a[248:251], v[200:203], a[128:131], a[248:251]
    global_load_lds_dwordx4 v247, s[8:9] offset:256
    v_mfma_f32_16x16x32_bf16 a[248:251], v[208:211], a[132:135], a[248:251]
    s_add_u32 m0, s29, 126720
    v_lshlrev_b32 v244, 2, v241
    v_sub_u32 v240, 224, v0
    v_mfma_f32_16x16x32_bf16 a[252:255], v[208:211], a[180:183], a[252:255]
    global_load_lds_dwordx4 v247, s[10:11] offset:256
G_3:
    s_cbranch_vccnz G_7
    v_mfma_f32_16x16x32_bf16 a[252:255], v[200:203], a[176:179], a[252:255]
    s_waitcnt lgkmcnt(0)
    v_sub_u32 v241, 968, v244
    v_ashrrev_i32 v239, 31, v240
    v_mfma_f32_16x16x32_bf16 v[20:23], v[168:171], a[40:43], v[20:23]
    ds_read_b64_tr_b16 v[0:1], v249 offset:8192
    v_bfi_b32 v244, v239, s49, v241
    v_mfma_f32_16x16x32_bf16 v[20:23], v[176:179], a[44:47], v[20:23]
    ds_read_b64_tr_b16 v[2:3], v249 offset:10240
    s_waitcnt vmcnt(19)
    v_mfma_f32_16x16x32_bf16 v[28:31], v[176:179], a[92:95], v[28:31]
    ds_read_b64_tr_b16 v[144:145], v249 offset:24576
    v_lshlrev_b32 v241, 16, v242
    v_mfma_f32_16x16x32_bf16 v[28:31], v[168:171], a[88:91], v[28:31]
    ds_read_b64_tr_b16 v[146:147], v249 offset:26624
    v_mul_f32 v240, 0x411cc471, v241
    v_mfma_f32_16x16x32_bf16 v[36:39], v[168:171], a[136:139], v[36:39]
    ds_read_b64_tr_b16 v[192:193], v245 offset:8192
    v_and_b32 v239, 0xffff0000, v242
    v_mfma_f32_16x16x32_bf16 v[36:39], v[176:179], a[140:143], v[36:39]
    ds_read_b64_tr_b16 v[194:195], v245 offset:10240
    v_mul_f32 v241, 0x411cc471, v239
    v_mfma_f32_16x16x32_bf16 v[44:47], v[176:179], a[188:191], v[44:47]
    ds_read_b64_tr_b16 v[200:201], v245 offset:24576
    v_lshlrev_b32 v238, 16, v243
    v_mfma_f32_16x16x32_bf16 v[44:47], v[168:171], a[184:187], v[44:47]
    s_add_u32 m0, s29, 130816
    ds_read_b64_tr_b16 v[202:203], v245 offset:26624
    v_mul_f32 v239, 0x411cc471, v238
    v_mfma_f32_16x16x32_bf16 v[8:11], v[220:223], a[40:43], v[8:11]
    global_load_lds_dwordx4 v247, s[12:13] offset:256
    v_mfma_f32_16x16x32_bf16 v[8:11], v[224:227], a[44:47], v[8:11]
    v_and_b32 v238, 0xffff0000, v243
    v_mul_f32 v237, 0x411cc471, v238
    v_mfma_f32_16x16x32_bf16 v[4:7], v[224:227], a[92:95], v[4:7]
    s_add_u32 m0, s29, 134912
    ds_write_b32 v244, v240 offset:0
    v_cvt_pk_bf16_f32 v168, v20, v21
    v_mfma_f32_16x16x32_bf16 v[4:7], v[220:223], a[88:91], v[4:7]
    global_load_lds_dwordx4 v247, s[14:15] offset:256
    v_mfma_f32_16x16x32_bf16 v[52:55], v[220:223], a[136:139], v[52:55]
    s_add_u32 m0, s29, 139008
    ds_write_b32 v244, v240 offset:956
    v_cvt_pk_bf16_f32 v169, v22, v23
    v_mfma_f32_16x16x32_bf16 v[52:55], v[224:227], a[140:143], v[52:55]
    global_load_lds_dwordx4 v247, s[16:17] offset:256
    v_mfma_f32_16x16x32_bf16 v[56:59], v[224:227], a[188:191], v[56:59]
    s_add_u32 m0, s29, 143104
    ds_write_b32 v244, v240 offset:1912
    v_cvt_pk_bf16_f32 v170, v8, v9
    v_mfma_f32_16x16x32_bf16 v[56:59], v[220:223], a[184:187], v[56:59]
    global_load_lds_dwordx4 v247, s[18:19] offset:256
    s_waitcnt lgkmcnt(3)
    v_mfma_f32_16x16x32_bf16 v[16:19], v[0:3], a[40:43], v[16:19]
    ds_read_b64_tr_b16 v[20:21], v254 offset:12288
    v_cvt_pk_bf16_f32 v171, v10, v11
    v_mfma_f32_16x16x32_bf16 v[16:19], v[144:147], a[44:47], v[16:19]
    ds_read_b64_tr_b16 v[22:23], v254 offset:14336
    v_cvt_pk_bf16_f32 v176, v28, v29
    v_mfma_f32_16x16x32_bf16 v[60:63], v[144:147], a[92:95], v[60:63]
    ds_read_b64_tr_b16 v[8:9], v254 offset:28672
    v_cvt_pk_bf16_f32 v177, v30, v31
    v_mfma_f32_16x16x32_bf16 v[60:63], v[0:3], a[88:91], v[60:63]
    ds_read_b64_tr_b16 v[10:11], v254 offset:30720
    v_cvt_pk_bf16_f32 v178, v4, v5
    v_mfma_f32_16x16x32_bf16 v[68:71], v[0:3], a[136:139], v[68:71]
    ds_read_b64_tr_b16 v[28:29], v253 offset:12288
    v_cvt_pk_bf16_f32 v208, v16, v17
    v_mfma_f32_16x16x32_bf16 v[68:71], v[144:147], a[140:143], v[68:71]
    ds_read_b64_tr_b16 v[30:31], v253 offset:14336
    v_cvt_pk_bf16_f32 v209, v18, v19
    v_mfma_f32_16x16x32_bf16 v[76:79], v[144:147], a[188:191], v[76:79]
    ds_read_b64_tr_b16 v[220:221], v253 offset:28672
    v_cvt_pk_bf16_f32 v224, v60, v61
    v_mfma_f32_16x16x32_bf16 v[76:79], v[0:3], a[184:187], v[76:79]
    s_add_u32 m0, s29, 147200
    ds_read_b64_tr_b16 v[222:223], v253 offset:30720
    v_cvt_pk_bf16_f32 v225, v62, v63
    v_mfma_f32_16x16x32_bf16 v[32:35], v[192:195], a[40:43], v[32:35]
    global_load_lds_dwordx4 v247, s[20:21] offset:256
    v_mfma_f32_16x16x32_bf16 v[32:35], v[200:203], a[44:47], v[32:35]
    v_cvt_pk_bf16_f32 v179, v6, v7
    v_cvt_pk_bf16_f32 v0, v36, v37
    v_mfma_f32_16x16x32_bf16 v[24:27], v[200:203], a[92:95], v[24:27]
    s_add_u32 m0, s29, 151296
    ds_write_b32 v244, v240 offset:2868
    v_cvt_pk_bf16_f32 v1, v38, v39
    v_mfma_f32_16x16x32_bf16 v[24:27], v[192:195], a[88:91], v[24:27]
    global_load_lds_dwordx4 v247, s[22:23] offset:256
    v_mfma_f32_16x16x32_bf16 v[84:87], v[192:195], a[136:139], v[84:87]
    s_add_u32 m0, s29, 155392
    ds_write_b32 v244, v241 offset:4096
    v_cvt_pk_bf16_f32 v210, v32, v33
    v_mfma_f32_16x16x32_bf16 v[84:87], v[200:203], a[140:143], v[84:87]
    global_load_lds_dwordx4 v247, s[24:25] offset:256
    v_mfma_f32_16x16x32_bf16 v[88:91], v[200:203], a[188:191], v[88:91]
    s_add_u32 m0, s29, 159488
    ds_write_b32 v244, v241 offset:5052
    v_cvt_pk_bf16_f32 v211, v34, v35
    v_mfma_f32_16x16x32_bf16 v[88:91], v[192:195], a[184:187], v[88:91]
    global_load_lds_dwordx4 v247, s[26:27] offset:256
    s_waitcnt lgkmcnt(3)
    v_mfma_f32_16x16x32_bf16 v[48:51], v[20:23], a[40:43], v[48:51]
    ds_read_b64_tr_b16 v[4:5], v249 offset:12288
    v_cvt_pk_bf16_f32 v226, v24, v25
    v_mfma_f32_16x16x32_bf16 v[48:51], v[8:11], a[44:47], v[48:51]
    ds_read_b64_tr_b16 v[6:7], v249 offset:14336
    v_cvt_pk_bf16_f32 v227, v26, v27
    v_mfma_f32_16x16x32_bf16 v[40:43], v[8:11], a[92:95], v[40:43]
    ds_read_b64_tr_b16 v[16:17], v249 offset:28672
    v_cvt_pk_bf16_f32 v2, v52, v53
    v_mfma_f32_16x16x32_bf16 v[40:43], v[20:23], a[88:91], v[40:43]
    ds_read_b64_tr_b16 v[18:19], v249 offset:30720
    v_cvt_pk_bf16_f32 v3, v54, v55
    v_mfma_f32_16x16x32_bf16 v[100:103], v[20:23], a[136:139], v[100:103]
    ds_read_b64_tr_b16 v[24:25], v245 offset:12288
    v_cvt_pk_bf16_f32 v32, v48, v49
    v_mfma_f32_16x16x32_bf16 v[100:103], v[8:11], a[140:143], v[100:103]
    ds_read_b64_tr_b16 v[26:27], v245 offset:14336
    v_cvt_pk_bf16_f32 v33, v50, v51
    v_mfma_f32_16x16x32_bf16 v[108:111], v[8:11], a[188:191], v[108:111]
    ds_read_b64_tr_b16 v[36:37], v245 offset:28672
    v_cvt_pk_bf16_f32 v52, v40, v41
    v_mfma_f32_16x16x32_bf16 v[108:111], v[20:23], a[184:187], v[108:111]
    ds_read_b64_tr_b16 v[38:39], v245 offset:30720
    v_cvt_pk_bf16_f32 v53, v42, v43
    v_mfma_f32_16x16x32_bf16 v[64:67], v[28:31], a[40:43], v[64:67]
    v_cvt_pk_bf16_f32 v8, v68, v69
    v_cvt_pk_bf16_f32 v9, v70, v71
    v_mfma_f32_16x16x32_bf16 v[64:67], v[220:223], a[44:47], v[64:67]
    v_cvt_pk_bf16_f32 v10, v84, v85
    v_cvt_pk_bf16_f32 v11, v86, v87
    v_mfma_f32_16x16x32_bf16 v[12:15], v[220:223], a[92:95], v[12:15]
    ds_write_b32 v244, v241 offset:6008
    v_cvt_pk_bf16_f32 v20, v100, v101
    v_mfma_f32_16x16x32_bf16 v[12:15], v[28:31], a[88:91], v[12:15]
    v_cvt_pk_bf16_f32 v21, v102, v103
    v_cvt_pk_bf16_f32 v40, v108, v109
    v_mfma_f32_16x16x32_bf16 v[116:119], v[28:31], a[136:139], v[116:119]
    ds_write_b32 v244, v241 offset:6964
    v_cvt_pk_bf16_f32 v34, v64, v65
    v_mfma_f32_16x16x32_bf16 v[116:119], v[220:223], a[140:143], v[116:119]
    v_cvt_pk_bf16_f32 v35, v66, v67
    v_cvt_pk_bf16_f32 v41, v110, v111
    v_mfma_f32_16x16x32_bf16 v[120:123], v[220:223], a[188:191], v[120:123]
    ds_write_b32 v244, v239 offset:8192
    v_cvt_pk_bf16_f32 v54, v12, v13
    v_mfma_f32_16x16x32_bf16 v[120:123], v[28:31], a[184:187], v[120:123]
    s_waitcnt lgkmcnt(3)
    v_cvt_pk_bf16_f32 v55, v14, v15
    v_cvt_pk_bf16_f32 v22, v116, v117
    v_mfma_f32_16x16x32_bf16 a[192:195], v[4:7], a[40:43], a[192:195]
    ds_read_b64_tr_b16 v[28:29], v254 offset:0
    v_cvt_pk_bf16_f32 v23, v118, v119
    v_mfma_f32_16x16x32_bf16 a[192:195], v[16:19], a[44:47], a[192:195]
    ds_read_b64_tr_b16 v[30:31], v254 offset:2048
    v_cvt_pk_bf16_f32 v42, v120, v121
    v_mfma_f32_16x16x32_bf16 a[196:199], v[16:19], a[92:95], a[196:199]
    ds_read_b64_tr_b16 v[12:13], v254 offset:16384
    v_cvt_pk_bf16_f32 v43, v122, v123
    v_mfma_f32_16x16x32_bf16 a[196:199], v[4:7], a[88:91], a[196:199]
    ds_read_b64_tr_b16 v[14:15], v254 offset:18432
    v_cvt_pk_bf16_f32 v48, v76, v77
    v_mfma_f32_16x16x32_bf16 a[200:203], v[4:7], a[136:139], a[200:203]
    ds_read_b64_tr_b16 v[60:61], v253 offset:0
    v_cvt_pk_bf16_f32 v49, v78, v79
    v_mfma_f32_16x16x32_bf16 a[200:203], v[16:19], a[140:143], a[200:203]
    ds_read_b64_tr_b16 v[62:63], v253 offset:2048
    v_cvt_pk_bf16_f32 v50, v88, v89
    v_mfma_f32_16x16x32_bf16 a[204:207], v[16:19], a[188:191], a[204:207]
    ds_read_b64_tr_b16 v[64:65], v253 offset:16384
    v_cvt_pk_bf16_f32 v51, v90, v91
    v_mfma_f32_16x16x32_bf16 a[204:207], v[4:7], a[184:187], a[204:207]
    ds_read_b64_tr_b16 v[66:67], v253 offset:18432
    v_cvt_pk_bf16_f32 v16, v44, v45
    v_mfma_f32_16x16x32_bf16 a[208:211], v[24:27], a[40:43], a[208:211]
    v_cvt_pk_bf16_f32 v17, v46, v47
    v_cvt_pk_bf16_f32 v18, v56, v57
    v_mfma_f32_16x16x32_bf16 a[208:211], v[36:39], a[44:47], a[208:211]
    v_cvt_pk_bf16_f32 v19, v58, v59
    v_accvgpr_read_b32 v243, a192
    v_mfma_f32_16x16x32_bf16 a[212:215], v[36:39], a[92:95], a[212:215]
    ds_write_b32 v244, v239 offset:9148
    v_accvgpr_read_b32 v242, a193
    v_mfma_f32_16x16x32_bf16 a[212:215], v[24:27], a[88:91], a[212:215]
    v_accvgpr_read_b32 v241, a194
    v_accvgpr_read_b32 v240, a195
    v_mfma_f32_16x16x32_bf16 a[216:219], v[24:27], a[136:139], a[216:219]
    ds_write_b32 v244, v239 offset:10104
    v_accvgpr_read_b32 v238, a208
    v_mfma_f32_16x16x32_bf16 a[216:219], v[36:39], a[140:143], a[216:219]
    v_accvgpr_read_b32 v236, a209
    v_accvgpr_read_b32 v235, a210
    v_mfma_f32_16x16x32_bf16 a[220:223], v[36:39], a[188:191], a[220:223]
    ds_write_b32 v244, v239 offset:11060
    v_accvgpr_read_b32 v234, a211
    v_mfma_f32_16x16x32_bf16 a[220:223], v[24:27], a[184:187], a[220:223]
    s_waitcnt lgkmcnt(3)
    v_cvt_pk_bf16_f32 v4, v243, v242
    v_cvt_pk_bf16_f32 v5, v241, v240
    v_mfma_f32_16x16x32_bf16 v[92:95], v[28:31], a[40:43], v[92:95]
    ds_read_b64_tr_b16 v[24:25], v249 offset:0
    v_cvt_pk_bf16_f32 v6, v238, v236
    v_mfma_f32_16x16x32_bf16 v[92:95], v[12:15], a[44:47], v[92:95]
    ds_read_b64_tr_b16 v[26:27], v249 offset:2048
    v_cvt_pk_bf16_f32 v7, v235, v234
    v_mfma_f32_16x16x32_bf16 v[104:107], v[12:15], a[92:95], v[104:107]
    ds_read_b64_tr_b16 v[36:37], v249 offset:16384
    v_accvgpr_read_b32 v243, a196
    v_mfma_f32_16x16x32_bf16 v[104:107], v[28:31], a[88:91], v[104:107]
    ds_read_b64_tr_b16 v[38:39], v249 offset:18432
    v_accvgpr_read_b32 v242, a197
    v_mfma_f32_16x16x32_bf16 v[132:135], v[28:31], a[136:139], v[132:135]
    ds_read_b64_tr_b16 v[44:45], v245 offset:0
    v_cvt_pk_bf16_f32 v56, v92, v93
    v_mfma_f32_16x16x32_bf16 v[132:135], v[12:15], a[140:143], v[132:135]
    ds_read_b64_tr_b16 v[46:47], v245 offset:2048
    v_cvt_pk_bf16_f32 v57, v94, v95
    v_mfma_f32_16x16x32_bf16 v[140:143], v[12:15], a[188:191], v[140:143]
    ds_read_b64_tr_b16 v[68:69], v245 offset:16384
    v_cvt_pk_bf16_f32 v76, v104, v105
    v_mfma_f32_16x16x32_bf16 v[140:143], v[28:31], a[184:187], v[140:143]
    ds_read_b64_tr_b16 v[70:71], v245 offset:18432
    v_cvt_pk_bf16_f32 v77, v106, v107
    v_mfma_f32_16x16x32_bf16 v[72:75], v[60:63], a[40:43], v[72:75]
    v_cvt_pk_bf16_f32 v12, v132, v133
    v_cvt_pk_bf16_f32 v13, v134, v135
    v_mfma_f32_16x16x32_bf16 v[72:75], v[64:67], a[44:47], v[72:75]
    v_accvgpr_read_b32 v241, a198
    v_accvgpr_read_b32 v240, a199
    v_mfma_f32_16x16x32_bf16 v[80:83], v[64:67], a[92:95], v[80:83]
    ds_write_b32 v244, v237 offset:12288
    v_cvt_pk_bf16_f32 v28, v140, v141
    v_mfma_f32_16x16x32_bf16 v[80:83], v[60:63], a[88:91], v[80:83]
    v_cvt_pk_bf16_f32 v29, v142, v143
    v_accvgpr_read_b32 v239, a212
    v_mfma_f32_16x16x32_bf16 v[148:151], v[60:63], a[136:139], v[148:151]
    ds_write_b32 v244, v237 offset:13244
    v_cvt_pk_bf16_f32 v58, v72, v73
    v_mfma_f32_16x16x32_bf16 v[148:151], v[64:67], a[140:143], v[148:151]
    v_cvt_pk_bf16_f32 v59, v74, v75
    v_accvgpr_read_b32 v238, a213
    v_mfma_f32_16x16x32_bf16 v[152:155], v[64:67], a[188:191], v[152:155]
    ds_write_b32 v244, v237 offset:14200
    v_cvt_pk_bf16_f32 v78, v80, v81
    v_mfma_f32_16x16x32_bf16 v[152:155], v[60:63], a[184:187], v[152:155]
    s_waitcnt lgkmcnt(3)
    v_cvt_pk_bf16_f32 v79, v82, v83
    v_cvt_pk_bf16_f32 v14, v148, v149
    v_mfma_f32_16x16x32_bf16 v[156:159], v[24:27], a[40:43], v[156:159]
    ds_read_b64_tr_b16 v[60:61], v254 offset:4096
    v_cvt_pk_bf16_f32 v15, v150, v151
    v_mfma_f32_16x16x32_bf16 v[156:159], v[36:39], a[44:47], v[156:159]
    ds_read_b64_tr_b16 v[62:63], v254 offset:6144
    v_cvt_pk_bf16_f32 v30, v152, v153
    v_mfma_f32_16x16x32_bf16 v[124:127], v[36:39], a[92:95], v[124:127]
    ds_read_b64_tr_b16 v[64:65], v254 offset:20480
    v_cvt_pk_bf16_f32 v31, v154, v155
    v_mfma_f32_16x16x32_bf16 v[124:127], v[24:27], a[88:91], v[124:127]
    ds_read_b64_tr_b16 v[66:67], v254 offset:22528
    v_accvgpr_read_b32 v236, a214
    v_mfma_f32_16x16x32_bf16 v[164:167], v[24:27], a[136:139], v[164:167]
    ds_read_b64_tr_b16 v[72:73], v253 offset:4096
    v_cvt_pk_bf16_f32 v80, v156, v157
    v_mfma_f32_16x16x32_bf16 v[164:167], v[36:39], a[140:143], v[164:167]
    ds_read_b64_tr_b16 v[74:75], v253 offset:6144
    v_cvt_pk_bf16_f32 v81, v158, v159
    v_mfma_f32_16x16x32_bf16 v[172:175], v[36:39], a[188:191], v[172:175]
    ds_read_b64_tr_b16 v[84:85], v253 offset:20480
    v_cvt_pk_bf16_f32 v88, v124, v125
    v_mfma_f32_16x16x32_bf16 v[172:175], v[24:27], a[184:187], v[172:175]
    ds_read_b64_tr_b16 v[86:87], v253 offset:22528
    v_cvt_pk_bf16_f32 v89, v126, v127
    v_mfma_f32_16x16x32_bf16 v[112:115], v[44:47], a[40:43], v[112:115]
    v_cvt_pk_bf16_f32 v24, v164, v165
    v_cvt_pk_bf16_f32 v25, v166, v167
    v_mfma_f32_16x16x32_bf16 v[112:115], v[68:71], a[44:47], v[112:115]
    v_accvgpr_read_b32 v254, a215
    v_cvt_pk_bf16_f32 v36, v243, v242
    v_mfma_f32_16x16x32_bf16 v[96:99], v[68:71], a[92:95], v[96:99]
    ds_write_b32 v244, v237 offset:15156
    v_cvt_pk_bf16_f32 v92, v172, v173
    v_mfma_f32_16x16x32_bf16 v[96:99], v[44:47], a[88:91], v[96:99]
    v_cvt_pk_bf16_f32 v93, v174, v175
    v_cvt_pk_bf16_f32 v37, v241, v240
    v_mfma_f32_16x16x32_bf16 v[180:183], v[44:47], a[136:139], v[180:183]
    v_cvt_pk_bf16_f32 v82, v112, v113
    v_cvt_pk_bf16_f32 v83, v114, v115
    v_mfma_f32_16x16x32_bf16 v[180:183], v[68:71], a[140:143], v[180:183]
    v_cvt_pk_bf16_f32 v38, v239, v238
    v_cvt_pk_bf16_f32 v39, v236, v254
    v_mfma_f32_16x16x32_bf16 v[184:187], v[68:71], a[188:191], v[184:187]
    v_cvt_pk_bf16_f32 v90, v96, v97
    v_cvt_pk_bf16_f32 v91, v98, v99
    v_mfma_f32_16x16x32_bf16 v[184:187], v[44:47], a[184:187], v[184:187]
    s_waitcnt lgkmcnt(1)
    v_accvgpr_read_b32 v254, a200
    v_accvgpr_read_b32 v253, a201
    v_mfma_f32_16x16x32_bf16 v[188:191], v[60:63], a[40:43], v[188:191]
    ds_read_b64_tr_b16 v[44:45], v249 offset:4096
    v_cvt_pk_bf16_f32 v26, v180, v181
    v_mfma_f32_16x16x32_bf16 v[188:191], v[64:67], a[44:47], v[188:191]
    ds_read_b64_tr_b16 v[46:47], v249 offset:6144
    v_cvt_pk_bf16_f32 v27, v182, v183
    v_mfma_f32_16x16x32_bf16 v[136:139], v[64:67], a[92:95], v[136:139]
    ds_read_b64_tr_b16 v[68:69], v249 offset:20480
    v_cvt_pk_bf16_f32 v94, v184, v185
    v_mfma_f32_16x16x32_bf16 v[136:139], v[60:63], a[88:91], v[136:139]
    ds_read_b64_tr_b16 v[70:71], v249 offset:22528
    v_cvt_pk_bf16_f32 v95, v186, v187
    v_mfma_f32_16x16x32_bf16 v[196:199], v[60:63], a[136:139], v[196:199]
    ds_read_b64_tr_b16 v[96:97], v245 offset:4096
    v_cvt_pk_bf16_f32 v100, v188, v189
    v_mfma_f32_16x16x32_bf16 v[196:199], v[64:67], a[140:143], v[196:199]
    ds_read_b64_tr_b16 v[98:99], v245 offset:6144
    v_cvt_pk_bf16_f32 v101, v190, v191
    v_mfma_f32_16x16x32_bf16 v[204:207], v[64:67], a[188:191], v[204:207]
    ds_read_b64_tr_b16 v[104:105], v245 offset:20480
    v_cvt_pk_bf16_f32 v108, v136, v137
    v_mfma_f32_16x16x32_bf16 v[204:207], v[60:63], a[184:187], v[204:207]
    ds_read_b64_tr_b16 v[106:107], v245 offset:22528
    v_cvt_pk_bf16_f32 v109, v138, v139
    v_mfma_f32_16x16x32_bf16 v[160:163], v[72:75], a[40:43], v[160:163]
    v_cvt_pk_bf16_f32 v60, v196, v197
    v_cvt_pk_bf16_f32 v61, v198, v199
    v_mfma_f32_16x16x32_bf16 v[160:163], v[84:87], a[44:47], v[160:163]
    v_accvgpr_read_b32 v249, a202
    v_accvgpr_read_b32 v245, a203
    v_mfma_f32_16x16x32_bf16 v[128:131], v[84:87], a[92:95], v[128:131]
    v_xor_b32 v244, 65536, v255
    v_cvt_pk_bf16_f32 v64, v204, v205
    v_mfma_f32_16x16x32_bf16 v[128:131], v[72:75], a[88:91], v[128:131]
    v_cvt_pk_bf16_f32 v65, v206, v207
    v_accvgpr_read_b32 v243, a216
    v_mfma_f32_16x16x32_bf16 v[212:215], v[72:75], a[136:139], v[212:215]
    v_cvt_pk_bf16_f32 v102, v160, v161
    v_cvt_pk_bf16_f32 v103, v162, v163
    v_mfma_f32_16x16x32_bf16 v[212:215], v[84:87], a[140:143], v[212:215]
    v_accvgpr_read_b32 v242, a217
    v_accvgpr_read_b32 v241, a218
    v_mfma_f32_16x16x32_bf16 v[216:219], v[84:87], a[188:191], v[216:219]
    v_cvt_pk_bf16_f32 v110, v128, v129
    v_cvt_pk_bf16_f32 v111, v130, v131
    v_mfma_f32_16x16x32_bf16 v[216:219], v[72:75], a[184:187], v[216:219]
    s_waitcnt vmcnt(12) lgkmcnt(0)
    s_barrier
    v_cvt_pk_bf16_f32 v62, v212, v213
    v_mfma_f32_16x16x32_bf16 a[224:227], v[44:47], a[40:43], a[224:227]
    ds_read_b64_tr_b16 v[72:73], v244 offset:0
    v_cvt_pk_bf16_f32 v63, v214, v215
    v_mfma_f32_16x16x32_bf16 a[224:227], v[68:71], a[44:47], a[224:227]
    ds_read_b64_tr_b16 v[74:75], v244 offset:2048
    v_cvt_pk_bf16_f32 v66, v216, v217
    v_mfma_f32_16x16x32_bf16 a[228:231], v[68:71], a[92:95], a[228:231]
    ds_read_b64_tr_b16 v[84:85], v244 offset:4096
    v_cvt_pk_bf16_f32 v67, v218, v219
    v_mfma_f32_16x16x32_bf16 a[228:231], v[44:47], a[88:91], a[228:231]
    ds_read_b64_tr_b16 v[86:87], v244 offset:6144
    v_accvgpr_read_b32 v240, a219
    v_mfma_f32_16x16x32_bf16 a[232:235], v[44:47], a[136:139], a[232:235]
    ds_read_b64_tr_b16 v[112:113], v244 offset:8192
    v_accvgpr_read_b32 v239, a224
    v_mfma_f32_16x16x32_bf16 a[232:235], v[68:71], a[140:143], a[232:235]
    ds_read_b64_tr_b16 v[114:115], v244 offset:10240
    v_accvgpr_read_b32 v238, a225
    v_mfma_f32_16x16x32_bf16 a[236:239], v[68:71], a[188:191], a[236:239]
    ds_read_b64_tr_b16 v[116:117], v244 offset:12288
    v_accvgpr_read_b32 v237, a226
    v_mfma_f32_16x16x32_bf16 a[236:239], v[44:47], a[184:187], a[236:239]
    s_add_u32 m0, s29, 15232
    ds_read_b64_tr_b16 v[118:119], v244 offset:14336
    v_accvgpr_read_b32 v236, a227
    v_mfma_f32_16x16x32_bf16 a[240:243], v[96:99], a[40:43], a[240:243]
    global_load_lds_dwordx4 v247, s[4:5] offset:1152
    v_mfma_f32_16x16x32_bf16 a[240:243], v[104:107], a[44:47], a[240:243]
    s_add_u32 m0, s29, 19328
    ds_read_b128 v[44:47], v246 offset:384
    v_cvt_pk_bf16_f32 v68, v239, v238
    v_mfma_f32_16x16x32_bf16 a[244:247], v[104:107], a[92:95], a[244:247]
    global_load_lds_dwordx4 v247, s[6:7] offset:1152
    v_mfma_f32_16x16x32_bf16 a[244:247], v[96:99], a[88:91], a[244:247]
    s_add_u32 m0, s29, 23424
    ds_read_b128 v[120:123], v246 offset:512
    v_accvgpr_read_b32 v239, a240
    v_mfma_f32_16x16x32_bf16 a[248:251], v[96:99], a[136:139], a[248:251]
    global_load_lds_dwordx4 v247, s[8:9] offset:1152
    v_mfma_f32_16x16x32_bf16 a[248:251], v[104:107], a[140:143], a[248:251]
    s_add_u32 m0, s29, 27520
    ds_read_b128 v[124:127], v246 offset:640
    v_accvgpr_read_b32 v238, a241
    v_mfma_f32_16x16x32_bf16 a[252:255], v[104:107], a[188:191], a[252:255]
    global_load_lds_dwordx4 v247, s[10:11] offset:1152
    v_mfma_f32_16x16x32_bf16 a[252:255], v[96:99], a[184:187], a[252:255]
    ds_read_b128 v[128:131], v246 offset:768
    s_waitcnt lgkmcnt(4)
    v_mfma_f32_16x16x32_bf16 v[104:107], v[72:75], a[0:3], 0
    ds_read_b64_tr_b16 v[96:97], v244 offset:16384
    v_accvgpr_read_b32 v235, a242
    v_mfma_f32_16x16x32_bf16 v[104:107], v[84:87], a[4:7], v[104:107]
    ds_read_b64_tr_b16 v[98:99], v244 offset:18432
    v_accvgpr_read_b32 v234, a243
    v_mfma_f32_16x16x32_bf16 v[104:107], v[112:115], a[8:11], v[104:107]
    ds_read_b64_tr_b16 v[132:133], v244 offset:20480
    v_cvt_pk_bf16_f32 v69, v237, v236
    v_mfma_f32_16x16x32_bf16 v[104:107], v[116:119], a[12:15], v[104:107]
    ds_read_b64_tr_b16 v[134:135], v244 offset:22528
    v_cvt_pk_bf16_f32 v70, v239, v238
    v_mfma_f32_16x16x32_bf16 v[136:139], v[116:119], a[60:63], 0
    ds_read_b64_tr_b16 v[140:141], v244 offset:24576
    v_cvt_pk_bf16_f32 v71, v235, v234
    v_mfma_f32_16x16x32_bf16 v[136:139], v[112:115], a[56:59], v[136:139]
    ds_read_b64_tr_b16 v[142:143], v244 offset:26624
    v_cvt_pk_bf16_f32 v144, v254, v253
    v_mfma_f32_16x16x32_bf16 v[136:139], v[84:87], a[52:55], v[136:139]
    ds_read_b64_tr_b16 v[148:149], v244 offset:28672
    v_cvt_pk_bf16_f32 v145, v249, v245
    v_mfma_f32_16x16x32_bf16 v[136:139], v[72:75], a[48:51], v[136:139]
    s_add_u32 m0, s29, 31616
    ds_read_b64_tr_b16 v[150:151], v244 offset:30720
    v_cvt_pk_bf16_f32 v146, v243, v242
    v_mfma_f32_16x16x32_bf16 v[152:155], v[72:75], a[96:99], 0
    global_load_lds_dwordx4 v247, s[12:13] offset:1152
    v_mfma_f32_16x16x32_bf16 v[152:155], v[84:87], a[100:103], v[152:155]
    ds_read_b128 v[156:159], v246 offset:256
    v_cvt_pk_bf16_f32 v147, v241, v240
    v_mfma_f32_16x16x32_bf16 v[152:155], v[112:115], a[104:107], v[152:155]
    ds_read_b128 v[160:163], v246 offset:384
    v_accvgpr_read_b32 v254, a204
    v_mfma_f32_16x16x32_bf16 v[152:155], v[116:119], a[108:111], v[152:155]
    ds_read_b128 v[164:167], v246 offset:512
    v_accvgpr_read_b32 v253, a205
    v_mfma_f32_16x16x32_bf16 v[172:175], v[116:119], a[156:159], 0
    ds_read_b128 v[180:183], v246 offset:640
    v_accvgpr_read_b32 v249, a206
    v_mfma_f32_16x16x32_bf16 v[172:175], v[112:115], a[152:155], v[172:175]
    v_accvgpr_read_b32 v245, a207
    v_accvgpr_read_b32 v243, a220
    v_mfma_f32_16x16x32_bf16 v[172:175], v[84:87], a[148:151], v[172:175]
    v_accvgpr_read_b32 v242, a221
    v_accvgpr_read_b32 v241, a222
    v_mfma_f32_16x16x32_bf16 v[172:175], v[72:75], a[144:147], v[172:175]
    s_waitcnt lgkmcnt(12)
    v_accvgpr_read_b32 v240, a223
    v_cvt_pk_bf16_f32 v84, v254, v253
    v_mfma_f32_16x16x32_bf16 v[44:47], v[168:171], v[56:59], v[44:47]
    v_cvt_pk_bf16_f32 v85, v249, v245
    v_cvt_pk_bf16_f32 v86, v243, v242
    v_mfma_f32_16x16x32_bf16 v[44:47], v[208:211], v[80:83], v[44:47]
    v_cvt_pk_bf16_f32 v87, v241, v240
    v_accvgpr_read_b32 v254, a228
    v_mfma_f32_16x16x32_bf16 v[44:47], v[32:35], v[100:103], v[44:47]
    v_accvgpr_read_b32 v253, a229
    v_accvgpr_read_b32 v249, a230
    v_mfma_f32_16x16x32_bf16 v[120:123], v[52:55], v[100:103], v[120:123]
    v_accvgpr_read_b32 v245, a231
    v_accvgpr_read_b32 v243, a244
    v_mfma_f32_16x16x32_bf16 v[120:123], v[224:227], v[80:83], v[120:123]
    v_accvgpr_read_b32 v242, a245
    v_accvgpr_read_b32 v241, a246
    v_mfma_f32_16x16x32_bf16 v[120:123], v[176:179], v[56:59], v[120:123]
    v_accvgpr_read_b32 v240, a247
    v_cvt_pk_bf16_f32 v72, v254, v253
    v_mfma_f32_16x16x32_bf16 v[124:127], v[0:3], v[56:59], v[124:127]
    v_cvt_pk_bf16_f32 v73, v249, v245
    v_cvt_pk_bf16_f32 v74, v243, v242
    v_mfma_f32_16x16x32_bf16 v[124:127], v[8:11], v[80:83], v[124:127]
    v_cvt_pk_bf16_f32 v75, v241, v240
    v_accvgpr_read_b32 v254, a232
    v_mfma_f32_16x16x32_bf16 v[124:127], v[20:23], v[100:103], v[124:127]
    v_accvgpr_read_b32 v253, a233
    v_accvgpr_read_b32 v249, a234
    v_mfma_f32_16x16x32_bf16 v[128:131], v[40:43], v[100:103], v[128:131]
    v_accvgpr_read_b32 v245, a235
    v_accvgpr_read_b32 v243, a248
    v_mfma_f32_16x16x32_bf16 v[128:131], v[48:51], v[80:83], v[128:131]
    v_accvgpr_read_b32 v242, a249
    v_accvgpr_read_b32 v241, a250
    v_mfma_f32_16x16x32_bf16 v[128:131], v[16:19], v[56:59], v[128:131]
    s_waitcnt lgkmcnt(4)
    v_accvgpr_read_b32 v240, a251
    v_cvt_pk_bf16_f32 v80, v254, v253
    v_mfma_f32_16x16x32_bf16 v[172:175], v[96:99], a[160:163], v[172:175]
    ds_read_b64_tr_b16 v[56:57], v244 offset:32768
    v_cvt_pk_bf16_f32 v81, v249, v245
    v_mfma_f32_16x16x32_bf16 v[172:175], v[132:135], a[164:167], v[172:175]
    ds_read_b64_tr_b16 v[58:59], v244 offset:34816
    v_cvt_pk_bf16_f32 v82, v243, v242
    v_mfma_f32_16x16x32_bf16 v[172:175], v[140:143], a[168:171], v[172:175]
    ds_read_b64_tr_b16 v[100:101], v244 offset:36864
    v_cvt_pk_bf16_f32 v83, v241, v240
    v_mfma_f32_16x16x32_bf16 v[172:175], v[148:151], a[172:175], v[172:175]
    ds_read_b64_tr_b16 v[102:103], v244 offset:38912
    v_accvgpr_read_b32 v254, a236
    v_mfma_f32_16x16x32_bf16 v[152:155], v[148:151], a[124:127], v[152:155]
    ds_read_b64_tr_b16 v[112:113], v244 offset:40960
    v_accvgpr_read_b32 v253, a237
    v_mfma_f32_16x16x32_bf16 v[152:155], v[140:143], a[120:123], v[152:155]
    ds_read_b64_tr_b16 v[114:115], v244 offset:43008
    v_accvgpr_read_b32 v249, a238
    v_mfma_f32_16x16x32_bf16 v[152:155], v[132:135], a[116:119], v[152:155]
    ds_read_b64_tr_b16 v[116:117], v244 offset:45056
    v_accvgpr_read_b32 v245, a239
    v_mfma_f32_16x16x32_bf16 v[152:155], v[96:99], a[112:115], v[152:155]
    s_add_u32 m0, s29, 35712
    ds_read_b64_tr_b16 v[118:119], v244 offset:47104
    v_accvgpr_read_b32 v243, a252
    v_mfma_f32_16x16x32_bf16 v[136:139], v[96:99], a[64:67], v[136:139]
    global_load_lds_dwordx4 v247, s[14:15] offset:1152
    v_mfma_f32_16x16x32_bf16 v[136:139], v[132:135], a[68:71], v[136:139]
    ds_read_b128 v[184:187], v246 offset:128
    v_accvgpr_read_b32 v244, a253
    v_mfma_f32_16x16x32_bf16 v[136:139], v[140:143], a[72:75], v[136:139]
    ds_read_b128 v[188:191], v246 offset:256
    v_accvgpr_read_b32 v242, a254
    v_mfma_f32_16x16x32_bf16 v[136:139], v[148:151], a[76:79], v[136:139]
    ds_read_b128 v[192:195], v246 offset:384
    v_accvgpr_read_b32 v241, a255
    v_mfma_f32_16x16x32_bf16 v[104:107], v[148:151], a[28:31], v[104:107]
    ds_read_b128 v[196:199], v246 offset:512
    v_cvt_pk_bf16_f32 v200, v254, v253
G_4:
    s_cbranch_vccnz G_8
    v_mfma_f32_16x16x32_bf16 v[104:107], v[140:143], a[24:27], v[104:107]
    v_cvt_pk_bf16_f32 v201, v249, v245
    v_cvt_pk_bf16_f32 v202, v243, v244
    v_mfma_f32_16x16x32_bf16 v[104:107], v[132:135], a[20:23], v[104:107]
    v_cvt_pk_bf16_f32 v203, v242, v241
    v_max3_f32 v254, v44, v45, v46
    v_mfma_f32_16x16x32_bf16 v[104:107], v[96:99], a[16:19], v[104:107]
    s_waitcnt lgkmcnt(12)
    v_max3_f32 v253, v124, v125, v126
    v_max3_f32 v254, v254, v47, v120
    v_mfma_f32_16x16x32_bf16 v[156:159], v[168:171], v[76:79], v[156:159]
    v_max3_f32 v253, v253, v127, v128
    v_max3_f32 v254, v254, v121, v122
    v_mfma_f32_16x16x32_bf16 v[156:159], v[208:211], v[88:91], v[156:159]
    v_max3_f32 v253, v253, v129, v130
    v_max_f32 v254, v254, v123
    v_mfma_f32_16x16x32_bf16 v[156:159], v[32:35], v[108:111], v[156:159]
    v_max_f32 v253, v253, v131
    v_add_f32 v254, v254, v252
    v_mfma_f32_16x16x32_bf16 v[160:163], v[52:55], v[108:111], v[160:163]
    v_add_f32 v253, v253, v251
    v_max_f32 v249, v254, v253
    v_mfma_f32_16x16x32_bf16 v[160:163], v[224:227], v[88:91], v[160:163]
    v_mfma_f32_16x16x32_bf16 v[160:163], v[176:179], v[76:79], v[160:163]
    v_mfma_f32_16x16x32_bf16 v[164:167], v[0:3], v[76:79], v[164:167]
    v_xor_b32 v254, 65568, v255
    v_max3_f32 v253, v156, v157, v158
    v_mfma_f32_16x16x32_bf16 v[164:167], v[8:11], v[88:91], v[164:167]
    v_mfma_f32_16x16x32_bf16 v[164:167], v[20:23], v[108:111], v[164:167]
    v_mfma_f32_16x16x32_bf16 v[180:183], v[40:43], v[108:111], v[180:183]
    v_mfma_f32_16x16x32_bf16 v[180:183], v[48:51], v[88:91], v[180:183]
    v_mfma_f32_16x16x32_bf16 v[180:183], v[16:19], v[76:79], v[180:183]
    s_waitcnt lgkmcnt(4)
    v_max3_f32 v253, v253, v159, v160
    v_max3_f32 v253, v253, v161, v162
    v_mfma_f32_16x16x32_bf16 v[104:107], v[56:59], a[32:35], v[104:107]
    ds_read_b64_tr_b16 v[76:77], v254 offset:0
    v_max3_f32 v245, v164, v165, v166
    v_mfma_f32_16x16x32_bf16 v[104:107], v[100:103], a[36:39], v[104:107]
    ds_read_b64_tr_b16 v[78:79], v254 offset:2048
    v_max3_f32 v245, v245, v167, v180
    v_mfma_f32_16x16x32_bf16 v[104:107], v[112:115], a[40:43], v[104:107]
    ds_read_b64_tr_b16 v[88:89], v254 offset:4096
    v_max3_f32 v245, v245, v181, v182
    v_mfma_f32_16x16x32_bf16 v[104:107], v[116:119], a[44:47], v[104:107]
    ds_read_b64_tr_b16 v[90:91], v254 offset:6144
    v_max_f32 v253, v253, v163
    v_mfma_f32_16x16x32_bf16 v[136:139], v[116:119], a[92:95], v[136:139]
    ds_read_b64_tr_b16 v[96:97], v254 offset:8192
    v_max_f32 v245, v245, v183
    v_mfma_f32_16x16x32_bf16 v[136:139], v[112:115], a[88:91], v[136:139]
    ds_read_b64_tr_b16 v[98:99], v254 offset:10240
    v_add_f32 v253, v253, v252
    v_mfma_f32_16x16x32_bf16 v[136:139], v[100:103], a[84:87], v[136:139]
    ds_read_b64_tr_b16 v[108:109], v254 offset:12288
    v_cvt_pk_bf16_f32 v132, v104, v105
    v_mfma_f32_16x16x32_bf16 v[136:139], v[56:59], a[80:83], v[136:139]
    s_add_u32 m0, s29, 39808
    ds_read_b64_tr_b16 v[110:111], v254 offset:14336
    v_cvt_pk_bf16_f32 v133, v106, v107
    v_mfma_f32_16x16x32_bf16 v[152:155], v[56:59], a[128:131], v[152:155]
    global_load_lds_dwordx4 v247, s[16:17] offset:1152
    v_mfma_f32_16x16x32_bf16 v[152:155], v[100:103], a[132:135], v[152:155]
    ds_read_b128 v[104:107], v246 offset:0
    v_add_f32 v245, v245, v251
    v_mfma_f32_16x16x32_bf16 v[152:155], v[112:115], a[136:139], v[152:155]
    ds_read_b128 v[140:143], v246 offset:128
    v_cvt_pk_bf16_f32 v148, v136, v137
    v_mfma_f32_16x16x32_bf16 v[152:155], v[116:119], a[140:143], v[152:155]
    ds_read_b128 v[204:207], v246 offset:256
    v_cvt_pk_bf16_f32 v149, v138, v139
    v_mfma_f32_16x16x32_bf16 v[172:175], v[116:119], a[188:191], v[172:175]
    ds_read_b128 v[212:215], v246 offset:384
    v_max_f32 v244, v253, v245
    v_mfma_f32_16x16x32_bf16 v[172:175], v[112:115], a[184:187], v[172:175]
    v_mfma_f32_16x16x32_bf16 v[172:175], v[100:103], a[180:183], v[172:175]
    v_permlane32_swap_b32 v249, v244
    v_mfma_f32_16x16x32_bf16 v[172:175], v[56:59], a[176:179], v[172:175]
    s_waitcnt lgkmcnt(12)
    v_cvt_pk_bf16_f32 v100, v152, v153
    v_cvt_pk_bf16_f32 v101, v154, v155
    v_mfma_f32_16x16x32_bf16 v[184:187], v[168:171], v[12:15], v[184:187]
    v_max_f32 v253, v249, v244
    v_mfma_f32_16x16x32_bf16 v[184:187], v[208:211], v[24:27], v[184:187]
    v_mfma_f32_16x16x32_bf16 v[184:187], v[32:35], v[60:63], v[184:187]
    v_mfma_f32_16x16x32_bf16 v[188:191], v[52:55], v[60:63], v[188:191]
    v_cvt_pk_bf16_f32 v56, v172, v173
    v_cvt_pk_bf16_f32 v57, v174, v175
    v_mfma_f32_16x16x32_bf16 v[188:191], v[224:227], v[24:27], v[188:191]
    v_mfma_f32_16x16x32_bf16 v[188:191], v[176:179], v[12:15], v[188:191]
    v_mfma_f32_16x16x32_bf16 v[192:195], v[0:3], v[12:15], v[192:195]
    v_mfma_f32_16x16x32_bf16 v[192:195], v[8:11], v[24:27], v[192:195]
    v_mfma_f32_16x16x32_bf16 v[192:195], v[20:23], v[60:63], v[192:195]
    v_max3_f32 v249, v184, v185, v186
    v_mfma_f32_16x16x32_bf16 v[196:199], v[40:43], v[60:63], v[196:199]
    v_mfma_f32_16x16x32_bf16 v[196:199], v[48:51], v[24:27], v[196:199]
    v_mfma_f32_16x16x32_bf16 v[196:199], v[16:19], v[12:15], v[196:199]
    s_waitcnt lgkmcnt(4)
    v_max3_f32 v249, v249, v187, v188
    v_max3_f32 v249, v249, v189, v190
    v_mfma_f32_16x16x32_bf16 v[12:15], v[76:79], a[0:3], 0
    ds_read_b64_tr_b16 v[24:25], v254 offset:16384
    v_max3_f32 v245, v192, v193, v194
    v_mfma_f32_16x16x32_bf16 v[12:15], v[88:91], a[4:7], v[12:15]
    ds_read_b64_tr_b16 v[26:27], v254 offset:18432
    v_max3_f32 v245, v245, v195, v196
    v_mfma_f32_16x16x32_bf16 v[12:15], v[96:99], a[8:11], v[12:15]
    ds_read_b64_tr_b16 v[60:61], v254 offset:20480
    v_max3_f32 v245, v245, v197, v198
    v_mfma_f32_16x16x32_bf16 v[12:15], v[108:111], a[12:15], v[12:15]
    ds_read_b64_tr_b16 v[62:63], v254 offset:22528
    v_max_f32 v245, v245, v199
    v_mfma_f32_16x16x32_bf16 v[112:115], v[108:111], a[60:63], 0
    ds_read_b64_tr_b16 v[116:117], v254 offset:24576
    v_max_f32 v249, v249, v191
    v_mfma_f32_16x16x32_bf16 v[112:115], v[96:99], a[56:59], v[112:115]
    ds_read_b64_tr_b16 v[118:119], v254 offset:26624
    v_add_f32 v245, v245, v252
    v_mfma_f32_16x16x32_bf16 v[112:115], v[88:91], a[52:55], v[112:115]
    ds_read_b64_tr_b16 v[136:137], v254 offset:28672
    v_add_f32 v249, v249, v251
    v_mfma_f32_16x16x32_bf16 v[112:115], v[76:79], a[48:51], v[112:115]
    s_add_u32 m0, s29, 43904
    ds_read_b64_tr_b16 v[138:139], v254 offset:30720
    v_max_f32 v244, v245, v249
    v_mfma_f32_16x16x32_bf16 v[152:155], v[76:79], a[96:99], 0
    global_load_lds_dwordx4 v247, s[18:19] offset:1152
    v_mfma_f32_16x16x32_bf16 v[152:155], v[88:91], a[100:103], v[152:155]
    v_mfma_f32_16x16x32_bf16 v[152:155], v[96:99], a[104:107], v[152:155]
    v_mfma_f32_16x16x32_bf16 v[152:155], v[108:111], a[108:111], v[152:155]
    v_mfma_f32_16x16x32_bf16 v[172:175], v[108:111], a[156:159], 0
    v_mfma_f32_16x16x32_bf16 v[172:175], v[96:99], a[152:155], v[172:175]
    v_mfma_f32_16x16x32_bf16 v[172:175], v[88:91], a[148:151], v[172:175]
    v_mfma_f32_16x16x32_bf16 v[172:175], v[76:79], a[144:147], v[172:175]
    s_waitcnt lgkmcnt(8)
    v_mfma_f32_16x16x32_bf16 v[104:107], v[168:171], v[28:31], v[104:107]
    v_mfma_f32_16x16x32_bf16 v[104:107], v[208:211], v[92:95], v[104:107]
    v_mfma_f32_16x16x32_bf16 v[104:107], v[32:35], v[64:67], v[104:107]
    v_mfma_f32_16x16x32_bf16 v[140:143], v[52:55], v[64:67], v[140:143]
    v_mfma_f32_16x16x32_bf16 v[140:143], v[224:227], v[92:95], v[140:143]
    v_mfma_f32_16x16x32_bf16 v[140:143], v[176:179], v[28:31], v[140:143]
    v_mfma_f32_16x16x32_bf16 v[204:207], v[0:3], v[28:31], v[204:207]
    v_mfma_f32_16x16x32_bf16 v[204:207], v[8:11], v[92:95], v[204:207]
    v_mfma_f32_16x16x32_bf16 v[204:207], v[20:23], v[64:67], v[204:207]
    v_mfma_f32_16x16x32_bf16 v[212:215], v[40:43], v[64:67], v[212:215]
    v_mfma_f32_16x16x32_bf16 v[212:215], v[48:51], v[92:95], v[212:215]
    v_max3_f32 v249, v104, v105, v106
    v_mfma_f32_16x16x32_bf16 v[212:215], v[16:19], v[28:31], v[212:215]
    s_waitcnt lgkmcnt(0)
    v_max3_f32 v249, v249, v107, v140
    v_max3_f32 v249, v249, v141, v142
    v_mfma_f32_16x16x32_bf16 v[172:175], v[24:27], a[160:163], v[172:175]
    ds_read_b64_tr_b16 v[0:1], v254 offset:32768
    v_max3_f32 v245, v204, v205, v206
    v_mfma_f32_16x16x32_bf16 v[172:175], v[60:63], a[164:167], v[172:175]
    ds_read_b64_tr_b16 v[2:3], v254 offset:34816
    v_max3_f32 v245, v245, v207, v212
    v_mfma_f32_16x16x32_bf16 v[172:175], v[116:119], a[168:171], v[172:175]
    ds_read_b64_tr_b16 v[8:9], v254 offset:36864
    v_max3_f32 v245, v245, v213, v214
    v_mfma_f32_16x16x32_bf16 v[172:175], v[136:139], a[172:175], v[172:175]
    ds_read_b64_tr_b16 v[10:11], v254 offset:38912
    v_max_f32 v245, v245, v215
    v_mfma_f32_16x16x32_bf16 v[152:155], v[136:139], a[124:127], v[152:155]
    ds_read_b64_tr_b16 v[16:17], v254 offset:40960
    v_max_f32 v249, v249, v143
    v_mfma_f32_16x16x32_bf16 v[152:155], v[116:119], a[120:123], v[152:155]
    ds_read_b64_tr_b16 v[18:19], v254 offset:43008
    v_add_f32 v245, v245, v252
    v_mfma_f32_16x16x32_bf16 v[152:155], v[60:63], a[116:119], v[152:155]
    ds_read_b64_tr_b16 v[20:21], v254 offset:45056
    v_add_f32 v249, v249, v251
    v_mfma_f32_16x16x32_bf16 v[152:155], v[24:27], a[112:115], v[152:155]
    s_add_u32 m0, s29, 48000
    ds_read_b64_tr_b16 v[22:23], v254 offset:47104
    v_max_f32 v243, v245, v249
    v_mfma_f32_16x16x32_bf16 v[112:115], v[24:27], a[64:67], v[112:115]
    global_load_lds_dwordx4 v247, s[20:21] offset:1152
    v_mfma_f32_16x16x32_bf16 v[112:115], v[60:63], a[68:71], v[112:115]
    v_permlane32_swap_b32 v244, v243
    v_mfma_f32_16x16x32_bf16 v[112:115], v[116:119], a[72:75], v[112:115]
    v_xor_b32 v254, 65600, v255
    v_max_f32 v249, v244, v243
    v_mfma_f32_16x16x32_bf16 v[112:115], v[136:139], a[76:79], v[112:115]
    v_mfma_f32_16x16x32_bf16 v[12:15], v[136:139], a[28:31], v[12:15]
    v_permlane16_swap_b32 v253, v249
    v_mfma_f32_16x16x32_bf16 v[12:15], v[116:119], a[24:27], v[12:15]
    v_max_f32 v245, v253, v249
    v_mov_b32 v244, v245
    v_mfma_f32_16x16x32_bf16 v[12:15], v[60:63], a[20:23], v[12:15]
    v_mfma_f32_16x16x32_bf16 v[12:15], v[24:27], a[16:19], v[12:15]
    s_waitcnt lgkmcnt(0)
    v_permlane32_swap_b32 v245, v244
    v_mfma_f32_16x16x32_bf16 v[12:15], v[0:3], a[32:35], v[12:15]
    ds_read_b64_tr_b16 v[24:25], v254 offset:0
    v_mov_b32 v253, v245
    v_mfma_f32_16x16x32_bf16 v[12:15], v[8:11], a[36:39], v[12:15]
    ds_read_b64_tr_b16 v[26:27], v254 offset:2048
    v_mov_b32 v249, v244
    v_mfma_f32_16x16x32_bf16 v[12:15], v[16:19], a[40:43], v[12:15]
    ds_read_b64_tr_b16 v[28:29], v254 offset:4096
    v_mfma_f32_16x16x32_bf16 v[12:15], v[20:23], a[44:47], v[12:15]
    ds_read_b64_tr_b16 v[30:31], v254 offset:6144
    v_mfma_f32_16x16x32_bf16 v[112:115], v[20:23], a[92:95], v[112:115]
    ds_read_b64_tr_b16 v[32:33], v254 offset:8192
    v_mfma_f32_16x16x32_bf16 v[112:115], v[16:19], a[88:91], v[112:115]
    ds_read_b64_tr_b16 v[34:35], v254 offset:10240
    v_mfma_f32_16x16x32_bf16 v[112:115], v[8:11], a[84:87], v[112:115]
    ds_read_b64_tr_b16 v[40:41], v254 offset:12288
    v_mfma_f32_16x16x32_bf16 v[112:115], v[0:3], a[80:83], v[112:115]
    s_add_u32 m0, s29, 52096
    ds_read_b64_tr_b16 v[42:43], v254 offset:14336
    v_cvt_pk_bf16_f32 v134, v12, v13
    v_mfma_f32_16x16x32_bf16 v[152:155], v[0:3], a[128:131], v[152:155]
    global_load_lds_dwordx4 v247, s[22:23] offset:1152
    v_mfma_f32_16x16x32_bf16 v[152:155], v[8:11], a[132:135], v[152:155]
    v_cvt_pk_bf16_f32 v135, v14, v15
    v_mfma_f32_16x16x32_bf16 v[152:155], v[16:19], a[136:139], v[152:155]
    v_cvt_pk_bf16_f32 v150, v112, v113
    v_cvt_pk_bf16_f32 v151, v114, v115
    v_mfma_f32_16x16x32_bf16 v[152:155], v[20:23], a[140:143], v[152:155]
    v_permlane16_swap_b32 v245, v253
    v_mfma_f32_16x16x32_bf16 v[172:175], v[20:23], a[188:191], v[172:175]
    v_permlane16_swap_b32 v244, v249
    v_mfma_f32_16x16x32_bf16 v[172:175], v[16:19], a[184:187], v[172:175]
    v_fma_f32 v243, v245, s32, v248
    v_fma_f32 v242, v244, s32, v248
    v_mfma_f32_16x16x32_bf16 v[172:175], v[8:11], a[180:183], v[172:175]
    v_fma_f32 v241, v253, s32, v250
    v_fma_f32 v240, v249, s32, v250
    v_mfma_f32_16x16x32_bf16 v[172:175], v[0:3], a[176:179], v[172:175]
    s_waitcnt lgkmcnt(0)
    v_cvt_pk_bf16_f32 v102, v152, v153
    v_cvt_pk_bf16_f32 v103, v154, v155
    v_mfma_f32_16x16x32_bf16 v[0:3], v[24:27], a[0:3], 0
    ds_read_b64_tr_b16 v[8:9], v254 offset:16384
    v_fma_f32 v44, v44, s31, v243
    v_mfma_f32_16x16x32_bf16 v[0:3], v[28:31], a[4:7], v[0:3]
    ds_read_b64_tr_b16 v[10:11], v254 offset:18432
    v_cvt_pk_bf16_f32 v58, v172, v173
    v_mfma_f32_16x16x32_bf16 v[0:3], v[32:35], a[8:11], v[0:3]
    ds_read_b64_tr_b16 v[12:13], v254 offset:20480
    v_cvt_pk_bf16_f32 v59, v174, v175
    v_mfma_f32_16x16x32_bf16 v[0:3], v[40:43], a[12:15], v[0:3]
    ds_read_b64_tr_b16 v[14:15], v254 offset:22528
    v_fma_f32 v45, v45, s31, v243
    v_mfma_f32_16x16x32_bf16 v[16:19], v[40:43], a[60:63], 0
    ds_read_b64_tr_b16 v[20:21], v254 offset:24576
    v_fma_f32 v156, v156, s31, v242
    v_mfma_f32_16x16x32_bf16 v[16:19], v[32:35], a[56:59], v[16:19]
    ds_read_b64_tr_b16 v[22:23], v254 offset:26624
    v_fma_f32 v157, v157, s31, v242
    v_mfma_f32_16x16x32_bf16 v[16:19], v[28:31], a[52:55], v[16:19]
    ds_read_b64_tr_b16 v[48:49], v254 offset:28672
    v_fma_f32 v184, v184, s31, v241
    v_mfma_f32_16x16x32_bf16 v[16:19], v[24:27], a[48:51], v[16:19]
    s_add_u32 m0, s29, 56192
    ds_read_b64_tr_b16 v[50:51], v254 offset:30720
    v_fma_f32 v185, v185, s31, v241
    v_mfma_f32_16x16x32_bf16 v[52:55], v[24:27], a[96:99], 0
    global_load_lds_dwordx4 v247, s[24:25] offset:1152
    v_mfma_f32_16x16x32_bf16 v[52:55], v[28:31], a[100:103], v[52:55]
    v_fma_f32 v104, v104, s31, v240
    v_fma_f32 v105, v105, s31, v240
    v_mfma_f32_16x16x32_bf16 v[52:55], v[32:35], a[104:107], v[52:55]
    v_exp_f32 v44, v44
    v_mfma_f32_16x16x32_bf16 v[52:55], v[40:43], a[108:111], v[52:55]
    v_exp_f32 v45, v45
    v_mfma_f32_16x16x32_bf16 v[60:63], v[40:43], a[156:159], 0
    v_fma_f32 v46, v46, s31, v243
    v_fma_f32 v158, v158, s31, v242
    v_mfma_f32_16x16x32_bf16 v[60:63], v[32:35], a[152:155], v[60:63]
    v_exp_f32 v156, v156
    v_mfma_f32_16x16x32_bf16 v[60:63], v[28:31], a[148:151], v[60:63]
    v_exp_f32 v157, v157
    v_mfma_f32_16x16x32_bf16 v[60:63], v[24:27], a[144:147], v[60:63]
    s_waitcnt lgkmcnt(0)
    v_exp_f32 v184, v184
    v_mfma_f32_16x16x32_bf16 v[60:63], v[8:11], a[160:163], v[60:63]
    ds_read_b64_tr_b16 v[24:25], v254 offset:32768
    v_fma_f32 v186, v186, s31, v241
    v_mfma_f32_16x16x32_bf16 v[60:63], v[12:15], a[164:167], v[60:63]
    ds_read_b64_tr_b16 v[26:27], v254 offset:34816
    v_fma_f32 v106, v106, s31, v240
    v_mfma_f32_16x16x32_bf16 v[60:63], v[20:23], a[168:171], v[60:63]
    ds_read_b64_tr_b16 v[28:29], v254 offset:36864
    v_fma_f32 v47, v47, s31, v243
    v_mfma_f32_16x16x32_bf16 v[60:63], v[48:51], a[172:175], v[60:63]
    ds_read_b64_tr_b16 v[30:31], v254 offset:38912
    v_fma_f32 v159, v159, s31, v242
    v_mfma_f32_16x16x32_bf16 v[52:55], v[48:51], a[124:127], v[52:55]
    ds_read_b64_tr_b16 v[32:33], v254 offset:40960
    v_fma_f32 v187, v187, s31, v241
    v_mfma_f32_16x16x32_bf16 v[52:55], v[20:23], a[120:123], v[52:55]
    ds_read_b64_tr_b16 v[34:35], v254 offset:43008
    v_fma_f32 v107, v107, s31, v240
    v_mfma_f32_16x16x32_bf16 v[52:55], v[12:15], a[116:119], v[52:55]
    ds_read_b64_tr_b16 v[40:41], v254 offset:45056
    v_fma_f32 v120, v120, s31, v243
    v_mfma_f32_16x16x32_bf16 v[52:55], v[8:11], a[112:115], v[52:55]
    s_add_u32 m0, s29, 60288
    ds_read_b64_tr_b16 v[42:43], v254 offset:47104
    v_mfma_f32_16x16x32_bf16 v[16:19], v[8:11], a[64:67], v[16:19]
    global_load_lds_dwordx4 v247, s[26:27] offset:1152
    v_mfma_f32_16x16x32_bf16 v[16:19], v[12:15], a[68:71], v[16:19]
    v_exp_f32 v185, v185
    v_mfma_f32_16x16x32_bf16 v[16:19], v[20:23], a[72:75], v[16:19]
    v_xor_b32 v254, 65632, v255
    v_fma_f32 v160, v160, s31, v242
    v_mfma_f32_16x16x32_bf16 v[16:19], v[48:51], a[76:79], v[16:19]
    v_exp_f32 v104, v104
    v_mfma_f32_16x16x32_bf16 v[0:3], v[48:51], a[28:31], v[0:3]
    v_exp_f32 v105, v105
    v_mfma_f32_16x16x32_bf16 v[0:3], v[20:23], a[24:27], v[0:3]
    v_exp_f32 v46, v46
    v_mfma_f32_16x16x32_bf16 v[0:3], v[12:15], a[20:23], v[0:3]
    v_exp_f32 v158, v158
    v_mfma_f32_16x16x32_bf16 v[0:3], v[8:11], a[16:19], v[0:3]
    s_waitcnt lgkmcnt(0)
    v_exp_f32 v186, v186
    v_mfma_f32_16x16x32_bf16 v[0:3], v[24:27], a[32:35], v[0:3]
    ds_read_b64_tr_b16 v[8:9], v254 offset:0
    v_fma_f32 v188, v188, s31, v241
    v_mfma_f32_16x16x32_bf16 v[0:3], v[28:31], a[36:39], v[0:3]
    ds_read_b64_tr_b16 v[10:11], v254 offset:2048
    v_fma_f32 v140, v140, s31, v240
    v_mfma_f32_16x16x32_bf16 v[0:3], v[32:35], a[40:43], v[0:3]
    ds_read_b64_tr_b16 v[12:13], v254 offset:4096
    v_add_f32 v239, v44, v45
    v_mfma_f32_16x16x32_bf16 v[0:3], v[40:43], a[44:47], v[0:3]
    ds_read_b64_tr_b16 v[14:15], v254 offset:6144
    v_fma_f32 v121, v121, s31, v243
    v_mfma_f32_16x16x32_bf16 v[16:19], v[40:43], a[92:95], v[16:19]
    ds_read_b64_tr_b16 v[20:21], v254 offset:8192
    v_add_f32 v238, v156, v157
    v_mfma_f32_16x16x32_bf16 v[16:19], v[32:35], a[88:91], v[16:19]
    ds_read_b64_tr_b16 v[22:23], v254 offset:10240
    v_fma_f32 v161, v161, s31, v242
    v_mfma_f32_16x16x32_bf16 v[16:19], v[28:31], a[84:87], v[16:19]
    ds_read_b64_tr_b16 v[48:49], v254 offset:12288
    v_cvt_pk_bf16_f32 v64, v0, v1
    v_mfma_f32_16x16x32_bf16 v[16:19], v[24:27], a[80:83], v[16:19]
    ds_read_b64_tr_b16 v[50:51], v254 offset:14336
    v_cvt_pk_bf16_f32 v65, v2, v3
    v_mfma_f32_16x16x32_bf16 v[52:55], v[24:27], a[128:131], v[52:55]
    v_exp_f32 v106, v106
    v_mfma_f32_16x16x32_bf16 v[52:55], v[28:31], a[132:135], v[52:55]
    v_exp_f32 v47, v47
    v_mfma_f32_16x16x32_bf16 v[52:55], v[32:35], a[136:139], v[52:55]
    v_exp_f32 v159, v159
    v_mfma_f32_16x16x32_bf16 v[52:55], v[40:43], a[140:143], v[52:55]
    v_cvt_pk_bf16_f32 v0, v16, v17
    v_cvt_pk_bf16_f32 v1, v18, v19
    v_mfma_f32_16x16x32_bf16 v[60:63], v[40:43], a[188:191], v[60:63]
    v_exp_f32 v187, v187
    v_mfma_f32_16x16x32_bf16 v[60:63], v[32:35], a[184:187], v[60:63]
    v_exp_f32 v107, v107
    v_mfma_f32_16x16x32_bf16 v[60:63], v[28:31], a[180:183], v[60:63]
    v_exp_f32 v120, v120
    v_mfma_f32_16x16x32_bf16 v[60:63], v[24:27], a[176:179], v[60:63]
    s_waitcnt lgkmcnt(0)
    v_cvt_pk_bf16_f32 v16, v52, v53
    v_cvt_pk_bf16_f32 v17, v54, v55
    v_mfma_f32_16x16x32_bf16 v[24:27], v[8:11], a[0:3], 0
    ds_read_b64_tr_b16 v[28:29], v254 offset:16384
    v_add_f32 v237, v184, v185
    v_mfma_f32_16x16x32_bf16 v[24:27], v[12:15], a[4:7], v[24:27]
    ds_read_b64_tr_b16 v[30:31], v254 offset:18432
    v_cvt_pk_bf16_f32 v32, v60, v61
    v_mfma_f32_16x16x32_bf16 v[24:27], v[20:23], a[8:11], v[24:27]
    ds_read_b64_tr_b16 v[40:41], v254 offset:20480
    v_cvt_pk_bf16_f32 v33, v62, v63
    v_mfma_f32_16x16x32_bf16 v[24:27], v[48:51], a[12:15], v[24:27]
    ds_read_b64_tr_b16 v[42:43], v254 offset:22528
    v_fma_f32 v189, v189, s31, v241
    v_mfma_f32_16x16x32_bf16 v[52:55], v[48:51], a[60:63], 0
    ds_read_b64_tr_b16 v[60:61], v254 offset:24576
    v_add_f32 v236, v104, v105
    v_mfma_f32_16x16x32_bf16 v[52:55], v[20:23], a[56:59], v[52:55]
    ds_read_b64_tr_b16 v[62:63], v254 offset:26624
    v_fma_f32 v141, v141, s31, v240
    v_mfma_f32_16x16x32_bf16 v[52:55], v[12:15], a[52:55], v[52:55]
    ds_read_b64_tr_b16 v[76:77], v254 offset:28672
    v_add_f32 v239, v239, v46
    v_mfma_f32_16x16x32_bf16 v[52:55], v[8:11], a[48:51], v[52:55]
    ds_read_b64_tr_b16 v[78:79], v254 offset:30720
    v_fma_f32 v122, v122, s31, v243
    v_mfma_f32_16x16x32_bf16 v[88:91], v[8:11], a[96:99], 0
    v_exp_f32 v160, v160
    v_mfma_f32_16x16x32_bf16 v[88:91], v[12:15], a[100:103], v[88:91]
    v_exp_f32 v188, v188
    v_mfma_f32_16x16x32_bf16 v[88:91], v[20:23], a[104:107], v[88:91]
    v_exp_f32 v140, v140
    v_mfma_f32_16x16x32_bf16 v[88:91], v[48:51], a[108:111], v[88:91]
    v_exp_f32 v121, v121
    v_mfma_f32_16x16x32_bf16 v[92:95], v[48:51], a[156:159], 0
    v_add_f32 v238, v238, v158
    v_fma_f32 v162, v162, s31, v242
    v_mfma_f32_16x16x32_bf16 v[92:95], v[20:23], a[152:155], v[92:95]
    v_exp_f32 v161, v161
    v_mfma_f32_16x16x32_bf16 v[92:95], v[12:15], a[148:151], v[92:95]
    v_add_f32 v237, v237, v186
    v_fma_f32 v190, v190, s31, v241
    v_mfma_f32_16x16x32_bf16 v[92:95], v[8:11], a[144:147], v[92:95]
    s_waitcnt lgkmcnt(0)
    v_exp_f32 v189, v189
    v_mfma_f32_16x16x32_bf16 v[92:95], v[28:31], a[160:163], v[92:95]
    ds_read_b64_tr_b16 v[8:9], v254 offset:32768
    v_add_f32 v236, v236, v106
    v_mfma_f32_16x16x32_bf16 v[92:95], v[40:43], a[164:167], v[92:95]
    ds_read_b64_tr_b16 v[10:11], v254 offset:34816
    v_mbcnt_lo_u32_b32 v235, -1, 0
    v_mfma_f32_16x16x32_bf16 v[92:95], v[60:63], a[168:171], v[92:95]
    ds_read_b64_tr_b16 v[12:13], v254 offset:36864
    v_mbcnt_hi_u32_b32 v234, -1, v235
    v_mfma_f32_16x16x32_bf16 v[92:95], v[76:79], a[172:175], v[92:95]
    ds_read_b64_tr_b16 v[14:15], v254 offset:38912
    v_min_u32 v233, 53, v234
    v_mfma_f32_16x16x32_bf16 v[88:91], v[76:79], a[124:127], v[88:91]
    ds_read_b64_tr_b16 v[20:21], v254 offset:40960
    v_lshlrev_b32 v235, 7, v233
    v_mfma_f32_16x16x32_bf16 v[88:91], v[60:63], a[120:123], v[88:91]
    ds_read_b64_tr_b16 v[22:23], v254 offset:43008
    v_min_u32 v232, 17, v234
    v_mfma_f32_16x16x32_bf16 v[88:91], v[40:43], a[116:119], v[88:91]
    ds_read_b64_tr_b16 v[48:49], v254 offset:45056
    v_lshlrev_b32 v233, 7, v232
    v_mfma_f32_16x16x32_bf16 v[88:91], v[28:31], a[112:115], v[88:91]
    ds_read_b64_tr_b16 v[50:51], v254 offset:47104
    v_min_u32 v231, 5, v234
    v_mfma_f32_16x16x32_bf16 v[52:55], v[28:31], a[64:67], v[52:55]
    v_exp_f32 v141, v141
    v_mfma_f32_16x16x32_bf16 v[52:55], v[40:43], a[68:71], v[52:55]
    v_fma_f32 v142, v142, s31, v240
    v_fma_f32 v254, v245, s32, v250
    v_mfma_f32_16x16x32_bf16 v[52:55], v[60:63], a[72:75], v[52:55]
    v_xor_b32 v234, 114688, v255
    v_add_f32 v239, v239, v47
    v_mfma_f32_16x16x32_bf16 v[52:55], v[76:79], a[76:79], v[52:55]
    v_exp_f32 v122, v122
    v_mfma_f32_16x16x32_bf16 v[24:27], v[76:79], a[28:31], v[24:27]
    v_fma_f32 v123, v123, s31, v243
    v_fma_f32 v245, v244, s32, v250
    v_mfma_f32_16x16x32_bf16 v[24:27], v[60:63], a[24:27], v[24:27]
    v_add_f32 v238, v238, v159
    v_fma_f32 v163, v163, s31, v242
    v_mfma_f32_16x16x32_bf16 v[24:27], v[40:43], a[20:23], v[24:27]
    v_exp_f32 v162, v162
    v_mfma_f32_16x16x32_bf16 v[24:27], v[28:31], a[16:19], v[24:27]
    s_waitcnt vmcnt(12) lgkmcnt(0)
    s_barrier
    v_fma_f32 v244, v253, s32, v248
    v_mfma_f32_16x16x32_bf16 v[24:27], v[8:11], a[32:35], v[24:27]
    ds_read_b64_tr_b16 v[28:29], v234 offset:0
    v_add_f32 v237, v237, v187
    v_mfma_f32_16x16x32_bf16 v[24:27], v[12:15], a[36:39], v[24:27]
    ds_read_b64_tr_b16 v[30:31], v234 offset:2048
    v_fma_f32 v191, v191, s31, v241
    v_mfma_f32_16x16x32_bf16 v[24:27], v[20:23], a[40:43], v[24:27]
    ds_read_b64_tr_b16 v[40:41], v234 offset:4096
    v_fma_f32 v253, v249, s32, v248
    v_mfma_f32_16x16x32_bf16 v[24:27], v[48:51], a[44:47], v[24:27]
    ds_read_b64_tr_b16 v[42:43], v234 offset:6144
    v_add_f32 v236, v236, v107
    v_mfma_f32_16x16x32_bf16 v[52:55], v[48:51], a[92:95], v[52:55]
    ds_read_b64_tr_b16 v[60:61], v234 offset:8192
    v_fma_f32 v143, v143, s31, v240
    v_mfma_f32_16x16x32_bf16 v[52:55], v[20:23], a[88:91], v[52:55]
    ds_read_b64_tr_b16 v[62:63], v234 offset:10240
    v_add_f32 v239, v239, v120
    v_mfma_f32_16x16x32_bf16 v[52:55], v[12:15], a[84:87], v[52:55]
    ds_read_b64_tr_b16 v[76:77], v234 offset:12288
    v_cvt_pk_bf16_f32 v66, v24, v25
    v_mfma_f32_16x16x32_bf16 v[52:55], v[8:11], a[80:83], v[52:55]
    s_add_u32 m0, s29, 64256
    ds_read_b64_tr_b16 v[78:79], v234 offset:14336
    v_cvt_pk_bf16_f32 v67, v26, v27
    v_mfma_f32_16x16x32_bf16 v[88:91], v[8:11], a[128:131], v[88:91]
    global_load_lds_dwordx4 v247, s[4:5] offset:1280
    v_mfma_f32_16x16x32_bf16 v[88:91], v[12:15], a[132:135], v[88:91]
    v_exp_f32 v190, v190
    v_mfma_f32_16x16x32_bf16 v[88:91], v[20:23], a[136:139], v[88:91]
    v_cvt_pk_bf16_f32 v2, v52, v53
    v_cvt_pk_bf16_f32 v3, v54, v55
    v_mfma_f32_16x16x32_bf16 v[88:91], v[48:51], a[140:143], v[88:91]
    v_exp_f32 v142, v142
    v_mfma_f32_16x16x32_bf16 v[92:95], v[48:51], a[188:191], v[92:95]
    v_exp_f32 v123, v123
    v_mfma_f32_16x16x32_bf16 v[92:95], v[20:23], a[184:187], v[92:95]
    v_fma_f32 v124, v124, s31, v254
    v_add_f32 v238, v238, v160
    v_mfma_f32_16x16x32_bf16 v[92:95], v[12:15], a[180:183], v[92:95]
    v_exp_f32 v163, v163
    v_mfma_f32_16x16x32_bf16 v[92:95], v[8:11], a[176:179], v[92:95]
    s_waitcnt lgkmcnt(0)
    v_cvt_pk_bf16_f32 v18, v88, v89
    v_cvt_pk_bf16_f32 v19, v90, v91
    v_mfma_f32_16x16x32_bf16 v[8:11], v[28:31], a[0:3], 0
    s_mul_i32 s46, s30, 6912
    ds_read_b64_tr_b16 v[12:13], v234 offset:16384
    v_fma_f32 v164, v164, s31, v245
    v_mfma_f32_16x16x32_bf16 v[8:11], v[40:43], a[4:7], v[8:11]
    s_mul_i32 s47, s30, 2304
    ds_read_b64_tr_b16 v[14:15], v234 offset:18432
    v_cvt_pk_bf16_f32 v34, v92, v93
    v_mfma_f32_16x16x32_bf16 v[8:11], v[60:63], a[8:11], v[8:11]
    s_mul_i32 s48, s30, 6
    ds_read_b64_tr_b16 v[20:21], v234 offset:20480
    v_add_u32 v249, s46, v235
    v_mfma_f32_16x16x32_bf16 v[8:11], v[76:79], a[12:15], v[8:11]
    ds_read_b64_tr_b16 v[22:23], v234 offset:22528
    v_add_u32 v243, s47, v233
    v_mfma_f32_16x16x32_bf16 v[24:27], v[76:79], a[60:63], 0
    ds_read_b64_tr_b16 v[48:49], v234 offset:24576
    v_add_u32 v242, s48, v231
    v_mfma_f32_16x16x32_bf16 v[24:27], v[60:63], a[56:59], v[24:27]
    ds_read_b64_tr_b16 v[50:51], v234 offset:26624
    v_lshlrev_b32 v241, 7, v242
    v_mfma_f32_16x16x32_bf16 v[24:27], v[40:43], a[52:55], v[24:27]
    ds_read_b64_tr_b16 v[52:53], v234 offset:28672
    v_min_u32 v240, L_code_end - L_pc - 4, v241
    v_mfma_f32_16x16x32_bf16 v[24:27], v[28:31], a[48:51], v[24:27]
    s_add_u32 m0, s29, 68352
    ds_read_b64_tr_b16 v[54:55], v234 offset:30720
    v_and_b32 v242, 0xfffffffc, v240
    v_mfma_f32_16x16x32_bf16 v[88:91], v[28:31], a[96:99], 0
    global_load_lds_dwordx4 v247, s[6:7] offset:1280
    v_mfma_f32_16x16x32_bf16 v[88:91], v[40:43], a[100:103], v[88:91]
    global_load_dword v241, v249, s[4:5]
    v_mfma_f32_16x16x32_bf16 v[88:91], v[60:63], a[104:107], v[88:91]
    v_cvt_pk_bf16_f32 v35, v94, v95
    v_add_f32 v237, v237, v188
    v_mfma_f32_16x16x32_bf16 v[88:91], v[76:79], a[108:111], v[88:91]
    global_load_dword v249, v243, s[44:45]
    v_mfma_f32_16x16x32_bf16 v[92:95], v[76:79], a[156:159], 0
    v_exp_f32 v191, v191
    v_mfma_f32_16x16x32_bf16 v[92:95], v[60:63], a[152:155], v[92:95]
    v_fma_f32 v192, v192, s31, v244
    v_add_f32 v236, v236, v140
    v_mfma_f32_16x16x32_bf16 v[92:95], v[40:43], a[148:151], v[92:95]
    v_exp_f32 v143, v143
    v_mfma_f32_16x16x32_bf16 v[92:95], v[28:31], a[144:147], v[92:95]
    s_waitcnt lgkmcnt(0)
    v_fma_f32 v204, v204, s31, v253
    v_add_f32 v239, v239, v121
    v_mfma_f32_16x16x32_bf16 v[92:95], v[12:15], a[160:163], v[92:95]
    global_load_dword v243, v242, s[50:51]
    v_mfma_f32_16x16x32_bf16 v[92:95], v[20:23], a[164:167], v[92:95]
    ds_read_b64_tr_b16 v[28:29], v234 offset:32768
    v_fma_f32 v125, v125, s31, v254
    v_mfma_f32_16x16x32_bf16 v[92:95], v[48:51], a[168:171], v[92:95]
    ds_read_b64_tr_b16 v[30:31], v234 offset:34816
    v_add_f32 v238, v238, v161
    v_mfma_f32_16x16x32_bf16 v[92:95], v[52:55], a[172:175], v[92:95]
    ds_read_b64_tr_b16 v[40:41], v234 offset:36864
    v_fma_f32 v165, v165, s31, v245
    v_mfma_f32_16x16x32_bf16 v[88:91], v[52:55], a[124:127], v[88:91]
    ds_read_b64_tr_b16 v[42:43], v234 offset:38912
    v_add_f32 v237, v237, v189
    v_mfma_f32_16x16x32_bf16 v[88:91], v[48:51], a[120:123], v[88:91]
    ds_read_b64_tr_b16 v[60:61], v234 offset:40960
    v_fma_f32 v193, v193, s31, v244
    v_mfma_f32_16x16x32_bf16 v[88:91], v[20:23], a[116:119], v[88:91]
    ds_read_b64_tr_b16 v[62:63], v234 offset:43008
    v_add_f32 v236, v236, v141
    v_mfma_f32_16x16x32_bf16 v[88:91], v[12:15], a[112:115], v[88:91]
    ds_read_b64_tr_b16 v[76:77], v234 offset:45056
G_5:
    s_cbranch_vccnz G_9
    v_fma_f32 v205, v205, s31, v253
    v_mfma_f32_16x16x32_bf16 v[24:27], v[12:15], a[64:67], v[24:27]
    s_add_u32 m0, s29, 72448
    ds_read_b64_tr_b16 v[78:79], v234 offset:47104
    v_add_f32 v239, v239, v122
    v_mfma_f32_16x16x32_bf16 v[24:27], v[20:23], a[68:71], v[24:27]
    global_load_lds_dwordx4 v247, s[8:9] offset:1280
    v_mfma_f32_16x16x32_bf16 v[24:27], v[48:51], a[72:75], v[24:27]
    v_xor_b32 v242, 114720, v255
    v_fma_f32 v126, v126, s31, v254
    v_mfma_f32_16x16x32_bf16 v[24:27], v[52:55], a[76:79], v[24:27]
    v_exp_f32 v124, v124
    v_mfma_f32_16x16x32_bf16 v[8:11], v[52:55], a[28:31], v[8:11]
    v_exp_f32 v164, v164
    v_mfma_f32_16x16x32_bf16 v[8:11], v[48:51], a[24:27], v[8:11]
    v_exp_f32 v192, v192
    v_mfma_f32_16x16x32_bf16 v[8:11], v[20:23], a[20:23], v[8:11]
    v_exp_f32 v204, v204
    v_mfma_f32_16x16x32_bf16 v[8:11], v[12:15], a[16:19], v[8:11]
    s_waitcnt lgkmcnt(0)
    v_exp_f32 v125, v125
    v_mfma_f32_16x16x32_bf16 v[8:11], v[28:31], a[32:35], v[8:11]
    ds_read_b64_tr_b16 v[12:13], v242 offset:0
    v_add_f32 v238, v238, v162
    v_mfma_f32_16x16x32_bf16 v[8:11], v[40:43], a[36:39], v[8:11]
    ds_read_b64_tr_b16 v[14:15], v242 offset:2048
    v_fma_f32 v166, v166, s31, v245
    v_mfma_f32_16x16x32_bf16 v[8:11], v[60:63], a[40:43], v[8:11]
    ds_read_b64_tr_b16 v[20:21], v242 offset:4096
    v_add_f32 v237, v237, v190
    v_mfma_f32_16x16x32_bf16 v[8:11], v[76:79], a[44:47], v[8:11]
    ds_read_b64_tr_b16 v[22:23], v242 offset:6144
    v_fma_f32 v194, v194, s31, v244
    v_mfma_f32_16x16x32_bf16 v[24:27], v[76:79], a[92:95], v[24:27]
    ds_read_b64_tr_b16 v[48:49], v242 offset:8192
    v_add_f32 v236, v236, v142
    v_mfma_f32_16x16x32_bf16 v[24:27], v[60:63], a[88:91], v[24:27]
    ds_read_b64_tr_b16 v[50:51], v242 offset:10240
    v_fma_f32 v206, v206, s31, v253
    v_mfma_f32_16x16x32_bf16 v[24:27], v[40:43], a[84:87], v[24:27]
    ds_read_b64_tr_b16 v[52:53], v242 offset:12288
    v_cvt_pk_bf16_f32 v96, v8, v9
    v_mfma_f32_16x16x32_bf16 v[24:27], v[28:31], a[80:83], v[24:27]
    s_add_u32 m0, s29, 76544
    ds_read_b64_tr_b16 v[54:55], v242 offset:14336
    v_cvt_pk_bf16_f32 v97, v10, v11
    v_mfma_f32_16x16x32_bf16 v[88:91], v[28:31], a[128:131], v[88:91]
    global_load_lds_dwordx4 v247, s[10:11] offset:1280
    v_mfma_f32_16x16x32_bf16 v[88:91], v[40:43], a[132:135], v[88:91]
    v_exp_f32 v165, v165
    v_mfma_f32_16x16x32_bf16 v[88:91], v[60:63], a[136:139], v[88:91]
    v_cvt_pk_bf16_f32 v8, v24, v25
    v_cvt_pk_bf16_f32 v9, v26, v27
    v_mfma_f32_16x16x32_bf16 v[88:91], v[76:79], a[140:143], v[88:91]
    v_exp_f32 v193, v193
    v_mfma_f32_16x16x32_bf16 v[92:95], v[76:79], a[188:191], v[92:95]
    v_exp_f32 v205, v205
    v_mfma_f32_16x16x32_bf16 v[92:95], v[60:63], a[184:187], v[92:95]
    v_add_f32 v239, v239, v123
    v_fma_f32 v127, v127, s31, v254
    v_mfma_f32_16x16x32_bf16 v[92:95], v[40:43], a[180:183], v[92:95]
    v_exp_f32 v126, v126
    v_mfma_f32_16x16x32_bf16 v[92:95], v[28:31], a[176:179], v[92:95]
    s_waitcnt lgkmcnt(0)
    v_cvt_pk_bf16_f32 v24, v88, v89
    v_cvt_pk_bf16_f32 v25, v90, v91
    v_mfma_f32_16x16x32_bf16 v[28:31], v[12:15], a[0:3], 0
    ds_read_b64_tr_b16 v[40:41], v242 offset:16384
    v_add_f32 v238, v238, v163
    v_mfma_f32_16x16x32_bf16 v[28:31], v[20:23], a[4:7], v[28:31]
    ds_read_b64_tr_b16 v[42:43], v242 offset:18432
    v_cvt_pk_bf16_f32 v60, v92, v93
    v_mfma_f32_16x16x32_bf16 v[28:31], v[48:51], a[8:11], v[28:31]
    ds_read_b64_tr_b16 v[76:77], v242 offset:20480
    v_cvt_pk_bf16_f32 v61, v94, v95
    v_mfma_f32_16x16x32_bf16 v[28:31], v[52:55], a[12:15], v[28:31]
    ds_read_b64_tr_b16 v[78:79], v242 offset:22528
    v_fma_f32 v167, v167, s31, v245
    v_mfma_f32_16x16x32_bf16 v[88:91], v[52:55], a[60:63], 0
    ds_read_b64_tr_b16 v[92:93], v242 offset:24576
    v_add_f32 v237, v237, v191
    v_mfma_f32_16x16x32_bf16 v[88:91], v[48:51], a[56:59], v[88:91]
    ds_read_b64_tr_b16 v[94:95], v242 offset:26624
    v_fma_f32 v195, v195, s31, v244
    v_mfma_f32_16x16x32_bf16 v[88:91], v[20:23], a[52:55], v[88:91]
    ds_read_b64_tr_b16 v[108:109], v242 offset:28672
    v_add_f32 v236, v236, v143
    v_mfma_f32_16x16x32_bf16 v[88:91], v[12:15], a[48:51], v[88:91]
    s_add_u32 m0, s29, 80640
    ds_read_b64_tr_b16 v[110:111], v242 offset:30720
    v_fma_f32 v207, v207, s31, v253
    v_mfma_f32_16x16x32_bf16 v[112:115], v[12:15], a[96:99], 0
    global_load_lds_dwordx4 v247, s[12:13] offset:1280
    v_mfma_f32_16x16x32_bf16 v[112:115], v[20:23], a[100:103], v[112:115]
    v_exp_f32 v166, v166
    v_mfma_f32_16x16x32_bf16 v[112:115], v[48:51], a[104:107], v[112:115]
    v_exp_f32 v194, v194
    v_mfma_f32_16x16x32_bf16 v[112:115], v[52:55], a[108:111], v[112:115]
    v_exp_f32 v206, v206
    v_mfma_f32_16x16x32_bf16 v[116:119], v[52:55], a[156:159], 0
    v_add_f32 v239, v239, v124
    v_fma_f32 v128, v128, s31, v254
    v_mfma_f32_16x16x32_bf16 v[116:119], v[48:51], a[152:155], v[116:119]
    v_exp_f32 v127, v127
    v_mfma_f32_16x16x32_bf16 v[116:119], v[20:23], a[148:151], v[116:119]
    v_add_f32 v238, v238, v164
    v_fma_f32 v180, v180, s31, v245
    v_mfma_f32_16x16x32_bf16 v[116:119], v[12:15], a[144:147], v[116:119]
    s_waitcnt lgkmcnt(0)
    v_exp_f32 v167, v167
    v_mfma_f32_16x16x32_bf16 v[116:119], v[40:43], a[160:163], v[116:119]
    ds_read_b64_tr_b16 v[12:13], v242 offset:32768
    v_add_f32 v237, v237, v192
    v_mfma_f32_16x16x32_bf16 v[116:119], v[76:79], a[164:167], v[116:119]
    ds_read_b64_tr_b16 v[14:15], v242 offset:34816
    v_fma_f32 v196, v196, s31, v244
    v_mfma_f32_16x16x32_bf16 v[116:119], v[92:95], a[168:171], v[116:119]
    ds_read_b64_tr_b16 v[20:21], v242 offset:36864
    v_add_f32 v236, v236, v204
    v_mfma_f32_16x16x32_bf16 v[116:119], v[108:111], a[172:175], v[116:119]
    ds_read_b64_tr_b16 v[22:23], v242 offset:38912
    v_fma_f32 v212, v212, s31, v253
    v_mfma_f32_16x16x32_bf16 v[112:115], v[108:111], a[124:127], v[112:115]
    ds_read_b64_tr_b16 v[48:49], v242 offset:40960
    v_add_f32 v239, v239, v125
    v_mfma_f32_16x16x32_bf16 v[112:115], v[92:95], a[120:123], v[112:115]
    ds_read_b64_tr_b16 v[50:51], v242 offset:43008
    v_fma_f32 v129, v129, s31, v254
    v_mfma_f32_16x16x32_bf16 v[112:115], v[76:79], a[116:119], v[112:115]
    ds_read_b64_tr_b16 v[52:53], v242 offset:45056
    v_add_f32 v238, v238, v165
    v_mfma_f32_16x16x32_bf16 v[112:115], v[40:43], a[112:115], v[112:115]
    s_add_u32 m0, s29, 84736
    ds_read_b64_tr_b16 v[54:55], v242 offset:47104
    v_fma_f32 v181, v181, s31, v245
    v_mfma_f32_16x16x32_bf16 v[88:91], v[40:43], a[64:67], v[88:91]
    global_load_lds_dwordx4 v247, s[14:15] offset:1280
    v_mfma_f32_16x16x32_bf16 v[88:91], v[76:79], a[68:71], v[88:91]
    v_exp_f32 v195, v195
    v_mfma_f32_16x16x32_bf16 v[88:91], v[92:95], a[72:75], v[88:91]
    v_xor_b32 v242, 114752, v255
    v_add_f32 v237, v237, v193
    v_mfma_f32_16x16x32_bf16 v[88:91], v[108:111], a[76:79], v[88:91]
    v_exp_f32 v207, v207
    v_mfma_f32_16x16x32_bf16 v[28:31], v[108:111], a[28:31], v[28:31]
    v_exp_f32 v128, v128
    v_mfma_f32_16x16x32_bf16 v[28:31], v[92:95], a[24:27], v[28:31]
    v_exp_f32 v180, v180
    v_mfma_f32_16x16x32_bf16 v[28:31], v[76:79], a[20:23], v[28:31]
    v_exp_f32 v196, v196
    v_mfma_f32_16x16x32_bf16 v[28:31], v[40:43], a[16:19], v[28:31]
    s_waitcnt lgkmcnt(0)
    v_fma_f32 v197, v197, s31, v244
    v_add_f32 v236, v236, v205
    v_mfma_f32_16x16x32_bf16 v[28:31], v[12:15], a[32:35], v[28:31]
    ds_read_b64_tr_b16 v[40:41], v242 offset:0
    v_fma_f32 v213, v213, s31, v253
    v_mfma_f32_16x16x32_bf16 v[28:31], v[20:23], a[36:39], v[28:31]
    ds_read_b64_tr_b16 v[42:43], v242 offset:2048
    v_add_f32 v239, v239, v126
    v_mfma_f32_16x16x32_bf16 v[28:31], v[48:51], a[40:43], v[28:31]
    ds_read_b64_tr_b16 v[76:77], v242 offset:4096
    v_fma_f32 v130, v130, s31, v254
    v_mfma_f32_16x16x32_bf16 v[28:31], v[52:55], a[44:47], v[28:31]
    ds_read_b64_tr_b16 v[78:79], v242 offset:6144
    v_add_f32 v238, v238, v166
    v_mfma_f32_16x16x32_bf16 v[88:91], v[52:55], a[92:95], v[88:91]
    ds_read_b64_tr_b16 v[92:93], v242 offset:8192
    v_fma_f32 v182, v182, s31, v245
    v_mfma_f32_16x16x32_bf16 v[88:91], v[48:51], a[88:91], v[88:91]
    ds_read_b64_tr_b16 v[94:95], v242 offset:10240
    v_add_f32 v237, v237, v194
    v_mfma_f32_16x16x32_bf16 v[88:91], v[20:23], a[84:87], v[88:91]
    ds_read_b64_tr_b16 v[108:109], v242 offset:12288
    v_cvt_pk_bf16_f32 v98, v28, v29
    v_mfma_f32_16x16x32_bf16 v[88:91], v[12:15], a[80:83], v[88:91]
    s_add_u32 m0, s29, 88832
    ds_read_b64_tr_b16 v[110:111], v242 offset:14336
    v_cvt_pk_bf16_f32 v99, v30, v31
    v_mfma_f32_16x16x32_bf16 v[112:115], v[12:15], a[128:131], v[112:115]
    global_load_lds_dwordx4 v247, s[16:17] offset:1280
    v_mfma_f32_16x16x32_bf16 v[112:115], v[20:23], a[132:135], v[112:115]
    v_exp_f32 v212, v212
    v_mfma_f32_16x16x32_bf16 v[112:115], v[48:51], a[136:139], v[112:115]
    v_cvt_pk_bf16_f32 v10, v88, v89
    v_cvt_pk_bf16_f32 v11, v90, v91
    v_mfma_f32_16x16x32_bf16 v[112:115], v[52:55], a[140:143], v[112:115]
    v_exp_f32 v129, v129
    v_mfma_f32_16x16x32_bf16 v[116:119], v[52:55], a[188:191], v[116:119]
    v_exp_f32 v181, v181
    v_mfma_f32_16x16x32_bf16 v[116:119], v[48:51], a[184:187], v[116:119]
    v_exp_f32 v197, v197
    v_mfma_f32_16x16x32_bf16 v[116:119], v[20:23], a[180:183], v[116:119]
    v_fma_f32 v198, v198, s31, v244
    v_add_f32 v236, v236, v206
    v_mfma_f32_16x16x32_bf16 v[116:119], v[12:15], a[176:179], v[116:119]
    s_waitcnt lgkmcnt(0)
    v_cvt_pk_bf16_f32 v26, v112, v113
    v_cvt_pk_bf16_f32 v27, v114, v115
    v_mfma_f32_16x16x32_bf16 v[12:15], v[40:43], a[0:3], 0
    ds_read_b64_tr_b16 v[20:21], v242 offset:16384
    v_fma_f32 v214, v214, s31, v253
    v_mfma_f32_16x16x32_bf16 v[12:15], v[76:79], a[4:7], v[12:15]
    ds_read_b64_tr_b16 v[22:23], v242 offset:18432
    v_cvt_pk_bf16_f32 v62, v116, v117
    v_mfma_f32_16x16x32_bf16 v[12:15], v[92:95], a[8:11], v[12:15]
    ds_read_b64_tr_b16 v[28:29], v242 offset:20480
    v_cvt_pk_bf16_f32 v63, v118, v119
    v_mfma_f32_16x16x32_bf16 v[12:15], v[108:111], a[12:15], v[12:15]
    ds_read_b64_tr_b16 v[30:31], v242 offset:22528
    v_add_f32 v239, v239, v127
    v_mfma_f32_16x16x32_bf16 v[48:51], v[108:111], a[60:63], 0
    ds_read_b64_tr_b16 v[52:53], v242 offset:24576
    v_fma_f32 v131, v131, s31, v254
    v_mfma_f32_16x16x32_bf16 v[48:51], v[92:95], a[56:59], v[48:51]
    ds_read_b64_tr_b16 v[54:55], v242 offset:26624
    v_add_f32 v238, v238, v167
    v_mfma_f32_16x16x32_bf16 v[48:51], v[76:79], a[52:55], v[48:51]
    ds_read_b64_tr_b16 v[88:89], v242 offset:28672
    v_fma_f32 v183, v183, s31, v245
    v_mfma_f32_16x16x32_bf16 v[48:51], v[40:43], a[48:51], v[48:51]
    s_add_u32 m0, s29, 92928
    ds_read_b64_tr_b16 v[90:91], v242 offset:30720
    v_add_f32 v237, v237, v195
    v_mfma_f32_16x16x32_bf16 v[112:115], v[40:43], a[96:99], 0
    global_load_lds_dwordx4 v247, s[18:19] offset:1280
    v_mfma_f32_16x16x32_bf16 v[112:115], v[76:79], a[100:103], v[112:115]
    v_exp_f32 v213, v213
    v_mfma_f32_16x16x32_bf16 v[112:115], v[92:95], a[104:107], v[112:115]
    v_exp_f32 v130, v130
    v_mfma_f32_16x16x32_bf16 v[112:115], v[108:111], a[108:111], v[112:115]
    v_exp_f32 v182, v182
    v_mfma_f32_16x16x32_bf16 v[116:119], v[108:111], a[156:159], 0
    v_exp_f32 v198, v198
    v_mfma_f32_16x16x32_bf16 v[116:119], v[92:95], a[152:155], v[116:119]
    v_fma_f32 v199, v199, s31, v244
    v_add_f32 v236, v236, v207
    v_mfma_f32_16x16x32_bf16 v[116:119], v[76:79], a[148:151], v[116:119]
    v_exp_f32 v214, v214
    v_mfma_f32_16x16x32_bf16 v[116:119], v[40:43], a[144:147], v[116:119]
    s_waitcnt lgkmcnt(0)
    v_fma_f32 v215, v215, s31, v253
    v_add_f32 v239, v239, v128
    v_mfma_f32_16x16x32_bf16 v[116:119], v[20:23], a[160:163], v[116:119]
    ds_read_b64_tr_b16 v[40:41], v242 offset:32768
    v_add_f32 v238, v238, v180
    v_mfma_f32_16x16x32_bf16 v[116:119], v[28:31], a[164:167], v[116:119]
    ds_read_b64_tr_b16 v[42:43], v242 offset:34816
    v_add_f32 v237, v237, v196
    v_mfma_f32_16x16x32_bf16 v[116:119], v[52:55], a[168:171], v[116:119]
    ds_read_b64_tr_b16 v[76:77], v242 offset:36864
    v_add_f32 v236, v236, v212
    v_mfma_f32_16x16x32_bf16 v[116:119], v[88:91], a[172:175], v[116:119]
    ds_read_b64_tr_b16 v[78:79], v242 offset:38912
    v_add_f32 v239, v239, v129
    v_mfma_f32_16x16x32_bf16 v[112:115], v[88:91], a[124:127], v[112:115]
    ds_read_b64_tr_b16 v[92:93], v242 offset:40960
    v_add_f32 v238, v238, v181
    v_mfma_f32_16x16x32_bf16 v[112:115], v[52:55], a[120:123], v[112:115]
    ds_read_b64_tr_b16 v[94:95], v242 offset:43008
    v_add_f32 v237, v237, v197
    v_mfma_f32_16x16x32_bf16 v[112:115], v[28:31], a[116:119], v[112:115]
    ds_read_b64_tr_b16 v[108:109], v242 offset:45056
    v_add_f32 v236, v236, v213
    v_mfma_f32_16x16x32_bf16 v[112:115], v[20:23], a[112:115], v[112:115]
    s_add_u32 m0, s29, 97024
    ds_read_b64_tr_b16 v[110:111], v242 offset:47104
    v_add_f32 v239, v239, v130
    v_mfma_f32_16x16x32_bf16 v[48:51], v[20:23], a[64:67], v[48:51]
    global_load_lds_dwordx4 v247, s[20:21] offset:1280
    v_mfma_f32_16x16x32_bf16 v[48:51], v[28:31], a[68:71], v[48:51]
    v_exp_f32 v131, v131
    v_mfma_f32_16x16x32_bf16 v[48:51], v[52:55], a[72:75], v[48:51]
    v_xor_b32 v254, 114784, v255
    v_add_f32 v238, v238, v182
    v_mfma_f32_16x16x32_bf16 v[48:51], v[88:91], a[76:79], v[48:51]
    v_exp_f32 v183, v183
    v_mfma_f32_16x16x32_bf16 v[12:15], v[88:91], a[28:31], v[12:15]
    v_exp_f32 v199, v199
    v_mfma_f32_16x16x32_bf16 v[12:15], v[52:55], a[24:27], v[12:15]
    v_exp_f32 v215, v215
    v_mfma_f32_16x16x32_bf16 v[12:15], v[28:31], a[20:23], v[12:15]
    v_add_f32 v237, v237, v198
    v_add_f32 v236, v236, v214
    v_mfma_f32_16x16x32_bf16 v[12:15], v[20:23], a[16:19], v[12:15]
    s_waitcnt lgkmcnt(0)
    v_add_f32 v239, v239, v131
    v_add_f32 v238, v238, v183
    v_mfma_f32_16x16x32_bf16 v[12:15], v[40:43], a[32:35], v[12:15]
    ds_read_b64_tr_b16 v[20:21], v254 offset:0
    v_add_f32 v237, v237, v199
    v_mfma_f32_16x16x32_bf16 v[12:15], v[76:79], a[36:39], v[12:15]
    ds_read_b64_tr_b16 v[22:23], v254 offset:2048
    v_add_f32 v236, v236, v215
    v_mfma_f32_16x16x32_bf16 v[12:15], v[92:95], a[40:43], v[12:15]
    ds_read_b64_tr_b16 v[28:29], v254 offset:4096
    v_mfma_f32_16x16x32_bf16 v[12:15], v[108:111], a[44:47], v[12:15]
    ds_read_b64_tr_b16 v[30:31], v254 offset:6144
    v_mfma_f32_16x16x32_bf16 v[48:51], v[108:111], a[92:95], v[48:51]
    ds_read_b64_tr_b16 v[52:53], v254 offset:8192
    v_mfma_f32_16x16x32_bf16 v[48:51], v[92:95], a[88:91], v[48:51]
    ds_read_b64_tr_b16 v[54:55], v254 offset:10240
    v_mfma_f32_16x16x32_bf16 v[48:51], v[76:79], a[84:87], v[48:51]
    ds_read_b64_tr_b16 v[88:89], v254 offset:12288
    v_mfma_f32_16x16x32_bf16 v[48:51], v[40:43], a[80:83], v[48:51]
    s_add_u32 m0, s29, 101120
    ds_read_b64_tr_b16 v[90:91], v254 offset:14336
    v_cvt_pk_bf16_f32 v136, v12, v13
    v_mfma_f32_16x16x32_bf16 v[112:115], v[40:43], a[128:131], v[112:115]
    global_load_lds_dwordx4 v247, s[22:23] offset:1280
    v_mfma_f32_16x16x32_bf16 v[112:115], v[76:79], a[132:135], v[112:115]
    v_cvt_pk_bf16_f32 v137, v14, v15
    v_mfma_f32_16x16x32_bf16 v[112:115], v[92:95], a[136:139], v[112:115]
    v_cvt_pk_bf16_f32 v152, v48, v49
    v_cvt_pk_bf16_f32 v153, v50, v51
    v_mfma_f32_16x16x32_bf16 v[112:115], v[108:111], a[140:143], v[112:115]
    v_permlane32_swap_b32 v239, v238
    v_mfma_f32_16x16x32_bf16 v[116:119], v[108:111], a[188:191], v[116:119]
    v_permlane32_swap_b32 v237, v236
    v_mfma_f32_16x16x32_bf16 v[116:119], v[92:95], a[184:187], v[116:119]
    v_add_f32 v253, v239, v238
    v_add_f32 v245, v237, v236
    v_mfma_f32_16x16x32_bf16 v[116:119], v[76:79], a[180:183], v[116:119]
    v_mfma_f32_16x16x32_bf16 v[116:119], v[40:43], a[176:179], v[116:119]
    s_waitcnt lgkmcnt(0)
    v_cvt_pk_bf16_f32 v12, v112, v113
    v_cvt_pk_bf16_f32 v13, v114, v115
    v_mfma_f32_16x16x32_bf16 v[40:43], v[20:23], a[0:3], 0
    ds_read_b64_tr_b16 v[48:49], v254 offset:16384
    v_mfma_f32_16x16x32_bf16 v[40:43], v[28:31], a[4:7], v[40:43]
    ds_read_b64_tr_b16 v[50:51], v254 offset:18432
    v_mfma_f32_16x16x32_bf16 v[40:43], v[52:55], a[8:11], v[40:43]
    ds_read_b64_tr_b16 v[76:77], v254 offset:20480
    v_cvt_pk_bf16_f32 v92, v116, v117
    v_mfma_f32_16x16x32_bf16 v[40:43], v[88:91], a[12:15], v[40:43]
    ds_read_b64_tr_b16 v[78:79], v254 offset:22528
    v_cvt_pk_bf16_f32 v93, v118, v119
    v_mfma_f32_16x16x32_bf16 v[108:111], v[88:91], a[60:63], 0
    ds_read_b64_tr_b16 v[112:113], v254 offset:24576
    v_mfma_f32_16x16x32_bf16 v[108:111], v[52:55], a[56:59], v[108:111]
    ds_read_b64_tr_b16 v[114:115], v254 offset:26624
    v_mfma_f32_16x16x32_bf16 v[108:111], v[28:31], a[52:55], v[108:111]
    ds_read_b64_tr_b16 v[116:117], v254 offset:28672
    v_mfma_f32_16x16x32_bf16 v[108:111], v[20:23], a[48:51], v[108:111]
    s_add_u32 m0, s29, 105216
    ds_read_b64_tr_b16 v[118:119], v254 offset:30720
    v_mfma_f32_16x16x32_bf16 v[168:171], v[20:23], a[96:99], 0
    global_load_lds_dwordx4 v247, s[24:25] offset:1280
    v_mfma_f32_16x16x32_bf16 v[168:171], v[28:31], a[100:103], v[168:171]
    v_permlane16_swap_b32 v253, v245
    v_mfma_f32_16x16x32_bf16 v[168:171], v[52:55], a[104:107], v[168:171]
    v_add_f32 v244, v253, v245
    v_mfma_f32_16x16x32_bf16 v[168:171], v[88:91], a[108:111], v[168:171]
    v_rcp_f32 v244, v244
    v_mfma_f32_16x16x32_bf16 v[172:175], v[88:91], a[156:159], 0
    v_mov_b32 v253, v244
    v_mfma_f32_16x16x32_bf16 v[172:175], v[52:55], a[152:155], v[172:175]
    v_mfma_f32_16x16x32_bf16 v[172:175], v[28:31], a[148:151], v[172:175]
    v_permlane32_swap_b32 v244, v253
    v_mfma_f32_16x16x32_bf16 v[172:175], v[20:23], a[144:147], v[172:175]
    s_waitcnt lgkmcnt(0)
    v_mov_b32 v245, v244
    v_mov_b32 v242, v253
    v_mfma_f32_16x16x32_bf16 v[172:175], v[48:51], a[160:163], v[172:175]
    ds_read_b64_tr_b16 v[20:21], v254 offset:32768
    v_mfma_f32_16x16x32_bf16 v[172:175], v[76:79], a[164:167], v[172:175]
    ds_read_b64_tr_b16 v[22:23], v254 offset:34816
    v_mfma_f32_16x16x32_bf16 v[172:175], v[112:115], a[168:171], v[172:175]
    ds_read_b64_tr_b16 v[28:29], v254 offset:36864
    v_mfma_f32_16x16x32_bf16 v[172:175], v[116:119], a[172:175], v[172:175]
    ds_read_b64_tr_b16 v[30:31], v254 offset:38912
    v_mfma_f32_16x16x32_bf16 v[168:171], v[116:119], a[124:127], v[168:171]
    ds_read_b64_tr_b16 v[52:53], v254 offset:40960
    v_mfma_f32_16x16x32_bf16 v[168:171], v[112:115], a[120:123], v[168:171]
    ds_read_b64_tr_b16 v[54:55], v254 offset:43008
    v_mfma_f32_16x16x32_bf16 v[168:171], v[76:79], a[116:119], v[168:171]
    ds_read_b64_tr_b16 v[88:89], v254 offset:45056
    v_mfma_f32_16x16x32_bf16 v[168:171], v[48:51], a[112:115], v[168:171]
    s_add_u32 m0, s29, 109312
    ds_read_b64_tr_b16 v[90:91], v254 offset:47104
    v_mfma_f32_16x16x32_bf16 v[108:111], v[48:51], a[64:67], v[108:111]
    global_load_lds_dwordx4 v247, s[26:27] offset:1280
    v_mfma_f32_16x16x32_bf16 v[108:111], v[76:79], a[68:71], v[108:111]
    v_permlane16_swap_b32 v244, v245
    v_mfma_f32_16x16x32_bf16 v[108:111], v[112:115], a[72:75], v[108:111]
    v_xor_b32 v254, 16384, v255
    v_mul_f32 v44, v44, v244
    v_mfma_f32_16x16x32_bf16 v[108:111], v[116:119], a[76:79], v[108:111]
    v_mul_f32 v45, v45, v244
    v_mul_f32 v46, v46, v244
    v_mfma_f32_16x16x32_bf16 v[40:43], v[116:119], a[28:31], v[40:43]
    v_mul_f32 v47, v47, v244
    v_mul_f32 v120, v120, v244
    v_mfma_f32_16x16x32_bf16 v[40:43], v[112:115], a[24:27], v[40:43]
    v_mul_f32 v121, v121, v244
    v_mul_f32 v122, v122, v244
    v_mfma_f32_16x16x32_bf16 v[40:43], v[76:79], a[20:23], v[40:43]
    v_mul_f32 v123, v123, v244
    v_cvt_pk_bf16_f32 v240, v44, v45
    v_mfma_f32_16x16x32_bf16 v[40:43], v[48:51], a[16:19], v[40:43]
    s_waitcnt vmcnt(10) lgkmcnt(0)
    s_barrier
    v_cvt_pk_bf16_f32 v239, v46, v47
    v_mfma_f32_16x16x32_bf16 v[40:43], v[20:23], a[32:35], v[40:43]
    ds_read_b64_tr_b16 v[48:49], v254 offset:0
    v_cvt_pk_bf16_f32 v249, v120, v121
    v_mfma_f32_16x16x32_bf16 v[40:43], v[28:31], a[36:39], v[40:43]
    ds_read_b64_tr_b16 v[50:51], v254 offset:2048
    v_cvt_pk_bf16_f32 v243, v122, v123
    v_mfma_f32_16x16x32_bf16 v[40:43], v[52:55], a[40:43], v[40:43]
    ds_read_b64_tr_b16 v[44:45], v254 offset:4096
    v_accvgpr_write_b32 a192, v240
    v_mfma_f32_16x16x32_bf16 v[40:43], v[88:91], a[44:47], v[40:43]
    ds_read_b64_tr_b16 v[46:47], v254 offset:6144
    v_accvgpr_write_b32 a193, v239
    v_mfma_f32_16x16x32_bf16 v[108:111], v[88:91], a[92:95], v[108:111]
    ds_read_b64_tr_b16 v[76:77], v254 offset:8192
    v_accvgpr_write_b32 a194, v249
    v_mfma_f32_16x16x32_bf16 v[108:111], v[52:55], a[88:91], v[108:111]
    ds_read_b64_tr_b16 v[78:79], v254 offset:10240
    v_accvgpr_write_b32 a195, v243
    v_mfma_f32_16x16x32_bf16 v[108:111], v[28:31], a[84:87], v[108:111]
    ds_read_b64_tr_b16 v[112:113], v254 offset:12288
    v_cvt_pk_bf16_f32 v138, v40, v41
    v_mfma_f32_16x16x32_bf16 v[108:111], v[20:23], a[80:83], v[108:111]
    s_add_u32 m0, s29, 114304
    ds_read_b64_tr_b16 v[114:115], v254 offset:14336
    v_cvt_pk_bf16_f32 v139, v42, v43
    v_mfma_f32_16x16x32_bf16 v[168:171], v[20:23], a[128:131], v[168:171]
    global_load_lds_dwordx4 v247, s[4:5] offset:384
    v_mfma_f32_16x16x32_bf16 v[168:171], v[28:31], a[132:135], v[168:171]
    v_permlane16_swap_b32 v253, v242
    v_mfma_f32_16x16x32_bf16 v[168:171], v[52:55], a[136:139], v[168:171]
    v_cvt_pk_bf16_f32 v154, v108, v109
    v_cvt_pk_bf16_f32 v155, v110, v111
    v_mfma_f32_16x16x32_bf16 v[168:171], v[88:91], a[140:143], v[168:171]
    v_mul_f32 v124, v124, v244
    v_mul_f32 v125, v125, v244
    v_mfma_f32_16x16x32_bf16 v[172:175], v[88:91], a[188:191], v[172:175]
    v_mul_f32 v126, v126, v244
    v_mul_f32 v127, v127, v244
    v_mfma_f32_16x16x32_bf16 v[172:175], v[52:55], a[184:187], v[172:175]
    v_mul_f32 v128, v128, v244
    v_mul_f32 v129, v129, v244
    v_mfma_f32_16x16x32_bf16 v[172:175], v[28:31], a[180:183], v[172:175]
    v_cvt_pk_bf16_f32 v14, v168, v169
    v_cvt_pk_bf16_f32 v15, v170, v171
    v_mfma_f32_16x16x32_bf16 v[172:175], v[20:23], a[176:179], v[172:175]
    s_waitcnt lgkmcnt(0)
    v_mul_f32 v130, v130, v244
    v_mul_f32 v131, v131, v244
    v_mfma_f32_16x16x32_bf16 v[20:23], v[48:51], a[0:3], 0
    ds_read_b64_tr_b16 v[28:29], v254 offset:16384
    v_cvt_pk_bf16_f32 v249, v124, v125
    v_mfma_f32_16x16x32_bf16 v[20:23], v[44:47], a[4:7], v[20:23]
    ds_read_b64_tr_b16 v[30:31], v254 offset:18432
    v_cvt_pk_bf16_f32 v94, v172, v173
    v_mfma_f32_16x16x32_bf16 v[20:23], v[76:79], a[8:11], v[20:23]
    ds_read_b64_tr_b16 v[40:41], v254 offset:20480
    v_cvt_pk_bf16_f32 v95, v174, v175
    v_mfma_f32_16x16x32_bf16 v[20:23], v[112:115], a[12:15], v[20:23]
    ds_read_b64_tr_b16 v[42:43], v254 offset:22528
    v_cvt_pk_bf16_f32 v244, v126, v127
    v_mfma_f32_16x16x32_bf16 v[52:55], v[112:115], a[60:63], 0
    ds_read_b64_tr_b16 v[88:89], v254 offset:24576
    v_cvt_pk_bf16_f32 v243, v128, v129
    v_mfma_f32_16x16x32_bf16 v[52:55], v[76:79], a[56:59], v[52:55]
    ds_read_b64_tr_b16 v[90:91], v254 offset:26624
    v_cvt_pk_bf16_f32 v241, v130, v131
    v_mfma_f32_16x16x32_bf16 v[52:55], v[44:47], a[52:55], v[52:55]
    ds_read_b64_tr_b16 v[108:109], v254 offset:28672
    v_accvgpr_write_b32 a196, v249
    v_mfma_f32_16x16x32_bf16 v[52:55], v[48:51], a[48:51], v[52:55]
    s_add_u32 m0, s29, 118400
    ds_read_b64_tr_b16 v[110:111], v254 offset:30720
    v_accvgpr_write_b32 a197, v244
    v_mfma_f32_16x16x32_bf16 v[116:119], v[48:51], a[96:99], 0
    global_load_lds_dwordx4 v247, s[6:7] offset:384
    v_mfma_f32_16x16x32_bf16 v[116:119], v[44:47], a[100:103], v[116:119]
    ds_read_b128 v[120:123], v246 offset:4480
    v_accvgpr_write_b32 a198, v243
    v_mfma_f32_16x16x32_bf16 v[116:119], v[76:79], a[104:107], v[116:119]
    ds_read_b128 v[124:127], v246 offset:4608
    v_accvgpr_write_b32 a199, v241
    v_mfma_f32_16x16x32_bf16 v[116:119], v[112:115], a[108:111], v[116:119]
    ds_read_b128 v[128:131], v246 offset:4736
    v_mul_f32 v164, v164, v253
    v_mfma_f32_16x16x32_bf16 v[168:171], v[112:115], a[156:159], 0
    ds_read_b128 v[172:175], v246 offset:4864
    v_mul_f32 v165, v165, v253
    v_mfma_f32_16x16x32_bf16 v[168:171], v[76:79], a[152:155], v[168:171]
    v_mul_f32 v166, v166, v253
    v_mul_f32 v167, v167, v253
    v_mfma_f32_16x16x32_bf16 v[168:171], v[44:47], a[148:151], v[168:171]
    v_mul_f32 v180, v180, v253
    v_mul_f32 v181, v181, v253
    v_mfma_f32_16x16x32_bf16 v[168:171], v[48:51], a[144:147], v[168:171]
    s_waitcnt lgkmcnt(4)
    v_mul_f32 v182, v182, v253
    v_mul_f32 v183, v183, v253
    v_mfma_f32_16x16x32_bf16 v[168:171], v[28:31], a[160:163], v[168:171]
    ds_read_b64_tr_b16 v[44:45], v254 offset:32768
    v_cvt_pk_bf16_f32 v249, v164, v165
    v_mfma_f32_16x16x32_bf16 v[168:171], v[40:43], a[164:167], v[168:171]
    ds_read_b64_tr_b16 v[46:47], v254 offset:34816
    v_cvt_pk_bf16_f32 v244, v166, v167
    v_mfma_f32_16x16x32_bf16 v[168:171], v[88:91], a[168:171], v[168:171]
    ds_read_b64_tr_b16 v[48:49], v254 offset:36864
    v_cvt_pk_bf16_f32 v243, v180, v181
    v_mfma_f32_16x16x32_bf16 v[168:171], v[108:111], a[172:175], v[168:171]
    ds_read_b64_tr_b16 v[50:51], v254 offset:38912
    v_cvt_pk_bf16_f32 v241, v182, v183
    v_mfma_f32_16x16x32_bf16 v[116:119], v[108:111], a[124:127], v[116:119]
    ds_read_b64_tr_b16 v[76:77], v254 offset:40960
    v_mul_f32 v156, v156, v253
    v_mfma_f32_16x16x32_bf16 v[116:119], v[88:91], a[120:123], v[116:119]
    ds_read_b64_tr_b16 v[78:79], v254 offset:43008
    v_mul_f32 v157, v157, v253
    v_mfma_f32_16x16x32_bf16 v[116:119], v[40:43], a[116:119], v[116:119]
    ds_read_b64_tr_b16 v[112:113], v254 offset:45056
    v_mul_f32 v158, v158, v253
    v_mfma_f32_16x16x32_bf16 v[116:119], v[28:31], a[112:115], v[116:119]
    s_add_u32 m0, s29, 122496
    ds_read_b64_tr_b16 v[114:115], v254 offset:47104
    v_mul_f32 v159, v159, v253
    v_mfma_f32_16x16x32_bf16 v[52:55], v[28:31], a[64:67], v[52:55]
    global_load_lds_dwordx4 v247, s[8:9] offset:384
    v_mfma_f32_16x16x32_bf16 v[52:55], v[40:43], a[68:71], v[52:55]
    ds_read_b128 v[164:167], v246 offset:4352
    v_mul_f32 v160, v160, v253
    v_mfma_f32_16x16x32_bf16 v[52:55], v[88:91], a[72:75], v[52:55]
    ds_read_b128 v[176:179], v246 offset:4480
    v_mul_f32 v161, v161, v253
    v_mfma_f32_16x16x32_bf16 v[52:55], v[108:111], a[76:79], v[52:55]
    ds_read_b128 v[180:183], v246 offset:4608
    v_mul_f32 v162, v162, v253
    v_mfma_f32_16x16x32_bf16 v[20:23], v[108:111], a[28:31], v[20:23]
    ds_read_b128 v[208:211], v246 offset:4736
    v_mul_f32 v163, v163, v253
    v_mfma_f32_16x16x32_bf16 v[20:23], v[88:91], a[24:27], v[20:23]
    v_accvgpr_write_b32 a200, v249
    v_accvgpr_write_b32 a201, v244
    v_mfma_f32_16x16x32_bf16 v[20:23], v[40:43], a[20:23], v[20:23]
    v_accvgpr_write_b32 a202, v243
    v_accvgpr_write_b32 a203, v241
    v_mfma_f32_16x16x32_bf16 v[20:23], v[28:31], a[16:19], v[20:23]
    s_waitcnt lgkmcnt(12)
    v_cvt_pk_bf16_f32 v254, v156, v157
    v_cvt_pk_bf16_f32 v253, v158, v159
    v_mfma_f32_16x16x32_bf16 v[120:123], v[4:7], v[68:71], v[120:123]
    v_cvt_pk_bf16_f32 v249, v160, v161
    v_cvt_pk_bf16_f32 v244, v162, v163
    v_mfma_f32_16x16x32_bf16 v[120:123], v[132:135], v[96:99], v[120:123]
    v_accvgpr_write_b32 a204, v254
    v_accvgpr_write_b32 a205, v253
    v_mfma_f32_16x16x32_bf16 v[120:123], v[64:67], v[136:139], v[120:123]
    v_accvgpr_write_b32 a206, v249
    v_accvgpr_write_b32 a207, v244
    v_mfma_f32_16x16x32_bf16 v[124:127], v[0:3], v[136:139], v[124:127]
    v_mul_f32 v184, v184, v245
    v_mul_f32 v185, v185, v245
    v_mfma_f32_16x16x32_bf16 v[124:127], v[148:151], v[96:99], v[124:127]
    v_mul_f32 v186, v186, v245
    v_mul_f32 v187, v187, v245
    v_mfma_f32_16x16x32_bf16 v[124:127], v[36:39], v[68:71], v[124:127]
    v_mul_f32 v188, v188, v245
    v_mul_f32 v189, v189, v245
    v_mfma_f32_16x16x32_bf16 v[128:131], v[144:147], v[68:71], v[128:131]
    v_xor_b32 v254, 16416, v255
    v_mul_f32 v190, v190, v245
    v_mfma_f32_16x16x32_bf16 v[128:131], v[100:103], v[96:99], v[128:131]
    v_mul_f32 v191, v191, v245
    v_cvt_pk_bf16_f32 v253, v184, v185
    v_mfma_f32_16x16x32_bf16 v[128:131], v[16:19], v[136:139], v[128:131]
    v_cvt_pk_bf16_f32 v249, v186, v187
    v_cvt_pk_bf16_f32 v244, v188, v189
    v_mfma_f32_16x16x32_bf16 v[172:175], v[32:35], v[136:139], v[172:175]
    v_cvt_pk_bf16_f32 v243, v190, v191
    v_accvgpr_write_b32 a208, v253
    v_mfma_f32_16x16x32_bf16 v[172:175], v[56:59], v[96:99], v[172:175]
    v_accvgpr_write_b32 a209, v249
G_6:
    s_cbranch_vccnz G_10
    v_accvgpr_write_b32 a210, v244
    v_mfma_f32_16x16x32_bf16 v[172:175], v[84:87], v[68:71], v[172:175]
    s_waitcnt lgkmcnt(4)
    v_accvgpr_write_b32 a211, v243
    v_mul_f32 v192, v192, v245
    v_mfma_f32_16x16x32_bf16 v[20:23], v[44:47], a[32:35], v[20:23]
    ds_read_b64_tr_b16 v[28:29], v254 offset:0
    v_mul_f32 v193, v193, v245
    v_mfma_f32_16x16x32_bf16 v[20:23], v[48:51], a[36:39], v[20:23]
    ds_read_b64_tr_b16 v[30:31], v254 offset:2048
    v_mul_f32 v194, v194, v245
    v_mfma_f32_16x16x32_bf16 v[20:23], v[76:79], a[40:43], v[20:23]
    ds_read_b64_tr_b16 v[40:41], v254 offset:4096
    v_mul_f32 v195, v195, v245
    v_mfma_f32_16x16x32_bf16 v[20:23], v[112:115], a[44:47], v[20:23]
    ds_read_b64_tr_b16 v[42:43], v254 offset:6144
    v_mul_f32 v196, v196, v245
    v_mfma_f32_16x16x32_bf16 v[52:55], v[112:115], a[92:95], v[52:55]
    ds_read_b64_tr_b16 v[68:69], v254 offset:8192
    v_mul_f32 v197, v197, v245
    v_mfma_f32_16x16x32_bf16 v[52:55], v[76:79], a[88:91], v[52:55]
    ds_read_b64_tr_b16 v[70:71], v254 offset:10240
    v_mul_f32 v198, v198, v245
    v_mfma_f32_16x16x32_bf16 v[52:55], v[48:51], a[84:87], v[52:55]
    ds_read_b64_tr_b16 v[88:89], v254 offset:12288
    v_cvt_pk_bf16_f32 v96, v20, v21
    v_mfma_f32_16x16x32_bf16 v[52:55], v[44:47], a[80:83], v[52:55]
    s_add_u32 m0, s29, 126592
    ds_read_b64_tr_b16 v[90:91], v254 offset:14336
    v_cvt_pk_bf16_f32 v97, v22, v23
    v_mfma_f32_16x16x32_bf16 v[116:119], v[44:47], a[128:131], v[116:119]
    global_load_lds_dwordx4 v247, s[10:11] offset:384
    v_mfma_f32_16x16x32_bf16 v[116:119], v[48:51], a[132:135], v[116:119]
    ds_read_b128 v[20:23], v246 offset:4224
    v_mul_f32 v199, v199, v245
    v_mfma_f32_16x16x32_bf16 v[116:119], v[76:79], a[136:139], v[116:119]
    ds_read_b128 v[108:111], v246 offset:4352
    v_cvt_pk_bf16_f32 v136, v52, v53
    v_mfma_f32_16x16x32_bf16 v[116:119], v[112:115], a[140:143], v[116:119]
    ds_read_b128 v[156:159], v246 offset:4480
    v_cvt_pk_bf16_f32 v137, v54, v55
    v_mfma_f32_16x16x32_bf16 v[168:171], v[112:115], a[188:191], v[168:171]
    ds_read_b128 v[160:163], v246 offset:4608
    v_cvt_pk_bf16_f32 v253, v192, v193
    v_mfma_f32_16x16x32_bf16 v[168:171], v[76:79], a[184:187], v[168:171]
    v_cvt_pk_bf16_f32 v249, v194, v195
    v_cvt_pk_bf16_f32 v245, v196, v197
    v_mfma_f32_16x16x32_bf16 v[168:171], v[48:51], a[180:183], v[168:171]
    v_cvt_pk_bf16_f32 v52, v116, v117
    v_cvt_pk_bf16_f32 v53, v118, v119
    v_mfma_f32_16x16x32_bf16 v[168:171], v[44:47], a[176:179], v[168:171]
    s_waitcnt lgkmcnt(12)
    v_cvt_pk_bf16_f32 v244, v198, v199
    v_accvgpr_write_b32 a212, v253
    v_mfma_f32_16x16x32_bf16 v[164:167], v[4:7], v[72:75], v[164:167]
    v_accvgpr_write_b32 a213, v249
    v_accvgpr_write_b32 a214, v245
    v_mfma_f32_16x16x32_bf16 v[164:167], v[132:135], v[8:11], v[164:167]
    v_accvgpr_write_b32 a215, v244
    v_mul_f32 v204, v204, v242
    v_mfma_f32_16x16x32_bf16 v[164:167], v[64:67], v[152:155], v[164:167]
    v_cvt_pk_bf16_f32 v44, v168, v169
    v_cvt_pk_bf16_f32 v45, v170, v171
    v_mfma_f32_16x16x32_bf16 v[176:179], v[0:3], v[152:155], v[176:179]
    v_mul_f32 v205, v205, v242
    v_mul_f32 v206, v206, v242
    v_mfma_f32_16x16x32_bf16 v[176:179], v[148:151], v[8:11], v[176:179]
    v_mul_f32 v207, v207, v242
    v_mul_f32 v212, v212, v242
    v_mfma_f32_16x16x32_bf16 v[176:179], v[36:39], v[72:75], v[176:179]
    v_mul_f32 v213, v213, v242
    v_mul_f32 v214, v214, v242
    v_mfma_f32_16x16x32_bf16 v[180:183], v[144:147], v[72:75], v[180:183]
    v_mul_f32 v215, v215, v242
    v_cvt_pk_bf16_f32 v253, v204, v205
    v_mfma_f32_16x16x32_bf16 v[180:183], v[100:103], v[8:11], v[180:183]
    v_cvt_pk_bf16_f32 v249, v206, v207
    v_cvt_pk_bf16_f32 v245, v212, v213
    v_mfma_f32_16x16x32_bf16 v[180:183], v[16:19], v[152:155], v[180:183]
    v_cvt_pk_bf16_f32 v244, v214, v215
    v_mul_f32 v104, v104, v242
    v_mfma_f32_16x16x32_bf16 v[208:211], v[32:35], v[152:155], v[208:211]
    v_mul_f32 v105, v105, v242
    v_mul_f32 v106, v106, v242
    v_mfma_f32_16x16x32_bf16 v[208:211], v[56:59], v[8:11], v[208:211]
    v_mul_f32 v107, v107, v242
    v_mul_f32 v140, v140, v242
    v_mfma_f32_16x16x32_bf16 v[208:211], v[84:87], v[72:75], v[208:211]
    s_waitcnt lgkmcnt(4)
    v_mul_f32 v141, v141, v242
    v_mul_f32 v142, v142, v242
    v_mfma_f32_16x16x32_bf16 v[8:11], v[28:31], a[0:3], 0
    ds_read_b64_tr_b16 v[48:49], v254 offset:16384
    v_mul_f32 v143, v143, v242
    v_mfma_f32_16x16x32_bf16 v[8:11], v[40:43], a[4:7], v[8:11]
    ds_read_b64_tr_b16 v[50:51], v254 offset:18432
    v_accvgpr_write_b32 a216, v253
    v_mfma_f32_16x16x32_bf16 v[8:11], v[68:71], a[8:11], v[8:11]
    ds_read_b64_tr_b16 v[72:73], v254 offset:20480
    v_accvgpr_write_b32 a217, v249
    v_mfma_f32_16x16x32_bf16 v[8:11], v[88:91], a[12:15], v[8:11]
    ds_read_b64_tr_b16 v[74:75], v254 offset:22528
    v_accvgpr_write_b32 a218, v245
    v_mfma_f32_16x16x32_bf16 v[76:79], v[88:91], a[60:63], 0
    ds_read_b64_tr_b16 v[112:113], v254 offset:24576
    v_accvgpr_write_b32 a219, v244
    v_mfma_f32_16x16x32_bf16 v[76:79], v[68:71], a[56:59], v[76:79]
    ds_read_b64_tr_b16 v[114:115], v254 offset:26624
    v_cvt_pk_bf16_f32 v253, v104, v105
    v_mfma_f32_16x16x32_bf16 v[76:79], v[40:43], a[52:55], v[76:79]
    ds_read_b64_tr_b16 v[116:117], v254 offset:28672
    v_cvt_pk_bf16_f32 v249, v106, v107
    v_mfma_f32_16x16x32_bf16 v[76:79], v[28:31], a[48:51], v[76:79]
    s_add_u32 m0, s29, 130688
    ds_read_b64_tr_b16 v[118:119], v254 offset:30720
    v_cvt_pk_bf16_f32 v245, v140, v141
    v_mfma_f32_16x16x32_bf16 v[104:107], v[28:31], a[96:99], 0
    global_load_lds_dwordx4 v247, s[12:13] offset:384
    v_mfma_f32_16x16x32_bf16 v[104:107], v[40:43], a[100:103], v[104:107]
    ds_read_b128 v[152:155], v246 offset:4096
    v_cvt_pk_bf16_f32 v244, v142, v143
    v_mfma_f32_16x16x32_bf16 v[104:107], v[68:71], a[104:107], v[104:107]
    ds_read_b128 v[168:171], v246 offset:4224
    v_accvgpr_write_b32 a220, v253
    v_mfma_f32_16x16x32_bf16 v[104:107], v[88:91], a[108:111], v[104:107]
    ds_read_b128 v[140:143], v246 offset:4352
    v_accvgpr_write_b32 a221, v249
    v_mfma_f32_16x16x32_bf16 v[184:187], v[88:91], a[156:159], 0
    ds_read_b128 v[188:191], v246 offset:4480
    v_accvgpr_write_b32 a222, v245
    v_mfma_f32_16x16x32_bf16 v[184:187], v[68:71], a[152:155], v[184:187]
    v_accvgpr_write_b32 a223, v244
    v_max3_f32 v253, v120, v121, v122
    v_mfma_f32_16x16x32_bf16 v[184:187], v[40:43], a[148:151], v[184:187]
    v_max3_f32 v249, v128, v129, v130
    v_max3_f32 v245, v164, v165, v166
    v_mfma_f32_16x16x32_bf16 v[184:187], v[28:31], a[144:147], v[184:187]
    s_waitcnt lgkmcnt(12)
    v_max3_f32 v244, v180, v181, v182
    v_max3_f32 v253, v253, v123, v124
    v_mfma_f32_16x16x32_bf16 v[20:23], v[4:7], v[80:83], v[20:23]
    v_max3_f32 v249, v249, v131, v172
    v_max3_f32 v245, v245, v167, v176
    v_mfma_f32_16x16x32_bf16 v[20:23], v[132:135], v[24:27], v[20:23]
    v_max3_f32 v244, v244, v183, v208
    v_max3_f32 v253, v253, v125, v126
    v_mfma_f32_16x16x32_bf16 v[20:23], v[64:67], v[12:15], v[20:23]
    v_max3_f32 v249, v249, v173, v174
    v_max3_f32 v245, v245, v177, v178
    v_mfma_f32_16x16x32_bf16 v[108:111], v[0:3], v[12:15], v[108:111]
    v_max3_f32 v244, v244, v209, v210
    v_max_f32 v253, v253, v127
    v_mfma_f32_16x16x32_bf16 v[108:111], v[148:151], v[24:27], v[108:111]
    v_max_f32 v249, v249, v175
    v_max_f32 v245, v245, v179
    v_mfma_f32_16x16x32_bf16 v[108:111], v[36:39], v[80:83], v[108:111]
    v_max3_f32 v243, v20, v21, v22
    v_max_f32 v244, v244, v211
    v_mfma_f32_16x16x32_bf16 v[156:159], v[144:147], v[80:83], v[156:159]
    v_add_f32 v253, v253, v252
    v_add_f32 v249, v249, v251
    v_mfma_f32_16x16x32_bf16 v[156:159], v[100:103], v[24:27], v[156:159]
    v_add_f32 v245, v245, v252
    v_add_f32 v244, v244, v251
    v_mfma_f32_16x16x32_bf16 v[156:159], v[16:19], v[12:15], v[156:159]
    v_max3_f32 v243, v243, v23, v108
    v_max3_f32 v243, v243, v109, v110
    v_mfma_f32_16x16x32_bf16 v[160:163], v[32:35], v[12:15], v[160:163]
    v_max_f32 v243, v243, v111
    v_add_f32 v243, v243, v251
    v_mfma_f32_16x16x32_bf16 v[160:163], v[56:59], v[24:27], v[160:163]
    v_max_f32 v242, v253, v249
    v_max_f32 v241, v245, v244
    v_mfma_f32_16x16x32_bf16 v[160:163], v[84:87], v[80:83], v[160:163]
    s_waitcnt lgkmcnt(4)
    v_max3_f32 v253, v156, v157, v158
    v_mfma_f32_16x16x32_bf16 v[184:187], v[48:51], a[160:163], v[184:187]
    ds_read_b64_tr_b16 v[12:13], v254 offset:32768
    v_mfma_f32_16x16x32_bf16 v[184:187], v[72:75], a[164:167], v[184:187]
    ds_read_b64_tr_b16 v[14:15], v254 offset:34816
    v_mfma_f32_16x16x32_bf16 v[184:187], v[112:115], a[168:171], v[184:187]
    ds_read_b64_tr_b16 v[24:25], v254 offset:36864
    v_max3_f32 v253, v253, v159, v160
    v_mfma_f32_16x16x32_bf16 v[184:187], v[116:119], a[172:175], v[184:187]
    ds_read_b64_tr_b16 v[26:27], v254 offset:38912
    v_max3_f32 v253, v253, v161, v162
    v_mfma_f32_16x16x32_bf16 v[104:107], v[116:119], a[124:127], v[104:107]
    ds_read_b64_tr_b16 v[28:29], v254 offset:40960
    v_max_f32 v253, v253, v163
    v_mfma_f32_16x16x32_bf16 v[104:107], v[112:115], a[120:123], v[104:107]
    ds_read_b64_tr_b16 v[30:31], v254 offset:43008
    v_add_f32 v253, v253, v252
    v_mfma_f32_16x16x32_bf16 v[104:107], v[72:75], a[116:119], v[104:107]
    ds_read_b64_tr_b16 v[40:41], v254 offset:45056
    v_max_f32 v249, v253, v243
    v_mfma_f32_16x16x32_bf16 v[104:107], v[48:51], a[112:115], v[104:107]
    s_add_u32 m0, s29, 134784
    ds_read_b64_tr_b16 v[42:43], v254 offset:47104
    v_mfma_f32_16x16x32_bf16 v[76:79], v[48:51], a[64:67], v[76:79]
    global_load_lds_dwordx4 v247, s[14:15] offset:384
    v_mfma_f32_16x16x32_bf16 v[76:79], v[72:75], a[68:71], v[76:79]
    v_permlane32_swap_b32 v242, v241
    v_mfma_f32_16x16x32_bf16 v[76:79], v[112:115], a[72:75], v[76:79]
    v_max_f32 v254, v242, v241
    v_mfma_f32_16x16x32_bf16 v[76:79], v[116:119], a[76:79], v[76:79]
    v_mfma_f32_16x16x32_bf16 v[8:11], v[116:119], a[28:31], v[8:11]
    v_mfma_f32_16x16x32_bf16 v[8:11], v[112:115], a[24:27], v[8:11]
    v_mfma_f32_16x16x32_bf16 v[8:11], v[72:75], a[20:23], v[8:11]
    v_mfma_f32_16x16x32_bf16 v[8:11], v[48:51], a[16:19], v[8:11]
    s_waitcnt lgkmcnt(8)
    v_mfma_f32_16x16x32_bf16 v[152:155], v[4:7], v[200:203], v[152:155]
    v_mfma_f32_16x16x32_bf16 v[152:155], v[132:135], v[60:63], v[152:155]
    v_mfma_f32_16x16x32_bf16 v[152:155], v[64:67], v[92:95], v[152:155]
    v_mfma_f32_16x16x32_bf16 v[168:171], v[0:3], v[92:95], v[168:171]
    v_mfma_f32_16x16x32_bf16 v[168:171], v[148:151], v[60:63], v[168:171]
    v_mfma_f32_16x16x32_bf16 v[168:171], v[36:39], v[200:203], v[168:171]
    v_mfma_f32_16x16x32_bf16 v[140:143], v[144:147], v[200:203], v[140:143]
    v_xor_b32 v253, 16448, v255
    v_mfma_f32_16x16x32_bf16 v[140:143], v[100:103], v[60:63], v[140:143]
    v_mfma_f32_16x16x32_bf16 v[140:143], v[16:19], v[92:95], v[140:143]
    v_mfma_f32_16x16x32_bf16 v[188:191], v[32:35], v[92:95], v[188:191]
    v_max3_f32 v245, v152, v153, v154
    v_mfma_f32_16x16x32_bf16 v[188:191], v[56:59], v[60:63], v[188:191]
    v_mfma_f32_16x16x32_bf16 v[188:191], v[84:87], v[200:203], v[188:191]
    s_waitcnt lgkmcnt(0)
    v_max3_f32 v245, v245, v155, v168
    v_max3_f32 v245, v245, v169, v170
    v_mfma_f32_16x16x32_bf16 v[8:11], v[12:15], a[32:35], v[8:11]
    ds_read_b64_tr_b16 v[0:1], v253 offset:0
    v_max3_f32 v244, v140, v141, v142
    v_mfma_f32_16x16x32_bf16 v[8:11], v[24:27], a[36:39], v[8:11]
    ds_read_b64_tr_b16 v[2:3], v253 offset:2048
    v_max3_f32 v244, v244, v143, v188
    v_mfma_f32_16x16x32_bf16 v[8:11], v[28:31], a[40:43], v[8:11]
    ds_read_b64_tr_b16 v[4:5], v253 offset:4096
    v_max3_f32 v244, v244, v189, v190
    v_mfma_f32_16x16x32_bf16 v[8:11], v[40:43], a[44:47], v[8:11]
    ds_read_b64_tr_b16 v[6:7], v253 offset:6144
    v_max_f32 v244, v244, v191
    v_mfma_f32_16x16x32_bf16 v[76:79], v[40:43], a[92:95], v[76:79]
    ds_read_b64_tr_b16 v[16:17], v253 offset:8192
    v_max_f32 v245, v245, v171
    v_mfma_f32_16x16x32_bf16 v[76:79], v[28:31], a[88:91], v[76:79]
    ds_read_b64_tr_b16 v[18:19], v253 offset:10240
    v_add_f32 v244, v244, v252
    v_mfma_f32_16x16x32_bf16 v[76:79], v[24:27], a[84:87], v[76:79]
    ds_read_b64_tr_b16 v[32:33], v253 offset:12288
    v_cvt_pk_bf16_f32 v98, v8, v9
    v_mfma_f32_16x16x32_bf16 v[76:79], v[12:15], a[80:83], v[76:79]
    s_add_u32 m0, s29, 138880
    ds_read_b64_tr_b16 v[34:35], v253 offset:14336
    v_cvt_pk_bf16_f32 v99, v10, v11
    v_mfma_f32_16x16x32_bf16 v[104:107], v[12:15], a[128:131], v[104:107]
    global_load_lds_dwordx4 v247, s[16:17] offset:384
    v_mfma_f32_16x16x32_bf16 v[104:107], v[24:27], a[132:135], v[104:107]
    v_add_f32 v245, v245, v251
    v_max_f32 v243, v244, v245
    v_mfma_f32_16x16x32_bf16 v[104:107], v[28:31], a[136:139], v[104:107]
    v_cvt_pk_bf16_f32 v138, v76, v77
    v_cvt_pk_bf16_f32 v139, v78, v79
    v_mfma_f32_16x16x32_bf16 v[104:107], v[40:43], a[140:143], v[104:107]
    v_permlane32_swap_b32 v249, v243
    v_mfma_f32_16x16x32_bf16 v[184:187], v[40:43], a[188:191], v[184:187]
    v_max_f32 v245, v249, v243
    v_mfma_f32_16x16x32_bf16 v[184:187], v[28:31], a[184:187], v[184:187]
    v_mfma_f32_16x16x32_bf16 v[184:187], v[24:27], a[180:183], v[184:187]
    v_permlane16_swap_b32 v254, v245
    v_mfma_f32_16x16x32_bf16 v[184:187], v[12:15], a[176:179], v[184:187]
    s_waitcnt lgkmcnt(0)
    v_cvt_pk_bf16_f32 v54, v104, v105
    v_cvt_pk_bf16_f32 v55, v106, v107
    v_mfma_f32_16x16x32_bf16 v[8:11], v[0:3], a[0:3], 0
    ds_read_b64_tr_b16 v[12:13], v253 offset:16384
    v_max_f32 v249, v254, v245
    v_mfma_f32_16x16x32_bf16 v[8:11], v[4:7], a[4:7], v[8:11]
    ds_read_b64_tr_b16 v[14:15], v253 offset:18432
    v_cvt_pk_bf16_f32 v46, v184, v185
    v_mfma_f32_16x16x32_bf16 v[8:11], v[16:19], a[8:11], v[8:11]
    ds_read_b64_tr_b16 v[24:25], v253 offset:20480
    v_cvt_pk_bf16_f32 v47, v186, v187
    v_mfma_f32_16x16x32_bf16 v[8:11], v[32:35], a[12:15], v[8:11]
    ds_read_b64_tr_b16 v[26:27], v253 offset:22528
    v_mov_b32 v254, v249
    v_mfma_f32_16x16x32_bf16 v[28:31], v[32:35], a[60:63], 0
    ds_read_b64_tr_b16 v[36:37], v253 offset:24576
    v_mfma_f32_16x16x32_bf16 v[28:31], v[16:19], a[56:59], v[28:31]
    ds_read_b64_tr_b16 v[38:39], v253 offset:26624
    v_mfma_f32_16x16x32_bf16 v[28:31], v[4:7], a[52:55], v[28:31]
    ds_read_b64_tr_b16 v[40:41], v253 offset:28672
    v_mfma_f32_16x16x32_bf16 v[28:31], v[0:3], a[48:51], v[28:31]
    s_add_u32 m0, s29, 142976
    ds_read_b64_tr_b16 v[42:43], v253 offset:30720
    v_mfma_f32_16x16x32_bf16 v[48:51], v[0:3], a[96:99], 0
    global_load_lds_dwordx4 v247, s[18:19] offset:384
    v_mfma_f32_16x16x32_bf16 v[48:51], v[4:7], a[100:103], v[48:51]
    v_permlane32_swap_b32 v249, v254
    v_mfma_f32_16x16x32_bf16 v[48:51], v[16:19], a[104:107], v[48:51]
    v_mov_b32 v245, v249
    v_mov_b32 v244, v254
    v_mfma_f32_16x16x32_bf16 v[48:51], v[32:35], a[108:111], v[48:51]
    v_permlane16_swap_b32 v249, v245
    v_mfma_f32_16x16x32_bf16 v[56:59], v[32:35], a[156:159], 0
    v_permlane16_swap_b32 v254, v244
    v_mfma_f32_16x16x32_bf16 v[56:59], v[16:19], a[152:155], v[56:59]
    v_fma_f32 v243, v249, s32, v248
    v_fma_f32 v242, v254, s32, v248
    v_mfma_f32_16x16x32_bf16 v[56:59], v[4:7], a[148:151], v[56:59]
    v_fma_f32 v241, v245, s32, v250
    v_fma_f32 v240, v244, s32, v250
    v_mfma_f32_16x16x32_bf16 v[56:59], v[0:3], a[144:147], v[56:59]
    s_waitcnt lgkmcnt(0)
    v_fma_f32 v120, v120, s31, v243
    v_fma_f32 v121, v121, s31, v243
    v_mfma_f32_16x16x32_bf16 v[56:59], v[12:15], a[160:163], v[56:59]
    ds_read_b64_tr_b16 v[0:1], v253 offset:32768
    v_fma_f32 v164, v164, s31, v242
    v_mfma_f32_16x16x32_bf16 v[56:59], v[24:27], a[164:167], v[56:59]
    ds_read_b64_tr_b16 v[2:3], v253 offset:34816
    v_fma_f32 v165, v165, s31, v242
    v_mfma_f32_16x16x32_bf16 v[56:59], v[36:39], a[168:171], v[56:59]
    ds_read_b64_tr_b16 v[4:5], v253 offset:36864
    v_fma_f32 v20, v20, s31, v241
    v_mfma_f32_16x16x32_bf16 v[56:59], v[40:43], a[172:175], v[56:59]
    ds_read_b64_tr_b16 v[6:7], v253 offset:38912
    v_fma_f32 v21, v21, s31, v241
    v_mfma_f32_16x16x32_bf16 v[48:51], v[40:43], a[124:127], v[48:51]
    ds_read_b64_tr_b16 v[16:17], v253 offset:40960
    v_fma_f32 v152, v152, s31, v240
    v_mfma_f32_16x16x32_bf16 v[48:51], v[36:39], a[120:123], v[48:51]
    ds_read_b64_tr_b16 v[18:19], v253 offset:43008
    v_fma_f32 v153, v153, s31, v240
    v_mfma_f32_16x16x32_bf16 v[48:51], v[24:27], a[116:119], v[48:51]
    ds_read_b64_tr_b16 v[32:33], v253 offset:45056
    v_fma_f32 v122, v122, s31, v243
    v_mfma_f32_16x16x32_bf16 v[48:51], v[12:15], a[112:115], v[48:51]
    s_add_u32 m0, s29, 147072
    ds_read_b64_tr_b16 v[34:35], v253 offset:47104
    v_fma_f32 v166, v166, s31, v242
    v_mfma_f32_16x16x32_bf16 v[28:31], v[12:15], a[64:67], v[28:31]
    global_load_lds_dwordx4 v247, s[20:21] offset:384
    v_mfma_f32_16x16x32_bf16 v[28:31], v[24:27], a[68:71], v[28:31]
    v_exp_f32 v120, v120
    v_mfma_f32_16x16x32_bf16 v[28:31], v[36:39], a[72:75], v[28:31]
    v_xor_b32 v253, 16480, v255
    v_fma_f32 v22, v22, s31, v241
    v_mfma_f32_16x16x32_bf16 v[28:31], v[40:43], a[76:79], v[28:31]
    v_exp_f32 v121, v121
    v_mfma_f32_16x16x32_bf16 v[8:11], v[40:43], a[28:31], v[8:11]
    v_exp_f32 v164, v164
    v_mfma_f32_16x16x32_bf16 v[8:11], v[36:39], a[24:27], v[8:11]
    v_exp_f32 v165, v165
    v_mfma_f32_16x16x32_bf16 v[8:11], v[24:27], a[20:23], v[8:11]
    v_exp_f32 v20, v20
    v_mfma_f32_16x16x32_bf16 v[8:11], v[12:15], a[16:19], v[8:11]
    s_waitcnt lgkmcnt(0)
    v_exp_f32 v21, v21
    v_mfma_f32_16x16x32_bf16 v[8:11], v[0:3], a[32:35], v[8:11]
    ds_read_b64_tr_b16 v[12:13], v253 offset:0
    v_fma_f32 v154, v154, s31, v240
    v_mfma_f32_16x16x32_bf16 v[8:11], v[4:7], a[36:39], v[8:11]
    ds_read_b64_tr_b16 v[14:15], v253 offset:2048
    v_fma_f32 v123, v123, s31, v243
    v_mfma_f32_16x16x32_bf16 v[8:11], v[16:19], a[40:43], v[8:11]
    ds_read_b64_tr_b16 v[24:25], v253 offset:4096
    v_fma_f32 v167, v167, s31, v242
    v_mfma_f32_16x16x32_bf16 v[8:11], v[32:35], a[44:47], v[8:11]
    ds_read_b64_tr_b16 v[26:27], v253 offset:6144
    v_fma_f32 v23, v23, s31, v241
    v_mfma_f32_16x16x32_bf16 v[28:31], v[32:35], a[92:95], v[28:31]
    ds_read_b64_tr_b16 v[36:37], v253 offset:8192
    v_fma_f32 v155, v155, s31, v240
    v_mfma_f32_16x16x32_bf16 v[28:31], v[16:19], a[88:91], v[28:31]
    ds_read_b64_tr_b16 v[38:39], v253 offset:10240
    v_fma_f32 v124, v124, s31, v243
    v_mfma_f32_16x16x32_bf16 v[28:31], v[4:7], a[84:87], v[28:31]
    ds_read_b64_tr_b16 v[40:41], v253 offset:12288
    v_cvt_pk_bf16_f32 v60, v8, v9
    v_mfma_f32_16x16x32_bf16 v[28:31], v[0:3], a[80:83], v[28:31]
    s_add_u32 m0, s29, 151168
    ds_read_b64_tr_b16 v[42:43], v253 offset:14336
    v_cvt_pk_bf16_f32 v61, v10, v11
    v_mfma_f32_16x16x32_bf16 v[48:51], v[0:3], a[128:131], v[48:51]
    global_load_lds_dwordx4 v247, s[22:23] offset:384
    v_mfma_f32_16x16x32_bf16 v[48:51], v[4:7], a[132:135], v[48:51]
    v_exp_f32 v152, v152
    v_mfma_f32_16x16x32_bf16 v[48:51], v[16:19], a[136:139], v[48:51]
    v_cvt_pk_bf16_f32 v8, v28, v29
    v_cvt_pk_bf16_f32 v9, v30, v31
    v_mfma_f32_16x16x32_bf16 v[48:51], v[32:35], a[140:143], v[48:51]
    v_exp_f32 v153, v153
    v_mfma_f32_16x16x32_bf16 v[56:59], v[32:35], a[188:191], v[56:59]
    v_exp_f32 v122, v122
    v_mfma_f32_16x16x32_bf16 v[56:59], v[16:19], a[184:187], v[56:59]
    v_exp_f32 v166, v166
    v_mfma_f32_16x16x32_bf16 v[56:59], v[4:7], a[180:183], v[56:59]
    v_exp_f32 v22, v22
    v_mfma_f32_16x16x32_bf16 v[56:59], v[0:3], a[176:179], v[56:59]
    s_waitcnt lgkmcnt(0)
    v_cvt_pk_bf16_f32 v4, v48, v49
    v_cvt_pk_bf16_f32 v5, v50, v51
    v_mfma_f32_16x16x32_bf16 v[0:3], v[12:15], a[0:3], 0
    ds_read_b64_tr_b16 v[16:17], v253 offset:16384
    v_fma_f32 v176, v176, s31, v242
    v_mfma_f32_16x16x32_bf16 v[0:3], v[24:27], a[4:7], v[0:3]
    ds_read_b64_tr_b16 v[18:19], v253 offset:18432
    v_cvt_pk_bf16_f32 v28, v56, v57
    v_mfma_f32_16x16x32_bf16 v[0:3], v[36:39], a[8:11], v[0:3]
    ds_read_b64_tr_b16 v[32:33], v253 offset:20480
    v_cvt_pk_bf16_f32 v29, v58, v59
    v_mfma_f32_16x16x32_bf16 v[0:3], v[40:43], a[12:15], v[0:3]
    ds_read_b64_tr_b16 v[34:35], v253 offset:22528
    v_fma_f32 v108, v108, s31, v241
    v_mfma_f32_16x16x32_bf16 v[48:51], v[40:43], a[60:63], 0
    ds_read_b64_tr_b16 v[56:57], v253 offset:24576
    v_fma_f32 v168, v168, s31, v240
    v_mfma_f32_16x16x32_bf16 v[48:51], v[36:39], a[56:59], v[48:51]
    ds_read_b64_tr_b16 v[58:59], v253 offset:26624
    v_add_f32 v239, v120, v121
    v_mfma_f32_16x16x32_bf16 v[48:51], v[24:27], a[52:55], v[48:51]
    ds_read_b64_tr_b16 v[64:65], v253 offset:28672
    v_fma_f32 v125, v125, s31, v243
    v_mfma_f32_16x16x32_bf16 v[48:51], v[12:15], a[48:51], v[48:51]
    s_add_u32 m0, s29, 155264
    ds_read_b64_tr_b16 v[66:67], v253 offset:30720
    v_add_f32 v238, v164, v165
    v_mfma_f32_16x16x32_bf16 v[68:71], v[12:15], a[96:99], 0
    global_load_lds_dwordx4 v247, s[24:25] offset:384
    v_mfma_f32_16x16x32_bf16 v[68:71], v[24:27], a[100:103], v[68:71]
    v_exp_f32 v154, v154
    v_mfma_f32_16x16x32_bf16 v[68:71], v[36:39], a[104:107], v[68:71]
    v_exp_f32 v123, v123
    v_mfma_f32_16x16x32_bf16 v[68:71], v[40:43], a[108:111], v[68:71]
    v_exp_f32 v167, v167
    v_mfma_f32_16x16x32_bf16 v[72:75], v[40:43], a[156:159], 0
    v_exp_f32 v23, v23
    v_mfma_f32_16x16x32_bf16 v[72:75], v[36:39], a[152:155], v[72:75]
    v_exp_f32 v155, v155
    v_mfma_f32_16x16x32_bf16 v[72:75], v[24:27], a[148:151], v[72:75]
    v_exp_f32 v124, v124
    v_mfma_f32_16x16x32_bf16 v[72:75], v[12:15], a[144:147], v[72:75]
    s_waitcnt lgkmcnt(0)
    v_exp_f32 v176, v176
    v_mfma_f32_16x16x32_bf16 v[72:75], v[16:19], a[160:163], v[72:75]
    ds_read_b64_tr_b16 v[12:13], v253 offset:32768
    v_fma_f32 v177, v177, s31, v242
    v_mfma_f32_16x16x32_bf16 v[72:75], v[32:35], a[164:167], v[72:75]
    ds_read_b64_tr_b16 v[14:15], v253 offset:34816
    v_add_f32 v237, v20, v21
    v_mfma_f32_16x16x32_bf16 v[72:75], v[56:59], a[168:171], v[72:75]
    ds_read_b64_tr_b16 v[24:25], v253 offset:36864
    v_fma_f32 v109, v109, s31, v241
    v_mfma_f32_16x16x32_bf16 v[72:75], v[64:67], a[172:175], v[72:75]
    ds_read_b64_tr_b16 v[26:27], v253 offset:38912
    v_add_f32 v236, v152, v153
    v_mfma_f32_16x16x32_bf16 v[68:71], v[64:67], a[124:127], v[68:71]
    ds_read_b64_tr_b16 v[36:37], v253 offset:40960
    v_fma_f32 v169, v169, s31, v240
    v_mfma_f32_16x16x32_bf16 v[68:71], v[56:59], a[120:123], v[68:71]
    ds_read_b64_tr_b16 v[38:39], v253 offset:43008
    v_add_f32 v239, v239, v122
    v_mfma_f32_16x16x32_bf16 v[68:71], v[32:35], a[116:119], v[68:71]
    ds_read_b64_tr_b16 v[40:41], v253 offset:45056
    v_fma_f32 v126, v126, s31, v243
    v_mfma_f32_16x16x32_bf16 v[68:71], v[16:19], a[112:115], v[68:71]
    s_add_u32 m0, s29, 159360
    ds_read_b64_tr_b16 v[42:43], v253 offset:47104
    v_add_f32 v238, v238, v166
    v_mfma_f32_16x16x32_bf16 v[48:51], v[16:19], a[64:67], v[48:51]
    global_load_lds_dwordx4 v247, s[26:27] offset:384
    v_mfma_f32_16x16x32_bf16 v[48:51], v[32:35], a[68:71], v[48:51]
    v_exp_f32 v108, v108
    v_mfma_f32_16x16x32_bf16 v[48:51], v[56:59], a[72:75], v[48:51]
    v_xor_b32 v253, 65536, v255
    v_fma_f32 v178, v178, s31, v242
    v_mfma_f32_16x16x32_bf16 v[48:51], v[64:67], a[76:79], v[48:51]
    v_exp_f32 v168, v168
    v_mfma_f32_16x16x32_bf16 v[0:3], v[64:67], a[28:31], v[0:3]
    v_exp_f32 v125, v125
    v_mfma_f32_16x16x32_bf16 v[0:3], v[56:59], a[24:27], v[0:3]
    v_exp_f32 v177, v177
    v_mfma_f32_16x16x32_bf16 v[0:3], v[32:35], a[20:23], v[0:3]
    v_add_f32 v237, v237, v22
    v_fma_f32 v110, v110, s31, v241
    v_mfma_f32_16x16x32_bf16 v[0:3], v[16:19], a[16:19], v[0:3]
    s_waitcnt vmcnt(12) lgkmcnt(0)
    s_barrier
    v_add_f32 v236, v236, v154
    v_mfma_f32_16x16x32_bf16 v[0:3], v[12:15], a[32:35], v[0:3]
    ds_read_b64_tr_b16 v[16:17], v253 offset:0
    v_fma_f32 v170, v170, s31, v240
    v_mfma_f32_16x16x32_bf16 v[0:3], v[24:27], a[36:39], v[0:3]
    ds_read_b64_tr_b16 v[18:19], v253 offset:2048
    v_fma_f32 v235, v249, s32, v250
    v_mfma_f32_16x16x32_bf16 v[0:3], v[36:39], a[40:43], v[0:3]
    ds_read_b64_tr_b16 v[32:33], v253 offset:4096
    v_add_f32 v239, v239, v123
    v_mfma_f32_16x16x32_bf16 v[0:3], v[40:43], a[44:47], v[0:3]
    ds_read_b64_tr_b16 v[34:35], v253 offset:6144
    v_fma_f32 v127, v127, s31, v243
    v_mfma_f32_16x16x32_bf16 v[48:51], v[40:43], a[92:95], v[48:51]
    ds_read_b64_tr_b16 v[56:57], v253 offset:8192
    v_fma_f32 v249, v254, s32, v250
    v_mfma_f32_16x16x32_bf16 v[48:51], v[36:39], a[88:91], v[48:51]
    ds_read_b64_tr_b16 v[58:59], v253 offset:10240
    v_add_f32 v238, v238, v167
    v_mfma_f32_16x16x32_bf16 v[48:51], v[24:27], a[84:87], v[48:51]
    ds_read_b64_tr_b16 v[64:65], v253 offset:12288
    v_cvt_pk_bf16_f32 v62, v0, v1
    v_mfma_f32_16x16x32_bf16 v[48:51], v[12:15], a[80:83], v[48:51]
    s_add_u32 m0, s29, 15872
    ds_read_b64_tr_b16 v[66:67], v253 offset:14336
    v_cvt_pk_bf16_f32 v63, v2, v3
    v_mfma_f32_16x16x32_bf16 v[68:71], v[12:15], a[128:131], v[68:71]
    global_load_lds_dwordx4 v247, s[4:5] offset:512
    v_mfma_f32_16x16x32_bf16 v[68:71], v[24:27], a[132:135], v[68:71]
    v_exp_f32 v109, v109
    v_mfma_f32_16x16x32_bf16 v[68:71], v[36:39], a[136:139], v[68:71]
    v_cvt_pk_bf16_f32 v10, v48, v49
    v_cvt_pk_bf16_f32 v11, v50, v51
    v_mfma_f32_16x16x32_bf16 v[68:71], v[40:43], a[140:143], v[68:71]
    v_exp_f32 v169, v169
    v_mfma_f32_16x16x32_bf16 v[72:75], v[40:43], a[188:191], v[72:75]
    v_exp_f32 v126, v126
    v_mfma_f32_16x16x32_bf16 v[72:75], v[36:39], a[184:187], v[72:75]
    v_exp_f32 v178, v178
    v_mfma_f32_16x16x32_bf16 v[72:75], v[24:27], a[180:183], v[72:75]
    v_fma_f32 v179, v179, s31, v242
    v_fma_f32 v254, v245, s32, v248
    v_mfma_f32_16x16x32_bf16 v[72:75], v[12:15], a[176:179], v[72:75]
    s_waitcnt lgkmcnt(0)
    v_cvt_pk_bf16_f32 v6, v68, v69
    v_cvt_pk_bf16_f32 v7, v70, v71
    v_mfma_f32_16x16x32_bf16 v[0:3], v[16:19], a[0:3], 0
    ds_read_b64_tr_b16 v[12:13], v253 offset:16384
    v_add_f32 v237, v237, v23
    v_mfma_f32_16x16x32_bf16 v[0:3], v[32:35], a[4:7], v[0:3]
    ds_read_b64_tr_b16 v[14:15], v253 offset:18432
    v_cvt_pk_bf16_f32 v30, v72, v73
    v_mfma_f32_16x16x32_bf16 v[0:3], v[56:59], a[8:11], v[0:3]
    ds_read_b64_tr_b16 v[24:25], v253 offset:20480
    v_cvt_pk_bf16_f32 v31, v74, v75
    v_mfma_f32_16x16x32_bf16 v[0:3], v[64:67], a[12:15], v[0:3]
    ds_read_b64_tr_b16 v[26:27], v253 offset:22528
    v_fma_f32 v111, v111, s31, v241
    v_mfma_f32_16x16x32_bf16 v[36:39], v[64:67], a[60:63], 0
    ds_read_b64_tr_b16 v[40:41], v253 offset:24576
    v_fma_f32 v245, v244, s32, v248
    v_mfma_f32_16x16x32_bf16 v[36:39], v[56:59], a[56:59], v[36:39]
    ds_read_b64_tr_b16 v[42:43], v253 offset:26624
    v_add_f32 v236, v236, v155
    v_mfma_f32_16x16x32_bf16 v[36:39], v[32:35], a[52:55], v[36:39]
    ds_read_b64_tr_b16 v[48:49], v253 offset:28672
    v_fma_f32 v171, v171, s31, v240
    v_mfma_f32_16x16x32_bf16 v[36:39], v[16:19], a[48:51], v[36:39]
    s_add_u32 m0, s29, 19968
    ds_read_b64_tr_b16 v[50:51], v253 offset:30720
    v_add_f32 v239, v239, v124
    v_mfma_f32_16x16x32_bf16 v[68:71], v[16:19], a[96:99], 0
    global_load_lds_dwordx4 v247, s[6:7] offset:512
    v_mfma_f32_16x16x32_bf16 v[68:71], v[32:35], a[100:103], v[68:71]
    v_exp_f32 v110, v110
    v_mfma_f32_16x16x32_bf16 v[68:71], v[56:59], a[104:107], v[68:71]
    v_exp_f32 v170, v170
    v_mfma_f32_16x16x32_bf16 v[68:71], v[64:67], a[108:111], v[68:71]
    v_exp_f32 v127, v127
    v_mfma_f32_16x16x32_bf16 v[72:75], v[64:67], a[156:159], 0
    v_fma_f32 v128, v128, s31, v235
    v_add_f32 v238, v238, v176
G_7:
    s_cbranch_vccnz G_11
    v_mfma_f32_16x16x32_bf16 v[72:75], v[56:59], a[152:155], v[72:75]
    v_exp_f32 v179, v179
    v_mfma_f32_16x16x32_bf16 v[72:75], v[32:35], a[148:151], v[72:75]
    v_fma_f32 v180, v180, s31, v249
    v_add_f32 v237, v237, v108
    v_mfma_f32_16x16x32_bf16 v[72:75], v[16:19], a[144:147], v[72:75]
    s_waitcnt lgkmcnt(0)
    v_exp_f32 v111, v111
    v_mfma_f32_16x16x32_bf16 v[72:75], v[12:15], a[160:163], v[72:75]
    ds_read_b64_tr_b16 v[16:17], v253 offset:32768
    v_fma_f32 v156, v156, s31, v254
    v_mfma_f32_16x16x32_bf16 v[72:75], v[24:27], a[164:167], v[72:75]
    ds_read_b64_tr_b16 v[18:19], v253 offset:34816
    v_add_f32 v236, v236, v168
    v_mfma_f32_16x16x32_bf16 v[72:75], v[40:43], a[168:171], v[72:75]
    ds_read_b64_tr_b16 v[32:33], v253 offset:36864
    v_fma_f32 v140, v140, s31, v245
    v_mfma_f32_16x16x32_bf16 v[72:75], v[48:51], a[172:175], v[72:75]
    ds_read_b64_tr_b16 v[34:35], v253 offset:38912
    v_add_f32 v239, v239, v125
    v_mfma_f32_16x16x32_bf16 v[68:71], v[48:51], a[124:127], v[68:71]
    ds_read_b64_tr_b16 v[56:57], v253 offset:40960
    v_fma_f32 v129, v129, s31, v235
    v_mfma_f32_16x16x32_bf16 v[68:71], v[40:43], a[120:123], v[68:71]
    ds_read_b64_tr_b16 v[58:59], v253 offset:43008
    v_add_f32 v238, v238, v177
    v_mfma_f32_16x16x32_bf16 v[68:71], v[24:27], a[116:119], v[68:71]
    ds_read_b64_tr_b16 v[64:65], v253 offset:45056
    v_fma_f32 v181, v181, s31, v249
    v_mfma_f32_16x16x32_bf16 v[68:71], v[12:15], a[112:115], v[68:71]
    s_add_u32 m0, s29, 24064
    ds_read_b64_tr_b16 v[66:67], v253 offset:47104
    v_add_f32 v237, v237, v109
    v_mfma_f32_16x16x32_bf16 v[36:39], v[12:15], a[64:67], v[36:39]
    global_load_lds_dwordx4 v247, s[8:9] offset:512
    v_mfma_f32_16x16x32_bf16 v[36:39], v[24:27], a[68:71], v[36:39]
    v_exp_f32 v171, v171
    v_mfma_f32_16x16x32_bf16 v[36:39], v[40:43], a[72:75], v[36:39]
    v_xor_b32 v253, 65568, v255
    v_fma_f32 v157, v157, s31, v254
    v_mfma_f32_16x16x32_bf16 v[36:39], v[48:51], a[76:79], v[36:39]
    v_exp_f32 v128, v128
    v_mfma_f32_16x16x32_bf16 v[0:3], v[48:51], a[28:31], v[0:3]
    v_exp_f32 v180, v180
    v_mfma_f32_16x16x32_bf16 v[0:3], v[40:43], a[24:27], v[0:3]
    v_exp_f32 v156, v156
    v_mfma_f32_16x16x32_bf16 v[0:3], v[24:27], a[20:23], v[0:3]
    v_add_f32 v236, v236, v169
    v_fma_f32 v141, v141, s31, v245
    v_mfma_f32_16x16x32_bf16 v[0:3], v[12:15], a[16:19], v[0:3]
    s_waitcnt lgkmcnt(0)
    v_exp_f32 v140, v140
    v_mfma_f32_16x16x32_bf16 v[0:3], v[16:19], a[32:35], v[0:3]
    ds_read_b64_tr_b16 v[12:13], v253 offset:0
    v_add_f32 v239, v239, v126
    v_mfma_f32_16x16x32_bf16 v[0:3], v[32:35], a[36:39], v[0:3]
    ds_read_b64_tr_b16 v[14:15], v253 offset:2048
    v_fma_f32 v130, v130, s31, v235
    v_mfma_f32_16x16x32_bf16 v[0:3], v[56:59], a[40:43], v[0:3]
    ds_read_b64_tr_b16 v[24:25], v253 offset:4096
    v_add_f32 v238, v238, v178
    v_mfma_f32_16x16x32_bf16 v[0:3], v[64:67], a[44:47], v[0:3]
    ds_read_b64_tr_b16 v[26:27], v253 offset:6144
    v_fma_f32 v182, v182, s31, v249
    v_mfma_f32_16x16x32_bf16 v[36:39], v[64:67], a[92:95], v[36:39]
    ds_read_b64_tr_b16 v[40:41], v253 offset:8192
    v_add_f32 v237, v237, v110
    v_mfma_f32_16x16x32_bf16 v[36:39], v[56:59], a[88:91], v[36:39]
    ds_read_b64_tr_b16 v[42:43], v253 offset:10240
    v_fma_f32 v158, v158, s31, v254
    v_mfma_f32_16x16x32_bf16 v[36:39], v[32:35], a[84:87], v[36:39]
    ds_read_b64_tr_b16 v[48:49], v253 offset:12288
    v_cvt_pk_bf16_f32 v76, v0, v1
    v_mfma_f32_16x16x32_bf16 v[36:39], v[16:19], a[80:83], v[36:39]
    s_add_u32 m0, s29, 28160
    ds_read_b64_tr_b16 v[50:51], v253 offset:14336
    v_cvt_pk_bf16_f32 v77, v2, v3
    v_mfma_f32_16x16x32_bf16 v[68:71], v[16:19], a[128:131], v[68:71]
    global_load_lds_dwordx4 v247, s[10:11] offset:512
    v_mfma_f32_16x16x32_bf16 v[68:71], v[32:35], a[132:135], v[68:71]
    v_exp_f32 v129, v129
    v_mfma_f32_16x16x32_bf16 v[68:71], v[56:59], a[136:139], v[68:71]
    v_cvt_pk_bf16_f32 v0, v36, v37
    v_cvt_pk_bf16_f32 v1, v38, v39
    v_mfma_f32_16x16x32_bf16 v[68:71], v[64:67], a[140:143], v[68:71]
    v_exp_f32 v181, v181
    v_mfma_f32_16x16x32_bf16 v[72:75], v[64:67], a[188:191], v[72:75]
    v_exp_f32 v157, v157
    v_mfma_f32_16x16x32_bf16 v[72:75], v[56:59], a[184:187], v[72:75]
    v_add_f32 v236, v236, v170
    v_fma_f32 v142, v142, s31, v245
    v_mfma_f32_16x16x32_bf16 v[72:75], v[32:35], a[180:183], v[72:75]
    v_exp_f32 v141, v141
    v_mfma_f32_16x16x32_bf16 v[72:75], v[16:19], a[176:179], v[72:75]
    s_waitcnt lgkmcnt(0)
    v_cvt_pk_bf16_f32 v32, v68, v69
    v_cvt_pk_bf16_f32 v33, v70, v71
    v_mfma_f32_16x16x32_bf16 v[16:19], v[12:15], a[0:3], 0
    ds_read_b64_tr_b16 v[36:37], v253 offset:16384
    v_add_f32 v239, v239, v127
    v_mfma_f32_16x16x32_bf16 v[16:19], v[24:27], a[4:7], v[16:19]
    ds_read_b64_tr_b16 v[38:39], v253 offset:18432
    v_cvt_pk_bf16_f32 v56, v72, v73
    v_mfma_f32_16x16x32_bf16 v[16:19], v[40:43], a[8:11], v[16:19]
    ds_read_b64_tr_b16 v[64:65], v253 offset:20480
    v_cvt_pk_bf16_f32 v57, v74, v75
    v_mfma_f32_16x16x32_bf16 v[16:19], v[48:51], a[12:15], v[16:19]
    ds_read_b64_tr_b16 v[66:67], v253 offset:22528
    v_fma_f32 v131, v131, s31, v235
    v_mfma_f32_16x16x32_bf16 v[68:71], v[48:51], a[60:63], 0
    ds_read_b64_tr_b16 v[72:73], v253 offset:24576
    v_add_f32 v238, v238, v179
    v_mfma_f32_16x16x32_bf16 v[68:71], v[40:43], a[56:59], v[68:71]
    ds_read_b64_tr_b16 v[74:75], v253 offset:26624
    v_fma_f32 v183, v183, s31, v249
    v_mfma_f32_16x16x32_bf16 v[68:71], v[24:27], a[52:55], v[68:71]
    ds_read_b64_tr_b16 v[80:81], v253 offset:28672
    v_add_f32 v237, v237, v111
    v_mfma_f32_16x16x32_bf16 v[68:71], v[12:15], a[48:51], v[68:71]
    s_add_u32 m0, s29, 32256
    ds_read_b64_tr_b16 v[82:83], v253 offset:30720
    v_fma_f32 v159, v159, s31, v254
    v_mfma_f32_16x16x32_bf16 v[84:87], v[12:15], a[96:99], 0
    global_load_lds_dwordx4 v247, s[12:13] offset:512
    v_mfma_f32_16x16x32_bf16 v[84:87], v[24:27], a[100:103], v[84:87]
    v_exp_f32 v130, v130
    v_mfma_f32_16x16x32_bf16 v[84:87], v[40:43], a[104:107], v[84:87]
    v_exp_f32 v182, v182
    v_mfma_f32_16x16x32_bf16 v[84:87], v[48:51], a[108:111], v[84:87]
    v_exp_f32 v158, v158
    v_mfma_f32_16x16x32_bf16 v[88:91], v[48:51], a[156:159], 0
    v_add_f32 v236, v236, v171
    v_fma_f32 v143, v143, s31, v245
    v_mfma_f32_16x16x32_bf16 v[88:91], v[40:43], a[152:155], v[88:91]
    v_exp_f32 v142, v142
    v_mfma_f32_16x16x32_bf16 v[88:91], v[24:27], a[148:151], v[88:91]
    v_add_f32 v239, v239, v128
    v_fma_f32 v172, v172, s31, v235
    v_mfma_f32_16x16x32_bf16 v[88:91], v[12:15], a[144:147], v[88:91]
    s_waitcnt lgkmcnt(0)
    v_exp_f32 v131, v131
    v_mfma_f32_16x16x32_bf16 v[88:91], v[36:39], a[160:163], v[88:91]
    ds_read_b64_tr_b16 v[12:13], v253 offset:32768
    v_add_f32 v238, v238, v180
    v_mfma_f32_16x16x32_bf16 v[88:91], v[64:67], a[164:167], v[88:91]
    ds_read_b64_tr_b16 v[14:15], v253 offset:34816
    v_fma_f32 v208, v208, s31, v249
    v_mfma_f32_16x16x32_bf16 v[88:91], v[72:75], a[168:171], v[88:91]
    ds_read_b64_tr_b16 v[24:25], v253 offset:36864
    v_add_f32 v237, v237, v156
    v_mfma_f32_16x16x32_bf16 v[88:91], v[80:83], a[172:175], v[88:91]
    ds_read_b64_tr_b16 v[26:27], v253 offset:38912
    v_fma_f32 v160, v160, s31, v254
    v_mfma_f32_16x16x32_bf16 v[84:87], v[80:83], a[124:127], v[84:87]
    ds_read_b64_tr_b16 v[40:41], v253 offset:40960
    v_add_f32 v236, v236, v140
    v_mfma_f32_16x16x32_bf16 v[84:87], v[72:75], a[120:123], v[84:87]
    ds_read_b64_tr_b16 v[42:43], v253 offset:43008
    v_fma_f32 v188, v188, s31, v245
    v_mfma_f32_16x16x32_bf16 v[84:87], v[64:67], a[116:119], v[84:87]
    ds_read_b64_tr_b16 v[48:49], v253 offset:45056
    v_add_f32 v239, v239, v129
    v_mfma_f32_16x16x32_bf16 v[84:87], v[36:39], a[112:115], v[84:87]
    s_add_u32 m0, s29, 36352
    ds_read_b64_tr_b16 v[50:51], v253 offset:47104
    v_fma_f32 v173, v173, s31, v235
    v_mfma_f32_16x16x32_bf16 v[68:71], v[36:39], a[64:67], v[68:71]
    global_load_lds_dwordx4 v247, s[14:15] offset:512
    v_mfma_f32_16x16x32_bf16 v[68:71], v[64:67], a[68:71], v[68:71]
    v_exp_f32 v183, v183
    v_mfma_f32_16x16x32_bf16 v[68:71], v[72:75], a[72:75], v[68:71]
    v_xor_b32 v253, 65600, v255
    v_add_f32 v238, v238, v181
    v_mfma_f32_16x16x32_bf16 v[68:71], v[80:83], a[76:79], v[68:71]
    v_exp_f32 v159, v159
    v_mfma_f32_16x16x32_bf16 v[16:19], v[80:83], a[28:31], v[16:19]
    v_exp_f32 v143, v143
    v_mfma_f32_16x16x32_bf16 v[16:19], v[72:75], a[24:27], v[16:19]
    v_exp_f32 v172, v172
    v_mfma_f32_16x16x32_bf16 v[16:19], v[64:67], a[20:23], v[16:19]
    v_exp_f32 v208, v208
    v_mfma_f32_16x16x32_bf16 v[16:19], v[36:39], a[16:19], v[16:19]
    s_waitcnt lgkmcnt(0)
    v_fma_f32 v209, v209, s31, v249
    v_add_f32 v237, v237, v157
    v_mfma_f32_16x16x32_bf16 v[16:19], v[12:15], a[32:35], v[16:19]
    ds_read_b64_tr_b16 v[36:37], v253 offset:0
    v_fma_f32 v161, v161, s31, v254
    v_mfma_f32_16x16x32_bf16 v[16:19], v[24:27], a[36:39], v[16:19]
    ds_read_b64_tr_b16 v[38:39], v253 offset:2048
    v_add_f32 v236, v236, v141
    v_mfma_f32_16x16x32_bf16 v[16:19], v[40:43], a[40:43], v[16:19]
    ds_read_b64_tr_b16 v[64:65], v253 offset:4096
    v_fma_f32 v189, v189, s31, v245
    v_mfma_f32_16x16x32_bf16 v[16:19], v[48:51], a[44:47], v[16:19]
    ds_read_b64_tr_b16 v[66:67], v253 offset:6144
    v_add_f32 v239, v239, v130
    v_mfma_f32_16x16x32_bf16 v[68:71], v[48:51], a[92:95], v[68:71]
    ds_read_b64_tr_b16 v[72:73], v253 offset:8192
    v_fma_f32 v174, v174, s31, v235
    v_mfma_f32_16x16x32_bf16 v[68:71], v[40:43], a[88:91], v[68:71]
    ds_read_b64_tr_b16 v[74:75], v253 offset:10240
    v_add_f32 v238, v238, v182
    v_mfma_f32_16x16x32_bf16 v[68:71], v[24:27], a[84:87], v[68:71]
    ds_read_b64_tr_b16 v[80:81], v253 offset:12288
    v_cvt_pk_bf16_f32 v78, v16, v17
    v_mfma_f32_16x16x32_bf16 v[68:71], v[12:15], a[80:83], v[68:71]
    s_add_u32 m0, s29, 40448
    ds_read_b64_tr_b16 v[82:83], v253 offset:14336
    v_cvt_pk_bf16_f32 v79, v18, v19
    v_mfma_f32_16x16x32_bf16 v[84:87], v[12:15], a[128:131], v[84:87]
    global_load_lds_dwordx4 v247, s[16:17] offset:512
    v_mfma_f32_16x16x32_bf16 v[84:87], v[24:27], a[132:135], v[84:87]
    v_exp_f32 v160, v160
    v_mfma_f32_16x16x32_bf16 v[84:87], v[40:43], a[136:139], v[84:87]
    v_cvt_pk_bf16_f32 v2, v68, v69
    v_cvt_pk_bf16_f32 v3, v70, v71
    v_mfma_f32_16x16x32_bf16 v[84:87], v[48:51], a[140:143], v[84:87]
    v_exp_f32 v188, v188
    v_mfma_f32_16x16x32_bf16 v[88:91], v[48:51], a[188:191], v[88:91]
    v_exp_f32 v173, v173
    v_mfma_f32_16x16x32_bf16 v[88:91], v[40:43], a[184:187], v[88:91]
    v_exp_f32 v209, v209
    v_mfma_f32_16x16x32_bf16 v[88:91], v[24:27], a[180:183], v[88:91]
    v_fma_f32 v210, v210, s31, v249
    v_add_f32 v237, v237, v158
    v_mfma_f32_16x16x32_bf16 v[88:91], v[12:15], a[176:179], v[88:91]
    s_waitcnt lgkmcnt(0)
    v_cvt_pk_bf16_f32 v34, v84, v85
    v_cvt_pk_bf16_f32 v35, v86, v87
    v_mfma_f32_16x16x32_bf16 v[12:15], v[36:39], a[0:3], 0
    ds_read_b64_tr_b16 v[16:17], v253 offset:16384
    v_fma_f32 v162, v162, s31, v254
    v_mfma_f32_16x16x32_bf16 v[12:15], v[64:67], a[4:7], v[12:15]
    ds_read_b64_tr_b16 v[18:19], v253 offset:18432
    v_cvt_pk_bf16_f32 v58, v88, v89
    v_mfma_f32_16x16x32_bf16 v[12:15], v[72:75], a[8:11], v[12:15]
    ds_read_b64_tr_b16 v[24:25], v253 offset:20480
    v_cvt_pk_bf16_f32 v59, v90, v91
    v_mfma_f32_16x16x32_bf16 v[12:15], v[80:83], a[12:15], v[12:15]
    ds_read_b64_tr_b16 v[26:27], v253 offset:22528
    v_add_f32 v236, v236, v142
    v_mfma_f32_16x16x32_bf16 v[40:43], v[80:83], a[60:63], 0
    ds_read_b64_tr_b16 v[48:49], v253 offset:24576
    v_fma_f32 v190, v190, s31, v245
    v_mfma_f32_16x16x32_bf16 v[40:43], v[72:75], a[56:59], v[40:43]
    ds_read_b64_tr_b16 v[50:51], v253 offset:26624
    v_add_f32 v239, v239, v131
    v_mfma_f32_16x16x32_bf16 v[40:43], v[64:67], a[52:55], v[40:43]
    ds_read_b64_tr_b16 v[68:69], v253 offset:28672
    v_fma_f32 v175, v175, s31, v235
    v_mfma_f32_16x16x32_bf16 v[40:43], v[36:39], a[48:51], v[40:43]
    s_add_u32 m0, s29, 44544
    ds_read_b64_tr_b16 v[70:71], v253 offset:30720
    v_add_f32 v238, v238, v183
    v_mfma_f32_16x16x32_bf16 v[84:87], v[36:39], a[96:99], 0
    global_load_lds_dwordx4 v247, s[18:19] offset:512
    v_mfma_f32_16x16x32_bf16 v[84:87], v[64:67], a[100:103], v[84:87]
    v_exp_f32 v161, v161
    v_mfma_f32_16x16x32_bf16 v[84:87], v[72:75], a[104:107], v[84:87]
    v_exp_f32 v189, v189
    v_mfma_f32_16x16x32_bf16 v[84:87], v[80:83], a[108:111], v[84:87]
    v_exp_f32 v174, v174
    v_mfma_f32_16x16x32_bf16 v[88:91], v[80:83], a[156:159], 0
    v_exp_f32 v210, v210
    v_mfma_f32_16x16x32_bf16 v[88:91], v[72:75], a[152:155], v[88:91]
    v_fma_f32 v211, v211, s31, v249
    v_add_f32 v237, v237, v159
    v_mfma_f32_16x16x32_bf16 v[88:91], v[64:67], a[148:151], v[88:91]
    v_exp_f32 v162, v162
    v_mfma_f32_16x16x32_bf16 v[88:91], v[36:39], a[144:147], v[88:91]
    s_waitcnt lgkmcnt(0)
    v_fma_f32 v163, v163, s31, v254
    v_add_f32 v236, v236, v143
    v_mfma_f32_16x16x32_bf16 v[88:91], v[16:19], a[160:163], v[88:91]
    ds_read_b64_tr_b16 v[36:37], v253 offset:32768
    v_fma_f32 v191, v191, s31, v245
    v_mfma_f32_16x16x32_bf16 v[88:91], v[24:27], a[164:167], v[88:91]
    ds_read_b64_tr_b16 v[38:39], v253 offset:34816
    v_add_f32 v239, v239, v172
    v_mfma_f32_16x16x32_bf16 v[88:91], v[48:51], a[168:171], v[88:91]
    ds_read_b64_tr_b16 v[64:65], v253 offset:36864
    v_add_f32 v238, v238, v208
    v_mfma_f32_16x16x32_bf16 v[88:91], v[68:71], a[172:175], v[88:91]
    ds_read_b64_tr_b16 v[66:67], v253 offset:38912
    v_add_f32 v237, v237, v160
    v_mfma_f32_16x16x32_bf16 v[84:87], v[68:71], a[124:127], v[84:87]
    ds_read_b64_tr_b16 v[72:73], v253 offset:40960
    v_add_f32 v236, v236, v188
    v_mfma_f32_16x16x32_bf16 v[84:87], v[48:51], a[120:123], v[84:87]
    ds_read_b64_tr_b16 v[74:75], v253 offset:43008
    v_add_f32 v239, v239, v173
    v_mfma_f32_16x16x32_bf16 v[84:87], v[24:27], a[116:119], v[84:87]
    ds_read_b64_tr_b16 v[80:81], v253 offset:45056
    v_add_f32 v238, v238, v209
    v_mfma_f32_16x16x32_bf16 v[84:87], v[16:19], a[112:115], v[84:87]
    s_add_u32 m0, s29, 48640
    ds_read_b64_tr_b16 v[82:83], v253 offset:47104
    v_add_f32 v237, v237, v161
    v_mfma_f32_16x16x32_bf16 v[40:43], v[16:19], a[64:67], v[40:43]
    global_load_lds_dwordx4 v247, s[20:21] offset:512
    v_mfma_f32_16x16x32_bf16 v[40:43], v[24:27], a[68:71], v[40:43]
    v_exp_f32 v190, v190
    v_mfma_f32_16x16x32_bf16 v[40:43], v[48:51], a[72:75], v[40:43]
    v_xor_b32 v254, 65632, v255
    v_add_f32 v236, v236, v189
    v_mfma_f32_16x16x32_bf16 v[40:43], v[68:71], a[76:79], v[40:43]
    v_exp_f32 v175, v175
    v_mfma_f32_16x16x32_bf16 v[12:15], v[68:71], a[28:31], v[12:15]
    v_exp_f32 v211, v211
    v_mfma_f32_16x16x32_bf16 v[12:15], v[48:51], a[24:27], v[12:15]
    v_exp_f32 v163, v163
    v_mfma_f32_16x16x32_bf16 v[12:15], v[24:27], a[20:23], v[12:15]
    v_exp_f32 v191, v191
    v_mfma_f32_16x16x32_bf16 v[12:15], v[16:19], a[16:19], v[12:15]
    s_waitcnt lgkmcnt(0)
    v_add_f32 v239, v239, v174
    v_add_f32 v238, v238, v210
    v_mfma_f32_16x16x32_bf16 v[12:15], v[36:39], a[32:35], v[12:15]
    ds_read_b64_tr_b16 v[16:17], v254 offset:0
    v_add_f32 v237, v237, v162
    v_mfma_f32_16x16x32_bf16 v[12:15], v[64:67], a[36:39], v[12:15]
    ds_read_b64_tr_b16 v[18:19], v254 offset:2048
    v_add_f32 v236, v236, v190
    v_mfma_f32_16x16x32_bf16 v[12:15], v[72:75], a[40:43], v[12:15]
    ds_read_b64_tr_b16 v[24:25], v254 offset:4096
    v_add_f32 v239, v239, v175
    v_mfma_f32_16x16x32_bf16 v[12:15], v[80:83], a[44:47], v[12:15]
    ds_read_b64_tr_b16 v[26:27], v254 offset:6144
    v_add_f32 v238, v238, v211
    v_mfma_f32_16x16x32_bf16 v[40:43], v[80:83], a[92:95], v[40:43]
    ds_read_b64_tr_b16 v[48:49], v254 offset:8192
    v_add_f32 v237, v237, v163
    v_mfma_f32_16x16x32_bf16 v[40:43], v[72:75], a[88:91], v[40:43]
    ds_read_b64_tr_b16 v[50:51], v254 offset:10240
    v_add_f32 v236, v236, v191
    v_mfma_f32_16x16x32_bf16 v[40:43], v[64:67], a[84:87], v[40:43]
    ds_read_b64_tr_b16 v[68:69], v254 offset:12288
    v_cvt_pk_bf16_f32 v92, v12, v13
    v_mfma_f32_16x16x32_bf16 v[40:43], v[36:39], a[80:83], v[40:43]
    s_add_u32 m0, s29, 52736
    ds_read_b64_tr_b16 v[70:71], v254 offset:14336
    v_cvt_pk_bf16_f32 v93, v14, v15
    v_mfma_f32_16x16x32_bf16 v[84:87], v[36:39], a[128:131], v[84:87]
    global_load_lds_dwordx4 v247, s[22:23] offset:512
    v_mfma_f32_16x16x32_bf16 v[84:87], v[64:67], a[132:135], v[84:87]
    v_permlane32_swap_b32 v239, v238
    v_mfma_f32_16x16x32_bf16 v[84:87], v[72:75], a[136:139], v[84:87]
    v_cvt_pk_bf16_f32 v12, v40, v41
    v_cvt_pk_bf16_f32 v13, v42, v43
    v_mfma_f32_16x16x32_bf16 v[84:87], v[80:83], a[140:143], v[84:87]
    v_permlane32_swap_b32 v237, v236
    v_mfma_f32_16x16x32_bf16 v[88:91], v[80:83], a[188:191], v[88:91]
    v_add_f32 v253, v239, v238
    v_add_f32 v249, v237, v236
    v_mfma_f32_16x16x32_bf16 v[88:91], v[72:75], a[184:187], v[88:91]
    v_mfma_f32_16x16x32_bf16 v[88:91], v[64:67], a[180:183], v[88:91]
    v_permlane16_swap_b32 v253, v249
    v_mfma_f32_16x16x32_bf16 v[88:91], v[36:39], a[176:179], v[88:91]
    s_waitcnt lgkmcnt(0)
    v_cvt_pk_bf16_f32 v40, v84, v85
    v_cvt_pk_bf16_f32 v41, v86, v87
    v_mfma_f32_16x16x32_bf16 v[36:39], v[16:19], a[0:3], 0
    ds_read_b64_tr_b16 v[64:65], v254 offset:16384
    v_add_f32 v245, v253, v249
    v_mfma_f32_16x16x32_bf16 v[36:39], v[24:27], a[4:7], v[36:39]
    ds_read_b64_tr_b16 v[66:67], v254 offset:18432
    v_cvt_pk_bf16_f32 v72, v88, v89
    v_mfma_f32_16x16x32_bf16 v[36:39], v[48:51], a[8:11], v[36:39]
    ds_read_b64_tr_b16 v[80:81], v254 offset:20480
    v_cvt_pk_bf16_f32 v73, v90, v91
    v_mfma_f32_16x16x32_bf16 v[36:39], v[68:71], a[12:15], v[36:39]
    ds_read_b64_tr_b16 v[82:83], v254 offset:22528
    v_mfma_f32_16x16x32_bf16 v[84:87], v[68:71], a[60:63], 0
    ds_read_b64_tr_b16 v[88:89], v254 offset:24576
    v_mfma_f32_16x16x32_bf16 v[84:87], v[48:51], a[56:59], v[84:87]
    ds_read_b64_tr_b16 v[90:91], v254 offset:26624
    v_mfma_f32_16x16x32_bf16 v[84:87], v[24:27], a[52:55], v[84:87]
    ds_read_b64_tr_b16 v[100:101], v254 offset:28672
    v_mfma_f32_16x16x32_bf16 v[84:87], v[16:19], a[48:51], v[84:87]
    s_add_u32 m0, s29, 56832
    ds_read_b64_tr_b16 v[102:103], v254 offset:30720
    v_mfma_f32_16x16x32_bf16 v[104:107], v[16:19], a[96:99], 0
    global_load_lds_dwordx4 v247, s[24:25] offset:512
    v_mfma_f32_16x16x32_bf16 v[104:107], v[24:27], a[100:103], v[104:107]
    v_rcp_f32 v245, v245
    v_mfma_f32_16x16x32_bf16 v[104:107], v[48:51], a[104:107], v[104:107]
    v_mov_b32 v253, v245
    v_mfma_f32_16x16x32_bf16 v[104:107], v[68:71], a[108:111], v[104:107]
    v_mfma_f32_16x16x32_bf16 v[112:115], v[68:71], a[156:159], 0
    v_permlane32_swap_b32 v245, v253
    v_mfma_f32_16x16x32_bf16 v[112:115], v[48:51], a[152:155], v[112:115]
    v_mov_b32 v249, v245
    v_mov_b32 v244, v253
    v_mfma_f32_16x16x32_bf16 v[112:115], v[24:27], a[148:151], v[112:115]
    v_permlane16_swap_b32 v245, v249
    v_mfma_f32_16x16x32_bf16 v[112:115], v[16:19], a[144:147], v[112:115]
    s_waitcnt lgkmcnt(0)
    v_mul_f32 v120, v120, v245
    v_mul_f32 v121, v121, v245
    v_mfma_f32_16x16x32_bf16 v[112:115], v[64:67], a[160:163], v[112:115]
    ds_read_b64_tr_b16 v[16:17], v254 offset:32768
    v_mul_f32 v122, v122, v245
    v_mfma_f32_16x16x32_bf16 v[112:115], v[80:83], a[164:167], v[112:115]
    ds_read_b64_tr_b16 v[18:19], v254 offset:34816
    v_mul_f32 v123, v123, v245
    v_mfma_f32_16x16x32_bf16 v[112:115], v[88:91], a[168:171], v[112:115]
    ds_read_b64_tr_b16 v[24:25], v254 offset:36864
    v_mul_f32 v124, v124, v245
    v_mfma_f32_16x16x32_bf16 v[112:115], v[100:103], a[172:175], v[112:115]
    ds_read_b64_tr_b16 v[26:27], v254 offset:38912
    v_mul_f32 v125, v125, v245
    v_mfma_f32_16x16x32_bf16 v[104:107], v[100:103], a[124:127], v[104:107]
    ds_read_b64_tr_b16 v[48:49], v254 offset:40960
    v_mul_f32 v126, v126, v245
    v_mfma_f32_16x16x32_bf16 v[104:107], v[88:91], a[120:123], v[104:107]
    ds_read_b64_tr_b16 v[50:51], v254 offset:43008
    v_mul_f32 v127, v127, v245
    v_mfma_f32_16x16x32_bf16 v[104:107], v[80:83], a[116:119], v[104:107]
    ds_read_b64_tr_b16 v[68:69], v254 offset:45056
    v_cvt_pk_bf16_f32 v243, v120, v121
    v_mfma_f32_16x16x32_bf16 v[104:107], v[64:67], a[112:115], v[104:107]
    s_add_u32 m0, s29, 60928
    ds_read_b64_tr_b16 v[70:71], v254 offset:47104
    v_cvt_pk_bf16_f32 v242, v122, v123
    v_mfma_f32_16x16x32_bf16 v[84:87], v[64:67], a[64:67], v[84:87]
    global_load_lds_dwordx4 v247, s[26:27] offset:512
    v_mfma_f32_16x16x32_bf16 v[84:87], v[80:83], a[68:71], v[84:87]
    v_cvt_pk_bf16_f32 v254, v124, v125
    v_cvt_pk_bf16_f32 v241, v126, v127
    v_mfma_f32_16x16x32_bf16 v[84:87], v[88:91], a[72:75], v[84:87]
    v_xor_b32 v240, 114688, v255
    v_accvgpr_write_b32 a224, v243
    v_mfma_f32_16x16x32_bf16 v[84:87], v[100:103], a[76:79], v[84:87]
    v_permlane16_swap_b32 v253, v244
    v_mfma_f32_16x16x32_bf16 v[36:39], v[100:103], a[28:31], v[36:39]
    v_accvgpr_write_b32 a225, v242
    v_accvgpr_write_b32 a226, v254
    v_mfma_f32_16x16x32_bf16 v[36:39], v[88:91], a[24:27], v[36:39]
    v_accvgpr_write_b32 a227, v241
    v_mul_f32 v128, v128, v245
    v_mfma_f32_16x16x32_bf16 v[36:39], v[80:83], a[20:23], v[36:39]
    v_mul_f32 v129, v129, v245
    v_mul_f32 v130, v130, v245
    v_mfma_f32_16x16x32_bf16 v[36:39], v[64:67], a[16:19], v[36:39]
    s_waitcnt vmcnt(12) lgkmcnt(0)
    s_barrier
    v_mul_f32 v131, v131, v245
    v_mfma_f32_16x16x32_bf16 v[36:39], v[16:19], a[32:35], v[36:39]
    ds_read_b64_tr_b16 v[64:65], v240 offset:0
    v_mul_f32 v172, v172, v245
    v_mfma_f32_16x16x32_bf16 v[36:39], v[24:27], a[36:39], v[36:39]
    ds_read_b64_tr_b16 v[66:67], v240 offset:2048
    v_mul_f32 v173, v173, v245
    v_mfma_f32_16x16x32_bf16 v[36:39], v[48:51], a[40:43], v[36:39]
    ds_read_b64_tr_b16 v[80:81], v240 offset:4096
    v_mul_f32 v174, v174, v245
    v_mfma_f32_16x16x32_bf16 v[36:39], v[68:71], a[44:47], v[36:39]
    ds_read_b64_tr_b16 v[82:83], v240 offset:6144
    v_mul_f32 v175, v175, v245
    v_mfma_f32_16x16x32_bf16 v[84:87], v[68:71], a[92:95], v[84:87]
    ds_read_b64_tr_b16 v[88:89], v240 offset:8192
    v_cvt_pk_bf16_f32 v254, v128, v129
    v_mfma_f32_16x16x32_bf16 v[84:87], v[48:51], a[88:91], v[84:87]
    ds_read_b64_tr_b16 v[90:91], v240 offset:10240
    v_cvt_pk_bf16_f32 v245, v130, v131
    v_mfma_f32_16x16x32_bf16 v[84:87], v[24:27], a[84:87], v[84:87]
    ds_read_b64_tr_b16 v[100:101], v240 offset:12288
    v_cvt_pk_bf16_f32 v94, v36, v37
    v_mfma_f32_16x16x32_bf16 v[84:87], v[16:19], a[80:83], v[84:87]
    s_add_u32 m0, s29, 64128
    ds_read_b64_tr_b16 v[102:103], v240 offset:14336
    v_cvt_pk_bf16_f32 v95, v38, v39
    v_mfma_f32_16x16x32_bf16 v[104:107], v[16:19], a[128:131], v[104:107]
    global_load_lds_dwordx4 v247, s[4:5] offset:1408
    v_mfma_f32_16x16x32_bf16 v[104:107], v[24:27], a[132:135], v[104:107]
    v_cvt_pk_bf16_f32 v243, v172, v173
    v_cvt_pk_bf16_f32 v242, v174, v175
    v_mfma_f32_16x16x32_bf16 v[104:107], v[48:51], a[136:139], v[104:107]
    v_cvt_pk_bf16_f32 v14, v84, v85
    v_cvt_pk_bf16_f32 v15, v86, v87
    v_mfma_f32_16x16x32_bf16 v[104:107], v[68:71], a[140:143], v[104:107]
    v_accvgpr_write_b32 a228, v254
    v_accvgpr_write_b32 a229, v245
    v_mfma_f32_16x16x32_bf16 v[112:115], v[68:71], a[188:191], v[112:115]
    v_accvgpr_write_b32 a230, v243
    v_accvgpr_write_b32 a231, v242
    v_mfma_f32_16x16x32_bf16 v[112:115], v[48:51], a[184:187], v[112:115]
    v_mul_f32 v180, v180, v253
    v_mul_f32 v181, v181, v253
    v_mfma_f32_16x16x32_bf16 v[112:115], v[24:27], a[180:183], v[112:115]
    v_cvt_pk_bf16_f32 v42, v104, v105
    v_cvt_pk_bf16_f32 v43, v106, v107
    v_mfma_f32_16x16x32_bf16 v[112:115], v[16:19], a[176:179], v[112:115]
    s_waitcnt lgkmcnt(0)
    v_mul_f32 v182, v182, v253
    v_mul_f32 v183, v183, v253
    v_mfma_f32_16x16x32_bf16 v[16:19], v[64:67], a[0:3], 0
    ds_read_b64_tr_b16 v[24:25], v240 offset:16384
    v_mul_f32 v208, v208, v253
    v_mfma_f32_16x16x32_bf16 v[16:19], v[80:83], a[4:7], v[16:19]
    ds_read_b64_tr_b16 v[26:27], v240 offset:18432
    v_cvt_pk_bf16_f32 v74, v112, v113
    v_mfma_f32_16x16x32_bf16 v[16:19], v[88:91], a[8:11], v[16:19]
    ds_read_b64_tr_b16 v[36:37], v240 offset:20480
    v_cvt_pk_bf16_f32 v75, v114, v115
    v_mfma_f32_16x16x32_bf16 v[16:19], v[100:103], a[12:15], v[16:19]
    ds_read_b64_tr_b16 v[38:39], v240 offset:22528
    v_mul_f32 v209, v209, v253
    v_mfma_f32_16x16x32_bf16 v[48:51], v[100:103], a[60:63], 0
    ds_read_b64_tr_b16 v[68:69], v240 offset:24576
    v_mul_f32 v210, v210, v253
    v_mfma_f32_16x16x32_bf16 v[48:51], v[88:91], a[56:59], v[48:51]
    ds_read_b64_tr_b16 v[70:71], v240 offset:26624
    v_mul_f32 v211, v211, v253
    v_mfma_f32_16x16x32_bf16 v[48:51], v[80:83], a[52:55], v[48:51]
    ds_read_b64_tr_b16 v[84:85], v240 offset:28672
    v_cvt_pk_bf16_f32 v254, v180, v181
    v_mfma_f32_16x16x32_bf16 v[48:51], v[64:67], a[48:51], v[48:51]
    s_add_u32 m0, s29, 68224
    ds_read_b64_tr_b16 v[86:87], v240 offset:30720
    v_cvt_pk_bf16_f32 v245, v182, v183
    v_mfma_f32_16x16x32_bf16 v[104:107], v[64:67], a[96:99], 0
    global_load_lds_dwordx4 v247, s[6:7] offset:1408
    v_mfma_f32_16x16x32_bf16 v[104:107], v[80:83], a[100:103], v[104:107]
    v_cvt_pk_bf16_f32 v243, v208, v209
    v_cvt_pk_bf16_f32 v242, v210, v211
    v_mfma_f32_16x16x32_bf16 v[104:107], v[88:91], a[104:107], v[104:107]
    v_mul_f32 v164, v164, v253
    v_mul_f32 v165, v165, v253
    v_mfma_f32_16x16x32_bf16 v[104:107], v[100:103], a[108:111], v[104:107]
    v_mul_f32 v166, v166, v253
    v_mul_f32 v167, v167, v253
    v_mfma_f32_16x16x32_bf16 v[112:115], v[100:103], a[156:159], 0
    v_mul_f32 v176, v176, v253
    v_mul_f32 v177, v177, v253
    v_mfma_f32_16x16x32_bf16 v[112:115], v[88:91], a[152:155], v[112:115]
    v_mul_f32 v178, v178, v253
    v_mul_f32 v179, v179, v253
    v_mfma_f32_16x16x32_bf16 v[112:115], v[80:83], a[148:151], v[112:115]
    v_accvgpr_write_b32 a232, v254
    v_accvgpr_write_b32 a233, v245
    v_mfma_f32_16x16x32_bf16 v[112:115], v[64:67], a[144:147], v[112:115]
    s_waitcnt lgkmcnt(0)
    v_accvgpr_write_b32 a234, v243
    v_accvgpr_write_b32 a235, v242
    v_mfma_f32_16x16x32_bf16 v[112:115], v[24:27], a[160:163], v[112:115]
    ds_read_b64_tr_b16 v[64:65], v240 offset:32768
    v_cvt_pk_bf16_f32 v254, v164, v165
    v_mfma_f32_16x16x32_bf16 v[112:115], v[36:39], a[164:167], v[112:115]
    ds_read_b64_tr_b16 v[66:67], v240 offset:34816
    v_cvt_pk_bf16_f32 v253, v166, v167
    v_mfma_f32_16x16x32_bf16 v[112:115], v[68:71], a[168:171], v[112:115]
    ds_read_b64_tr_b16 v[80:81], v240 offset:36864
    v_cvt_pk_bf16_f32 v245, v176, v177
    v_mfma_f32_16x16x32_bf16 v[112:115], v[84:87], a[172:175], v[112:115]
    ds_read_b64_tr_b16 v[82:83], v240 offset:38912
    v_cvt_pk_bf16_f32 v243, v178, v179
    v_mfma_f32_16x16x32_bf16 v[104:107], v[84:87], a[124:127], v[104:107]
    ds_read_b64_tr_b16 v[88:89], v240 offset:40960
    v_accvgpr_write_b32 a236, v254
    v_mfma_f32_16x16x32_bf16 v[104:107], v[68:71], a[120:123], v[104:107]
    ds_read_b64_tr_b16 v[90:91], v240 offset:43008
    v_accvgpr_write_b32 a237, v253
    v_mfma_f32_16x16x32_bf16 v[104:107], v[36:39], a[116:119], v[104:107]
    ds_read_b64_tr_b16 v[100:101], v240 offset:45056
    v_accvgpr_write_b32 a238, v245
    v_mfma_f32_16x16x32_bf16 v[104:107], v[24:27], a[112:115], v[104:107]
    s_add_u32 m0, s29, 72320
    ds_read_b64_tr_b16 v[102:103], v240 offset:47104
    v_accvgpr_write_b32 a239, v243
    v_mfma_f32_16x16x32_bf16 v[48:51], v[24:27], a[64:67], v[48:51]
    global_load_lds_dwordx4 v247, s[8:9] offset:1408
    v_mfma_f32_16x16x32_bf16 v[48:51], v[36:39], a[68:71], v[48:51]
    v_mul_f32 v20, v20, v249
    v_mul_f32 v21, v21, v249
    v_mfma_f32_16x16x32_bf16 v[48:51], v[68:71], a[72:75], v[48:51]
    v_xor_b32 v254, 114720, v255
    v_mul_f32 v22, v22, v249
    v_mfma_f32_16x16x32_bf16 v[48:51], v[84:87], a[76:79], v[48:51]
    v_mul_f32 v23, v23, v249
    v_mul_f32 v108, v108, v249
    v_mfma_f32_16x16x32_bf16 v[16:19], v[84:87], a[28:31], v[16:19]
    v_mul_f32 v109, v109, v249
    v_mul_f32 v110, v110, v249
G_8:
    s_cbranch_vccnz G_12
    v_mfma_f32_16x16x32_bf16 v[16:19], v[68:71], a[24:27], v[16:19]
    v_mul_f32 v111, v111, v249
    v_cvt_pk_bf16_f32 v253, v20, v21
    v_mfma_f32_16x16x32_bf16 v[16:19], v[36:39], a[20:23], v[16:19]
    v_cvt_pk_bf16_f32 v245, v22, v23
    v_cvt_pk_bf16_f32 v243, v108, v109
    v_mfma_f32_16x16x32_bf16 v[16:19], v[24:27], a[16:19], v[16:19]
    s_waitcnt lgkmcnt(0)
    v_cvt_pk_bf16_f32 v242, v110, v111
    v_accvgpr_write_b32 a240, v253
    v_mfma_f32_16x16x32_bf16 v[16:19], v[64:67], a[32:35], v[16:19]
    ds_read_b64_tr_b16 v[20:21], v254 offset:0
    v_accvgpr_write_b32 a241, v245
    v_mfma_f32_16x16x32_bf16 v[16:19], v[80:83], a[36:39], v[16:19]
    ds_read_b64_tr_b16 v[22:23], v254 offset:2048
    v_accvgpr_write_b32 a242, v243
    v_mfma_f32_16x16x32_bf16 v[16:19], v[88:91], a[40:43], v[16:19]
    ds_read_b64_tr_b16 v[24:25], v254 offset:4096
    v_accvgpr_write_b32 a243, v242
    v_mfma_f32_16x16x32_bf16 v[16:19], v[100:103], a[44:47], v[16:19]
    ds_read_b64_tr_b16 v[26:27], v254 offset:6144
    v_mul_f32 v156, v156, v249
    v_mfma_f32_16x16x32_bf16 v[48:51], v[100:103], a[92:95], v[48:51]
    ds_read_b64_tr_b16 v[36:37], v254 offset:8192
    v_mul_f32 v157, v157, v249
    v_mfma_f32_16x16x32_bf16 v[48:51], v[88:91], a[88:91], v[48:51]
    ds_read_b64_tr_b16 v[38:39], v254 offset:10240
    v_mul_f32 v158, v158, v249
    v_mfma_f32_16x16x32_bf16 v[48:51], v[80:83], a[84:87], v[48:51]
    ds_read_b64_tr_b16 v[68:69], v254 offset:12288
    v_cvt_pk_bf16_f32 v84, v16, v17
    v_mfma_f32_16x16x32_bf16 v[48:51], v[64:67], a[80:83], v[48:51]
    s_add_u32 m0, s29, 76416
    ds_read_b64_tr_b16 v[70:71], v254 offset:14336
    v_cvt_pk_bf16_f32 v85, v18, v19
    v_mfma_f32_16x16x32_bf16 v[104:107], v[64:67], a[128:131], v[104:107]
    global_load_lds_dwordx4 v247, s[10:11] offset:1408
    v_mfma_f32_16x16x32_bf16 v[104:107], v[80:83], a[132:135], v[104:107]
    v_mul_f32 v159, v159, v249
    v_mul_f32 v160, v160, v249
    v_mfma_f32_16x16x32_bf16 v[104:107], v[88:91], a[136:139], v[104:107]
    v_cvt_pk_bf16_f32 v16, v48, v49
    v_cvt_pk_bf16_f32 v17, v50, v51
    v_mfma_f32_16x16x32_bf16 v[104:107], v[100:103], a[140:143], v[104:107]
    v_mul_f32 v161, v161, v249
    v_mul_f32 v162, v162, v249
    v_mfma_f32_16x16x32_bf16 v[112:115], v[100:103], a[188:191], v[112:115]
    v_mul_f32 v163, v163, v249
    v_cvt_pk_bf16_f32 v253, v156, v157
    v_mfma_f32_16x16x32_bf16 v[112:115], v[88:91], a[184:187], v[112:115]
    v_cvt_pk_bf16_f32 v245, v158, v159
    v_cvt_pk_bf16_f32 v249, v160, v161
    v_mfma_f32_16x16x32_bf16 v[112:115], v[80:83], a[180:183], v[112:115]
    v_cvt_pk_bf16_f32 v48, v104, v105
    v_cvt_pk_bf16_f32 v49, v106, v107
    v_mfma_f32_16x16x32_bf16 v[112:115], v[64:67], a[176:179], v[112:115]
    s_waitcnt lgkmcnt(0)
    v_cvt_pk_bf16_f32 v243, v162, v163
    v_accvgpr_write_b32 a244, v253
    v_mfma_f32_16x16x32_bf16 v[64:67], v[20:23], a[0:3], 0
    ds_read_b64_tr_b16 v[80:81], v254 offset:16384
    v_accvgpr_write_b32 a245, v245
    v_mfma_f32_16x16x32_bf16 v[64:67], v[24:27], a[4:7], v[64:67]
    ds_read_b64_tr_b16 v[82:83], v254 offset:18432
    v_cvt_pk_bf16_f32 v88, v112, v113
    v_mfma_f32_16x16x32_bf16 v[64:67], v[36:39], a[8:11], v[64:67]
    ds_read_b64_tr_b16 v[100:101], v254 offset:20480
    v_cvt_pk_bf16_f32 v89, v114, v115
    v_mfma_f32_16x16x32_bf16 v[64:67], v[68:71], a[12:15], v[64:67]
    ds_read_b64_tr_b16 v[102:103], v254 offset:22528
    v_accvgpr_write_b32 a246, v249
    v_mfma_f32_16x16x32_bf16 v[104:107], v[68:71], a[60:63], 0
    ds_read_b64_tr_b16 v[108:109], v254 offset:24576
    v_accvgpr_write_b32 a247, v243
    v_mfma_f32_16x16x32_bf16 v[104:107], v[36:39], a[56:59], v[104:107]
    ds_read_b64_tr_b16 v[110:111], v254 offset:26624
    v_mul_f32 v140, v140, v244
    v_mfma_f32_16x16x32_bf16 v[104:107], v[24:27], a[52:55], v[104:107]
    ds_read_b64_tr_b16 v[112:113], v254 offset:28672
    v_mul_f32 v141, v141, v244
    v_mfma_f32_16x16x32_bf16 v[104:107], v[20:23], a[48:51], v[104:107]
    s_add_u32 m0, s29, 80512
    ds_read_b64_tr_b16 v[114:115], v254 offset:30720
    v_mul_f32 v142, v142, v244
    v_mfma_f32_16x16x32_bf16 v[116:119], v[20:23], a[96:99], 0
    global_load_lds_dwordx4 v247, s[12:13] offset:1408
    v_mfma_f32_16x16x32_bf16 v[116:119], v[24:27], a[100:103], v[116:119]
    v_mul_f32 v143, v143, v244
    v_mul_f32 v188, v188, v244
    v_mfma_f32_16x16x32_bf16 v[116:119], v[36:39], a[104:107], v[116:119]
    v_mul_f32 v189, v189, v244
    v_mul_f32 v190, v190, v244
    v_mfma_f32_16x16x32_bf16 v[116:119], v[68:71], a[108:111], v[116:119]
    v_mul_f32 v191, v191, v244
    v_cvt_pk_bf16_f32 v253, v140, v141
    v_mfma_f32_16x16x32_bf16 v[120:123], v[68:71], a[156:159], 0
    v_cvt_pk_bf16_f32 v249, v142, v143
    v_cvt_pk_bf16_f32 v245, v188, v189
    v_mfma_f32_16x16x32_bf16 v[120:123], v[36:39], a[152:155], v[120:123]
    v_cvt_pk_bf16_f32 v243, v190, v191
    v_mul_f32 v152, v152, v244
    v_mfma_f32_16x16x32_bf16 v[120:123], v[24:27], a[148:151], v[120:123]
    v_mul_f32 v153, v153, v244
    v_mul_f32 v154, v154, v244
    v_mfma_f32_16x16x32_bf16 v[120:123], v[20:23], a[144:147], v[120:123]
    s_waitcnt lgkmcnt(0)
    v_mul_f32 v155, v155, v244
    v_mul_f32 v168, v168, v244
    v_mfma_f32_16x16x32_bf16 v[120:123], v[80:83], a[160:163], v[120:123]
    ds_read_b64_tr_b16 v[20:21], v254 offset:32768
    v_mul_f32 v169, v169, v244
    v_mfma_f32_16x16x32_bf16 v[120:123], v[100:103], a[164:167], v[120:123]
    ds_read_b64_tr_b16 v[22:23], v254 offset:34816
    v_mul_f32 v170, v170, v244
    v_mfma_f32_16x16x32_bf16 v[120:123], v[108:111], a[168:171], v[120:123]
    ds_read_b64_tr_b16 v[24:25], v254 offset:36864
    v_mul_f32 v171, v171, v244
    v_mfma_f32_16x16x32_bf16 v[120:123], v[112:115], a[172:175], v[120:123]
    ds_read_b64_tr_b16 v[26:27], v254 offset:38912
    v_accvgpr_write_b32 a248, v253
    v_mfma_f32_16x16x32_bf16 v[116:119], v[112:115], a[124:127], v[116:119]
    ds_read_b64_tr_b16 v[36:37], v254 offset:40960
    v_accvgpr_write_b32 a249, v249
    v_mfma_f32_16x16x32_bf16 v[116:119], v[108:111], a[120:123], v[116:119]
    ds_read_b64_tr_b16 v[38:39], v254 offset:43008
    v_accvgpr_write_b32 a250, v245
    v_mfma_f32_16x16x32_bf16 v[116:119], v[100:103], a[116:119], v[116:119]
    ds_read_b64_tr_b16 v[68:69], v254 offset:45056
    v_accvgpr_write_b32 a251, v243
    v_mfma_f32_16x16x32_bf16 v[116:119], v[80:83], a[112:115], v[116:119]
    s_add_u32 m0, s29, 84608
    ds_read_b64_tr_b16 v[70:71], v254 offset:47104
    v_cvt_pk_bf16_f32 v253, v152, v153
    v_mfma_f32_16x16x32_bf16 v[104:107], v[80:83], a[64:67], v[104:107]
    global_load_lds_dwordx4 v247, s[14:15] offset:1408
    v_mfma_f32_16x16x32_bf16 v[104:107], v[100:103], a[68:71], v[104:107]
    v_cvt_pk_bf16_f32 v254, v154, v155
    v_cvt_pk_bf16_f32 v249, v168, v169
    v_mfma_f32_16x16x32_bf16 v[104:107], v[108:111], a[72:75], v[104:107]
    v_xor_b32 v245, 114752, v255
    v_cvt_pk_bf16_f32 v244, v170, v171
    v_mfma_f32_16x16x32_bf16 v[104:107], v[112:115], a[76:79], v[104:107]
    v_accvgpr_write_b32 a252, v253
    v_accvgpr_write_b32 a253, v254
    v_mfma_f32_16x16x32_bf16 v[64:67], v[112:115], a[28:31], v[64:67]
    v_accvgpr_write_b32 a254, v249
    v_accvgpr_write_b32 a255, v244
    v_mfma_f32_16x16x32_bf16 v[64:67], v[108:111], a[24:27], v[64:67]
    v_mfma_f32_16x16x32_bf16 v[64:67], v[100:103], a[20:23], v[64:67]
    v_mfma_f32_16x16x32_bf16 v[64:67], v[80:83], a[16:19], v[64:67]
    s_waitcnt lgkmcnt(0)
    v_mfma_f32_16x16x32_bf16 v[64:67], v[20:23], a[32:35], v[64:67]
    ds_read_b64_tr_b16 v[100:101], v245 offset:0
    v_mfma_f32_16x16x32_bf16 v[64:67], v[24:27], a[36:39], v[64:67]
    ds_read_b64_tr_b16 v[102:103], v245 offset:2048
    v_mfma_f32_16x16x32_bf16 v[64:67], v[36:39], a[40:43], v[64:67]
    ds_read_b64_tr_b16 v[80:81], v245 offset:4096
    v_mfma_f32_16x16x32_bf16 v[64:67], v[68:71], a[44:47], v[64:67]
    ds_read_b64_tr_b16 v[82:83], v245 offset:6144
    v_mfma_f32_16x16x32_bf16 v[104:107], v[68:71], a[92:95], v[104:107]
    ds_read_b64_tr_b16 v[108:109], v245 offset:8192
    v_mfma_f32_16x16x32_bf16 v[104:107], v[36:39], a[88:91], v[104:107]
    ds_read_b64_tr_b16 v[110:111], v245 offset:10240
    v_mfma_f32_16x16x32_bf16 v[104:107], v[24:27], a[84:87], v[104:107]
    ds_read_b64_tr_b16 v[112:113], v245 offset:12288
    v_mfma_f32_16x16x32_bf16 v[104:107], v[20:23], a[80:83], v[104:107]
    s_add_u32 m0, s29, 88704
    ds_read_b64_tr_b16 v[114:115], v245 offset:14336
    v_cvt_pk_bf16_f32 v86, v64, v65
    v_mfma_f32_16x16x32_bf16 v[116:119], v[20:23], a[128:131], v[116:119]
    global_load_lds_dwordx4 v247, s[16:17] offset:1408
    v_mfma_f32_16x16x32_bf16 v[116:119], v[24:27], a[132:135], v[116:119]
    v_cvt_pk_bf16_f32 v87, v66, v67
    v_mfma_f32_16x16x32_bf16 v[116:119], v[36:39], a[136:139], v[116:119]
    v_cvt_pk_bf16_f32 v18, v104, v105
    v_cvt_pk_bf16_f32 v19, v106, v107
    v_mfma_f32_16x16x32_bf16 v[116:119], v[68:71], a[140:143], v[116:119]
    v_mfma_f32_16x16x32_bf16 v[120:123], v[68:71], a[188:191], v[120:123]
    v_mfma_f32_16x16x32_bf16 v[120:123], v[36:39], a[184:187], v[120:123]
    v_mfma_f32_16x16x32_bf16 v[120:123], v[24:27], a[180:183], v[120:123]
    v_mfma_f32_16x16x32_bf16 v[120:123], v[20:23], a[176:179], v[120:123]
    s_waitcnt lgkmcnt(0)
    v_mfma_f32_16x16x32_bf16 v[36:39], v[100:103], a[0:3], 0
    ds_read_b64_tr_b16 v[24:25], v245 offset:16384
    v_mfma_f32_16x16x32_bf16 v[36:39], v[80:83], a[4:7], v[36:39]
    ds_read_b64_tr_b16 v[26:27], v245 offset:18432
    v_cvt_pk_bf16_f32 v50, v116, v117
    v_mfma_f32_16x16x32_bf16 v[36:39], v[108:111], a[8:11], v[36:39]
    ds_read_b64_tr_b16 v[20:21], v245 offset:20480
    v_cvt_pk_bf16_f32 v51, v118, v119
    v_mfma_f32_16x16x32_bf16 v[36:39], v[112:115], a[12:15], v[36:39]
    ds_read_b64_tr_b16 v[22:23], v245 offset:22528
    v_cvt_pk_bf16_f32 v90, v120, v121
    v_mfma_f32_16x16x32_bf16 v[64:67], v[112:115], a[60:63], 0
    ds_read_b64_tr_b16 v[68:69], v245 offset:24576
    v_cvt_pk_bf16_f32 v91, v122, v123
    v_mfma_f32_16x16x32_bf16 v[64:67], v[108:111], a[56:59], v[64:67]
    ds_read_b64_tr_b16 v[70:71], v245 offset:26624
    v_mfma_f32_16x16x32_bf16 v[64:67], v[80:83], a[52:55], v[64:67]
    ds_read_b64_tr_b16 v[104:105], v245 offset:28672
    v_mfma_f32_16x16x32_bf16 v[64:67], v[100:103], a[48:51], v[64:67]
    s_add_u32 m0, s29, 92800
    ds_read_b64_tr_b16 v[106:107], v245 offset:30720
    v_mfma_f32_16x16x32_bf16 v[116:119], v[100:103], a[96:99], 0
    global_load_lds_dwordx4 v247, s[18:19] offset:1408
    v_mfma_f32_16x16x32_bf16 v[116:119], v[80:83], a[100:103], v[116:119]
    v_mfma_f32_16x16x32_bf16 v[116:119], v[108:111], a[104:107], v[116:119]
    v_mfma_f32_16x16x32_bf16 v[116:119], v[112:115], a[108:111], v[116:119]
    v_mfma_f32_16x16x32_bf16 v[120:123], v[112:115], a[156:159], 0
    v_mfma_f32_16x16x32_bf16 v[120:123], v[108:111], a[152:155], v[120:123]
    v_mfma_f32_16x16x32_bf16 v[120:123], v[80:83], a[148:151], v[120:123]
    v_mfma_f32_16x16x32_bf16 v[120:123], v[100:103], a[144:147], v[120:123]
    s_waitcnt lgkmcnt(0)
    v_mfma_f32_16x16x32_bf16 v[120:123], v[24:27], a[160:163], v[120:123]
    ds_read_b64_tr_b16 v[80:81], v245 offset:32768
    v_mfma_f32_16x16x32_bf16 v[120:123], v[20:23], a[164:167], v[120:123]
    ds_read_b64_tr_b16 v[82:83], v245 offset:34816
    v_mfma_f32_16x16x32_bf16 v[120:123], v[68:71], a[168:171], v[120:123]
    ds_read_b64_tr_b16 v[100:101], v245 offset:36864
    v_mfma_f32_16x16x32_bf16 v[120:123], v[104:107], a[172:175], v[120:123]
    ds_read_b64_tr_b16 v[102:103], v245 offset:38912
    v_mfma_f32_16x16x32_bf16 v[116:119], v[104:107], a[124:127], v[116:119]
    ds_read_b64_tr_b16 v[108:109], v245 offset:40960
    v_mfma_f32_16x16x32_bf16 v[116:119], v[68:71], a[120:123], v[116:119]
    ds_read_b64_tr_b16 v[110:111], v245 offset:43008
    v_mfma_f32_16x16x32_bf16 v[116:119], v[20:23], a[116:119], v[116:119]
    ds_read_b64_tr_b16 v[112:113], v245 offset:45056
    v_mfma_f32_16x16x32_bf16 v[116:119], v[24:27], a[112:115], v[116:119]
    s_add_u32 m0, s29, 96896
    ds_read_b64_tr_b16 v[114:115], v245 offset:47104
    v_mfma_f32_16x16x32_bf16 v[64:67], v[24:27], a[64:67], v[64:67]
    global_load_lds_dwordx4 v247, s[20:21] offset:1408
    v_mfma_f32_16x16x32_bf16 v[64:67], v[20:23], a[68:71], v[64:67]
    v_mfma_f32_16x16x32_bf16 v[64:67], v[68:71], a[72:75], v[64:67]
    v_xor_b32 v254, 114784, v255
    v_mfma_f32_16x16x32_bf16 v[64:67], v[104:107], a[76:79], v[64:67]
    v_mfma_f32_16x16x32_bf16 v[36:39], v[104:107], a[28:31], v[36:39]
    v_mfma_f32_16x16x32_bf16 v[36:39], v[68:71], a[24:27], v[36:39]
    v_mfma_f32_16x16x32_bf16 v[36:39], v[20:23], a[20:23], v[36:39]
    v_mfma_f32_16x16x32_bf16 v[36:39], v[24:27], a[16:19], v[36:39]
    s_waitcnt lgkmcnt(0)
    v_mfma_f32_16x16x32_bf16 v[36:39], v[80:83], a[32:35], v[36:39]
    ds_read_b64_tr_b16 v[20:21], v254 offset:0
    v_mfma_f32_16x16x32_bf16 v[36:39], v[100:103], a[36:39], v[36:39]
    ds_read_b64_tr_b16 v[22:23], v254 offset:2048
    v_mfma_f32_16x16x32_bf16 v[36:39], v[108:111], a[40:43], v[36:39]
    ds_read_b64_tr_b16 v[24:25], v254 offset:4096
    v_mfma_f32_16x16x32_bf16 v[36:39], v[112:115], a[44:47], v[36:39]
    ds_read_b64_tr_b16 v[26:27], v254 offset:6144
    v_mfma_f32_16x16x32_bf16 v[64:67], v[112:115], a[92:95], v[64:67]
    ds_read_b64_tr_b16 v[68:69], v254 offset:8192
    v_mfma_f32_16x16x32_bf16 v[64:67], v[108:111], a[88:91], v[64:67]
    ds_read_b64_tr_b16 v[70:71], v254 offset:10240
    v_mfma_f32_16x16x32_bf16 v[64:67], v[100:103], a[84:87], v[64:67]
    ds_read_b64_tr_b16 v[104:105], v254 offset:12288
    v_mfma_f32_16x16x32_bf16 v[64:67], v[80:83], a[80:83], v[64:67]
    s_add_u32 m0, s29, 100992
    ds_read_b64_tr_b16 v[106:107], v254 offset:14336
    v_cvt_pk_bf16_f32 v124, v36, v37
    v_mfma_f32_16x16x32_bf16 v[116:119], v[80:83], a[128:131], v[116:119]
    global_load_lds_dwordx4 v247, s[22:23] offset:1408
    v_mfma_f32_16x16x32_bf16 v[116:119], v[100:103], a[132:135], v[116:119]
    v_cvt_pk_bf16_f32 v125, v38, v39
    v_mfma_f32_16x16x32_bf16 v[116:119], v[108:111], a[136:139], v[116:119]
    v_cvt_pk_bf16_f32 v128, v64, v65
    v_cvt_pk_bf16_f32 v129, v66, v67
    v_mfma_f32_16x16x32_bf16 v[116:119], v[112:115], a[140:143], v[116:119]
    v_mfma_f32_16x16x32_bf16 v[120:123], v[112:115], a[188:191], v[120:123]
    v_mfma_f32_16x16x32_bf16 v[120:123], v[108:111], a[184:187], v[120:123]
    v_mfma_f32_16x16x32_bf16 v[120:123], v[100:103], a[180:183], v[120:123]
    v_mfma_f32_16x16x32_bf16 v[120:123], v[80:83], a[176:179], v[120:123]
    s_waitcnt lgkmcnt(0)
    v_mfma_f32_16x16x32_bf16 v[36:39], v[20:23], a[0:3], 0
    ds_read_b64_tr_b16 v[64:65], v254 offset:16384
    v_mfma_f32_16x16x32_bf16 v[36:39], v[24:27], a[4:7], v[36:39]
    ds_read_b64_tr_b16 v[66:67], v254 offset:18432
    v_cvt_pk_bf16_f32 v80, v116, v117
    v_mfma_f32_16x16x32_bf16 v[36:39], v[68:71], a[8:11], v[36:39]
    ds_read_b64_tr_b16 v[100:101], v254 offset:20480
    v_cvt_pk_bf16_f32 v81, v118, v119
    v_mfma_f32_16x16x32_bf16 v[36:39], v[104:107], a[12:15], v[36:39]
    ds_read_b64_tr_b16 v[102:103], v254 offset:22528
    v_cvt_pk_bf16_f32 v108, v120, v121
    v_mfma_f32_16x16x32_bf16 v[112:115], v[104:107], a[60:63], 0
    ds_read_b64_tr_b16 v[116:117], v254 offset:24576
    v_cvt_pk_bf16_f32 v109, v122, v123
    v_mfma_f32_16x16x32_bf16 v[112:115], v[68:71], a[56:59], v[112:115]
    ds_read_b64_tr_b16 v[118:119], v254 offset:26624
    v_mfma_f32_16x16x32_bf16 v[112:115], v[24:27], a[52:55], v[112:115]
    ds_read_b64_tr_b16 v[120:121], v254 offset:28672
    v_mfma_f32_16x16x32_bf16 v[112:115], v[20:23], a[48:51], v[112:115]
    s_add_u32 m0, s29, 105088
    ds_read_b64_tr_b16 v[122:123], v254 offset:30720
    v_mfma_f32_16x16x32_bf16 v[132:135], v[20:23], a[96:99], 0
    global_load_lds_dwordx4 v247, s[24:25] offset:1408
    v_mfma_f32_16x16x32_bf16 v[132:135], v[24:27], a[100:103], v[132:135]
    v_mfma_f32_16x16x32_bf16 v[132:135], v[68:71], a[104:107], v[132:135]
    v_mfma_f32_16x16x32_bf16 v[132:135], v[104:107], a[108:111], v[132:135]
    v_mfma_f32_16x16x32_bf16 v[140:143], v[104:107], a[156:159], 0
    v_mfma_f32_16x16x32_bf16 v[140:143], v[68:71], a[152:155], v[140:143]
    v_mfma_f32_16x16x32_bf16 v[140:143], v[24:27], a[148:151], v[140:143]
    v_mfma_f32_16x16x32_bf16 v[140:143], v[20:23], a[144:147], v[140:143]
    s_waitcnt lgkmcnt(0)
    v_mfma_f32_16x16x32_bf16 v[140:143], v[64:67], a[160:163], v[140:143]
    ds_read_b64_tr_b16 v[24:25], v254 offset:32768
    v_mfma_f32_16x16x32_bf16 v[140:143], v[100:103], a[164:167], v[140:143]
    ds_read_b64_tr_b16 v[26:27], v254 offset:34816
    v_mfma_f32_16x16x32_bf16 v[140:143], v[116:119], a[168:171], v[140:143]
    ds_read_b64_tr_b16 v[20:21], v254 offset:36864
    v_mfma_f32_16x16x32_bf16 v[140:143], v[120:123], a[172:175], v[140:143]
    ds_read_b64_tr_b16 v[22:23], v254 offset:38912
    v_mfma_f32_16x16x32_bf16 v[132:135], v[120:123], a[124:127], v[132:135]
    ds_read_b64_tr_b16 v[68:69], v254 offset:40960
    v_mfma_f32_16x16x32_bf16 v[132:135], v[116:119], a[120:123], v[132:135]
    ds_read_b64_tr_b16 v[70:71], v254 offset:43008
    v_mfma_f32_16x16x32_bf16 v[132:135], v[100:103], a[116:119], v[132:135]
    ds_read_b64_tr_b16 v[104:105], v254 offset:45056
    v_mfma_f32_16x16x32_bf16 v[132:135], v[64:67], a[112:115], v[132:135]
    s_add_u32 m0, s29, 109184
    ds_read_b64_tr_b16 v[106:107], v254 offset:47104
    v_mfma_f32_16x16x32_bf16 v[112:115], v[64:67], a[64:67], v[112:115]
    global_load_lds_dwordx4 v247, s[26:27] offset:1408
    v_mfma_f32_16x16x32_bf16 v[112:115], v[100:103], a[68:71], v[112:115]
    v_mfma_f32_16x16x32_bf16 v[112:115], v[116:119], a[72:75], v[112:115]
    v_xor_b32 v254, 16384, v255
    v_mfma_f32_16x16x32_bf16 v[112:115], v[120:123], a[76:79], v[112:115]
    v_mfma_f32_16x16x32_bf16 v[36:39], v[120:123], a[28:31], v[36:39]
    v_mfma_f32_16x16x32_bf16 v[36:39], v[116:119], a[24:27], v[36:39]
    v_mfma_f32_16x16x32_bf16 v[36:39], v[100:103], a[20:23], v[36:39]
    v_mfma_f32_16x16x32_bf16 v[36:39], v[64:67], a[16:19], v[36:39]
    s_waitcnt vmcnt(12) lgkmcnt(0)
    s_barrier
    v_mfma_f32_16x16x32_bf16 v[36:39], v[24:27], a[32:35], v[36:39]
    ds_read_b64_tr_b16 v[64:65], v254 offset:0
    v_mfma_f32_16x16x32_bf16 v[36:39], v[20:23], a[36:39], v[36:39]
    ds_read_b64_tr_b16 v[66:67], v254 offset:2048
    v_mfma_f32_16x16x32_bf16 v[36:39], v[68:71], a[40:43], v[36:39]
    ds_read_b64_tr_b16 v[100:101], v254 offset:4096
    v_mfma_f32_16x16x32_bf16 v[36:39], v[104:107], a[44:47], v[36:39]
    ds_read_b64_tr_b16 v[102:103], v254 offset:6144
    v_mfma_f32_16x16x32_bf16 v[112:115], v[104:107], a[92:95], v[112:115]
    ds_read_b64_tr_b16 v[116:117], v254 offset:8192
    v_mfma_f32_16x16x32_bf16 v[112:115], v[68:71], a[88:91], v[112:115]
    ds_read_b64_tr_b16 v[118:119], v254 offset:10240
    v_mfma_f32_16x16x32_bf16 v[112:115], v[20:23], a[84:87], v[112:115]
    ds_read_b64_tr_b16 v[120:121], v254 offset:12288
    v_mfma_f32_16x16x32_bf16 v[112:115], v[24:27], a[80:83], v[112:115]
    s_add_u32 m0, s29, 114048
    ds_read_b64_tr_b16 v[122:123], v254 offset:14336
    v_cvt_pk_bf16_f32 v126, v36, v37
    v_mfma_f32_16x16x32_bf16 v[132:135], v[24:27], a[128:131], v[132:135]
    global_load_lds_dwordx4 v247, s[4:5] offset:640
    v_mfma_f32_16x16x32_bf16 v[132:135], v[20:23], a[132:135], v[132:135]
    v_cvt_pk_bf16_f32 v127, v38, v39
    v_mfma_f32_16x16x32_bf16 v[132:135], v[68:71], a[136:139], v[132:135]
    v_cvt_pk_bf16_f32 v130, v112, v113
    v_cvt_pk_bf16_f32 v131, v114, v115
    v_mfma_f32_16x16x32_bf16 v[132:135], v[104:107], a[140:143], v[132:135]
    v_mfma_f32_16x16x32_bf16 v[140:143], v[104:107], a[188:191], v[140:143]
    v_mfma_f32_16x16x32_bf16 v[140:143], v[68:71], a[184:187], v[140:143]
    v_mfma_f32_16x16x32_bf16 v[140:143], v[20:23], a[180:183], v[140:143]
    v_mfma_f32_16x16x32_bf16 v[140:143], v[24:27], a[176:179], v[140:143]
    s_waitcnt lgkmcnt(0)
    v_mfma_f32_16x16x32_bf16 v[36:39], v[64:67], a[0:3], 0
    ds_read_b64_tr_b16 v[20:21], v254 offset:16384
    v_mfma_f32_16x16x32_bf16 v[36:39], v[100:103], a[4:7], v[36:39]
    ds_read_b64_tr_b16 v[22:23], v254 offset:18432
    v_cvt_pk_bf16_f32 v82, v132, v133
    v_mfma_f32_16x16x32_bf16 v[36:39], v[116:119], a[8:11], v[36:39]
    ds_read_b64_tr_b16 v[24:25], v254 offset:20480
    v_cvt_pk_bf16_f32 v83, v134, v135
    v_mfma_f32_16x16x32_bf16 v[36:39], v[120:123], a[12:15], v[36:39]
    ds_read_b64_tr_b16 v[26:27], v254 offset:22528
    v_cvt_pk_bf16_f32 v110, v140, v141
    v_mfma_f32_16x16x32_bf16 v[68:71], v[120:123], a[60:63], 0
    ds_read_b64_tr_b16 v[104:105], v254 offset:24576
    v_cvt_pk_bf16_f32 v111, v142, v143
    v_mfma_f32_16x16x32_bf16 v[68:71], v[116:119], a[56:59], v[68:71]
    ds_read_b64_tr_b16 v[106:107], v254 offset:26624
    v_mfma_f32_16x16x32_bf16 v[68:71], v[100:103], a[52:55], v[68:71]
    ds_read_b64_tr_b16 v[112:113], v254 offset:28672
    v_mfma_f32_16x16x32_bf16 v[68:71], v[64:67], a[48:51], v[68:71]
    s_add_u32 m0, s29, 118144
    ds_read_b64_tr_b16 v[114:115], v254 offset:30720
    v_mfma_f32_16x16x32_bf16 v[132:135], v[64:67], a[96:99], 0
    global_load_lds_dwordx4 v247, s[6:7] offset:640
    v_mfma_f32_16x16x32_bf16 v[132:135], v[100:103], a[100:103], v[132:135]
    v_mfma_f32_16x16x32_bf16 v[132:135], v[116:119], a[104:107], v[132:135]
    v_mfma_f32_16x16x32_bf16 v[132:135], v[120:123], a[108:111], v[132:135]
    v_mfma_f32_16x16x32_bf16 v[140:143], v[120:123], a[156:159], 0
    v_mfma_f32_16x16x32_bf16 v[140:143], v[116:119], a[152:155], v[140:143]
    v_mfma_f32_16x16x32_bf16 v[140:143], v[100:103], a[148:151], v[140:143]
    v_mfma_f32_16x16x32_bf16 v[140:143], v[64:67], a[144:147], v[140:143]
    s_waitcnt lgkmcnt(0)
    v_mfma_f32_16x16x32_bf16 v[140:143], v[20:23], a[160:163], v[140:143]
    ds_read_b64_tr_b16 v[100:101], v254 offset:32768
    v_mfma_f32_16x16x32_bf16 v[140:143], v[24:27], a[164:167], v[140:143]
    ds_read_b64_tr_b16 v[102:103], v254 offset:34816
    v_mfma_f32_16x16x32_bf16 v[140:143], v[104:107], a[168:171], v[140:143]
    ds_read_b64_tr_b16 v[64:65], v254 offset:36864
    v_mfma_f32_16x16x32_bf16 v[140:143], v[112:115], a[172:175], v[140:143]
    ds_read_b64_tr_b16 v[66:67], v254 offset:38912
    v_mfma_f32_16x16x32_bf16 v[132:135], v[112:115], a[124:127], v[132:135]
    ds_read_b64_tr_b16 v[116:117], v254 offset:40960
    v_mfma_f32_16x16x32_bf16 v[132:135], v[104:107], a[120:123], v[132:135]
    ds_read_b64_tr_b16 v[118:119], v254 offset:43008
    v_mfma_f32_16x16x32_bf16 v[132:135], v[24:27], a[116:119], v[132:135]
    ds_read_b64_tr_b16 v[120:121], v254 offset:45056
    v_mfma_f32_16x16x32_bf16 v[132:135], v[20:23], a[112:115], v[132:135]
    s_add_u32 m0, s29, 122240
    ds_read_b64_tr_b16 v[122:123], v254 offset:47104
    v_mfma_f32_16x16x32_bf16 v[68:71], v[20:23], a[64:67], v[68:71]
    global_load_lds_dwordx4 v247, s[8:9] offset:640
    v_mfma_f32_16x16x32_bf16 v[68:71], v[24:27], a[68:71], v[68:71]
    v_mfma_f32_16x16x32_bf16 v[68:71], v[104:107], a[72:75], v[68:71]
    v_xor_b32 v254, 16416, v255
    v_mfma_f32_16x16x32_bf16 v[68:71], v[112:115], a[76:79], v[68:71]
    v_mfma_f32_16x16x32_bf16 v[36:39], v[112:115], a[28:31], v[36:39]
    v_mfma_f32_16x16x32_bf16 v[36:39], v[104:107], a[24:27], v[36:39]
    v_mfma_f32_16x16x32_bf16 v[36:39], v[24:27], a[20:23], v[36:39]
    v_mfma_f32_16x16x32_bf16 v[36:39], v[20:23], a[16:19], v[36:39]
    s_waitcnt lgkmcnt(0)
    v_mfma_f32_16x16x32_bf16 v[36:39], v[100:103], a[32:35], v[36:39]
    ds_read_b64_tr_b16 v[24:25], v254 offset:0
    v_mfma_f32_16x16x32_bf16 v[36:39], v[64:67], a[36:39], v[36:39]
    ds_read_b64_tr_b16 v[26:27], v254 offset:2048
    v_mfma_f32_16x16x32_bf16 v[36:39], v[116:119], a[40:43], v[36:39]
    ds_read_b64_tr_b16 v[20:21], v254 offset:4096
    v_mfma_f32_16x16x32_bf16 v[36:39], v[120:123], a[44:47], v[36:39]
    ds_read_b64_tr_b16 v[22:23], v254 offset:6144
    v_mfma_f32_16x16x32_bf16 v[68:71], v[120:123], a[92:95], v[68:71]
    ds_read_b64_tr_b16 v[104:105], v254 offset:8192
    v_mfma_f32_16x16x32_bf16 v[68:71], v[116:119], a[88:91], v[68:71]
    ds_read_b64_tr_b16 v[106:107], v254 offset:10240
    v_mfma_f32_16x16x32_bf16 v[68:71], v[64:67], a[84:87], v[68:71]
    ds_read_b64_tr_b16 v[112:113], v254 offset:12288
    v_mfma_f32_16x16x32_bf16 v[68:71], v[100:103], a[80:83], v[68:71]
    s_add_u32 m0, s29, 126336
    ds_read_b64_tr_b16 v[114:115], v254 offset:14336
    v_cvt_pk_bf16_f32 v144, v36, v37
    v_mfma_f32_16x16x32_bf16 v[132:135], v[100:103], a[128:131], v[132:135]
    global_load_lds_dwordx4 v247, s[10:11] offset:640
    v_mfma_f32_16x16x32_bf16 v[132:135], v[64:67], a[132:135], v[132:135]
    v_cvt_pk_bf16_f32 v145, v38, v39
    v_mfma_f32_16x16x32_bf16 v[132:135], v[116:119], a[136:139], v[132:135]
    v_cvt_pk_bf16_f32 v148, v68, v69
    v_cvt_pk_bf16_f32 v149, v70, v71
    v_mfma_f32_16x16x32_bf16 v[132:135], v[120:123], a[140:143], v[132:135]
    v_mfma_f32_16x16x32_bf16 v[140:143], v[120:123], a[188:191], v[140:143]
    v_mfma_f32_16x16x32_bf16 v[140:143], v[116:119], a[184:187], v[140:143]
    v_mfma_f32_16x16x32_bf16 v[140:143], v[64:67], a[180:183], v[140:143]
    v_mfma_f32_16x16x32_bf16 v[140:143], v[100:103], a[176:179], v[140:143]
    s_waitcnt lgkmcnt(0)
    v_mfma_f32_16x16x32_bf16 v[36:39], v[24:27], a[0:3], 0
    ds_read_b64_tr_b16 v[64:65], v254 offset:16384
    v_mfma_f32_16x16x32_bf16 v[36:39], v[20:23], a[4:7], v[36:39]
    ds_read_b64_tr_b16 v[66:67], v254 offset:18432
    v_cvt_pk_bf16_f32 v68, v132, v133
    v_mfma_f32_16x16x32_bf16 v[36:39], v[104:107], a[8:11], v[36:39]
    ds_read_b64_tr_b16 v[100:101], v254 offset:20480
    v_cvt_pk_bf16_f32 v69, v134, v135
    v_mfma_f32_16x16x32_bf16 v[36:39], v[112:115], a[12:15], v[36:39]
    ds_read_b64_tr_b16 v[102:103], v254 offset:22528
    v_cvt_pk_bf16_f32 v116, v140, v141
    v_mfma_f32_16x16x32_bf16 v[120:123], v[112:115], a[60:63], 0
    ds_read_b64_tr_b16 v[132:133], v254 offset:24576
    v_cvt_pk_bf16_f32 v117, v142, v143
    v_mfma_f32_16x16x32_bf16 v[120:123], v[104:107], a[56:59], v[120:123]
    ds_read_b64_tr_b16 v[134:135], v254 offset:26624
    v_mfma_f32_16x16x32_bf16 v[120:123], v[20:23], a[52:55], v[120:123]
    ds_read_b64_tr_b16 v[140:141], v254 offset:28672
    v_mfma_f32_16x16x32_bf16 v[120:123], v[24:27], a[48:51], v[120:123]
    s_add_u32 m0, s29, 130432
    ds_read_b64_tr_b16 v[142:143], v254 offset:30720
    v_mfma_f32_16x16x32_bf16 v[152:155], v[24:27], a[96:99], 0
    global_load_lds_dwordx4 v247, s[12:13] offset:640
    v_mfma_f32_16x16x32_bf16 v[152:155], v[20:23], a[100:103], v[152:155]
    v_mfma_f32_16x16x32_bf16 v[152:155], v[104:107], a[104:107], v[152:155]
    v_mfma_f32_16x16x32_bf16 v[152:155], v[112:115], a[108:111], v[152:155]
    v_mfma_f32_16x16x32_bf16 v[156:159], v[112:115], a[156:159], 0
    v_mfma_f32_16x16x32_bf16 v[156:159], v[104:107], a[152:155], v[156:159]
    v_mfma_f32_16x16x32_bf16 v[156:159], v[20:23], a[148:151], v[156:159]
    v_mfma_f32_16x16x32_bf16 v[156:159], v[24:27], a[144:147], v[156:159]
    s_waitcnt lgkmcnt(0)
    v_mfma_f32_16x16x32_bf16 v[156:159], v[64:67], a[160:163], v[156:159]
    ds_read_b64_tr_b16 v[20:21], v254 offset:32768
    v_mfma_f32_16x16x32_bf16 v[156:159], v[100:103], a[164:167], v[156:159]
    ds_read_b64_tr_b16 v[22:23], v254 offset:34816
    v_mfma_f32_16x16x32_bf16 v[156:159], v[132:135], a[168:171], v[156:159]
    ds_read_b64_tr_b16 v[24:25], v254 offset:36864
    v_mfma_f32_16x16x32_bf16 v[156:159], v[140:143], a[172:175], v[156:159]
    ds_read_b64_tr_b16 v[26:27], v254 offset:38912
    v_mfma_f32_16x16x32_bf16 v[152:155], v[140:143], a[124:127], v[152:155]
    ds_read_b64_tr_b16 v[104:105], v254 offset:40960
    v_mfma_f32_16x16x32_bf16 v[152:155], v[132:135], a[120:123], v[152:155]
    ds_read_b64_tr_b16 v[106:107], v254 offset:43008
    v_mfma_f32_16x16x32_bf16 v[152:155], v[100:103], a[116:119], v[152:155]
    ds_read_b64_tr_b16 v[112:113], v254 offset:45056
    v_mfma_f32_16x16x32_bf16 v[152:155], v[64:67], a[112:115], v[152:155]
    s_add_u32 m0, s29, 134528
    ds_read_b64_tr_b16 v[114:115], v254 offset:47104
    v_mfma_f32_16x16x32_bf16 v[120:123], v[64:67], a[64:67], v[120:123]
    global_load_lds_dwordx4 v247, s[14:15] offset:640
    v_mfma_f32_16x16x32_bf16 v[120:123], v[100:103], a[68:71], v[120:123]
    v_mfma_f32_16x16x32_bf16 v[120:123], v[132:135], a[72:75], v[120:123]
    v_xor_b32 v254, 16448, v255
    v_mfma_f32_16x16x32_bf16 v[120:123], v[140:143], a[76:79], v[120:123]
    v_mfma_f32_16x16x32_bf16 v[36:39], v[140:143], a[28:31], v[36:39]
    v_mfma_f32_16x16x32_bf16 v[36:39], v[132:135], a[24:27], v[36:39]
    v_mfma_f32_16x16x32_bf16 v[36:39], v[100:103], a[20:23], v[36:39]
    v_mfma_f32_16x16x32_bf16 v[36:39], v[64:67], a[16:19], v[36:39]
    s_waitcnt lgkmcnt(0)
    v_mfma_f32_16x16x32_bf16 v[36:39], v[20:23], a[32:35], v[36:39]
    ds_read_b64_tr_b16 v[100:101], v254 offset:0
    v_mfma_f32_16x16x32_bf16 v[36:39], v[24:27], a[36:39], v[36:39]
    ds_read_b64_tr_b16 v[102:103], v254 offset:2048
    v_mfma_f32_16x16x32_bf16 v[36:39], v[104:107], a[40:43], v[36:39]
    ds_read_b64_tr_b16 v[64:65], v254 offset:4096
    v_mfma_f32_16x16x32_bf16 v[36:39], v[112:115], a[44:47], v[36:39]
    ds_read_b64_tr_b16 v[66:67], v254 offset:6144
    v_mfma_f32_16x16x32_bf16 v[120:123], v[112:115], a[92:95], v[120:123]
    ds_read_b64_tr_b16 v[132:133], v254 offset:8192
    v_mfma_f32_16x16x32_bf16 v[120:123], v[104:107], a[88:91], v[120:123]
    ds_read_b64_tr_b16 v[134:135], v254 offset:10240
    v_mfma_f32_16x16x32_bf16 v[120:123], v[24:27], a[84:87], v[120:123]
    ds_read_b64_tr_b16 v[140:141], v254 offset:12288
    v_mfma_f32_16x16x32_bf16 v[120:123], v[20:23], a[80:83], v[120:123]
    s_add_u32 m0, s29, 138624
    ds_read_b64_tr_b16 v[142:143], v254 offset:14336
    v_cvt_pk_bf16_f32 v146, v36, v37
    v_mfma_f32_16x16x32_bf16 v[152:155], v[20:23], a[128:131], v[152:155]
    global_load_lds_dwordx4 v247, s[16:17] offset:640
    v_mfma_f32_16x16x32_bf16 v[152:155], v[24:27], a[132:135], v[152:155]
G_9:
    s_cbranch_vccnz R_ret0
    v_cvt_pk_bf16_f32 v147, v38, v39
    v_mfma_f32_16x16x32_bf16 v[152:155], v[104:107], a[136:139], v[152:155]
    v_cvt_pk_bf16_f32 v150, v120, v121
    v_cvt_pk_bf16_f32 v151, v122, v123
    v_mfma_f32_16x16x32_bf16 v[152:155], v[112:115], a[140:143], v[152:155]
    v_mfma_f32_16x16x32_bf16 v[156:159], v[112:115], a[188:191], v[156:159]
    v_mfma_f32_16x16x32_bf16 v[156:159], v[104:107], a[184:187], v[156:159]
    v_mfma_f32_16x16x32_bf16 v[156:159], v[24:27], a[180:183], v[156:159]
    v_mfma_f32_16x16x32_bf16 v[156:159], v[20:23], a[176:179], v[156:159]
    s_waitcnt lgkmcnt(0)
    v_mfma_f32_16x16x32_bf16 v[36:39], v[100:103], a[0:3], 0
    ds_read_b64_tr_b16 v[24:25], v254 offset:16384
    v_mfma_f32_16x16x32_bf16 v[36:39], v[64:67], a[4:7], v[36:39]
    ds_read_b64_tr_b16 v[26:27], v254 offset:18432
    v_cvt_pk_bf16_f32 v70, v152, v153
    v_mfma_f32_16x16x32_bf16 v[36:39], v[132:135], a[8:11], v[36:39]
    ds_read_b64_tr_b16 v[20:21], v254 offset:20480
    v_cvt_pk_bf16_f32 v71, v154, v155
    v_mfma_f32_16x16x32_bf16 v[36:39], v[140:143], a[12:15], v[36:39]
    ds_read_b64_tr_b16 v[22:23], v254 offset:22528
    v_cvt_pk_bf16_f32 v118, v156, v157
    v_mfma_f32_16x16x32_bf16 v[104:107], v[140:143], a[60:63], 0
    ds_read_b64_tr_b16 v[112:113], v254 offset:24576
    v_cvt_pk_bf16_f32 v119, v158, v159
    v_mfma_f32_16x16x32_bf16 v[104:107], v[132:135], a[56:59], v[104:107]
    ds_read_b64_tr_b16 v[114:115], v254 offset:26624
    v_mfma_f32_16x16x32_bf16 v[104:107], v[64:67], a[52:55], v[104:107]
    ds_read_b64_tr_b16 v[120:121], v254 offset:28672
    v_mfma_f32_16x16x32_bf16 v[104:107], v[100:103], a[48:51], v[104:107]
    s_add_u32 m0, s29, 142720
    ds_read_b64_tr_b16 v[122:123], v254 offset:30720
    v_mfma_f32_16x16x32_bf16 v[152:155], v[100:103], a[96:99], 0
    global_load_lds_dwordx4 v247, s[18:19] offset:640
    v_mfma_f32_16x16x32_bf16 v[152:155], v[64:67], a[100:103], v[152:155]
    ds_read_b128 v[156:159], v246 offset:8576
    v_mfma_f32_16x16x32_bf16 v[152:155], v[132:135], a[104:107], v[152:155]
    ds_read_b128 v[160:163], v246 offset:8704
    v_mfma_f32_16x16x32_bf16 v[152:155], v[140:143], a[108:111], v[152:155]
    ds_read_b128 v[164:167], v246 offset:8832
    v_mfma_f32_16x16x32_bf16 v[168:171], v[140:143], a[156:159], 0
    ds_read_b128 v[172:175], v246 offset:8960
    v_mfma_f32_16x16x32_bf16 v[168:171], v[132:135], a[152:155], v[168:171]
    v_mfma_f32_16x16x32_bf16 v[168:171], v[64:67], a[148:151], v[168:171]
    v_mfma_f32_16x16x32_bf16 v[168:171], v[100:103], a[144:147], v[168:171]
    s_waitcnt lgkmcnt(4)
    v_mfma_f32_16x16x32_bf16 v[168:171], v[24:27], a[160:163], v[168:171]
    ds_read_b64_tr_b16 v[64:65], v254 offset:32768
    v_mfma_f32_16x16x32_bf16 v[168:171], v[20:23], a[164:167], v[168:171]
    ds_read_b64_tr_b16 v[66:67], v254 offset:34816
    v_mfma_f32_16x16x32_bf16 v[168:171], v[112:115], a[168:171], v[168:171]
    ds_read_b64_tr_b16 v[100:101], v254 offset:36864
    v_mfma_f32_16x16x32_bf16 v[168:171], v[120:123], a[172:175], v[168:171]
    ds_read_b64_tr_b16 v[102:103], v254 offset:38912
    v_mfma_f32_16x16x32_bf16 v[152:155], v[120:123], a[124:127], v[152:155]
    ds_read_b64_tr_b16 v[132:133], v254 offset:40960
    v_mfma_f32_16x16x32_bf16 v[152:155], v[112:115], a[120:123], v[152:155]
    ds_read_b64_tr_b16 v[134:135], v254 offset:43008
    v_mfma_f32_16x16x32_bf16 v[152:155], v[20:23], a[116:119], v[152:155]
    ds_read_b64_tr_b16 v[140:141], v254 offset:45056
    v_mfma_f32_16x16x32_bf16 v[152:155], v[24:27], a[112:115], v[152:155]
    s_add_u32 m0, s29, 146816
    ds_read_b64_tr_b16 v[142:143], v254 offset:47104
    v_mfma_f32_16x16x32_bf16 v[104:107], v[24:27], a[64:67], v[104:107]
    global_load_lds_dwordx4 v247, s[20:21] offset:640
    v_mfma_f32_16x16x32_bf16 v[104:107], v[20:23], a[68:71], v[104:107]
    ds_read_b128 v[176:179], v246 offset:8448
    v_mfma_f32_16x16x32_bf16 v[104:107], v[112:115], a[72:75], v[104:107]
    ds_read_b128 v[180:183], v246 offset:8576
    v_mfma_f32_16x16x32_bf16 v[104:107], v[120:123], a[76:79], v[104:107]
    ds_read_b128 v[184:187], v246 offset:8704
    v_mfma_f32_16x16x32_bf16 v[36:39], v[120:123], a[28:31], v[36:39]
    ds_read_b128 v[188:191], v246 offset:8832
    v_mfma_f32_16x16x32_bf16 v[36:39], v[112:115], a[24:27], v[36:39]
    v_mfma_f32_16x16x32_bf16 v[36:39], v[20:23], a[20:23], v[36:39]
    v_mfma_f32_16x16x32_bf16 v[36:39], v[24:27], a[16:19], v[36:39]
    s_waitcnt lgkmcnt(12)
    v_mfma_f32_16x16x32_bf16 v[156:159], v[96:99], v[84:87], v[156:159]
    v_mfma_f32_16x16x32_bf16 v[156:159], v[60:63], v[124:127], v[156:159]
    v_mfma_f32_16x16x32_bf16 v[156:159], v[76:79], v[144:147], v[156:159]
    v_mfma_f32_16x16x32_bf16 v[160:163], v[0:3], v[144:147], v[160:163]
    v_mfma_f32_16x16x32_bf16 v[160:163], v[8:11], v[124:127], v[160:163]
    v_mfma_f32_16x16x32_bf16 v[160:163], v[136:139], v[84:87], v[160:163]
    v_mfma_f32_16x16x32_bf16 v[164:167], v[52:55], v[84:87], v[164:167]
    v_xor_b32 v254, 16480, v255
    v_mfma_f32_16x16x32_bf16 v[164:167], v[4:7], v[124:127], v[164:167]
    v_mfma_f32_16x16x32_bf16 v[164:167], v[32:35], v[144:147], v[164:167]
    v_mfma_f32_16x16x32_bf16 v[172:175], v[56:59], v[144:147], v[172:175]
    v_max3_f32 v253, v156, v157, v158
    v_mfma_f32_16x16x32_bf16 v[172:175], v[28:31], v[124:127], v[172:175]
    v_mfma_f32_16x16x32_bf16 v[172:175], v[44:47], v[84:87], v[172:175]
    s_waitcnt lgkmcnt(4)
    v_max3_f32 v253, v253, v159, v160
    v_max3_f32 v253, v253, v161, v162
    v_mfma_f32_16x16x32_bf16 v[36:39], v[64:67], a[32:35], v[36:39]
    ds_read_b64_tr_b16 v[20:21], v254 offset:0
    v_max3_f32 v249, v164, v165, v166
    v_mfma_f32_16x16x32_bf16 v[36:39], v[100:103], a[36:39], v[36:39]
    ds_read_b64_tr_b16 v[22:23], v254 offset:2048
    v_max3_f32 v249, v249, v167, v172
    v_mfma_f32_16x16x32_bf16 v[36:39], v[132:135], a[40:43], v[36:39]
    ds_read_b64_tr_b16 v[24:25], v254 offset:4096
    v_max3_f32 v249, v249, v173, v174
    v_mfma_f32_16x16x32_bf16 v[36:39], v[140:143], a[44:47], v[36:39]
    ds_read_b64_tr_b16 v[26:27], v254 offset:6144
    v_max_f32 v253, v253, v163
    v_mfma_f32_16x16x32_bf16 v[104:107], v[140:143], a[92:95], v[104:107]
    ds_read_b64_tr_b16 v[84:85], v254 offset:8192
    v_max_f32 v249, v249, v175
    v_mfma_f32_16x16x32_bf16 v[104:107], v[132:135], a[88:91], v[104:107]
    ds_read_b64_tr_b16 v[86:87], v254 offset:10240
    v_add_f32 v253, v253, v252
    v_mfma_f32_16x16x32_bf16 v[104:107], v[100:103], a[84:87], v[104:107]
    ds_read_b64_tr_b16 v[112:113], v254 offset:12288
    v_cvt_pk_bf16_f32 v120, v36, v37
    v_mfma_f32_16x16x32_bf16 v[104:107], v[64:67], a[80:83], v[104:107]
    s_add_u32 m0, s29, 150912
    ds_read_b64_tr_b16 v[114:115], v254 offset:14336
    v_cvt_pk_bf16_f32 v121, v38, v39
    v_mfma_f32_16x16x32_bf16 v[152:155], v[64:67], a[128:131], v[152:155]
    global_load_lds_dwordx4 v247, s[22:23] offset:640
    v_mfma_f32_16x16x32_bf16 v[152:155], v[100:103], a[132:135], v[152:155]
    ds_read_b128 v[36:39], v246 offset:8320
    v_add_f32 v249, v249, v251
    v_mfma_f32_16x16x32_bf16 v[152:155], v[132:135], a[136:139], v[152:155]
    ds_read_b128 v[124:127], v246 offset:8448
    v_cvt_pk_bf16_f32 v144, v104, v105
    v_mfma_f32_16x16x32_bf16 v[152:155], v[140:143], a[140:143], v[152:155]
    ds_read_b128 v[192:195], v246 offset:8576
    v_cvt_pk_bf16_f32 v145, v106, v107
    v_mfma_f32_16x16x32_bf16 v[168:171], v[140:143], a[188:191], v[168:171]
    ds_read_b128 v[196:199], v246 offset:8704
    v_max_f32 v245, v253, v249
    v_mfma_f32_16x16x32_bf16 v[168:171], v[132:135], a[184:187], v[168:171]
    v_mfma_f32_16x16x32_bf16 v[168:171], v[100:103], a[180:183], v[168:171]
    v_mfma_f32_16x16x32_bf16 v[168:171], v[64:67], a[176:179], v[168:171]
    s_waitcnt lgkmcnt(12)
    v_cvt_pk_bf16_f32 v104, v152, v153
    v_cvt_pk_bf16_f32 v105, v154, v155
    v_mfma_f32_16x16x32_bf16 v[176:179], v[96:99], v[16:19], v[176:179]
    v_mfma_f32_16x16x32_bf16 v[176:179], v[60:63], v[128:131], v[176:179]
    v_mfma_f32_16x16x32_bf16 v[176:179], v[76:79], v[148:151], v[176:179]
    v_mfma_f32_16x16x32_bf16 v[180:183], v[0:3], v[148:151], v[180:183]
    v_mfma_f32_16x16x32_bf16 v[180:183], v[8:11], v[128:131], v[180:183]
    v_cvt_pk_bf16_f32 v64, v168, v169
    v_cvt_pk_bf16_f32 v65, v170, v171
    v_mfma_f32_16x16x32_bf16 v[180:183], v[136:139], v[16:19], v[180:183]
    v_mfma_f32_16x16x32_bf16 v[184:187], v[52:55], v[16:19], v[184:187]
    v_mfma_f32_16x16x32_bf16 v[184:187], v[4:7], v[128:131], v[184:187]
    v_mfma_f32_16x16x32_bf16 v[184:187], v[32:35], v[148:151], v[184:187]
    v_max3_f32 v253, v176, v177, v178
    v_mfma_f32_16x16x32_bf16 v[188:191], v[56:59], v[148:151], v[188:191]
    v_mfma_f32_16x16x32_bf16 v[188:191], v[28:31], v[128:131], v[188:191]
    v_mfma_f32_16x16x32_bf16 v[188:191], v[44:47], v[16:19], v[188:191]
    s_waitcnt lgkmcnt(4)
    v_max3_f32 v253, v253, v179, v180
    v_max3_f32 v253, v253, v181, v182
    v_mfma_f32_16x16x32_bf16 v[16:19], v[20:23], a[0:3], 0
    ds_read_b64_tr_b16 v[100:101], v254 offset:16384
    v_max3_f32 v249, v184, v185, v186
    v_mfma_f32_16x16x32_bf16 v[16:19], v[24:27], a[4:7], v[16:19]
    ds_read_b64_tr_b16 v[102:103], v254 offset:18432
    v_max3_f32 v249, v249, v187, v188
    v_mfma_f32_16x16x32_bf16 v[16:19], v[84:87], a[8:11], v[16:19]
    ds_read_b64_tr_b16 v[128:129], v254 offset:20480
    v_max3_f32 v249, v249, v189, v190
    v_mfma_f32_16x16x32_bf16 v[16:19], v[112:115], a[12:15], v[16:19]
    ds_read_b64_tr_b16 v[130:131], v254 offset:22528
    v_max_f32 v253, v253, v183
    v_mfma_f32_16x16x32_bf16 v[132:135], v[112:115], a[60:63], 0
    ds_read_b64_tr_b16 v[140:141], v254 offset:24576
    v_max_f32 v249, v249, v191
    v_mfma_f32_16x16x32_bf16 v[132:135], v[84:87], a[56:59], v[132:135]
    ds_read_b64_tr_b16 v[142:143], v254 offset:26624
    v_add_f32 v253, v253, v252
    v_mfma_f32_16x16x32_bf16 v[132:135], v[24:27], a[52:55], v[132:135]
    ds_read_b64_tr_b16 v[148:149], v254 offset:28672
    v_add_f32 v249, v249, v251
    v_mfma_f32_16x16x32_bf16 v[132:135], v[20:23], a[48:51], v[132:135]
    s_add_u32 m0, s29, 155008
    ds_read_b64_tr_b16 v[150:151], v254 offset:30720
    v_max_f32 v244, v253, v249
    v_mfma_f32_16x16x32_bf16 v[152:155], v[20:23], a[96:99], 0
    global_load_lds_dwordx4 v247, s[24:25] offset:640
    v_mfma_f32_16x16x32_bf16 v[152:155], v[24:27], a[100:103], v[152:155]
    ds_read_b128 v[168:171], v246 offset:8192
    v_mfma_f32_16x16x32_bf16 v[152:155], v[84:87], a[104:107], v[152:155]
    ds_read_b128 v[200:203], v246 offset:8320
    v_mfma_f32_16x16x32_bf16 v[152:155], v[112:115], a[108:111], v[152:155]
    ds_read_b128 v[204:207], v246 offset:8448
    v_mfma_f32_16x16x32_bf16 v[208:211], v[112:115], a[156:159], 0
    ds_read_b128 v[212:215], v246 offset:8576
    v_mfma_f32_16x16x32_bf16 v[208:211], v[84:87], a[152:155], v[208:211]
    v_permlane32_swap_b32 v245, v244
    v_mfma_f32_16x16x32_bf16 v[208:211], v[24:27], a[148:151], v[208:211]
    v_max_f32 v253, v245, v244
    v_mfma_f32_16x16x32_bf16 v[208:211], v[20:23], a[144:147], v[208:211]
    s_waitcnt lgkmcnt(12)
    v_mfma_f32_16x16x32_bf16 v[36:39], v[96:99], v[48:51], v[36:39]
    v_mfma_f32_16x16x32_bf16 v[36:39], v[60:63], v[80:83], v[36:39]
    v_mfma_f32_16x16x32_bf16 v[36:39], v[76:79], v[68:71], v[36:39]
    v_mfma_f32_16x16x32_bf16 v[124:127], v[0:3], v[68:71], v[124:127]
    v_mfma_f32_16x16x32_bf16 v[124:127], v[8:11], v[80:83], v[124:127]
    v_mfma_f32_16x16x32_bf16 v[124:127], v[136:139], v[48:51], v[124:127]
    v_mfma_f32_16x16x32_bf16 v[192:195], v[52:55], v[48:51], v[192:195]
    v_mfma_f32_16x16x32_bf16 v[192:195], v[4:7], v[80:83], v[192:195]
    v_mfma_f32_16x16x32_bf16 v[192:195], v[32:35], v[68:71], v[192:195]
    v_mfma_f32_16x16x32_bf16 v[196:199], v[56:59], v[68:71], v[196:199]
    v_mfma_f32_16x16x32_bf16 v[196:199], v[28:31], v[80:83], v[196:199]
    v_max3_f32 v249, v36, v37, v38
    v_mfma_f32_16x16x32_bf16 v[196:199], v[44:47], v[48:51], v[196:199]
    s_waitcnt lgkmcnt(4)
    v_max3_f32 v249, v249, v39, v124
    v_max3_f32 v249, v249, v125, v126
    v_mfma_f32_16x16x32_bf16 v[208:211], v[100:103], a[160:163], v[208:211]
    ds_read_b64_tr_b16 v[20:21], v254 offset:32768
    v_max3_f32 v245, v192, v193, v194
    v_mfma_f32_16x16x32_bf16 v[208:211], v[128:131], a[164:167], v[208:211]
    ds_read_b64_tr_b16 v[22:23], v254 offset:34816
    v_max3_f32 v245, v245, v195, v196
    v_mfma_f32_16x16x32_bf16 v[208:211], v[140:143], a[168:171], v[208:211]
    ds_read_b64_tr_b16 v[24:25], v254 offset:36864
    v_max3_f32 v245, v245, v197, v198
    v_mfma_f32_16x16x32_bf16 v[208:211], v[148:151], a[172:175], v[208:211]
    ds_read_b64_tr_b16 v[26:27], v254 offset:38912
    v_max_f32 v245, v245, v199
    v_mfma_f32_16x16x32_bf16 v[152:155], v[148:151], a[124:127], v[152:155]
    ds_read_b64_tr_b16 v[48:49], v254 offset:40960
    v_max_f32 v249, v249, v127
    v_mfma_f32_16x16x32_bf16 v[152:155], v[140:143], a[120:123], v[152:155]
    ds_read_b64_tr_b16 v[50:51], v254 offset:43008
    v_add_f32 v245, v245, v252
    v_mfma_f32_16x16x32_bf16 v[152:155], v[128:131], a[116:119], v[152:155]
    ds_read_b64_tr_b16 v[68:69], v254 offset:45056
    v_add_f32 v249, v249, v251
    v_mfma_f32_16x16x32_bf16 v[152:155], v[100:103], a[112:115], v[152:155]
    s_add_u32 m0, s29, 159104
    ds_read_b64_tr_b16 v[70:71], v254 offset:47104
    v_max_f32 v244, v245, v249
    v_mfma_f32_16x16x32_bf16 v[132:135], v[100:103], a[64:67], v[132:135]
    global_load_lds_dwordx4 v247, s[26:27] offset:640
    v_mfma_f32_16x16x32_bf16 v[132:135], v[128:131], a[68:71], v[132:135]
    v_mfma_f32_16x16x32_bf16 v[132:135], v[140:143], a[72:75], v[132:135]
    v_mfma_f32_16x16x32_bf16 v[132:135], v[148:151], a[76:79], v[132:135]
    v_mfma_f32_16x16x32_bf16 v[16:19], v[148:151], a[28:31], v[16:19]
    v_mfma_f32_16x16x32_bf16 v[16:19], v[140:143], a[24:27], v[16:19]
    v_mfma_f32_16x16x32_bf16 v[16:19], v[128:131], a[20:23], v[16:19]
    v_mfma_f32_16x16x32_bf16 v[16:19], v[100:103], a[16:19], v[16:19]
    s_waitcnt lgkmcnt(8)
    v_mfma_f32_16x16x32_bf16 v[168:171], v[96:99], v[88:91], v[168:171]
    v_mfma_f32_16x16x32_bf16 v[168:171], v[60:63], v[108:111], v[168:171]
    v_mfma_f32_16x16x32_bf16 v[168:171], v[76:79], v[116:119], v[168:171]
    v_mfma_f32_16x16x32_bf16 v[200:203], v[0:3], v[116:119], v[200:203]
    v_mfma_f32_16x16x32_bf16 v[200:203], v[8:11], v[108:111], v[200:203]
    v_mfma_f32_16x16x32_bf16 v[200:203], v[136:139], v[88:91], v[200:203]
    v_mfma_f32_16x16x32_bf16 v[204:207], v[52:55], v[88:91], v[204:207]
    v_xor_b32 v254, 65536, v255
    v_mfma_f32_16x16x32_bf16 v[204:207], v[4:7], v[108:111], v[204:207]
    v_mfma_f32_16x16x32_bf16 v[204:207], v[32:35], v[116:119], v[204:207]
    v_mfma_f32_16x16x32_bf16 v[212:215], v[56:59], v[116:119], v[212:215]
    v_max3_f32 v249, v168, v169, v170
    v_mfma_f32_16x16x32_bf16 v[212:215], v[28:31], v[108:111], v[212:215]
    v_mfma_f32_16x16x32_bf16 v[212:215], v[44:47], v[88:91], v[212:215]
    s_waitcnt vmcnt(12) lgkmcnt(0)
    s_barrier
    v_max3_f32 v249, v249, v171, v200
    v_mfma_f32_16x16x32_bf16 v[16:19], v[20:23], a[32:35], v[16:19]
    ds_read_b64_tr_b16 v[0:1], v254 offset:0
    v_max3_f32 v245, v204, v205, v206
    v_mfma_f32_16x16x32_bf16 v[16:19], v[24:27], a[36:39], v[16:19]
    ds_read_b64_tr_b16 v[2:3], v254 offset:2048
    v_max3_f32 v245, v245, v207, v212
    v_mfma_f32_16x16x32_bf16 v[16:19], v[48:51], a[40:43], v[16:19]
    ds_read_b64_tr_b16 v[4:5], v254 offset:4096
    v_max3_f32 v245, v245, v213, v214
    v_mfma_f32_16x16x32_bf16 v[16:19], v[68:71], a[44:47], v[16:19]
    ds_read_b64_tr_b16 v[6:7], v254 offset:6144
    v_max3_f32 v249, v249, v201, v202
    v_mfma_f32_16x16x32_bf16 v[132:135], v[68:71], a[92:95], v[132:135]
    ds_read_b64_tr_b16 v[8:9], v254 offset:8192
    v_max_f32 v245, v245, v215
    v_mfma_f32_16x16x32_bf16 v[132:135], v[48:51], a[88:91], v[132:135]
    ds_read_b64_tr_b16 v[10:11], v254 offset:10240
    v_max_f32 v249, v249, v203
    v_mfma_f32_16x16x32_bf16 v[132:135], v[24:27], a[84:87], v[132:135]
    ds_read_b64_tr_b16 v[28:29], v254 offset:12288
    v_cvt_pk_bf16_f32 v122, v16, v17
    v_mfma_f32_16x16x32_bf16 v[132:135], v[20:23], a[80:83], v[132:135]
    s_add_u32 m0, s29, 14848
    ds_read_b64_tr_b16 v[30:31], v254 offset:14336
    v_cvt_pk_bf16_f32 v123, v18, v19
    v_mfma_f32_16x16x32_bf16 v[152:155], v[20:23], a[128:131], v[152:155]
    global_load_lds_dwordx4 v247, s[4:5] offset:1536
    v_mfma_f32_16x16x32_bf16 v[152:155], v[24:27], a[132:135], v[152:155]
    v_add_f32 v245, v245, v252
    v_add_f32 v249, v249, v251
    v_mfma_f32_16x16x32_bf16 v[152:155], v[48:51], a[136:139], v[152:155]
    v_cvt_pk_bf16_f32 v146, v132, v133
    v_cvt_pk_bf16_f32 v147, v134, v135
    v_mfma_f32_16x16x32_bf16 v[152:155], v[68:71], a[140:143], v[152:155]
    v_max_f32 v243, v245, v249
    v_mfma_f32_16x16x32_bf16 v[208:211], v[68:71], a[188:191], v[208:211]
    v_mfma_f32_16x16x32_bf16 v[208:211], v[48:51], a[184:187], v[208:211]
    v_permlane32_swap_b32 v244, v243
    v_mfma_f32_16x16x32_bf16 v[208:211], v[24:27], a[180:183], v[208:211]
    v_max_f32 v249, v244, v243
    v_mfma_f32_16x16x32_bf16 v[208:211], v[20:23], a[176:179], v[208:211]
    s_waitcnt lgkmcnt(0)
    v_cvt_pk_bf16_f32 v106, v152, v153
    v_cvt_pk_bf16_f32 v107, v154, v155
    v_mfma_f32_16x16x32_bf16 v[16:19], v[0:3], a[0:3], 0
    ds_read_b64_tr_b16 v[20:21], v254 offset:16384
    v_mfma_f32_16x16x32_bf16 v[16:19], v[4:7], a[4:7], v[16:19]
    ds_read_b64_tr_b16 v[22:23], v254 offset:18432
    v_mfma_f32_16x16x32_bf16 v[16:19], v[8:11], a[8:11], v[16:19]
    ds_read_b64_tr_b16 v[24:25], v254 offset:20480
    v_cvt_pk_bf16_f32 v66, v208, v209
    v_mfma_f32_16x16x32_bf16 v[16:19], v[28:31], a[12:15], v[16:19]
    ds_read_b64_tr_b16 v[26:27], v254 offset:22528
    v_cvt_pk_bf16_f32 v67, v210, v211
    v_mfma_f32_16x16x32_bf16 v[32:35], v[28:31], a[60:63], 0
    ds_read_b64_tr_b16 v[44:45], v254 offset:24576
    v_mfma_f32_16x16x32_bf16 v[32:35], v[8:11], a[56:59], v[32:35]
    ds_read_b64_tr_b16 v[46:47], v254 offset:26624
    v_mfma_f32_16x16x32_bf16 v[32:35], v[4:7], a[52:55], v[32:35]
    ds_read_b64_tr_b16 v[48:49], v254 offset:28672
    v_mfma_f32_16x16x32_bf16 v[32:35], v[0:3], a[48:51], v[32:35]
    s_add_u32 m0, s29, 18944
    ds_read_b64_tr_b16 v[50:51], v254 offset:30720
    v_mfma_f32_16x16x32_bf16 v[52:55], v[0:3], a[96:99], 0
    global_load_lds_dwordx4 v247, s[6:7] offset:1536
    v_mfma_f32_16x16x32_bf16 v[52:55], v[4:7], a[100:103], v[52:55]
    v_permlane16_swap_b32 v253, v249
    v_mfma_f32_16x16x32_bf16 v[52:55], v[8:11], a[104:107], v[52:55]
    v_max_f32 v245, v253, v249
    v_mov_b32 v244, v245
    v_mfma_f32_16x16x32_bf16 v[52:55], v[28:31], a[108:111], v[52:55]
    v_mfma_f32_16x16x32_bf16 v[56:59], v[28:31], a[156:159], 0
    v_permlane32_swap_b32 v245, v244
    v_mfma_f32_16x16x32_bf16 v[56:59], v[8:11], a[152:155], v[56:59]
    v_mov_b32 v253, v245
    v_mov_b32 v249, v244
    v_mfma_f32_16x16x32_bf16 v[56:59], v[4:7], a[148:151], v[56:59]
    v_permlane16_swap_b32 v245, v253
    v_mfma_f32_16x16x32_bf16 v[56:59], v[0:3], a[144:147], v[56:59]
    s_waitcnt lgkmcnt(0)
    v_permlane16_swap_b32 v244, v249
    v_mfma_f32_16x16x32_bf16 v[56:59], v[20:23], a[160:163], v[56:59]
    ds_read_b64_tr_b16 v[0:1], v254 offset:32768
    v_fma_f32 v243, v245, s32, v248
    v_mfma_f32_16x16x32_bf16 v[56:59], v[24:27], a[164:167], v[56:59]
    ds_read_b64_tr_b16 v[2:3], v254 offset:34816
    v_fma_f32 v242, v244, s32, v248
    v_mfma_f32_16x16x32_bf16 v[56:59], v[44:47], a[168:171], v[56:59]
    ds_read_b64_tr_b16 v[4:5], v254 offset:36864
    v_fma_f32 v241, v253, s32, v250
    v_mfma_f32_16x16x32_bf16 v[56:59], v[48:51], a[172:175], v[56:59]
    ds_read_b64_tr_b16 v[6:7], v254 offset:38912
    v_fma_f32 v240, v249, s32, v250
    v_mfma_f32_16x16x32_bf16 v[52:55], v[48:51], a[124:127], v[52:55]
    ds_read_b64_tr_b16 v[8:9], v254 offset:40960
    v_fma_f32 v156, v156, s31, v243
    v_mfma_f32_16x16x32_bf16 v[52:55], v[44:47], a[120:123], v[52:55]
    ds_read_b64_tr_b16 v[10:11], v254 offset:43008
    v_fma_f32 v157, v157, s31, v243
    v_mfma_f32_16x16x32_bf16 v[52:55], v[24:27], a[116:119], v[52:55]
    ds_read_b64_tr_b16 v[28:29], v254 offset:45056
    v_fma_f32 v176, v176, s31, v242
    v_mfma_f32_16x16x32_bf16 v[52:55], v[20:23], a[112:115], v[52:55]
    s_add_u32 m0, s29, 23040
    ds_read_b64_tr_b16 v[30:31], v254 offset:47104
    v_fma_f32 v177, v177, s31, v242
    v_mfma_f32_16x16x32_bf16 v[32:35], v[20:23], a[64:67], v[32:35]
    global_load_lds_dwordx4 v247, s[8:9] offset:1536
    v_mfma_f32_16x16x32_bf16 v[32:35], v[24:27], a[68:71], v[32:35]
    v_fma_f32 v36, v36, s31, v241
    v_fma_f32 v37, v37, s31, v241
    v_mfma_f32_16x16x32_bf16 v[32:35], v[44:47], a[72:75], v[32:35]
    v_xor_b32 v254, 65568, v255
    v_fma_f32 v168, v168, s31, v240
    v_mfma_f32_16x16x32_bf16 v[32:35], v[48:51], a[76:79], v[32:35]
    v_fma_f32 v169, v169, s31, v240
    v_fma_f32 v158, v158, s31, v243
    v_mfma_f32_16x16x32_bf16 v[16:19], v[48:51], a[28:31], v[16:19]
    v_exp_f32 v156, v156
    v_mfma_f32_16x16x32_bf16 v[16:19], v[44:47], a[24:27], v[16:19]
    v_exp_f32 v157, v157
    v_mfma_f32_16x16x32_bf16 v[16:19], v[24:27], a[20:23], v[16:19]
    v_exp_f32 v176, v176
    v_mfma_f32_16x16x32_bf16 v[16:19], v[20:23], a[16:19], v[16:19]
    s_waitcnt lgkmcnt(0)
    v_exp_f32 v177, v177
    v_mfma_f32_16x16x32_bf16 v[16:19], v[0:3], a[32:35], v[16:19]
    ds_read_b64_tr_b16 v[20:21], v254 offset:0
    v_fma_f32 v178, v178, s31, v242
    v_mfma_f32_16x16x32_bf16 v[16:19], v[4:7], a[36:39], v[16:19]
    ds_read_b64_tr_b16 v[22:23], v254 offset:2048
    v_fma_f32 v38, v38, s31, v241
    v_mfma_f32_16x16x32_bf16 v[16:19], v[8:11], a[40:43], v[16:19]
    ds_read_b64_tr_b16 v[24:25], v254 offset:4096
    v_fma_f32 v170, v170, s31, v240
    v_mfma_f32_16x16x32_bf16 v[16:19], v[28:31], a[44:47], v[16:19]
    ds_read_b64_tr_b16 v[26:27], v254 offset:6144
    v_fma_f32 v159, v159, s31, v243
    v_mfma_f32_16x16x32_bf16 v[32:35], v[28:31], a[92:95], v[32:35]
    ds_read_b64_tr_b16 v[44:45], v254 offset:8192
    v_fma_f32 v179, v179, s31, v242
    v_mfma_f32_16x16x32_bf16 v[32:35], v[8:11], a[88:91], v[32:35]
    ds_read_b64_tr_b16 v[46:47], v254 offset:10240
    v_fma_f32 v39, v39, s31, v241
    v_mfma_f32_16x16x32_bf16 v[32:35], v[4:7], a[84:87], v[32:35]
    ds_read_b64_tr_b16 v[48:49], v254 offset:12288
    v_cvt_pk_bf16_f32 v60, v16, v17
    v_mfma_f32_16x16x32_bf16 v[32:35], v[0:3], a[80:83], v[32:35]
    s_add_u32 m0, s29, 27136
    ds_read_b64_tr_b16 v[50:51], v254 offset:14336
    v_cvt_pk_bf16_f32 v61, v18, v19
    v_mfma_f32_16x16x32_bf16 v[52:55], v[0:3], a[128:131], v[52:55]
    global_load_lds_dwordx4 v247, s[10:11] offset:1536
    v_mfma_f32_16x16x32_bf16 v[52:55], v[4:7], a[132:135], v[52:55]
    v_exp_f32 v36, v36
    v_mfma_f32_16x16x32_bf16 v[52:55], v[8:11], a[136:139], v[52:55]
    v_cvt_pk_bf16_f32 v16, v32, v33
    v_cvt_pk_bf16_f32 v17, v34, v35
    v_mfma_f32_16x16x32_bf16 v[52:55], v[28:31], a[140:143], v[52:55]
    v_exp_f32 v37, v37
    v_mfma_f32_16x16x32_bf16 v[56:59], v[28:31], a[188:191], v[56:59]
    v_exp_f32 v168, v168
    v_mfma_f32_16x16x32_bf16 v[56:59], v[8:11], a[184:187], v[56:59]
    v_exp_f32 v169, v169
    v_mfma_f32_16x16x32_bf16 v[56:59], v[4:7], a[180:183], v[56:59]
    v_exp_f32 v158, v158
    v_mfma_f32_16x16x32_bf16 v[56:59], v[0:3], a[176:179], v[56:59]
    s_waitcnt lgkmcnt(0)
    v_cvt_pk_bf16_f32 v4, v52, v53
    v_cvt_pk_bf16_f32 v5, v54, v55
    v_mfma_f32_16x16x32_bf16 v[0:3], v[20:23], a[0:3], 0
    ds_read_b64_tr_b16 v[8:9], v254 offset:16384
    v_fma_f32 v171, v171, s31, v240
    v_mfma_f32_16x16x32_bf16 v[0:3], v[24:27], a[4:7], v[0:3]
    ds_read_b64_tr_b16 v[10:11], v254 offset:18432
    v_cvt_pk_bf16_f32 v28, v56, v57
    v_mfma_f32_16x16x32_bf16 v[0:3], v[44:47], a[8:11], v[0:3]
    ds_read_b64_tr_b16 v[32:33], v254 offset:20480
    v_cvt_pk_bf16_f32 v29, v58, v59
    v_mfma_f32_16x16x32_bf16 v[0:3], v[48:51], a[12:15], v[0:3]
    ds_read_b64_tr_b16 v[34:35], v254 offset:22528
    v_fma_f32 v160, v160, s31, v243
    v_mfma_f32_16x16x32_bf16 v[52:55], v[48:51], a[60:63], 0
    ds_read_b64_tr_b16 v[56:57], v254 offset:24576
    v_fma_f32 v180, v180, s31, v242
    v_mfma_f32_16x16x32_bf16 v[52:55], v[44:47], a[56:59], v[52:55]
    ds_read_b64_tr_b16 v[58:59], v254 offset:26624
    v_fma_f32 v124, v124, s31, v241
    v_mfma_f32_16x16x32_bf16 v[52:55], v[24:27], a[52:55], v[52:55]
    ds_read_b64_tr_b16 v[68:69], v254 offset:28672
    v_fma_f32 v200, v200, s31, v240
    v_mfma_f32_16x16x32_bf16 v[52:55], v[20:23], a[48:51], v[52:55]
    s_add_u32 m0, s29, 31232
    ds_read_b64_tr_b16 v[70:71], v254 offset:30720
    v_add_f32 v239, v156, v157
    v_mfma_f32_16x16x32_bf16 v[76:79], v[20:23], a[96:99], 0
    global_load_lds_dwordx4 v247, s[12:13] offset:1536
    v_mfma_f32_16x16x32_bf16 v[76:79], v[24:27], a[100:103], v[76:79]
    v_exp_f32 v178, v178
    v_mfma_f32_16x16x32_bf16 v[76:79], v[44:47], a[104:107], v[76:79]
    v_exp_f32 v38, v38
    v_mfma_f32_16x16x32_bf16 v[76:79], v[48:51], a[108:111], v[76:79]
    v_exp_f32 v170, v170
    v_mfma_f32_16x16x32_bf16 v[80:83], v[48:51], a[156:159], 0
    v_exp_f32 v159, v159
    v_mfma_f32_16x16x32_bf16 v[80:83], v[44:47], a[152:155], v[80:83]
    v_exp_f32 v179, v179
    v_mfma_f32_16x16x32_bf16 v[80:83], v[24:27], a[148:151], v[80:83]
    v_exp_f32 v39, v39
    v_mfma_f32_16x16x32_bf16 v[80:83], v[20:23], a[144:147], v[80:83]
    s_waitcnt lgkmcnt(0)
    v_exp_f32 v171, v171
    v_mfma_f32_16x16x32_bf16 v[80:83], v[8:11], a[160:163], v[80:83]
    ds_read_b64_tr_b16 v[20:21], v254 offset:32768
    v_fma_f32 v161, v161, s31, v243
    v_mfma_f32_16x16x32_bf16 v[80:83], v[32:35], a[164:167], v[80:83]
    ds_read_b64_tr_b16 v[22:23], v254 offset:34816
    v_add_f32 v238, v176, v177
    v_mfma_f32_16x16x32_bf16 v[80:83], v[56:59], a[168:171], v[80:83]
    ds_read_b64_tr_b16 v[24:25], v254 offset:36864
    v_fma_f32 v181, v181, s31, v242
    v_mfma_f32_16x16x32_bf16 v[80:83], v[68:71], a[172:175], v[80:83]
    ds_read_b64_tr_b16 v[26:27], v254 offset:38912
    v_add_f32 v237, v36, v37
    v_mfma_f32_16x16x32_bf16 v[76:79], v[68:71], a[124:127], v[76:79]
    ds_read_b64_tr_b16 v[44:45], v254 offset:40960
    v_fma_f32 v125, v125, s31, v241
    v_mfma_f32_16x16x32_bf16 v[76:79], v[56:59], a[120:123], v[76:79]
    ds_read_b64_tr_b16 v[46:47], v254 offset:43008
    v_add_f32 v236, v168, v169
    v_mfma_f32_16x16x32_bf16 v[76:79], v[32:35], a[116:119], v[76:79]
    ds_read_b64_tr_b16 v[48:49], v254 offset:45056
    v_fma_f32 v201, v201, s31, v240
    v_mfma_f32_16x16x32_bf16 v[76:79], v[8:11], a[112:115], v[76:79]
    s_add_u32 m0, s29, 35328
    ds_read_b64_tr_b16 v[50:51], v254 offset:47104
    v_add_f32 v239, v239, v158
    v_mfma_f32_16x16x32_bf16 v[52:55], v[8:11], a[64:67], v[52:55]
    global_load_lds_dwordx4 v247, s[14:15] offset:1536
    v_mfma_f32_16x16x32_bf16 v[52:55], v[32:35], a[68:71], v[52:55]
    v_exp_f32 v160, v160
    v_mfma_f32_16x16x32_bf16 v[52:55], v[56:59], a[72:75], v[52:55]
    v_xor_b32 v254, 65600, v255
    v_fma_f32 v162, v162, s31, v243
    v_mfma_f32_16x16x32_bf16 v[52:55], v[68:71], a[76:79], v[52:55]
    v_exp_f32 v180, v180
    v_mfma_f32_16x16x32_bf16 v[0:3], v[68:71], a[28:31], v[0:3]
    v_exp_f32 v124, v124
    v_mfma_f32_16x16x32_bf16 v[0:3], v[56:59], a[24:27], v[0:3]
    v_exp_f32 v200, v200
    v_mfma_f32_16x16x32_bf16 v[0:3], v[32:35], a[20:23], v[0:3]
    v_exp_f32 v161, v161
    v_mfma_f32_16x16x32_bf16 v[0:3], v[8:11], a[16:19], v[0:3]
    s_waitcnt lgkmcnt(0)
    v_add_f32 v238, v238, v178
    v_fma_f32 v182, v182, s31, v242
    v_mfma_f32_16x16x32_bf16 v[0:3], v[20:23], a[32:35], v[0:3]
    ds_read_b64_tr_b16 v[8:9], v254 offset:0
    v_add_f32 v237, v237, v38
    v_mfma_f32_16x16x32_bf16 v[0:3], v[24:27], a[36:39], v[0:3]
    ds_read_b64_tr_b16 v[10:11], v254 offset:2048
    v_fma_f32 v126, v126, s31, v241
    v_mfma_f32_16x16x32_bf16 v[0:3], v[44:47], a[40:43], v[0:3]
    ds_read_b64_tr_b16 v[32:33], v254 offset:4096
    v_add_f32 v236, v236, v170
    v_mfma_f32_16x16x32_bf16 v[0:3], v[48:51], a[44:47], v[0:3]
    ds_read_b64_tr_b16 v[34:35], v254 offset:6144
    v_fma_f32 v202, v202, s31, v240
    v_mfma_f32_16x16x32_bf16 v[52:55], v[48:51], a[92:95], v[52:55]
    ds_read_b64_tr_b16 v[56:57], v254 offset:8192
    v_fma_f32 v235, v245, s32, v250
    v_mfma_f32_16x16x32_bf16 v[52:55], v[44:47], a[88:91], v[52:55]
    ds_read_b64_tr_b16 v[58:59], v254 offset:10240
    v_add_f32 v239, v239, v159
    v_mfma_f32_16x16x32_bf16 v[52:55], v[24:27], a[84:87], v[52:55]
    ds_read_b64_tr_b16 v[68:69], v254 offset:12288
    v_cvt_pk_bf16_f32 v62, v0, v1
    v_mfma_f32_16x16x32_bf16 v[52:55], v[20:23], a[80:83], v[52:55]
    s_add_u32 m0, s29, 39424
    ds_read_b64_tr_b16 v[70:71], v254 offset:14336
    v_cvt_pk_bf16_f32 v63, v2, v3
    v_mfma_f32_16x16x32_bf16 v[76:79], v[20:23], a[128:131], v[76:79]
    global_load_lds_dwordx4 v247, s[16:17] offset:1536
    v_mfma_f32_16x16x32_bf16 v[76:79], v[24:27], a[132:135], v[76:79]
    v_exp_f32 v181, v181
    v_mfma_f32_16x16x32_bf16 v[76:79], v[44:47], a[136:139], v[76:79]
G_10:
    s_cbranch_vccnz R_ret0
    v_cvt_pk_bf16_f32 v18, v52, v53
    v_cvt_pk_bf16_f32 v19, v54, v55
    v_mfma_f32_16x16x32_bf16 v[76:79], v[48:51], a[140:143], v[76:79]
    v_exp_f32 v125, v125
    v_mfma_f32_16x16x32_bf16 v[80:83], v[48:51], a[188:191], v[80:83]
    v_exp_f32 v201, v201
    v_mfma_f32_16x16x32_bf16 v[80:83], v[44:47], a[184:187], v[80:83]
    v_exp_f32 v162, v162
    v_mfma_f32_16x16x32_bf16 v[80:83], v[24:27], a[180:183], v[80:83]
    v_fma_f32 v163, v163, s31, v243
    v_fma_f32 v245, v244, s32, v250
    v_mfma_f32_16x16x32_bf16 v[80:83], v[20:23], a[176:179], v[80:83]
    s_waitcnt lgkmcnt(0)
    v_cvt_pk_bf16_f32 v6, v76, v77
    v_cvt_pk_bf16_f32 v7, v78, v79
    v_mfma_f32_16x16x32_bf16 v[0:3], v[8:11], a[0:3], 0
    ds_read_b64_tr_b16 v[20:21], v254 offset:16384
    v_add_f32 v238, v238, v179
    v_mfma_f32_16x16x32_bf16 v[0:3], v[32:35], a[4:7], v[0:3]
    ds_read_b64_tr_b16 v[22:23], v254 offset:18432
    v_cvt_pk_bf16_f32 v30, v80, v81
    v_mfma_f32_16x16x32_bf16 v[0:3], v[56:59], a[8:11], v[0:3]
    ds_read_b64_tr_b16 v[24:25], v254 offset:20480
    v_cvt_pk_bf16_f32 v31, v82, v83
    v_mfma_f32_16x16x32_bf16 v[0:3], v[68:71], a[12:15], v[0:3]
    ds_read_b64_tr_b16 v[26:27], v254 offset:22528
    v_fma_f32 v183, v183, s31, v242
    v_mfma_f32_16x16x32_bf16 v[44:47], v[68:71], a[60:63], 0
    ds_read_b64_tr_b16 v[48:49], v254 offset:24576
    v_fma_f32 v244, v253, s32, v248
    v_mfma_f32_16x16x32_bf16 v[44:47], v[56:59], a[56:59], v[44:47]
    ds_read_b64_tr_b16 v[50:51], v254 offset:26624
    v_add_f32 v237, v237, v39
    v_mfma_f32_16x16x32_bf16 v[44:47], v[32:35], a[52:55], v[44:47]
    ds_read_b64_tr_b16 v[52:53], v254 offset:28672
    v_fma_f32 v127, v127, s31, v241
    v_mfma_f32_16x16x32_bf16 v[44:47], v[8:11], a[48:51], v[44:47]
    s_add_u32 m0, s29, 43520
    ds_read_b64_tr_b16 v[54:55], v254 offset:30720
    v_fma_f32 v253, v249, s32, v248
    v_mfma_f32_16x16x32_bf16 v[76:79], v[8:11], a[96:99], 0
    global_load_lds_dwordx4 v247, s[18:19] offset:1536
    v_mfma_f32_16x16x32_bf16 v[76:79], v[32:35], a[100:103], v[76:79]
    v_exp_f32 v182, v182
    v_mfma_f32_16x16x32_bf16 v[76:79], v[56:59], a[104:107], v[76:79]
    v_exp_f32 v126, v126
    v_mfma_f32_16x16x32_bf16 v[76:79], v[68:71], a[108:111], v[76:79]
    v_add_f32 v236, v236, v171
    v_fma_f32 v203, v203, s31, v240
    v_mfma_f32_16x16x32_bf16 v[80:83], v[68:71], a[156:159], 0
    v_exp_f32 v202, v202
    v_mfma_f32_16x16x32_bf16 v[80:83], v[56:59], a[152:155], v[80:83]
    v_add_f32 v239, v239, v160
    v_fma_f32 v164, v164, s31, v235
    v_mfma_f32_16x16x32_bf16 v[80:83], v[32:35], a[148:151], v[80:83]
    v_exp_f32 v163, v163
    v_mfma_f32_16x16x32_bf16 v[80:83], v[8:11], a[144:147], v[80:83]
    s_waitcnt lgkmcnt(0)
    v_add_f32 v238, v238, v180
    v_fma_f32 v184, v184, s31, v245
    v_mfma_f32_16x16x32_bf16 v[80:83], v[20:23], a[160:163], v[80:83]
    ds_read_b64_tr_b16 v[8:9], v254 offset:32768
    v_add_f32 v237, v237, v124
    v_mfma_f32_16x16x32_bf16 v[80:83], v[24:27], a[164:167], v[80:83]
    ds_read_b64_tr_b16 v[10:11], v254 offset:34816
    v_fma_f32 v192, v192, s31, v244
    v_mfma_f32_16x16x32_bf16 v[80:83], v[48:51], a[168:171], v[80:83]
    ds_read_b64_tr_b16 v[32:33], v254 offset:36864
    v_add_f32 v236, v236, v200
    v_mfma_f32_16x16x32_bf16 v[80:83], v[52:55], a[172:175], v[80:83]
    ds_read_b64_tr_b16 v[34:35], v254 offset:38912
    v_fma_f32 v204, v204, s31, v253
    v_mfma_f32_16x16x32_bf16 v[76:79], v[52:55], a[124:127], v[76:79]
    ds_read_b64_tr_b16 v[56:57], v254 offset:40960
    v_add_f32 v239, v239, v161
    v_mfma_f32_16x16x32_bf16 v[76:79], v[48:51], a[120:123], v[76:79]
    ds_read_b64_tr_b16 v[58:59], v254 offset:43008
    v_fma_f32 v165, v165, s31, v235
    v_mfma_f32_16x16x32_bf16 v[76:79], v[24:27], a[116:119], v[76:79]
    ds_read_b64_tr_b16 v[68:69], v254 offset:45056
    v_add_f32 v238, v238, v181
    v_mfma_f32_16x16x32_bf16 v[76:79], v[20:23], a[112:115], v[76:79]
    s_add_u32 m0, s29, 47616
    ds_read_b64_tr_b16 v[70:71], v254 offset:47104
    v_fma_f32 v185, v185, s31, v245
    v_mfma_f32_16x16x32_bf16 v[44:47], v[20:23], a[64:67], v[44:47]
    global_load_lds_dwordx4 v247, s[20:21] offset:1536
    v_mfma_f32_16x16x32_bf16 v[44:47], v[24:27], a[68:71], v[44:47]
    v_exp_f32 v183, v183
    v_mfma_f32_16x16x32_bf16 v[44:47], v[48:51], a[72:75], v[44:47]
    v_xor_b32 v254, 65632, v255
    v_add_f32 v237, v237, v125
    v_mfma_f32_16x16x32_bf16 v[44:47], v[52:55], a[76:79], v[44:47]
    v_exp_f32 v127, v127
    v_mfma_f32_16x16x32_bf16 v[0:3], v[52:55], a[28:31], v[0:3]
    v_exp_f32 v203, v203
    v_mfma_f32_16x16x32_bf16 v[0:3], v[48:51], a[24:27], v[0:3]
    v_exp_f32 v164, v164
    v_mfma_f32_16x16x32_bf16 v[0:3], v[24:27], a[20:23], v[0:3]
    v_exp_f32 v184, v184
    v_mfma_f32_16x16x32_bf16 v[0:3], v[20:23], a[16:19], v[0:3]
    s_waitcnt lgkmcnt(0)
    v_exp_f32 v192, v192
    v_mfma_f32_16x16x32_bf16 v[0:3], v[8:11], a[32:35], v[0:3]
    ds_read_b64_tr_b16 v[20:21], v254 offset:0
    v_fma_f32 v193, v193, s31, v244
    v_mfma_f32_16x16x32_bf16 v[0:3], v[32:35], a[36:39], v[0:3]
    ds_read_b64_tr_b16 v[22:23], v254 offset:2048
    v_add_f32 v236, v236, v201
    v_mfma_f32_16x16x32_bf16 v[0:3], v[56:59], a[40:43], v[0:3]
    ds_read_b64_tr_b16 v[24:25], v254 offset:4096
    v_fma_f32 v205, v205, s31, v253
    v_mfma_f32_16x16x32_bf16 v[0:3], v[68:71], a[44:47], v[0:3]
    ds_read_b64_tr_b16 v[26:27], v254 offset:6144
    v_add_f32 v239, v239, v162
    v_mfma_f32_16x16x32_bf16 v[44:47], v[68:71], a[92:95], v[44:47]
    ds_read_b64_tr_b16 v[48:49], v254 offset:8192
    v_fma_f32 v166, v166, s31, v235
    v_mfma_f32_16x16x32_bf16 v[44:47], v[56:59], a[88:91], v[44:47]
    ds_read_b64_tr_b16 v[50:51], v254 offset:10240
    v_add_f32 v238, v238, v182
    v_mfma_f32_16x16x32_bf16 v[44:47], v[32:35], a[84:87], v[44:47]
    ds_read_b64_tr_b16 v[52:53], v254 offset:12288
    v_cvt_pk_bf16_f32 v84, v0, v1
    v_mfma_f32_16x16x32_bf16 v[44:47], v[8:11], a[80:83], v[44:47]
    s_add_u32 m0, s29, 51712
    ds_read_b64_tr_b16 v[54:55], v254 offset:14336
    v_cvt_pk_bf16_f32 v85, v2, v3
    v_mfma_f32_16x16x32_bf16 v[76:79], v[8:11], a[128:131], v[76:79]
    global_load_lds_dwordx4 v247, s[22:23] offset:1536
    v_mfma_f32_16x16x32_bf16 v[76:79], v[32:35], a[132:135], v[76:79]
    v_exp_f32 v204, v204
    v_mfma_f32_16x16x32_bf16 v[76:79], v[56:59], a[136:139], v[76:79]
    v_cvt_pk_bf16_f32 v0, v44, v45
    v_cvt_pk_bf16_f32 v1, v46, v47
    v_mfma_f32_16x16x32_bf16 v[76:79], v[68:71], a[140:143], v[76:79]
    v_exp_f32 v165, v165
    v_mfma_f32_16x16x32_bf16 v[80:83], v[68:71], a[188:191], v[80:83]
    v_exp_f32 v185, v185
    v_mfma_f32_16x16x32_bf16 v[80:83], v[56:59], a[184:187], v[80:83]
    v_fma_f32 v186, v186, s31, v245
    v_add_f32 v237, v237, v126
    v_mfma_f32_16x16x32_bf16 v[80:83], v[32:35], a[180:183], v[80:83]
    v_exp_f32 v193, v193
    v_mfma_f32_16x16x32_bf16 v[80:83], v[8:11], a[176:179], v[80:83]
    s_waitcnt lgkmcnt(0)
    v_cvt_pk_bf16_f32 v32, v76, v77
    v_cvt_pk_bf16_f32 v33, v78, v79
    v_mfma_f32_16x16x32_bf16 v[8:11], v[20:23], a[0:3], 0
    ds_read_b64_tr_b16 v[44:45], v254 offset:16384
    v_fma_f32 v194, v194, s31, v244
    v_mfma_f32_16x16x32_bf16 v[8:11], v[24:27], a[4:7], v[8:11]
    ds_read_b64_tr_b16 v[46:47], v254 offset:18432
    v_cvt_pk_bf16_f32 v56, v80, v81
    v_mfma_f32_16x16x32_bf16 v[8:11], v[48:51], a[8:11], v[8:11]
    ds_read_b64_tr_b16 v[68:69], v254 offset:20480
    v_cvt_pk_bf16_f32 v57, v82, v83
    v_mfma_f32_16x16x32_bf16 v[8:11], v[52:55], a[12:15], v[8:11]
    ds_read_b64_tr_b16 v[70:71], v254 offset:22528
    v_add_f32 v236, v236, v202
    v_mfma_f32_16x16x32_bf16 v[76:79], v[52:55], a[60:63], 0
    ds_read_b64_tr_b16 v[80:81], v254 offset:24576
    v_fma_f32 v206, v206, s31, v253
    v_mfma_f32_16x16x32_bf16 v[76:79], v[48:51], a[56:59], v[76:79]
    ds_read_b64_tr_b16 v[82:83], v254 offset:26624
    v_add_f32 v239, v239, v163
    v_mfma_f32_16x16x32_bf16 v[76:79], v[24:27], a[52:55], v[76:79]
    ds_read_b64_tr_b16 v[88:89], v254 offset:28672
    v_fma_f32 v167, v167, s31, v235
    v_mfma_f32_16x16x32_bf16 v[76:79], v[20:23], a[48:51], v[76:79]
    s_add_u32 m0, s29, 55808
    ds_read_b64_tr_b16 v[90:91], v254 offset:30720
    v_add_f32 v238, v238, v183
    v_mfma_f32_16x16x32_bf16 v[96:99], v[20:23], a[96:99], 0
    global_load_lds_dwordx4 v247, s[24:25] offset:1536
    v_mfma_f32_16x16x32_bf16 v[96:99], v[24:27], a[100:103], v[96:99]
    v_exp_f32 v205, v205
    v_mfma_f32_16x16x32_bf16 v[96:99], v[48:51], a[104:107], v[96:99]
    v_exp_f32 v166, v166
    v_mfma_f32_16x16x32_bf16 v[96:99], v[52:55], a[108:111], v[96:99]
    v_exp_f32 v186, v186
    v_mfma_f32_16x16x32_bf16 v[100:103], v[52:55], a[156:159], 0
    v_fma_f32 v187, v187, s31, v245
    v_add_f32 v237, v237, v127
    v_mfma_f32_16x16x32_bf16 v[100:103], v[48:51], a[152:155], v[100:103]
    v_exp_f32 v194, v194
    v_mfma_f32_16x16x32_bf16 v[100:103], v[24:27], a[148:151], v[100:103]
    v_fma_f32 v195, v195, s31, v244
    v_add_f32 v236, v236, v203
    v_mfma_f32_16x16x32_bf16 v[100:103], v[20:23], a[144:147], v[100:103]
    s_waitcnt lgkmcnt(0)
    v_exp_f32 v206, v206
    v_mfma_f32_16x16x32_bf16 v[100:103], v[44:47], a[160:163], v[100:103]
    ds_read_b64_tr_b16 v[20:21], v254 offset:32768
    v_fma_f32 v207, v207, s31, v253
    v_mfma_f32_16x16x32_bf16 v[100:103], v[68:71], a[164:167], v[100:103]
    ds_read_b64_tr_b16 v[22:23], v254 offset:34816
    v_add_f32 v239, v239, v164
    v_mfma_f32_16x16x32_bf16 v[100:103], v[80:83], a[168:171], v[100:103]
    ds_read_b64_tr_b16 v[24:25], v254 offset:36864
    v_fma_f32 v172, v172, s31, v235
    v_mfma_f32_16x16x32_bf16 v[100:103], v[88:91], a[172:175], v[100:103]
    ds_read_b64_tr_b16 v[26:27], v254 offset:38912
    v_add_f32 v238, v238, v184
    v_mfma_f32_16x16x32_bf16 v[96:99], v[88:91], a[124:127], v[96:99]
    ds_read_b64_tr_b16 v[48:49], v254 offset:40960
    v_fma_f32 v188, v188, s31, v245
    v_mfma_f32_16x16x32_bf16 v[96:99], v[80:83], a[120:123], v[96:99]
    ds_read_b64_tr_b16 v[50:51], v254 offset:43008
    v_add_f32 v237, v237, v192
    v_mfma_f32_16x16x32_bf16 v[96:99], v[68:71], a[116:119], v[96:99]
    ds_read_b64_tr_b16 v[52:53], v254 offset:45056
    v_fma_f32 v196, v196, s31, v244
    v_mfma_f32_16x16x32_bf16 v[96:99], v[44:47], a[112:115], v[96:99]
    s_add_u32 m0, s29, 59904
    ds_read_b64_tr_b16 v[54:55], v254 offset:47104
    v_add_f32 v236, v236, v204
    v_mfma_f32_16x16x32_bf16 v[76:79], v[44:47], a[64:67], v[76:79]
    global_load_lds_dwordx4 v247, s[26:27] offset:1536
    v_mfma_f32_16x16x32_bf16 v[76:79], v[68:71], a[68:71], v[76:79]
    v_exp_f32 v167, v167
    v_mfma_f32_16x16x32_bf16 v[76:79], v[80:83], a[72:75], v[76:79]
    v_xor_b32 v254, 114688, v255
    v_fma_f32 v212, v212, s31, v253
    v_mfma_f32_16x16x32_bf16 v[76:79], v[88:91], a[76:79], v[76:79]
    v_exp_f32 v187, v187
    v_mfma_f32_16x16x32_bf16 v[8:11], v[88:91], a[28:31], v[8:11]
    v_exp_f32 v195, v195
    v_mfma_f32_16x16x32_bf16 v[8:11], v[80:83], a[24:27], v[8:11]
    v_exp_f32 v207, v207
    v_mfma_f32_16x16x32_bf16 v[8:11], v[68:71], a[20:23], v[8:11]
    v_add_f32 v239, v239, v165
    v_fma_f32 v173, v173, s31, v235
    v_mfma_f32_16x16x32_bf16 v[8:11], v[44:47], a[16:19], v[8:11]
    s_waitcnt vmcnt(12) lgkmcnt(0)
    s_barrier
    v_add_f32 v238, v238, v185
    v_mfma_f32_16x16x32_bf16 v[8:11], v[20:23], a[32:35], v[8:11]
    ds_read_b64_tr_b16 v[44:45], v254 offset:0
    v_fma_f32 v189, v189, s31, v245
    v_mfma_f32_16x16x32_bf16 v[8:11], v[24:27], a[36:39], v[8:11]
    ds_read_b64_tr_b16 v[46:47], v254 offset:2048
    v_add_f32 v237, v237, v193
    v_mfma_f32_16x16x32_bf16 v[8:11], v[48:51], a[40:43], v[8:11]
    ds_read_b64_tr_b16 v[68:69], v254 offset:4096
    v_fma_f32 v197, v197, s31, v244
    v_mfma_f32_16x16x32_bf16 v[8:11], v[52:55], a[44:47], v[8:11]
    ds_read_b64_tr_b16 v[70:71], v254 offset:6144
    v_add_f32 v236, v236, v205
    v_mfma_f32_16x16x32_bf16 v[76:79], v[52:55], a[92:95], v[76:79]
    ds_read_b64_tr_b16 v[80:81], v254 offset:8192
    v_fma_f32 v213, v213, s31, v253
    v_mfma_f32_16x16x32_bf16 v[76:79], v[48:51], a[88:91], v[76:79]
    ds_read_b64_tr_b16 v[82:83], v254 offset:10240
    v_add_f32 v239, v239, v166
    v_mfma_f32_16x16x32_bf16 v[76:79], v[24:27], a[84:87], v[76:79]
    ds_read_b64_tr_b16 v[88:89], v254 offset:12288
    v_cvt_pk_bf16_f32 v86, v8, v9
    v_mfma_f32_16x16x32_bf16 v[76:79], v[20:23], a[80:83], v[76:79]
    s_add_u32 m0, s29, 63872
    ds_read_b64_tr_b16 v[90:91], v254 offset:14336
    v_cvt_pk_bf16_f32 v87, v10, v11
    v_mfma_f32_16x16x32_bf16 v[96:99], v[20:23], a[128:131], v[96:99]
    global_load_lds_dwordx4 v247, s[4:5] offset:1664
    v_mfma_f32_16x16x32_bf16 v[96:99], v[24:27], a[132:135], v[96:99]
    v_exp_f32 v172, v172
    v_mfma_f32_16x16x32_bf16 v[96:99], v[48:51], a[136:139], v[96:99]
    v_cvt_pk_bf16_f32 v2, v76, v77
    v_cvt_pk_bf16_f32 v3, v78, v79
    v_mfma_f32_16x16x32_bf16 v[96:99], v[52:55], a[140:143], v[96:99]
    v_exp_f32 v188, v188
    v_mfma_f32_16x16x32_bf16 v[100:103], v[52:55], a[188:191], v[100:103]
    v_exp_f32 v196, v196
    v_mfma_f32_16x16x32_bf16 v[100:103], v[48:51], a[184:187], v[100:103]
    v_exp_f32 v212, v212
    v_mfma_f32_16x16x32_bf16 v[100:103], v[24:27], a[180:183], v[100:103]
    v_exp_f32 v173, v173
    v_mfma_f32_16x16x32_bf16 v[100:103], v[20:23], a[176:179], v[100:103]
    s_waitcnt lgkmcnt(0)
    v_cvt_pk_bf16_f32 v34, v96, v97
    v_cvt_pk_bf16_f32 v35, v98, v99
    v_mfma_f32_16x16x32_bf16 v[8:11], v[44:47], a[0:3], 0
    ds_read_b64_tr_b16 v[20:21], v254 offset:16384
    v_fma_f32 v174, v174, s31, v235
    v_mfma_f32_16x16x32_bf16 v[8:11], v[68:71], a[4:7], v[8:11]
    ds_read_b64_tr_b16 v[22:23], v254 offset:18432
    v_cvt_pk_bf16_f32 v58, v100, v101
    v_mfma_f32_16x16x32_bf16 v[8:11], v[80:83], a[8:11], v[8:11]
    ds_read_b64_tr_b16 v[24:25], v254 offset:20480
    v_cvt_pk_bf16_f32 v59, v102, v103
    v_mfma_f32_16x16x32_bf16 v[8:11], v[88:91], a[12:15], v[8:11]
    ds_read_b64_tr_b16 v[26:27], v254 offset:22528
    v_add_f32 v238, v238, v186
    v_mfma_f32_16x16x32_bf16 v[48:51], v[88:91], a[60:63], 0
    ds_read_b64_tr_b16 v[52:53], v254 offset:24576
    v_fma_f32 v190, v190, s31, v245
    v_mfma_f32_16x16x32_bf16 v[48:51], v[80:83], a[56:59], v[48:51]
    ds_read_b64_tr_b16 v[54:55], v254 offset:26624
    v_add_f32 v237, v237, v194
    v_mfma_f32_16x16x32_bf16 v[48:51], v[68:71], a[52:55], v[48:51]
    ds_read_b64_tr_b16 v[76:77], v254 offset:28672
    v_fma_f32 v198, v198, s31, v244
    v_mfma_f32_16x16x32_bf16 v[48:51], v[44:47], a[48:51], v[48:51]
    s_add_u32 m0, s29, 67968
    ds_read_b64_tr_b16 v[78:79], v254 offset:30720
    v_add_f32 v236, v236, v206
    v_mfma_f32_16x16x32_bf16 v[96:99], v[44:47], a[96:99], 0
    global_load_lds_dwordx4 v247, s[6:7] offset:1664
    v_mfma_f32_16x16x32_bf16 v[96:99], v[68:71], a[100:103], v[96:99]
    v_exp_f32 v189, v189
    v_mfma_f32_16x16x32_bf16 v[96:99], v[80:83], a[104:107], v[96:99]
    v_exp_f32 v197, v197
    v_mfma_f32_16x16x32_bf16 v[96:99], v[88:91], a[108:111], v[96:99]
    v_exp_f32 v213, v213
    v_mfma_f32_16x16x32_bf16 v[100:103], v[88:91], a[156:159], 0
    v_fma_f32 v214, v214, s31, v253
    v_add_f32 v239, v239, v167
    v_mfma_f32_16x16x32_bf16 v[100:103], v[80:83], a[152:155], v[100:103]
    v_exp_f32 v174, v174
    v_mfma_f32_16x16x32_bf16 v[100:103], v[68:71], a[148:151], v[100:103]
    v_fma_f32 v175, v175, s31, v235
    v_add_f32 v238, v238, v187
    v_mfma_f32_16x16x32_bf16 v[100:103], v[44:47], a[144:147], v[100:103]
    s_waitcnt lgkmcnt(0)
    v_exp_f32 v190, v190
    v_mfma_f32_16x16x32_bf16 v[100:103], v[20:23], a[160:163], v[100:103]
    ds_read_b64_tr_b16 v[44:45], v254 offset:32768
    v_fma_f32 v191, v191, s31, v245
    v_mfma_f32_16x16x32_bf16 v[100:103], v[24:27], a[164:167], v[100:103]
    ds_read_b64_tr_b16 v[46:47], v254 offset:34816
    v_add_f32 v237, v237, v195
    v_mfma_f32_16x16x32_bf16 v[100:103], v[52:55], a[168:171], v[100:103]
    ds_read_b64_tr_b16 v[68:69], v254 offset:36864
    v_fma_f32 v199, v199, s31, v244
    v_mfma_f32_16x16x32_bf16 v[100:103], v[76:79], a[172:175], v[100:103]
    ds_read_b64_tr_b16 v[70:71], v254 offset:38912
    v_add_f32 v236, v236, v207
    v_mfma_f32_16x16x32_bf16 v[96:99], v[76:79], a[124:127], v[96:99]
    ds_read_b64_tr_b16 v[80:81], v254 offset:40960
    v_fma_f32 v215, v215, s31, v253
    v_mfma_f32_16x16x32_bf16 v[96:99], v[52:55], a[120:123], v[96:99]
    ds_read_b64_tr_b16 v[82:83], v254 offset:43008
    v_add_f32 v239, v239, v172
    v_mfma_f32_16x16x32_bf16 v[96:99], v[24:27], a[116:119], v[96:99]
    ds_read_b64_tr_b16 v[88:89], v254 offset:45056
    v_add_f32 v238, v238, v188
    v_mfma_f32_16x16x32_bf16 v[96:99], v[20:23], a[112:115], v[96:99]
    s_add_u32 m0, s29, 72064
    ds_read_b64_tr_b16 v[90:91], v254 offset:47104
    v_add_f32 v237, v237, v196
    v_mfma_f32_16x16x32_bf16 v[48:51], v[20:23], a[64:67], v[48:51]
    global_load_lds_dwordx4 v247, s[8:9] offset:1664
    v_mfma_f32_16x16x32_bf16 v[48:51], v[24:27], a[68:71], v[48:51]
    v_exp_f32 v198, v198
    v_mfma_f32_16x16x32_bf16 v[48:51], v[52:55], a[72:75], v[48:51]
    v_xor_b32 v254, 114720, v255
    v_add_f32 v236, v236, v212
    v_mfma_f32_16x16x32_bf16 v[48:51], v[76:79], a[76:79], v[48:51]
    v_exp_f32 v214, v214
    v_mfma_f32_16x16x32_bf16 v[8:11], v[76:79], a[28:31], v[8:11]
    v_exp_f32 v175, v175
    v_mfma_f32_16x16x32_bf16 v[8:11], v[52:55], a[24:27], v[8:11]
    v_exp_f32 v191, v191
    v_mfma_f32_16x16x32_bf16 v[8:11], v[24:27], a[20:23], v[8:11]
    v_exp_f32 v199, v199
    v_mfma_f32_16x16x32_bf16 v[8:11], v[20:23], a[16:19], v[8:11]
    s_waitcnt lgkmcnt(0)
    v_exp_f32 v215, v215
    v_mfma_f32_16x16x32_bf16 v[8:11], v[44:47], a[32:35], v[8:11]
    ds_read_b64_tr_b16 v[20:21], v254 offset:0
    v_add_f32 v239, v239, v173
    v_mfma_f32_16x16x32_bf16 v[8:11], v[68:71], a[36:39], v[8:11]
    ds_read_b64_tr_b16 v[22:23], v254 offset:2048
    v_add_f32 v238, v238, v189
    v_mfma_f32_16x16x32_bf16 v[8:11], v[80:83], a[40:43], v[8:11]
    ds_read_b64_tr_b16 v[24:25], v254 offset:4096
    v_add_f32 v237, v237, v197
    v_mfma_f32_16x16x32_bf16 v[8:11], v[88:91], a[44:47], v[8:11]
    ds_read_b64_tr_b16 v[26:27], v254 offset:6144
    v_add_f32 v236, v236, v213
    v_mfma_f32_16x16x32_bf16 v[48:51], v[88:91], a[92:95], v[48:51]
    ds_read_b64_tr_b16 v[52:53], v254 offset:8192
    v_add_f32 v239, v239, v174
    v_mfma_f32_16x16x32_bf16 v[48:51], v[80:83], a[88:91], v[48:51]
    ds_read_b64_tr_b16 v[54:55], v254 offset:10240
    v_add_f32 v238, v238, v190
    v_mfma_f32_16x16x32_bf16 v[48:51], v[68:71], a[84:87], v[48:51]
    ds_read_b64_tr_b16 v[76:77], v254 offset:12288
    v_cvt_pk_bf16_f32 v108, v8, v9
    v_mfma_f32_16x16x32_bf16 v[48:51], v[44:47], a[80:83], v[48:51]
    s_add_u32 m0, s29, 76160
    ds_read_b64_tr_b16 v[78:79], v254 offset:14336
    v_cvt_pk_bf16_f32 v109, v10, v11
    v_mfma_f32_16x16x32_bf16 v[96:99], v[44:47], a[128:131], v[96:99]
    global_load_lds_dwordx4 v247, s[10:11] offset:1664
    v_mfma_f32_16x16x32_bf16 v[96:99], v[68:71], a[132:135], v[96:99]
    v_add_f32 v237, v237, v198
    v_add_f32 v236, v236, v214
    v_mfma_f32_16x16x32_bf16 v[96:99], v[80:83], a[136:139], v[96:99]
    v_cvt_pk_bf16_f32 v8, v48, v49
    v_cvt_pk_bf16_f32 v9, v50, v51
    v_mfma_f32_16x16x32_bf16 v[96:99], v[88:91], a[140:143], v[96:99]
    v_add_f32 v239, v239, v175
    v_add_f32 v238, v238, v191
    v_mfma_f32_16x16x32_bf16 v[100:103], v[88:91], a[188:191], v[100:103]
    v_add_f32 v237, v237, v199
    v_add_f32 v236, v236, v215
    v_mfma_f32_16x16x32_bf16 v[100:103], v[80:83], a[184:187], v[100:103]
    v_permlane32_swap_b32 v239, v238
    v_mfma_f32_16x16x32_bf16 v[100:103], v[68:71], a[180:183], v[100:103]
    v_cvt_pk_bf16_f32 v48, v96, v97
    v_cvt_pk_bf16_f32 v49, v98, v99
    v_mfma_f32_16x16x32_bf16 v[100:103], v[44:47], a[176:179], v[100:103]
    s_waitcnt lgkmcnt(0)
    v_permlane32_swap_b32 v237, v236
    v_mfma_f32_16x16x32_bf16 v[68:71], v[20:23], a[0:3], 0
    ds_read_b64_tr_b16 v[44:45], v254 offset:16384
    v_add_f32 v253, v239, v238
    v_mfma_f32_16x16x32_bf16 v[68:71], v[24:27], a[4:7], v[68:71]
    ds_read_b64_tr_b16 v[46:47], v254 offset:18432
    v_add_f32 v249, v237, v236
    v_mfma_f32_16x16x32_bf16 v[68:71], v[52:55], a[8:11], v[68:71]
    ds_read_b64_tr_b16 v[80:81], v254 offset:20480
    v_cvt_pk_bf16_f32 v88, v100, v101
    v_mfma_f32_16x16x32_bf16 v[68:71], v[76:79], a[12:15], v[68:71]
    ds_read_b64_tr_b16 v[82:83], v254 offset:22528
    v_cvt_pk_bf16_f32 v89, v102, v103
    v_mfma_f32_16x16x32_bf16 v[96:99], v[76:79], a[60:63], 0
    ds_read_b64_tr_b16 v[112:113], v254 offset:24576
    v_mfma_f32_16x16x32_bf16 v[96:99], v[52:55], a[56:59], v[96:99]
    ds_read_b64_tr_b16 v[114:115], v254 offset:26624
    v_mfma_f32_16x16x32_bf16 v[96:99], v[24:27], a[52:55], v[96:99]
    ds_read_b64_tr_b16 v[100:101], v254 offset:28672
    v_mfma_f32_16x16x32_bf16 v[96:99], v[20:23], a[48:51], v[96:99]
    s_add_u32 m0, s29, 80256
    ds_read_b64_tr_b16 v[102:103], v254 offset:30720
    v_mfma_f32_16x16x32_bf16 v[116:119], v[20:23], a[96:99], 0
    global_load_lds_dwordx4 v247, s[12:13] offset:1664
    v_mfma_f32_16x16x32_bf16 v[116:119], v[24:27], a[100:103], v[116:119]
    v_permlane16_swap_b32 v253, v249
    v_mfma_f32_16x16x32_bf16 v[116:119], v[52:55], a[104:107], v[116:119]
    v_add_f32 v245, v253, v249
    v_mfma_f32_16x16x32_bf16 v[116:119], v[76:79], a[108:111], v[116:119]
    v_rcp_f32 v245, v245
    v_mfma_f32_16x16x32_bf16 v[128:131], v[76:79], a[156:159], 0
    v_mov_b32 v253, v245
    v_mfma_f32_16x16x32_bf16 v[128:131], v[52:55], a[152:155], v[128:131]
    v_mfma_f32_16x16x32_bf16 v[128:131], v[24:27], a[148:151], v[128:131]
    v_permlane32_swap_b32 v245, v253
    v_mfma_f32_16x16x32_bf16 v[128:131], v[20:23], a[144:147], v[128:131]
    s_waitcnt lgkmcnt(0)
    v_mov_b32 v249, v245
    v_mov_b32 v244, v253
    v_mfma_f32_16x16x32_bf16 v[128:131], v[44:47], a[160:163], v[128:131]
    ds_read_b64_tr_b16 v[20:21], v254 offset:32768
    v_mfma_f32_16x16x32_bf16 v[128:131], v[80:83], a[164:167], v[128:131]
    ds_read_b64_tr_b16 v[22:23], v254 offset:34816
    v_mfma_f32_16x16x32_bf16 v[128:131], v[112:115], a[168:171], v[128:131]
    ds_read_b64_tr_b16 v[24:25], v254 offset:36864
    v_mfma_f32_16x16x32_bf16 v[128:131], v[100:103], a[172:175], v[128:131]
    ds_read_b64_tr_b16 v[26:27], v254 offset:38912
    v_mfma_f32_16x16x32_bf16 v[116:119], v[100:103], a[124:127], v[116:119]
    ds_read_b64_tr_b16 v[52:53], v254 offset:40960
    v_mfma_f32_16x16x32_bf16 v[116:119], v[112:115], a[120:123], v[116:119]
    ds_read_b64_tr_b16 v[54:55], v254 offset:43008
    v_mfma_f32_16x16x32_bf16 v[116:119], v[80:83], a[116:119], v[116:119]
    ds_read_b64_tr_b16 v[76:77], v254 offset:45056
    v_mfma_f32_16x16x32_bf16 v[116:119], v[44:47], a[112:115], v[116:119]
    s_add_u32 m0, s29, 84352
    ds_read_b64_tr_b16 v[78:79], v254 offset:47104
    v_mfma_f32_16x16x32_bf16 v[96:99], v[44:47], a[64:67], v[96:99]
    global_load_lds_dwordx4 v247, s[14:15] offset:1664
    v_mfma_f32_16x16x32_bf16 v[96:99], v[80:83], a[68:71], v[96:99]
    v_permlane16_swap_b32 v245, v249
    v_mfma_f32_16x16x32_bf16 v[96:99], v[112:115], a[72:75], v[96:99]
    v_xor_b32 v254, 114752, v255
    v_mul_f32 v156, v156, v245
    v_mfma_f32_16x16x32_bf16 v[96:99], v[100:103], a[76:79], v[96:99]
    v_mul_f32 v157, v157, v245
    v_mul_f32 v158, v158, v245
    v_mfma_f32_16x16x32_bf16 v[68:71], v[100:103], a[28:31], v[68:71]
    v_mul_f32 v159, v159, v245
    v_mul_f32 v160, v160, v245
    v_mfma_f32_16x16x32_bf16 v[68:71], v[112:115], a[24:27], v[68:71]
    v_mul_f32 v161, v161, v245
    v_mul_f32 v162, v162, v245
    v_mfma_f32_16x16x32_bf16 v[68:71], v[80:83], a[20:23], v[68:71]
    v_mul_f32 v163, v163, v245
    v_cvt_pk_bf16_f32 v100, v156, v157
    v_mfma_f32_16x16x32_bf16 v[68:71], v[44:47], a[16:19], v[68:71]
    s_waitcnt lgkmcnt(0)
    v_cvt_pk_bf16_f32 v101, v158, v159
    v_cvt_pk_bf16_f32 v102, v160, v161
    v_mfma_f32_16x16x32_bf16 v[68:71], v[20:23], a[32:35], v[68:71]
    ds_read_b64_tr_b16 v[44:45], v254 offset:0
    v_cvt_pk_bf16_f32 v103, v162, v163
    v_mfma_f32_16x16x32_bf16 v[68:71], v[24:27], a[36:39], v[68:71]
    ds_read_b64_tr_b16 v[46:47], v254 offset:2048
    v_mul_f32 v164, v164, v245
    v_mfma_f32_16x16x32_bf16 v[68:71], v[52:55], a[40:43], v[68:71]
    ds_read_b64_tr_b16 v[80:81], v254 offset:4096
    v_mul_f32 v165, v165, v245
    v_mfma_f32_16x16x32_bf16 v[68:71], v[76:79], a[44:47], v[68:71]
    ds_read_b64_tr_b16 v[82:83], v254 offset:6144
    v_mul_f32 v166, v166, v245
    v_mfma_f32_16x16x32_bf16 v[96:99], v[76:79], a[92:95], v[96:99]
    ds_read_b64_tr_b16 v[112:113], v254 offset:8192
    v_mul_f32 v167, v167, v245
    v_mfma_f32_16x16x32_bf16 v[96:99], v[52:55], a[88:91], v[96:99]
    ds_read_b64_tr_b16 v[114:115], v254 offset:10240
    v_mul_f32 v172, v172, v245
    v_mfma_f32_16x16x32_bf16 v[96:99], v[24:27], a[84:87], v[96:99]
    ds_read_b64_tr_b16 v[132:133], v254 offset:12288
    v_cvt_pk_bf16_f32 v110, v68, v69
    v_mfma_f32_16x16x32_bf16 v[96:99], v[20:23], a[80:83], v[96:99]
    s_add_u32 m0, s29, 88448
    ds_read_b64_tr_b16 v[134:135], v254 offset:14336
    v_cvt_pk_bf16_f32 v111, v70, v71
    v_mfma_f32_16x16x32_bf16 v[116:119], v[20:23], a[128:131], v[116:119]
    global_load_lds_dwordx4 v247, s[16:17] offset:1664
    v_mfma_f32_16x16x32_bf16 v[116:119], v[24:27], a[132:135], v[116:119]
    v_permlane16_swap_b32 v253, v244
    v_mfma_f32_16x16x32_bf16 v[116:119], v[52:55], a[136:139], v[116:119]
    v_cvt_pk_bf16_f32 v10, v96, v97
    v_cvt_pk_bf16_f32 v11, v98, v99
    v_mfma_f32_16x16x32_bf16 v[116:119], v[76:79], a[140:143], v[116:119]
    v_mul_f32 v173, v173, v245
    v_mul_f32 v174, v174, v245
    v_mfma_f32_16x16x32_bf16 v[128:131], v[76:79], a[188:191], v[128:131]
    v_mul_f32 v175, v175, v245
    v_cvt_pk_bf16_f32 v68, v164, v165
    v_mfma_f32_16x16x32_bf16 v[128:131], v[52:55], a[184:187], v[128:131]
    v_cvt_pk_bf16_f32 v69, v166, v167
    v_cvt_pk_bf16_f32 v70, v172, v173
    v_mfma_f32_16x16x32_bf16 v[128:131], v[24:27], a[180:183], v[128:131]
    v_cvt_pk_bf16_f32 v50, v116, v117
    v_cvt_pk_bf16_f32 v51, v118, v119
    v_mfma_f32_16x16x32_bf16 v[128:131], v[20:23], a[176:179], v[128:131]
    s_waitcnt lgkmcnt(0)
    v_cvt_pk_bf16_f32 v71, v174, v175
    v_mul_f32 v184, v184, v253
    v_mfma_f32_16x16x32_bf16 v[20:23], v[44:47], a[0:3], 0
    ds_read_b64_tr_b16 v[24:25], v254 offset:16384
    v_mul_f32 v185, v185, v253
    v_mfma_f32_16x16x32_bf16 v[20:23], v[80:83], a[4:7], v[20:23]
    ds_read_b64_tr_b16 v[26:27], v254 offset:18432
    v_cvt_pk_bf16_f32 v90, v128, v129
    v_mfma_f32_16x16x32_bf16 v[20:23], v[112:115], a[8:11], v[20:23]
    ds_read_b64_tr_b16 v[52:53], v254 offset:20480
    v_cvt_pk_bf16_f32 v91, v130, v131
    v_mfma_f32_16x16x32_bf16 v[20:23], v[132:135], a[12:15], v[20:23]
    ds_read_b64_tr_b16 v[54:55], v254 offset:22528
    v_mul_f32 v186, v186, v253
    v_mfma_f32_16x16x32_bf16 v[76:79], v[132:135], a[60:63], 0
    ds_read_b64_tr_b16 v[96:97], v254 offset:24576
    v_mul_f32 v187, v187, v253
    v_mfma_f32_16x16x32_bf16 v[76:79], v[112:115], a[56:59], v[76:79]
    ds_read_b64_tr_b16 v[98:99], v254 offset:26624
    v_mul_f32 v188, v188, v253
    v_mfma_f32_16x16x32_bf16 v[76:79], v[80:83], a[52:55], v[76:79]
    ds_read_b64_tr_b16 v[116:117], v254 offset:28672
    v_mul_f32 v189, v189, v253
    v_mfma_f32_16x16x32_bf16 v[76:79], v[44:47], a[48:51], v[76:79]
    s_add_u32 m0, s29, 92544
    ds_read_b64_tr_b16 v[118:119], v254 offset:30720
    v_mul_f32 v190, v190, v253
    v_mfma_f32_16x16x32_bf16 v[128:131], v[44:47], a[96:99], 0
    global_load_lds_dwordx4 v247, s[18:19] offset:1664
    v_mfma_f32_16x16x32_bf16 v[128:131], v[80:83], a[100:103], v[128:131]
    v_mul_f32 v191, v191, v253
    v_cvt_pk_bf16_f32 v136, v184, v185
    v_mfma_f32_16x16x32_bf16 v[128:131], v[112:115], a[104:107], v[128:131]
    v_cvt_pk_bf16_f32 v137, v186, v187
    v_cvt_pk_bf16_f32 v138, v188, v189
    v_mfma_f32_16x16x32_bf16 v[128:131], v[132:135], a[108:111], v[128:131]
    v_cvt_pk_bf16_f32 v139, v190, v191
    v_mul_f32 v176, v176, v253
    v_mfma_f32_16x16x32_bf16 v[140:143], v[132:135], a[156:159], 0
    v_mul_f32 v177, v177, v253
    v_mul_f32 v178, v178, v253
    v_mfma_f32_16x16x32_bf16 v[140:143], v[112:115], a[152:155], v[140:143]
    v_mul_f32 v179, v179, v253
    v_mul_f32 v180, v180, v253
    v_mfma_f32_16x16x32_bf16 v[140:143], v[80:83], a[148:151], v[140:143]
    v_mul_f32 v181, v181, v253
    v_mul_f32 v182, v182, v253
    v_mfma_f32_16x16x32_bf16 v[140:143], v[44:47], a[144:147], v[140:143]
G_11:
    s_cbranch_vccnz R_ret0
    s_waitcnt lgkmcnt(0)
    v_mul_f32 v183, v183, v253
    v_cvt_pk_bf16_f32 v80, v176, v177
    v_mfma_f32_16x16x32_bf16 v[140:143], v[24:27], a[160:163], v[140:143]
    ds_read_b64_tr_b16 v[44:45], v254 offset:32768
    v_cvt_pk_bf16_f32 v81, v178, v179
    v_mfma_f32_16x16x32_bf16 v[140:143], v[52:55], a[164:167], v[140:143]
    ds_read_b64_tr_b16 v[46:47], v254 offset:34816
    v_cvt_pk_bf16_f32 v82, v180, v181
    v_mfma_f32_16x16x32_bf16 v[140:143], v[96:99], a[168:171], v[140:143]
    ds_read_b64_tr_b16 v[112:113], v254 offset:36864
    v_cvt_pk_bf16_f32 v83, v182, v183
    v_mfma_f32_16x16x32_bf16 v[140:143], v[116:119], a[172:175], v[140:143]
    ds_read_b64_tr_b16 v[114:115], v254 offset:38912
    v_mul_f32 v36, v36, v249
    v_mfma_f32_16x16x32_bf16 v[128:131], v[116:119], a[124:127], v[128:131]
    ds_read_b64_tr_b16 v[132:133], v254 offset:40960
    v_mul_f32 v37, v37, v249
    v_mfma_f32_16x16x32_bf16 v[128:131], v[96:99], a[120:123], v[128:131]
    ds_read_b64_tr_b16 v[134:135], v254 offset:43008
    v_mul_f32 v38, v38, v249
    v_mfma_f32_16x16x32_bf16 v[128:131], v[52:55], a[116:119], v[128:131]
    ds_read_b64_tr_b16 v[148:149], v254 offset:45056
    v_mul_f32 v39, v39, v249
    v_mfma_f32_16x16x32_bf16 v[128:131], v[24:27], a[112:115], v[128:131]
    s_add_u32 m0, s29, 96640
    ds_read_b64_tr_b16 v[150:151], v254 offset:47104
    v_mul_f32 v124, v124, v249
    v_mfma_f32_16x16x32_bf16 v[76:79], v[24:27], a[64:67], v[76:79]
    global_load_lds_dwordx4 v247, s[20:21] offset:1664
    v_mfma_f32_16x16x32_bf16 v[76:79], v[52:55], a[68:71], v[76:79]
    v_mul_f32 v125, v125, v249
    v_mul_f32 v126, v126, v249
    v_mfma_f32_16x16x32_bf16 v[76:79], v[96:99], a[72:75], v[76:79]
    v_xor_b32 v254, 114784, v255
    v_mul_f32 v127, v127, v249
    v_mfma_f32_16x16x32_bf16 v[76:79], v[116:119], a[76:79], v[76:79]
    v_cvt_pk_bf16_f32 v152, v36, v37
    v_cvt_pk_bf16_f32 v153, v38, v39
    v_mfma_f32_16x16x32_bf16 v[20:23], v[116:119], a[28:31], v[20:23]
    v_cvt_pk_bf16_f32 v154, v124, v125
    v_cvt_pk_bf16_f32 v155, v126, v127
    v_mfma_f32_16x16x32_bf16 v[20:23], v[96:99], a[24:27], v[20:23]
    v_mul_f32 v192, v192, v249
    v_mul_f32 v193, v193, v249
    v_mfma_f32_16x16x32_bf16 v[20:23], v[52:55], a[20:23], v[20:23]
    v_mul_f32 v194, v194, v249
    v_mul_f32 v195, v195, v249
    v_mfma_f32_16x16x32_bf16 v[20:23], v[24:27], a[16:19], v[20:23]
    s_waitcnt lgkmcnt(0)
    v_mul_f32 v196, v196, v249
    v_mul_f32 v197, v197, v249
    v_mfma_f32_16x16x32_bf16 v[20:23], v[44:47], a[32:35], v[20:23]
    ds_read_b64_tr_b16 v[24:25], v254 offset:0
    v_mul_f32 v198, v198, v249
    v_mfma_f32_16x16x32_bf16 v[20:23], v[112:115], a[36:39], v[20:23]
    ds_read_b64_tr_b16 v[26:27], v254 offset:2048
    v_mul_f32 v199, v199, v249
    v_mfma_f32_16x16x32_bf16 v[20:23], v[132:135], a[40:43], v[20:23]
    ds_read_b64_tr_b16 v[36:37], v254 offset:4096
    v_cvt_pk_bf16_f32 v52, v192, v193
    v_mfma_f32_16x16x32_bf16 v[20:23], v[148:151], a[44:47], v[20:23]
    ds_read_b64_tr_b16 v[38:39], v254 offset:6144
    v_cvt_pk_bf16_f32 v53, v194, v195
    v_mfma_f32_16x16x32_bf16 v[76:79], v[148:151], a[92:95], v[76:79]
    ds_read_b64_tr_b16 v[96:97], v254 offset:8192
    v_cvt_pk_bf16_f32 v54, v196, v197
    v_mfma_f32_16x16x32_bf16 v[76:79], v[132:135], a[88:91], v[76:79]
    ds_read_b64_tr_b16 v[98:99], v254 offset:10240
    v_cvt_pk_bf16_f32 v55, v198, v199
    v_mfma_f32_16x16x32_bf16 v[76:79], v[112:115], a[84:87], v[76:79]
    ds_read_b64_tr_b16 v[116:117], v254 offset:12288
    v_cvt_pk_bf16_f32 v124, v20, v21
    v_mfma_f32_16x16x32_bf16 v[76:79], v[44:47], a[80:83], v[76:79]
    s_add_u32 m0, s29, 100736
    ds_read_b64_tr_b16 v[118:119], v254 offset:14336
    v_cvt_pk_bf16_f32 v125, v22, v23
    v_mfma_f32_16x16x32_bf16 v[128:131], v[44:47], a[128:131], v[128:131]
    global_load_lds_dwordx4 v247, s[22:23] offset:1664
    v_mfma_f32_16x16x32_bf16 v[128:131], v[112:115], a[132:135], v[128:131]
    v_mul_f32 v204, v204, v244
    v_mul_f32 v205, v205, v244
    v_mfma_f32_16x16x32_bf16 v[128:131], v[132:135], a[136:139], v[128:131]
    v_cvt_pk_bf16_f32 v20, v76, v77
    v_cvt_pk_bf16_f32 v21, v78, v79
    v_mfma_f32_16x16x32_bf16 v[128:131], v[148:151], a[140:143], v[128:131]
    v_mul_f32 v206, v206, v244
    v_mul_f32 v207, v207, v244
    v_mfma_f32_16x16x32_bf16 v[140:143], v[148:151], a[188:191], v[140:143]
    v_mul_f32 v212, v212, v244
    v_mul_f32 v213, v213, v244
    v_mfma_f32_16x16x32_bf16 v[140:143], v[132:135], a[184:187], v[140:143]
    v_mul_f32 v214, v214, v244
    v_mul_f32 v215, v215, v244
    v_mfma_f32_16x16x32_bf16 v[140:143], v[112:115], a[180:183], v[140:143]
    v_cvt_pk_bf16_f32 v76, v128, v129
    v_cvt_pk_bf16_f32 v77, v130, v131
    v_mfma_f32_16x16x32_bf16 v[140:143], v[44:47], a[176:179], v[140:143]
    s_waitcnt lgkmcnt(0)
    v_cvt_pk_bf16_f32 v112, v204, v205
    v_cvt_pk_bf16_f32 v113, v206, v207
    v_mfma_f32_16x16x32_bf16 v[44:47], v[24:27], a[0:3], 0
    ds_read_b64_tr_b16 v[128:129], v254 offset:16384
    v_cvt_pk_bf16_f32 v114, v212, v213
    v_mfma_f32_16x16x32_bf16 v[44:47], v[36:39], a[4:7], v[44:47]
    ds_read_b64_tr_b16 v[130:131], v254 offset:18432
    v_cvt_pk_bf16_f32 v132, v140, v141
    v_mfma_f32_16x16x32_bf16 v[44:47], v[96:99], a[8:11], v[44:47]
    ds_read_b64_tr_b16 v[148:149], v254 offset:20480
    v_cvt_pk_bf16_f32 v133, v142, v143
    v_mfma_f32_16x16x32_bf16 v[44:47], v[116:119], a[12:15], v[44:47]
    ds_read_b64_tr_b16 v[150:151], v254 offset:22528
    v_cvt_pk_bf16_f32 v115, v214, v215
    v_mfma_f32_16x16x32_bf16 v[140:143], v[116:119], a[60:63], 0
    ds_read_b64_tr_b16 v[156:157], v254 offset:24576
    v_mul_f32 v168, v168, v244
    v_mfma_f32_16x16x32_bf16 v[140:143], v[96:99], a[56:59], v[140:143]
    ds_read_b64_tr_b16 v[158:159], v254 offset:26624
    v_mul_f32 v169, v169, v244
    v_mfma_f32_16x16x32_bf16 v[140:143], v[36:39], a[52:55], v[140:143]
    ds_read_b64_tr_b16 v[160:161], v254 offset:28672
    v_mul_f32 v170, v170, v244
    v_mfma_f32_16x16x32_bf16 v[140:143], v[24:27], a[48:51], v[140:143]
    s_add_u32 m0, s29, 104832
    ds_read_b64_tr_b16 v[162:163], v254 offset:30720
    v_mul_f32 v171, v171, v244
    v_mfma_f32_16x16x32_bf16 v[164:167], v[24:27], a[96:99], 0
    global_load_lds_dwordx4 v247, s[24:25] offset:1664
    v_mfma_f32_16x16x32_bf16 v[164:167], v[36:39], a[100:103], v[164:167]
    v_mul_f32 v200, v200, v244
    v_mul_f32 v201, v201, v244
    v_mfma_f32_16x16x32_bf16 v[164:167], v[96:99], a[104:107], v[164:167]
    v_mul_f32 v202, v202, v244
    v_mul_f32 v203, v203, v244
    v_mfma_f32_16x16x32_bf16 v[164:167], v[116:119], a[108:111], v[164:167]
    v_cvt_pk_bf16_f32 v172, v168, v169
    v_cvt_pk_bf16_f32 v173, v170, v171
    v_mfma_f32_16x16x32_bf16 v[176:179], v[116:119], a[156:159], 0
    v_cvt_pk_bf16_f32 v174, v200, v201
    v_cvt_pk_bf16_f32 v175, v202, v203
    v_mfma_f32_16x16x32_bf16 v[176:179], v[96:99], a[152:155], v[176:179]
    v_mfma_f32_16x16x32_bf16 v[176:179], v[36:39], a[148:151], v[176:179]
    v_mfma_f32_16x16x32_bf16 v[176:179], v[24:27], a[144:147], v[176:179]
    s_waitcnt lgkmcnt(0)
    v_mfma_f32_16x16x32_bf16 v[176:179], v[128:131], a[160:163], v[176:179]
    ds_read_b64_tr_b16 v[36:37], v254 offset:32768
    v_mfma_f32_16x16x32_bf16 v[176:179], v[148:151], a[164:167], v[176:179]
    ds_read_b64_tr_b16 v[38:39], v254 offset:34816
    v_mfma_f32_16x16x32_bf16 v[176:179], v[156:159], a[168:171], v[176:179]
    ds_read_b64_tr_b16 v[24:25], v254 offset:36864
    v_mfma_f32_16x16x32_bf16 v[176:179], v[160:163], a[172:175], v[176:179]
    ds_read_b64_tr_b16 v[26:27], v254 offset:38912
    v_mfma_f32_16x16x32_bf16 v[164:167], v[160:163], a[124:127], v[164:167]
    ds_read_b64_tr_b16 v[96:97], v254 offset:40960
    v_mfma_f32_16x16x32_bf16 v[164:167], v[156:159], a[120:123], v[164:167]
    ds_read_b64_tr_b16 v[98:99], v254 offset:43008
    v_mfma_f32_16x16x32_bf16 v[164:167], v[148:151], a[116:119], v[164:167]
    ds_read_b64_tr_b16 v[116:117], v254 offset:45056
    v_mfma_f32_16x16x32_bf16 v[164:167], v[128:131], a[112:115], v[164:167]
    s_add_u32 m0, s29, 108928
    ds_read_b64_tr_b16 v[118:119], v254 offset:47104
    v_mfma_f32_16x16x32_bf16 v[140:143], v[128:131], a[64:67], v[140:143]
    global_load_lds_dwordx4 v247, s[26:27] offset:1664
    v_mfma_f32_16x16x32_bf16 v[140:143], v[148:151], a[68:71], v[140:143]
    v_mfma_f32_16x16x32_bf16 v[140:143], v[156:159], a[72:75], v[140:143]
    v_xor_b32 v254, 16384, v255
    v_mfma_f32_16x16x32_bf16 v[140:143], v[160:163], a[76:79], v[140:143]
    v_mfma_f32_16x16x32_bf16 v[44:47], v[160:163], a[28:31], v[44:47]
    v_mfma_f32_16x16x32_bf16 v[44:47], v[156:159], a[24:27], v[44:47]
    v_mfma_f32_16x16x32_bf16 v[44:47], v[148:151], a[20:23], v[44:47]
    v_mfma_f32_16x16x32_bf16 v[44:47], v[128:131], a[16:19], v[44:47]
    s_waitcnt vmcnt(12) lgkmcnt(0)
    s_barrier
    v_mfma_f32_16x16x32_bf16 v[44:47], v[36:39], a[32:35], v[44:47]
    ds_read_b64_tr_b16 v[128:129], v254 offset:0
    v_mfma_f32_16x16x32_bf16 v[44:47], v[24:27], a[36:39], v[44:47]
    ds_read_b64_tr_b16 v[130:131], v254 offset:2048
    v_mfma_f32_16x16x32_bf16 v[44:47], v[96:99], a[40:43], v[44:47]
    ds_read_b64_tr_b16 v[148:149], v254 offset:4096
    v_mfma_f32_16x16x32_bf16 v[44:47], v[116:119], a[44:47], v[44:47]
    ds_read_b64_tr_b16 v[150:151], v254 offset:6144
    v_mfma_f32_16x16x32_bf16 v[140:143], v[116:119], a[92:95], v[140:143]
    ds_read_b64_tr_b16 v[156:157], v254 offset:8192
    v_mfma_f32_16x16x32_bf16 v[140:143], v[96:99], a[88:91], v[140:143]
    ds_read_b64_tr_b16 v[158:159], v254 offset:10240
    v_mfma_f32_16x16x32_bf16 v[140:143], v[24:27], a[84:87], v[140:143]
    ds_read_b64_tr_b16 v[160:161], v254 offset:12288
    v_mfma_f32_16x16x32_bf16 v[140:143], v[36:39], a[80:83], v[140:143]
    s_add_u32 m0, s29, 112896
    ds_read_b64_tr_b16 v[162:163], v254 offset:14336
    v_cvt_pk_bf16_f32 v126, v44, v45
    v_mfma_f32_16x16x32_bf16 v[164:167], v[36:39], a[128:131], v[164:167]
    global_load_lds_dwordx4 v247, s[4:5] offset:1792
    v_mfma_f32_16x16x32_bf16 v[164:167], v[24:27], a[132:135], v[164:167]
    v_cvt_pk_bf16_f32 v127, v46, v47
    v_mfma_f32_16x16x32_bf16 v[164:167], v[96:99], a[136:139], v[164:167]
    v_cvt_pk_bf16_f32 v22, v140, v141
    v_cvt_pk_bf16_f32 v23, v142, v143
    v_mfma_f32_16x16x32_bf16 v[164:167], v[116:119], a[140:143], v[164:167]
    v_mfma_f32_16x16x32_bf16 v[176:179], v[116:119], a[188:191], v[176:179]
    v_mfma_f32_16x16x32_bf16 v[176:179], v[96:99], a[184:187], v[176:179]
    v_mfma_f32_16x16x32_bf16 v[176:179], v[24:27], a[180:183], v[176:179]
    v_mfma_f32_16x16x32_bf16 v[176:179], v[36:39], a[176:179], v[176:179]
    s_waitcnt lgkmcnt(0)
    s_mov_b64 vcc, -1
    s_cmp_eq_u32 s28, 0
    s_cbranch_scc1 G_13
    s_cmp_eq_u32 s28, 1
    s_cbranch_scc1 G_14
    s_cmp_eq_u32 s28, 2
    s_cbranch_scc1 G_15
    s_branch G_16
R_ret1:
    s_mov_b64 vcc, 0
    v_mfma_f32_16x16x32_bf16 v[24:27], a[0:3], v[128:131], 0
    ds_read_b64_tr_b16 v[36:37], v254 offset:16384
    v_cvt_pk_bf16_f32 v78, v164, v165
    v_mfma_f32_16x16x32_bf16 v[24:27], a[4:7], v[148:151], v[24:27]
    ds_read_b64_tr_b16 v[38:39], v254 offset:18432
    v_cvt_pk_bf16_f32 v79, v166, v167
    v_mfma_f32_16x16x32_bf16 v[24:27], a[8:11], v[156:159], v[24:27]
    ds_read_b64_tr_b16 v[44:45], v254 offset:20480
    v_cvt_pk_bf16_f32 v134, v176, v177
    v_mfma_f32_16x16x32_bf16 v[24:27], a[12:15], v[160:163], v[24:27]
    ds_read_b64_tr_b16 v[46:47], v254 offset:22528
    v_cvt_pk_bf16_f32 v135, v178, v179
    v_mfma_f32_16x16x32_bf16 v[96:99], a[60:63], v[160:163], 0
    ds_read_b64_tr_b16 v[116:117], v254 offset:24576
    v_mfma_f32_16x16x32_bf16 v[96:99], a[56:59], v[156:159], v[96:99]
    ds_read_b64_tr_b16 v[118:119], v254 offset:26624
    v_mfma_f32_16x16x32_bf16 v[96:99], a[52:55], v[148:151], v[96:99]
    ds_read_b64_tr_b16 v[140:141], v254 offset:28672
    v_mfma_f32_16x16x32_bf16 v[96:99], a[48:51], v[128:131], v[96:99]
    s_add_u32 m0, s29, 116992
    ds_read_b64_tr_b16 v[142:143], v254 offset:30720
    v_mfma_f32_16x16x32_bf16 v[164:167], a[96:99], v[128:131], 0
    global_load_lds_dwordx4 v247, s[6:7] offset:1792
    v_mfma_f32_16x16x32_bf16 v[164:167], a[100:103], v[148:151], v[164:167]
    ds_read_b128 v[168:171], v246 offset:12672
    v_mfma_f32_16x16x32_bf16 v[164:167], a[104:107], v[156:159], v[164:167]
    ds_read_b128 v[176:179], v246 offset:12800
    v_mfma_f32_16x16x32_bf16 v[164:167], a[108:111], v[160:163], v[164:167]
    ds_read_b128 v[180:183], v246 offset:12928
    v_mfma_f32_16x16x32_bf16 v[184:187], a[156:159], v[160:163], 0
    ds_read_b128 v[188:191], v246 offset:13056
    v_mfma_f32_16x16x32_bf16 v[184:187], a[152:155], v[156:159], v[184:187]
    v_mfma_f32_16x16x32_bf16 v[184:187], a[148:151], v[148:151], v[184:187]
    v_mfma_f32_16x16x32_bf16 v[184:187], a[144:147], v[128:131], v[184:187]
    s_waitcnt lgkmcnt(4)
    v_mfma_f32_16x16x32_bf16 v[184:187], a[160:163], v[36:39], v[184:187]
    ds_read_b64_tr_b16 v[148:149], v254 offset:32768
    v_mfma_f32_16x16x32_bf16 v[184:187], a[164:167], v[44:47], v[184:187]
    ds_read_b64_tr_b16 v[150:151], v254 offset:34816
    v_mfma_f32_16x16x32_bf16 v[184:187], a[168:171], v[116:119], v[184:187]
    ds_read_b64_tr_b16 v[128:129], v254 offset:36864
    v_mfma_f32_16x16x32_bf16 v[184:187], a[172:175], v[140:143], v[184:187]
    ds_read_b64_tr_b16 v[130:131], v254 offset:38912
    v_mfma_f32_16x16x32_bf16 v[164:167], a[124:127], v[140:143], v[164:167]
    ds_read_b64_tr_b16 v[156:157], v254 offset:40960
    v_mfma_f32_16x16x32_bf16 v[164:167], a[120:123], v[116:119], v[164:167]
    ds_read_b64_tr_b16 v[158:159], v254 offset:43008
    v_mfma_f32_16x16x32_bf16 v[164:167], a[116:119], v[44:47], v[164:167]
    ds_read_b64_tr_b16 v[160:161], v254 offset:45056
    v_mfma_f32_16x16x32_bf16 v[164:167], a[112:115], v[36:39], v[164:167]
    s_add_u32 m0, s29, 121088
    ds_read_b64_tr_b16 v[162:163], v254 offset:47104
    v_mfma_f32_16x16x32_bf16 v[96:99], a[64:67], v[36:39], v[96:99]
    global_load_lds_dwordx4 v247, s[8:9] offset:1792
    v_mfma_f32_16x16x32_bf16 v[96:99], a[68:71], v[44:47], v[96:99]
    ds_read_b128 v[192:195], v246 offset:12544
    v_mfma_f32_16x16x32_bf16 v[96:99], a[72:75], v[116:119], v[96:99]
    ds_read_b128 v[196:199], v246 offset:12672
    v_mfma_f32_16x16x32_bf16 v[96:99], a[76:79], v[140:143], v[96:99]
    ds_read_b128 v[200:203], v246 offset:12800
    v_mfma_f32_16x16x32_bf16 v[24:27], a[28:31], v[140:143], v[24:27]
    ds_read_b128 v[204:207], v246 offset:12928
    v_mfma_f32_16x16x32_bf16 v[24:27], a[24:27], v[116:119], v[24:27]
    v_mfma_f32_16x16x32_bf16 v[24:27], a[20:23], v[44:47], v[24:27]
    v_mfma_f32_16x16x32_bf16 v[24:27], a[16:19], v[36:39], v[24:27]
    s_waitcnt lgkmcnt(12)
    v_mfma_f32_16x16x32_bf16 v[168:171], v[92:95], v[120:123], v[168:171]
    v_mfma_f32_16x16x32_bf16 v[168:171], v[60:63], v[108:111], v[168:171]
    v_mfma_f32_16x16x32_bf16 v[168:171], v[84:87], v[124:127], v[168:171]
    v_mfma_f32_16x16x32_bf16 v[176:179], v[0:3], v[124:127], v[176:179]
    v_mfma_f32_16x16x32_bf16 v[176:179], v[16:19], v[108:111], v[176:179]
    v_mfma_f32_16x16x32_bf16 v[176:179], v[12:15], v[120:123], v[176:179]
    v_mfma_f32_16x16x32_bf16 v[180:183], v[40:43], v[120:123], v[180:183]
    v_xor_b32 v254, 16416, v255
    v_mfma_f32_16x16x32_bf16 v[180:183], v[4:7], v[108:111], v[180:183]
    v_mfma_f32_16x16x32_bf16 v[180:183], v[32:35], v[124:127], v[180:183]
    v_mfma_f32_16x16x32_bf16 v[188:191], v[56:59], v[124:127], v[188:191]
    v_max3_f32 v253, v168, v169, v170
    v_mfma_f32_16x16x32_bf16 v[188:191], v[28:31], v[108:111], v[188:191]
    v_mfma_f32_16x16x32_bf16 v[188:191], v[72:75], v[120:123], v[188:191]
    s_waitcnt lgkmcnt(4)
    v_max3_f32 v253, v253, v171, v176
    v_max3_f32 v253, v253, v177, v178
    v_mfma_f32_16x16x32_bf16 v[24:27], a[32:35], v[148:151], v[24:27]
    ds_read_b64_tr_b16 v[36:37], v254 offset:0
    v_max3_f32 v249, v180, v181, v182
    v_mfma_f32_16x16x32_bf16 v[24:27], a[36:39], v[128:131], v[24:27]
    ds_read_b64_tr_b16 v[38:39], v254 offset:2048
    v_max3_f32 v249, v249, v183, v188
    v_mfma_f32_16x16x32_bf16 v[24:27], a[40:43], v[156:159], v[24:27]
    ds_read_b64_tr_b16 v[44:45], v254 offset:4096
    v_max3_f32 v249, v249, v189, v190
    v_mfma_f32_16x16x32_bf16 v[24:27], a[44:47], v[160:163], v[24:27]
    ds_read_b64_tr_b16 v[46:47], v254 offset:6144
    v_max_f32 v253, v253, v179
    v_mfma_f32_16x16x32_bf16 v[96:99], a[92:95], v[160:163], v[96:99]
    ds_read_b64_tr_b16 v[108:109], v254 offset:8192
    v_max_f32 v249, v249, v191
    v_mfma_f32_16x16x32_bf16 v[96:99], a[88:91], v[156:159], v[96:99]
    ds_read_b64_tr_b16 v[110:111], v254 offset:10240
    v_add_f32 v253, v253, v252
    v_mfma_f32_16x16x32_bf16 v[96:99], a[84:87], v[128:131], v[96:99]
    ds_read_b64_tr_b16 v[116:117], v254 offset:12288
    v_cvt_pk_bf16_f32 v120, v24, v25
    v_mfma_f32_16x16x32_bf16 v[96:99], a[80:83], v[148:151], v[96:99]
    s_add_u32 m0, s29, 125184
    ds_read_b64_tr_b16 v[118:119], v254 offset:14336
    v_cvt_pk_bf16_f32 v121, v26, v27
    v_mfma_f32_16x16x32_bf16 v[164:167], a[128:131], v[148:151], v[164:167]
    global_load_lds_dwordx4 v247, s[10:11] offset:1792
    v_mfma_f32_16x16x32_bf16 v[164:167], a[132:135], v[128:131], v[164:167]
    ds_read_b128 v[24:27], v246 offset:12416
    v_add_f32 v249, v249, v251
    v_mfma_f32_16x16x32_bf16 v[164:167], a[136:139], v[156:159], v[164:167]
    ds_read_b128 v[124:127], v246 offset:12544
    v_cvt_pk_bf16_f32 v122, v96, v97
    v_mfma_f32_16x16x32_bf16 v[164:167], a[140:143], v[160:163], v[164:167]
    ds_read_b128 v[140:143], v246 offset:12672
    v_cvt_pk_bf16_f32 v123, v98, v99
    v_mfma_f32_16x16x32_bf16 v[184:187], a[188:191], v[160:163], v[184:187]
    ds_read_b128 v[208:211], v246 offset:12800
    v_max_f32 v245, v253, v249
    v_mfma_f32_16x16x32_bf16 v[184:187], a[184:187], v[156:159], v[184:187]
    v_mfma_f32_16x16x32_bf16 v[184:187], a[180:183], v[128:131], v[184:187]
    v_mfma_f32_16x16x32_bf16 v[184:187], a[176:179], v[148:151], v[184:187]
    s_waitcnt lgkmcnt(12)
    v_cvt_pk_bf16_f32 v96, v164, v165
    v_cvt_pk_bf16_f32 v97, v166, v167
    v_mfma_f32_16x16x32_bf16 v[192:195], v[92:95], v[144:147], v[192:195]
    v_mfma_f32_16x16x32_bf16 v[192:195], v[60:63], v[8:11], v[192:195]
    v_mfma_f32_16x16x32_bf16 v[192:195], v[84:87], v[20:23], v[192:195]
    v_mfma_f32_16x16x32_bf16 v[196:199], v[0:3], v[20:23], v[196:199]
    v_mfma_f32_16x16x32_bf16 v[196:199], v[16:19], v[8:11], v[196:199]
    v_cvt_pk_bf16_f32 v98, v184, v185
    v_cvt_pk_bf16_f32 v99, v186, v187
    v_mfma_f32_16x16x32_bf16 v[196:199], v[12:15], v[144:147], v[196:199]
    v_mfma_f32_16x16x32_bf16 v[200:203], v[40:43], v[144:147], v[200:203]
    v_mfma_f32_16x16x32_bf16 v[200:203], v[4:7], v[8:11], v[200:203]
    v_mfma_f32_16x16x32_bf16 v[200:203], v[32:35], v[20:23], v[200:203]
    v_max3_f32 v253, v192, v193, v194
    v_mfma_f32_16x16x32_bf16 v[204:207], v[56:59], v[20:23], v[204:207]
    v_mfma_f32_16x16x32_bf16 v[204:207], v[28:31], v[8:11], v[204:207]
    v_mfma_f32_16x16x32_bf16 v[204:207], v[72:75], v[144:147], v[204:207]
    s_waitcnt lgkmcnt(4)
    v_max3_f32 v253, v253, v195, v196
    v_max3_f32 v253, v253, v197, v198
    v_mfma_f32_16x16x32_bf16 v[8:11], a[0:3], v[36:39], 0
    ds_read_b64_tr_b16 v[20:21], v254 offset:16384
    v_max3_f32 v249, v200, v201, v202
    v_mfma_f32_16x16x32_bf16 v[8:11], a[4:7], v[44:47], v[8:11]
    ds_read_b64_tr_b16 v[22:23], v254 offset:18432
    v_max3_f32 v249, v249, v203, v204
    v_mfma_f32_16x16x32_bf16 v[8:11], a[8:11], v[108:111], v[8:11]
    ds_read_b64_tr_b16 v[128:129], v254 offset:20480
    v_max3_f32 v249, v249, v205, v206
    v_mfma_f32_16x16x32_bf16 v[8:11], a[12:15], v[116:119], v[8:11]
    ds_read_b64_tr_b16 v[130:131], v254 offset:22528
    v_max_f32 v253, v253, v199
    v_mfma_f32_16x16x32_bf16 v[144:147], a[60:63], v[116:119], 0
    ds_read_b64_tr_b16 v[148:149], v254 offset:24576
    v_max_f32 v249, v249, v207
    v_mfma_f32_16x16x32_bf16 v[144:147], a[56:59], v[108:111], v[144:147]
    ds_read_b64_tr_b16 v[150:151], v254 offset:26624
    v_add_f32 v253, v253, v252
    v_mfma_f32_16x16x32_bf16 v[144:147], a[52:55], v[44:47], v[144:147]
    ds_read_b64_tr_b16 v[156:157], v254 offset:28672
    v_add_f32 v249, v249, v251
    v_mfma_f32_16x16x32_bf16 v[144:147], a[48:51], v[36:39], v[144:147]
    s_add_u32 m0, s29, 129280
    ds_read_b64_tr_b16 v[158:159], v254 offset:30720
    v_max_f32 v244, v253, v249
    v_mfma_f32_16x16x32_bf16 v[160:163], a[96:99], v[36:39], 0
    global_load_lds_dwordx4 v247, s[12:13] offset:1792
    v_mfma_f32_16x16x32_bf16 v[160:163], a[100:103], v[44:47], v[160:163]
    ds_read_b128 v[164:167], v246 offset:12288
    v_mfma_f32_16x16x32_bf16 v[160:163], a[104:107], v[108:111], v[160:163]
    ds_read_b128 v[184:187], v246 offset:12416
    v_mfma_f32_16x16x32_bf16 v[160:163], a[108:111], v[116:119], v[160:163]
    ds_read_b128 v[212:215], v246 offset:12544
    v_mfma_f32_16x16x32_bf16 v[216:219], a[156:159], v[116:119], 0
    ds_read_b128 v[220:223], v246 offset:12672
    v_mfma_f32_16x16x32_bf16 v[216:219], a[152:155], v[108:111], v[216:219]
    v_permlane32_swap_b32 v245, v244
    v_mfma_f32_16x16x32_bf16 v[216:219], a[148:151], v[44:47], v[216:219]
    v_max_f32 v253, v245, v244
    v_mfma_f32_16x16x32_bf16 v[216:219], a[144:147], v[36:39], v[216:219]
    s_waitcnt lgkmcnt(12)
    v_mfma_f32_16x16x32_bf16 v[24:27], v[92:95], v[104:107], v[24:27]
    v_mfma_f32_16x16x32_bf16 v[24:27], v[60:63], v[48:51], v[24:27]
    v_mfma_f32_16x16x32_bf16 v[24:27], v[84:87], v[76:79], v[24:27]
    v_mfma_f32_16x16x32_bf16 v[124:127], v[0:3], v[76:79], v[124:127]
    v_mfma_f32_16x16x32_bf16 v[124:127], v[16:19], v[48:51], v[124:127]
    v_mfma_f32_16x16x32_bf16 v[124:127], v[12:15], v[104:107], v[124:127]
    v_mfma_f32_16x16x32_bf16 v[140:143], v[40:43], v[104:107], v[140:143]
    v_mfma_f32_16x16x32_bf16 v[140:143], v[4:7], v[48:51], v[140:143]
    v_mfma_f32_16x16x32_bf16 v[140:143], v[32:35], v[76:79], v[140:143]
    v_mfma_f32_16x16x32_bf16 v[208:211], v[56:59], v[76:79], v[208:211]
    v_mfma_f32_16x16x32_bf16 v[208:211], v[28:31], v[48:51], v[208:211]
    v_max3_f32 v249, v24, v25, v26
    v_mfma_f32_16x16x32_bf16 v[208:211], v[72:75], v[104:107], v[208:211]
    v_mfma_f32_16x16x32_bf16 v[36:39], v[120:123], a[192:195], 0
    v_max3_f32 v249, v249, v27, v124
    v_max3_f32 v249, v249, v125, v126
    v_mfma_f32_16x16x32_bf16 v[36:39], v[96:99], a[196:199], v[36:39]
    v_max3_f32 v246, v140, v141, v142
    v_max_f32 v249, v249, v127
    v_mfma_f32_16x16x32_bf16 v[44:47], v[96:99], a[200:203], 0
    v_add_f32 v249, v249, v251
    v_mfma_f32_16x16x32_bf16 v[44:47], v[120:123], a[204:207], v[44:47]
    v_max3_f32 v246, v246, v143, v208
    v_max3_f32 v246, v246, v209, v210
    v_mfma_f32_16x16x32_bf16 v[48:51], v[120:123], a[208:211], 0
    v_max_f32 v246, v246, v211
    v_add_f32 v246, v246, v252
    v_mfma_f32_16x16x32_bf16 v[48:51], v[96:99], a[212:215], v[48:51]
    v_max_f32 v245, v246, v249
    v_cvt_pk_bf16_f32 v76, v36, v37
    v_mfma_f32_16x16x32_bf16 v[104:107], v[96:99], a[216:219], 0
    v_cvt_pk_bf16_f32 v77, v38, v39
    v_cvt_pk_bf16_f32 v108, v44, v45
    v_mfma_f32_16x16x32_bf16 v[104:107], v[120:123], a[220:223], v[104:107]
    s_waitcnt lgkmcnt(4)
    v_cvt_pk_bf16_f32 v109, v46, v47
    v_cvt_pk_bf16_f32 v36, v48, v49
    v_mfma_f32_16x16x32_bf16 v[216:219], a[160:163], v[20:23], v[216:219]
    ds_read_b64_tr_b16 v[96:97], v254 offset:32768
    v_cvt_pk_bf16_f32 v37, v50, v51
    v_mfma_f32_16x16x32_bf16 v[216:219], a[164:167], v[128:131], v[216:219]
    ds_read_b64_tr_b16 v[98:99], v254 offset:34816
    v_cvt_pk_bf16_f32 v44, v104, v105
    v_mfma_f32_16x16x32_bf16 v[216:219], a[168:171], v[148:151], v[216:219]
    ds_read_b64_tr_b16 v[48:49], v254 offset:36864
    v_cvt_pk_bf16_f32 v45, v106, v107
    v_mfma_f32_16x16x32_bf16 v[216:219], a[172:175], v[156:159], v[216:219]
    ds_read_b64_tr_b16 v[50:51], v254 offset:38912
    v_mfma_f32_16x16x32_bf16 v[160:163], a[124:127], v[156:159], v[160:163]
    ds_read_b64_tr_b16 v[104:105], v254 offset:40960
    v_mfma_f32_16x16x32_bf16 v[160:163], a[120:123], v[148:151], v[160:163]
    ds_read_b64_tr_b16 v[106:107], v254 offset:43008
    v_mfma_f32_16x16x32_bf16 v[160:163], a[116:119], v[128:131], v[160:163]
    ds_read_b64_tr_b16 v[116:117], v254 offset:45056
    v_mfma_f32_16x16x32_bf16 v[160:163], a[112:115], v[20:23], v[160:163]
    s_add_u32 m0, s29, 133376
    ds_read_b64_tr_b16 v[118:119], v254 offset:47104
    v_mfma_f32_16x16x32_bf16 v[144:147], a[64:67], v[20:23], v[144:147]
    global_load_lds_dwordx4 v247, s[14:15] offset:1792
    v_mfma_f32_16x16x32_bf16 v[144:147], a[68:71], v[128:131], v[144:147]
    v_mfma_f32_16x16x32_bf16 v[144:147], a[72:75], v[148:151], v[144:147]
    v_mfma_f32_16x16x32_bf16 v[144:147], a[76:79], v[156:159], v[144:147]
    v_mfma_f32_16x16x32_bf16 v[8:11], a[28:31], v[156:159], v[8:11]
    v_mfma_f32_16x16x32_bf16 v[8:11], a[24:27], v[148:151], v[8:11]
    v_mfma_f32_16x16x32_bf16 v[8:11], a[20:23], v[128:131], v[8:11]
    v_mfma_f32_16x16x32_bf16 v[8:11], a[16:19], v[20:23], v[8:11]
    s_waitcnt lgkmcnt(8)
    v_mfma_f32_16x16x32_bf16 v[164:167], v[92:95], v[64:67], v[164:167]
    v_mfma_f32_16x16x32_bf16 v[164:167], v[60:63], v[88:91], v[164:167]
    v_mfma_f32_16x16x32_bf16 v[164:167], v[84:87], v[132:135], v[164:167]
    v_mfma_f32_16x16x32_bf16 v[184:187], v[0:3], v[132:135], v[184:187]
    v_mfma_f32_16x16x32_bf16 v[184:187], v[16:19], v[88:91], v[184:187]
    v_mfma_f32_16x16x32_bf16 v[184:187], v[12:15], v[64:67], v[184:187]
    v_mfma_f32_16x16x32_bf16 v[212:215], v[40:43], v[64:67], v[212:215]
    v_xor_b32 v254, 16448, v255
    v_mfma_f32_16x16x32_bf16 v[212:215], v[4:7], v[88:91], v[212:215]
    v_mfma_f32_16x16x32_bf16 v[212:215], v[32:35], v[132:135], v[212:215]
    v_mfma_f32_16x16x32_bf16 v[220:223], v[56:59], v[132:135], v[220:223]
    v_max3_f32 v249, v164, v165, v166
    v_mfma_f32_16x16x32_bf16 v[220:223], v[28:31], v[88:91], v[220:223]
    v_mfma_f32_16x16x32_bf16 v[220:223], v[72:75], v[64:67], v[220:223]
    s_waitcnt lgkmcnt(0)
    v_max3_f32 v249, v249, v167, v184
    v_max3_f32 v249, v249, v185, v186
    v_mfma_f32_16x16x32_bf16 v[8:11], a[32:35], v[96:99], v[8:11]
    ds_read_b64_tr_b16 v[0:1], v254 offset:0
    v_max3_f32 v246, v212, v213, v214
    v_mfma_f32_16x16x32_bf16 v[8:11], a[36:39], v[48:51], v[8:11]
    ds_read_b64_tr_b16 v[2:3], v254 offset:2048
    v_max3_f32 v246, v246, v215, v220
    v_mfma_f32_16x16x32_bf16 v[8:11], a[40:43], v[104:107], v[8:11]
    ds_read_b64_tr_b16 v[4:5], v254 offset:4096
    v_max3_f32 v246, v246, v221, v222
    v_mfma_f32_16x16x32_bf16 v[8:11], a[44:47], v[116:119], v[8:11]
    ds_read_b64_tr_b16 v[6:7], v254 offset:6144
    v_max_f32 v246, v246, v223
    v_mfma_f32_16x16x32_bf16 v[144:147], a[92:95], v[116:119], v[144:147]
    ds_read_b64_tr_b16 v[12:13], v254 offset:8192
    v_max_f32 v249, v249, v187
    v_mfma_f32_16x16x32_bf16 v[144:147], a[88:91], v[104:107], v[144:147]
    ds_read_b64_tr_b16 v[14:15], v254 offset:10240
    v_add_f32 v246, v246, v252
    v_mfma_f32_16x16x32_bf16 v[144:147], a[84:87], v[48:51], v[144:147]
    ds_read_b64_tr_b16 v[16:17], v254 offset:12288
    v_cvt_pk_bf16_f32 v20, v8, v9
    v_mfma_f32_16x16x32_bf16 v[144:147], a[80:83], v[96:99], v[144:147]
    s_add_u32 m0, s29, 137472
    ds_read_b64_tr_b16 v[18:19], v254 offset:14336
    v_cvt_pk_bf16_f32 v21, v10, v11
    v_mfma_f32_16x16x32_bf16 v[160:163], a[128:131], v[96:99], v[160:163]
    global_load_lds_dwordx4 v247, s[16:17] offset:1792
    v_mfma_f32_16x16x32_bf16 v[160:163], a[132:135], v[48:51], v[160:163]
    v_add_f32 v249, v249, v251
    v_max_f32 v252, v246, v249
    v_mfma_f32_16x16x32_bf16 v[160:163], a[136:139], v[104:107], v[160:163]
    v_cvt_pk_bf16_f32 v22, v144, v145
    v_cvt_pk_bf16_f32 v23, v146, v147
    v_mfma_f32_16x16x32_bf16 v[160:163], a[140:143], v[116:119], v[160:163]
    v_permlane32_swap_b32 v245, v252
    v_mfma_f32_16x16x32_bf16 v[216:219], a[188:191], v[116:119], v[216:219]
    v_max_f32 v251, v245, v252
    v_mfma_f32_16x16x32_bf16 v[216:219], a[184:187], v[104:107], v[216:219]
    v_mfma_f32_16x16x32_bf16 v[216:219], a[180:183], v[48:51], v[216:219]
    v_permlane16_swap_b32 v253, v251
    v_mfma_f32_16x16x32_bf16 v[216:219], a[176:179], v[96:99], v[216:219]
    s_waitcnt lgkmcnt(0)
    v_cvt_pk_bf16_f32 v8, v160, v161
    v_cvt_pk_bf16_f32 v9, v162, v163
    v_mfma_f32_16x16x32_bf16 v[28:31], a[0:3], v[0:3], 0
    ds_read_b64_tr_b16 v[32:33], v254 offset:16384
    v_max_f32 v252, v253, v251
    v_mfma_f32_16x16x32_bf16 v[28:31], a[4:7], v[4:7], v[28:31]
    ds_read_b64_tr_b16 v[34:35], v254 offset:18432
    v_cvt_pk_bf16_f32 v10, v216, v217
    v_mfma_f32_16x16x32_bf16 v[28:31], a[8:11], v[12:15], v[28:31]
    ds_read_b64_tr_b16 v[40:41], v254 offset:20480
    v_cvt_pk_bf16_f32 v11, v218, v219
    v_mfma_f32_16x16x32_bf16 v[28:31], a[12:15], v[16:19], v[28:31]
    ds_read_b64_tr_b16 v[42:43], v254 offset:22528
    v_mov_b32 v253, v252
    v_mfma_f32_16x16x32_bf16 v[48:51], a[60:63], v[16:19], 0
    ds_read_b64_tr_b16 v[56:57], v254 offset:24576
    v_mfma_f32_16x16x32_bf16 v[48:51], a[56:59], v[12:15], v[48:51]
    ds_read_b64_tr_b16 v[58:59], v254 offset:26624
    v_mfma_f32_16x16x32_bf16 v[48:51], a[52:55], v[4:7], v[48:51]
    ds_read_b64_tr_b16 v[60:61], v254 offset:28672
    v_mfma_f32_16x16x32_bf16 v[48:51], a[48:51], v[0:3], v[48:51]
    s_add_u32 m0, s29, 141568
    ds_read_b64_tr_b16 v[62:63], v254 offset:30720
    v_mfma_f32_16x16x32_bf16 v[64:67], a[96:99], v[0:3], 0
    global_load_lds_dwordx4 v247, s[18:19] offset:1792
    v_mfma_f32_16x16x32_bf16 v[64:67], a[100:103], v[4:7], v[64:67]
    v_permlane32_swap_b32 v252, v253
    v_mfma_f32_16x16x32_bf16 v[64:67], a[104:107], v[12:15], v[64:67]
    v_mov_b32 v251, v252
    v_mov_b32 v249, v253
G_12:
    s_cbranch_vccnz R_ret0
    v_mfma_f32_16x16x32_bf16 v[64:67], a[108:111], v[16:19], v[64:67]
    v_permlane16_swap_b32 v252, v251
    v_mfma_f32_16x16x32_bf16 v[72:75], a[156:159], v[16:19], 0
    v_permlane16_swap_b32 v253, v249
    v_mfma_f32_16x16x32_bf16 v[72:75], a[152:155], v[12:15], v[72:75]
    v_fma_f32 v246, v252, s32, v248
    v_fma_f32 v245, v253, s32, v248
    v_mfma_f32_16x16x32_bf16 v[72:75], a[148:151], v[4:7], v[72:75]
    v_fma_f32 v244, v251, s32, v250
    v_fma_f32 v243, v249, s32, v250
    v_mfma_f32_16x16x32_bf16 v[72:75], a[144:147], v[0:3], v[72:75]
    v_fma_f32 v168, v168, s31, v246
    v_fma_f32 v169, v169, s31, v246
    v_mfma_f32_16x16x32_bf16 v[4:7], v[20:23], a[192:195], 0
    v_fma_f32 v192, v192, s31, v245
    v_fma_f32 v193, v193, s31, v245
    v_mfma_f32_16x16x32_bf16 v[4:7], v[8:11], a[196:199], v[4:7]
    v_fma_f32 v24, v24, s31, v244
    v_fma_f32 v25, v25, s31, v244
    v_mfma_f32_16x16x32_bf16 v[0:3], v[8:11], a[200:203], 0
    v_fma_f32 v164, v164, s31, v243
    v_fma_f32 v165, v165, s31, v243
    v_mfma_f32_16x16x32_bf16 v[0:3], v[20:23], a[204:207], v[0:3]
    v_exp_f32 v168, v168
    v_mfma_f32_16x16x32_bf16 v[12:15], v[20:23], a[208:211], 0
    v_exp_f32 v169, v169
    v_mfma_f32_16x16x32_bf16 v[12:15], v[8:11], a[212:215], v[12:15]
    v_fma_f32 v170, v170, s31, v246
    v_fma_f32 v194, v194, s31, v245
    v_mfma_f32_16x16x32_bf16 v[16:19], v[8:11], a[216:219], 0
    v_exp_f32 v192, v192
    v_mfma_f32_16x16x32_bf16 v[16:19], v[20:23], a[220:223], v[16:19]
    s_waitcnt lgkmcnt(0)
    v_exp_f32 v193, v193
    v_mfma_f32_16x16x32_bf16 v[72:75], a[160:163], v[32:35], v[72:75]
    ds_read_b64_tr_b16 v[8:9], v254 offset:32768
    v_fma_f32 v26, v26, s31, v244
    v_mfma_f32_16x16x32_bf16 v[72:75], a[164:167], v[40:43], v[72:75]
    ds_read_b64_tr_b16 v[10:11], v254 offset:34816
    v_fma_f32 v166, v166, s31, v243
    v_mfma_f32_16x16x32_bf16 v[72:75], a[168:171], v[56:59], v[72:75]
    ds_read_b64_tr_b16 v[20:21], v254 offset:36864
    v_fma_f32 v171, v171, s31, v246
    v_mfma_f32_16x16x32_bf16 v[72:75], a[172:175], v[60:63], v[72:75]
    ds_read_b64_tr_b16 v[22:23], v254 offset:38912
    v_fma_f32 v195, v195, s31, v245
    v_mfma_f32_16x16x32_bf16 v[64:67], a[124:127], v[60:63], v[64:67]
    ds_read_b64_tr_b16 v[84:85], v254 offset:40960
    v_fma_f32 v27, v27, s31, v244
    v_mfma_f32_16x16x32_bf16 v[64:67], a[120:123], v[56:59], v[64:67]
    ds_read_b64_tr_b16 v[86:87], v254 offset:43008
    v_fma_f32 v167, v167, s31, v243
    v_mfma_f32_16x16x32_bf16 v[64:67], a[116:119], v[40:43], v[64:67]
    ds_read_b64_tr_b16 v[88:89], v254 offset:45056
    v_fma_f32 v176, v176, s31, v246
    v_mfma_f32_16x16x32_bf16 v[64:67], a[112:115], v[32:35], v[64:67]
    s_add_u32 m0, s29, 145664
    ds_read_b64_tr_b16 v[90:91], v254 offset:47104
    v_fma_f32 v196, v196, s31, v245
    v_mfma_f32_16x16x32_bf16 v[48:51], a[64:67], v[32:35], v[48:51]
    global_load_lds_dwordx4 v247, s[20:21] offset:1792
    v_mfma_f32_16x16x32_bf16 v[48:51], a[68:71], v[40:43], v[48:51]
    v_exp_f32 v24, v24
    v_mfma_f32_16x16x32_bf16 v[48:51], a[72:75], v[56:59], v[48:51]
    v_xor_b32 v254, 16480, v255
    v_fma_f32 v124, v124, s31, v244
    v_mfma_f32_16x16x32_bf16 v[48:51], a[76:79], v[60:63], v[48:51]
    v_exp_f32 v25, v25
    v_mfma_f32_16x16x32_bf16 v[28:31], a[28:31], v[60:63], v[28:31]
    v_exp_f32 v164, v164
    v_mfma_f32_16x16x32_bf16 v[28:31], a[24:27], v[56:59], v[28:31]
    v_exp_f32 v165, v165
    v_mfma_f32_16x16x32_bf16 v[28:31], a[20:23], v[40:43], v[28:31]
    v_exp_f32 v170, v170
    v_mfma_f32_16x16x32_bf16 v[28:31], a[16:19], v[32:35], v[28:31]
    s_waitcnt lgkmcnt(0)
    v_exp_f32 v194, v194
    v_mfma_f32_16x16x32_bf16 v[28:31], a[32:35], v[8:11], v[28:31]
    ds_read_b64_tr_b16 v[32:33], v254 offset:0
    v_fma_f32 v184, v184, s31, v243
    v_mfma_f32_16x16x32_bf16 v[28:31], a[36:39], v[20:23], v[28:31]
    ds_read_b64_tr_b16 v[34:35], v254 offset:2048
    v_add_f32 v242, v168, v169
    v_mfma_f32_16x16x32_bf16 v[28:31], a[40:43], v[84:87], v[28:31]
    ds_read_b64_tr_b16 v[40:41], v254 offset:4096
    v_fma_f32 v177, v177, s31, v246
    v_mfma_f32_16x16x32_bf16 v[28:31], a[44:47], v[88:91], v[28:31]
    ds_read_b64_tr_b16 v[42:43], v254 offset:6144
    v_add_f32 v241, v192, v193
    v_mfma_f32_16x16x32_bf16 v[48:51], a[92:95], v[88:91], v[48:51]
    ds_read_b64_tr_b16 v[56:57], v254 offset:8192
    v_fma_f32 v197, v197, s31, v245
    v_mfma_f32_16x16x32_bf16 v[48:51], a[88:91], v[84:87], v[48:51]
    ds_read_b64_tr_b16 v[58:59], v254 offset:10240
    v_add_f32 v240, v24, v25
    v_mfma_f32_16x16x32_bf16 v[48:51], a[84:87], v[20:23], v[48:51]
    ds_read_b64_tr_b16 v[60:61], v254 offset:12288
    v_cvt_pk_bf16_f32 v92, v28, v29
    v_mfma_f32_16x16x32_bf16 v[48:51], a[80:83], v[8:11], v[48:51]
    s_add_u32 m0, s29, 149760
    ds_read_b64_tr_b16 v[62:63], v254 offset:14336
    v_cvt_pk_bf16_f32 v93, v30, v31
    v_mfma_f32_16x16x32_bf16 v[64:67], a[128:131], v[8:11], v[64:67]
    global_load_lds_dwordx4 v247, s[22:23] offset:1792
    v_mfma_f32_16x16x32_bf16 v[64:67], a[132:135], v[20:23], v[64:67]
    v_exp_f32 v26, v26
    v_mfma_f32_16x16x32_bf16 v[64:67], a[136:139], v[84:87], v[64:67]
    v_cvt_pk_bf16_f32 v94, v48, v49
    v_cvt_pk_bf16_f32 v95, v50, v51
    v_mfma_f32_16x16x32_bf16 v[64:67], a[140:143], v[88:91], v[64:67]
    v_exp_f32 v166, v166
    v_mfma_f32_16x16x32_bf16 v[72:75], a[188:191], v[88:91], v[72:75]
    v_exp_f32 v171, v171
    v_mfma_f32_16x16x32_bf16 v[72:75], a[184:187], v[84:87], v[72:75]
    v_exp_f32 v195, v195
    v_mfma_f32_16x16x32_bf16 v[72:75], a[180:183], v[20:23], v[72:75]
    v_exp_f32 v27, v27
    v_mfma_f32_16x16x32_bf16 v[72:75], a[176:179], v[8:11], v[72:75]
    s_waitcnt lgkmcnt(0)
    v_cvt_pk_bf16_f32 v20, v64, v65
    v_cvt_pk_bf16_f32 v21, v66, v67
    v_mfma_f32_16x16x32_bf16 v[8:11], a[0:3], v[32:35], 0
    ds_read_b64_tr_b16 v[28:29], v254 offset:16384
    v_fma_f32 v125, v125, s31, v244
    v_mfma_f32_16x16x32_bf16 v[8:11], a[4:7], v[40:43], v[8:11]
    ds_read_b64_tr_b16 v[30:31], v254 offset:18432
    v_cvt_pk_bf16_f32 v22, v72, v73
    v_mfma_f32_16x16x32_bf16 v[8:11], a[8:11], v[56:59], v[8:11]
    ds_read_b64_tr_b16 v[48:49], v254 offset:20480
    v_cvt_pk_bf16_f32 v23, v74, v75
    v_mfma_f32_16x16x32_bf16 v[8:11], a[12:15], v[60:63], v[8:11]
    ds_read_b64_tr_b16 v[50:51], v254 offset:22528
    v_add_f32 v239, v164, v165
    v_mfma_f32_16x16x32_bf16 v[64:67], a[60:63], v[60:63], 0
    ds_read_b64_tr_b16 v[72:73], v254 offset:24576
    v_fma_f32 v185, v185, s31, v243
    v_mfma_f32_16x16x32_bf16 v[64:67], a[56:59], v[56:59], v[64:67]
    ds_read_b64_tr_b16 v[74:75], v254 offset:26624
    v_add_f32 v242, v242, v170
    v_mfma_f32_16x16x32_bf16 v[64:67], a[52:55], v[40:43], v[64:67]
    ds_read_b64_tr_b16 v[84:85], v254 offset:28672
    v_fma_f32 v178, v178, s31, v246
    v_mfma_f32_16x16x32_bf16 v[64:67], a[48:51], v[32:35], v[64:67]
    s_add_u32 m0, s29, 153856
    ds_read_b64_tr_b16 v[86:87], v254 offset:30720
    v_add_f32 v241, v241, v194
    v_mfma_f32_16x16x32_bf16 v[88:91], a[96:99], v[32:35], 0
    global_load_lds_dwordx4 v247, s[24:25] offset:1792
    v_mfma_f32_16x16x32_bf16 v[88:91], a[100:103], v[40:43], v[88:91]
    v_exp_f32 v167, v167
    v_mfma_f32_16x16x32_bf16 v[88:91], a[104:107], v[56:59], v[88:91]
    v_exp_f32 v176, v176
    v_mfma_f32_16x16x32_bf16 v[88:91], a[108:111], v[60:63], v[88:91]
    v_exp_f32 v196, v196
    v_mfma_f32_16x16x32_bf16 v[96:99], a[156:159], v[60:63], 0
    v_exp_f32 v124, v124
    v_mfma_f32_16x16x32_bf16 v[96:99], a[152:155], v[56:59], v[96:99]
    v_exp_f32 v184, v184
    v_mfma_f32_16x16x32_bf16 v[96:99], a[148:151], v[40:43], v[96:99]
    v_exp_f32 v177, v177
    v_mfma_f32_16x16x32_bf16 v[96:99], a[144:147], v[32:35], v[96:99]
    v_exp_f32 v197, v197
    v_mfma_f32_16x16x32_bf16 v[40:43], v[92:95], a[192:195], 0
    v_fma_f32 v198, v198, s31, v245
    v_add_f32 v240, v240, v26
    v_mfma_f32_16x16x32_bf16 v[40:43], v[20:23], a[196:199], v[40:43]
    v_exp_f32 v125, v125
    v_mfma_f32_16x16x32_bf16 v[32:35], v[20:23], a[200:203], 0
    v_fma_f32 v126, v126, s31, v244
    v_add_f32 v239, v239, v166
    v_mfma_f32_16x16x32_bf16 v[32:35], v[92:95], a[204:207], v[32:35]
    v_exp_f32 v185, v185
    v_mfma_f32_16x16x32_bf16 v[56:59], v[92:95], a[208:211], 0
    v_fma_f32 v186, v186, s31, v243
    v_fma_f32 v238, v252, s32, v250
    v_mfma_f32_16x16x32_bf16 v[56:59], v[20:23], a[212:215], v[56:59]
    v_add_f32 v242, v242, v171
    v_fma_f32 v179, v179, s31, v246
    v_mfma_f32_16x16x32_bf16 v[60:63], v[20:23], a[216:219], 0
    v_exp_f32 v178, v178
    v_mfma_f32_16x16x32_bf16 v[60:63], v[92:95], a[220:223], v[60:63]
    s_waitcnt lgkmcnt(0)
    v_fma_f32 v252, v253, s32, v250
    v_add_f32 v241, v241, v195
    v_mfma_f32_16x16x32_bf16 v[96:99], a[160:163], v[28:31], v[96:99]
    ds_read_b64_tr_b16 v[20:21], v254 offset:32768
    v_fma_f32 v199, v199, s31, v245
    v_mfma_f32_16x16x32_bf16 v[96:99], a[164:167], v[48:51], v[96:99]
    ds_read_b64_tr_b16 v[22:23], v254 offset:34816
    v_fma_f32 v253, v251, s32, v248
    v_mfma_f32_16x16x32_bf16 v[96:99], a[168:171], v[72:75], v[96:99]
    ds_read_b64_tr_b16 v[92:93], v254 offset:36864
    v_add_f32 v240, v240, v27
    v_mfma_f32_16x16x32_bf16 v[96:99], a[172:175], v[84:87], v[96:99]
    ds_read_b64_tr_b16 v[94:95], v254 offset:38912
    v_fma_f32 v127, v127, s31, v244
    v_mfma_f32_16x16x32_bf16 v[88:91], a[124:127], v[84:87], v[88:91]
    ds_read_b64_tr_b16 v[104:105], v254 offset:40960
    v_fma_f32 v251, v249, s32, v248
    v_mfma_f32_16x16x32_bf16 v[88:91], a[120:123], v[72:75], v[88:91]
    ds_read_b64_tr_b16 v[106:107], v254 offset:43008
    v_add_f32 v239, v239, v167
    v_mfma_f32_16x16x32_bf16 v[88:91], a[116:119], v[48:51], v[88:91]
    ds_read_b64_tr_b16 v[116:117], v254 offset:45056
    v_fma_f32 v187, v187, s31, v243
    v_mfma_f32_16x16x32_bf16 v[88:91], a[112:115], v[28:31], v[88:91]
    s_add_u32 m0, s29, 157952
    ds_read_b64_tr_b16 v[118:119], v254 offset:47104
    v_add_f32 v242, v242, v176
    v_mfma_f32_16x16x32_bf16 v[64:67], a[64:67], v[28:31], v[64:67]
    global_load_lds_dwordx4 v247, s[26:27] offset:1792
    v_mfma_f32_16x16x32_bf16 v[64:67], a[68:71], v[48:51], v[64:67]
    v_exp_f32 v198, v198
    v_mfma_f32_16x16x32_bf16 v[64:67], a[72:75], v[72:75], v[64:67]
    v_xor_b32 v254, 65536, v255
    v_fma_f32 v180, v180, s31, v238
    v_mfma_f32_16x16x32_bf16 v[64:67], a[76:79], v[84:87], v[64:67]
    v_exp_f32 v126, v126
    v_mfma_f32_16x16x32_bf16 v[8:11], a[28:31], v[84:87], v[8:11]
    v_exp_f32 v186, v186
    v_mfma_f32_16x16x32_bf16 v[8:11], a[24:27], v[72:75], v[8:11]
    v_exp_f32 v179, v179
    v_mfma_f32_16x16x32_bf16 v[8:11], a[20:23], v[48:51], v[8:11]
    v_add_f32 v241, v241, v196
    v_fma_f32 v200, v200, s31, v252
    v_mfma_f32_16x16x32_bf16 v[8:11], a[16:19], v[28:31], v[8:11]
    s_waitcnt vmcnt(12) lgkmcnt(0)
    s_barrier
    v_add_f32 v240, v240, v124
    v_mfma_f32_16x16x32_bf16 v[8:11], a[32:35], v[20:23], v[8:11]
    ds_read_b64_tr_b16 v[28:29], v254 offset:0
    v_fma_f32 v140, v140, s31, v253
    v_mfma_f32_16x16x32_bf16 v[8:11], a[36:39], v[92:95], v[8:11]
    ds_read_b64_tr_b16 v[30:31], v254 offset:2048
    v_add_f32 v239, v239, v184
    v_mfma_f32_16x16x32_bf16 v[8:11], a[40:43], v[104:107], v[8:11]
    ds_read_b64_tr_b16 v[48:49], v254 offset:4096
    v_fma_f32 v212, v212, s31, v251
    v_mfma_f32_16x16x32_bf16 v[8:11], a[44:47], v[116:119], v[8:11]
    ds_read_b64_tr_b16 v[50:51], v254 offset:6144
    v_add_f32 v242, v242, v177
    v_mfma_f32_16x16x32_bf16 v[64:67], a[92:95], v[116:119], v[64:67]
    ds_read_b64_tr_b16 v[72:73], v254 offset:8192
    v_fma_f32 v181, v181, s31, v238
    v_mfma_f32_16x16x32_bf16 v[64:67], a[88:91], v[104:107], v[64:67]
    ds_read_b64_tr_b16 v[74:75], v254 offset:10240
    v_add_f32 v241, v241, v197
    v_mfma_f32_16x16x32_bf16 v[64:67], a[84:87], v[92:95], v[64:67]
    ds_read_b64_tr_b16 v[84:85], v254 offset:12288
    v_cvt_pk_bf16_f32 v120, v8, v9
    v_mfma_f32_16x16x32_bf16 v[64:67], a[80:83], v[20:23], v[64:67]
    s_add_u32 m0, s29, 14464
    ds_read_b64_tr_b16 v[86:87], v254 offset:14336
    v_cvt_pk_bf16_f32 v121, v10, v11
    v_mfma_f32_16x16x32_bf16 v[88:91], a[128:131], v[20:23], v[88:91]
    global_load_lds_dwordx4 v247, s[4:5] offset:1920
    v_mfma_f32_16x16x32_bf16 v[88:91], a[132:135], v[92:95], v[88:91]
    v_exp_f32 v199, v199
    v_mfma_f32_16x16x32_bf16 v[88:91], a[136:139], v[104:107], v[88:91]
    v_cvt_pk_bf16_f32 v122, v64, v65
    v_cvt_pk_bf16_f32 v123, v66, v67
    v_mfma_f32_16x16x32_bf16 v[88:91], a[140:143], v[116:119], v[88:91]
    v_exp_f32 v127, v127
    v_mfma_f32_16x16x32_bf16 v[96:99], a[188:191], v[116:119], v[96:99]
    v_exp_f32 v187, v187
    v_mfma_f32_16x16x32_bf16 v[96:99], a[184:187], v[104:107], v[96:99]
    v_exp_f32 v180, v180
    v_mfma_f32_16x16x32_bf16 v[96:99], a[180:183], v[92:95], v[96:99]
    v_exp_f32 v200, v200
    v_mfma_f32_16x16x32_bf16 v[96:99], a[176:179], v[20:23], v[96:99]
    s_waitcnt lgkmcnt(0)
    v_cvt_pk_bf16_f32 v8, v88, v89
    v_cvt_pk_bf16_f32 v9, v90, v91
    v_mfma_f32_16x16x32_bf16 v[20:23], a[0:3], v[28:31], 0
    ds_read_b64_tr_b16 v[64:65], v254 offset:16384
    v_fma_f32 v201, v201, s31, v252
    v_mfma_f32_16x16x32_bf16 v[20:23], a[4:7], v[48:51], v[20:23]
    ds_read_b64_tr_b16 v[66:67], v254 offset:18432
    v_cvt_pk_bf16_f32 v10, v96, v97
    v_mfma_f32_16x16x32_bf16 v[20:23], a[8:11], v[72:75], v[20:23]
    ds_read_b64_tr_b16 v[88:89], v254 offset:20480
    v_cvt_pk_bf16_f32 v11, v98, v99
    v_mfma_f32_16x16x32_bf16 v[20:23], a[12:15], v[84:87], v[20:23]
    ds_read_b64_tr_b16 v[90:91], v254 offset:22528
    v_add_f32 v240, v240, v125
    v_mfma_f32_16x16x32_bf16 v[92:95], a[60:63], v[84:87], 0
    ds_read_b64_tr_b16 v[96:97], v254 offset:24576
    v_fma_f32 v141, v141, s31, v253
    v_mfma_f32_16x16x32_bf16 v[92:95], a[56:59], v[72:75], v[92:95]
    ds_read_b64_tr_b16 v[98:99], v254 offset:26624
    v_add_f32 v239, v239, v185
    v_mfma_f32_16x16x32_bf16 v[92:95], a[52:55], v[48:51], v[92:95]
    ds_read_b64_tr_b16 v[104:105], v254 offset:28672
    v_fma_f32 v213, v213, s31, v251
    v_mfma_f32_16x16x32_bf16 v[92:95], a[48:51], v[28:31], v[92:95]
    s_add_u32 m0, s29, 18560
    ds_read_b64_tr_b16 v[106:107], v254 offset:30720
    v_add_f32 v242, v242, v178
    v_mfma_f32_16x16x32_bf16 v[116:119], a[96:99], v[28:31], 0
    global_load_lds_dwordx4 v247, s[6:7] offset:1920
    v_mfma_f32_16x16x32_bf16 v[116:119], a[100:103], v[48:51], v[116:119]
    v_exp_f32 v140, v140
    v_mfma_f32_16x16x32_bf16 v[116:119], a[104:107], v[72:75], v[116:119]
    v_exp_f32 v212, v212
    v_mfma_f32_16x16x32_bf16 v[116:119], a[108:111], v[84:87], v[116:119]
    v_exp_f32 v181, v181
    v_mfma_f32_16x16x32_bf16 v[128:131], a[156:159], v[84:87], 0
    v_fma_f32 v182, v182, s31, v238
    v_add_f32 v241, v241, v198
    v_mfma_f32_16x16x32_bf16 v[128:131], a[152:155], v[72:75], v[128:131]
    v_exp_f32 v201, v201
    v_mfma_f32_16x16x32_bf16 v[128:131], a[148:151], v[48:51], v[128:131]
    v_fma_f32 v202, v202, s31, v252
    v_add_f32 v240, v240, v126
    v_mfma_f32_16x16x32_bf16 v[128:131], a[144:147], v[28:31], v[128:131]
    v_exp_f32 v141, v141
    v_mfma_f32_16x16x32_bf16 v[48:51], v[120:123], a[192:195], 0
    v_fma_f32 v142, v142, s31, v253
    v_add_f32 v239, v239, v186
    v_mfma_f32_16x16x32_bf16 v[48:51], v[8:11], a[196:199], v[48:51]
    v_exp_f32 v213, v213
    v_mfma_f32_16x16x32_bf16 v[28:31], v[8:11], a[200:203], 0
    v_fma_f32 v214, v214, s31, v251
    v_add_f32 v242, v242, v179
    v_mfma_f32_16x16x32_bf16 v[28:31], v[120:123], a[204:207], v[28:31]
    v_exp_f32 v182, v182
    v_mfma_f32_16x16x32_bf16 v[72:75], v[120:123], a[208:211], 0
    v_fma_f32 v183, v183, s31, v238
    v_add_f32 v241, v241, v199
    v_mfma_f32_16x16x32_bf16 v[72:75], v[8:11], a[212:215], v[72:75]
    v_exp_f32 v202, v202
    v_mfma_f32_16x16x32_bf16 v[84:87], v[8:11], a[216:219], 0
    v_fma_f32 v203, v203, s31, v252
    v_add_f32 v240, v240, v127
    v_mfma_f32_16x16x32_bf16 v[84:87], v[120:123], a[220:223], v[84:87]
    s_waitcnt lgkmcnt(0)
    v_exp_f32 v142, v142
    v_mfma_f32_16x16x32_bf16 v[128:131], a[160:163], v[64:67], v[128:131]
    ds_read_b64_tr_b16 v[8:9], v254 offset:32768
    v_fma_f32 v143, v143, s31, v253
    v_mfma_f32_16x16x32_bf16 v[128:131], a[164:167], v[88:91], v[128:131]
    ds_read_b64_tr_b16 v[10:11], v254 offset:34816
    v_add_f32 v239, v239, v187
    v_mfma_f32_16x16x32_bf16 v[128:131], a[168:171], v[96:99], v[128:131]
    ds_read_b64_tr_b16 v[120:121], v254 offset:36864
    v_fma_f32 v215, v215, s31, v251
    v_mfma_f32_16x16x32_bf16 v[128:131], a[172:175], v[104:107], v[128:131]
    ds_read_b64_tr_b16 v[122:123], v254 offset:38912
    v_add_f32 v242, v242, v180
    v_mfma_f32_16x16x32_bf16 v[116:119], a[124:127], v[104:107], v[116:119]
    ds_read_b64_tr_b16 v[132:133], v254 offset:40960
    v_fma_f32 v188, v188, s31, v238
    v_mfma_f32_16x16x32_bf16 v[116:119], a[120:123], v[96:99], v[116:119]
    ds_read_b64_tr_b16 v[134:135], v254 offset:43008
    v_add_f32 v241, v241, v200
    v_mfma_f32_16x16x32_bf16 v[116:119], a[116:119], v[88:91], v[116:119]
    ds_read_b64_tr_b16 v[144:145], v254 offset:45056
    v_fma_f32 v204, v204, s31, v252
    v_mfma_f32_16x16x32_bf16 v[116:119], a[112:115], v[64:67], v[116:119]
    s_add_u32 m0, s29, 22656
    ds_read_b64_tr_b16 v[146:147], v254 offset:47104
    v_add_f32 v240, v240, v140
    v_mfma_f32_16x16x32_bf16 v[92:95], a[64:67], v[64:67], v[92:95]
    global_load_lds_dwordx4 v247, s[8:9] offset:1920
    v_mfma_f32_16x16x32_bf16 v[92:95], a[68:71], v[88:91], v[92:95]
    v_exp_f32 v214, v214
    v_mfma_f32_16x16x32_bf16 v[92:95], a[72:75], v[96:99], v[92:95]
    v_xor_b32 v254, 65568, v255
    v_fma_f32 v208, v208, s31, v253
    v_mfma_f32_16x16x32_bf16 v[92:95], a[76:79], v[104:107], v[92:95]
    v_exp_f32 v183, v183
    v_mfma_f32_16x16x32_bf16 v[20:23], a[28:31], v[104:107], v[20:23]
    v_exp_f32 v203, v203
    v_mfma_f32_16x16x32_bf16 v[20:23], a[24:27], v[96:99], v[20:23]
    v_exp_f32 v143, v143
    v_mfma_f32_16x16x32_bf16 v[20:23], a[20:23], v[88:91], v[20:23]
    v_add_f32 v239, v239, v212
    v_fma_f32 v220, v220, s31, v251
    v_mfma_f32_16x16x32_bf16 v[20:23], a[16:19], v[64:67], v[20:23]
    s_waitcnt lgkmcnt(0)
    v_exp_f32 v215, v215
    v_mfma_f32_16x16x32_bf16 v[20:23], a[32:35], v[8:11], v[20:23]
    ds_read_b64_tr_b16 v[64:65], v254 offset:0
    v_add_f32 v242, v242, v181
    v_mfma_f32_16x16x32_bf16 v[20:23], a[36:39], v[120:123], v[20:23]
    ds_read_b64_tr_b16 v[66:67], v254 offset:2048
    v_fma_f32 v189, v189, s31, v238
    v_mfma_f32_16x16x32_bf16 v[20:23], a[40:43], v[132:135], v[20:23]
    ds_read_b64_tr_b16 v[88:89], v254 offset:4096
    v_add_f32 v241, v241, v201
    v_mfma_f32_16x16x32_bf16 v[20:23], a[44:47], v[144:147], v[20:23]
    ds_read_b64_tr_b16 v[90:91], v254 offset:6144
    v_fma_f32 v205, v205, s31, v252
    v_mfma_f32_16x16x32_bf16 v[92:95], a[92:95], v[144:147], v[92:95]
    ds_read_b64_tr_b16 v[96:97], v254 offset:8192
    v_add_f32 v240, v240, v141
    v_mfma_f32_16x16x32_bf16 v[92:95], a[88:91], v[132:135], v[92:95]
    ds_read_b64_tr_b16 v[98:99], v254 offset:10240
    v_fma_f32 v209, v209, s31, v253
    v_mfma_f32_16x16x32_bf16 v[92:95], a[84:87], v[120:123], v[92:95]
    ds_read_b64_tr_b16 v[104:105], v254 offset:12288
    v_cvt_pk_bf16_f32 v148, v20, v21
    v_mfma_f32_16x16x32_bf16 v[92:95], a[80:83], v[8:11], v[92:95]
    s_add_u32 m0, s29, 26752
    ds_read_b64_tr_b16 v[106:107], v254 offset:14336
    v_cvt_pk_bf16_f32 v149, v22, v23
    v_mfma_f32_16x16x32_bf16 v[116:119], a[128:131], v[8:11], v[116:119]
    global_load_lds_dwordx4 v247, s[10:11] offset:1920
    v_mfma_f32_16x16x32_bf16 v[116:119], a[132:135], v[120:123], v[116:119]
    v_exp_f32 v188, v188
    v_mfma_f32_16x16x32_bf16 v[116:119], a[136:139], v[132:135], v[116:119]
    v_cvt_pk_bf16_f32 v150, v92, v93
    v_cvt_pk_bf16_f32 v151, v94, v95
    v_mfma_f32_16x16x32_bf16 v[116:119], a[140:143], v[144:147], v[116:119]
    v_exp_f32 v204, v204
    v_mfma_f32_16x16x32_bf16 v[128:131], a[188:191], v[144:147], v[128:131]
    v_exp_f32 v208, v208
    v_mfma_f32_16x16x32_bf16 v[128:131], a[184:187], v[132:135], v[128:131]
    v_add_f32 v239, v239, v213
    v_fma_f32 v221, v221, s31, v251
    v_mfma_f32_16x16x32_bf16 v[128:131], a[180:183], v[120:123], v[128:131]
    v_exp_f32 v220, v220
    v_mfma_f32_16x16x32_bf16 v[128:131], a[176:179], v[8:11], v[128:131]
    s_waitcnt lgkmcnt(0)
    v_cvt_pk_bf16_f32 v20, v116, v117
    v_cvt_pk_bf16_f32 v21, v118, v119
    v_mfma_f32_16x16x32_bf16 v[8:11], a[0:3], v[64:67], 0
    ds_read_b64_tr_b16 v[92:93], v254 offset:16384
    v_add_f32 v242, v242, v182
    v_mfma_f32_16x16x32_bf16 v[8:11], a[4:7], v[88:91], v[8:11]
    ds_read_b64_tr_b16 v[94:95], v254 offset:18432
    v_cvt_pk_bf16_f32 v22, v128, v129
    v_mfma_f32_16x16x32_bf16 v[8:11], a[8:11], v[96:99], v[8:11]
    ds_read_b64_tr_b16 v[116:117], v254 offset:20480
    v_cvt_pk_bf16_f32 v23, v130, v131
    v_mfma_f32_16x16x32_bf16 v[8:11], a[12:15], v[104:107], v[8:11]
    ds_read_b64_tr_b16 v[118:119], v254 offset:22528
    v_fma_f32 v190, v190, s31, v238
    v_mfma_f32_16x16x32_bf16 v[120:123], a[60:63], v[104:107], 0
    ds_read_b64_tr_b16 v[128:129], v254 offset:24576
    v_add_f32 v241, v241, v202
    v_mfma_f32_16x16x32_bf16 v[120:123], a[56:59], v[96:99], v[120:123]
    ds_read_b64_tr_b16 v[130:131], v254 offset:26624
    v_fma_f32 v206, v206, s31, v252
    v_mfma_f32_16x16x32_bf16 v[120:123], a[52:55], v[88:91], v[120:123]
    ds_read_b64_tr_b16 v[132:133], v254 offset:28672
    v_add_f32 v240, v240, v142
    v_mfma_f32_16x16x32_bf16 v[120:123], a[48:51], v[64:67], v[120:123]
    s_add_u32 m0, s29, 30848
    ds_read_b64_tr_b16 v[134:135], v254 offset:30720
    v_fma_f32 v210, v210, s31, v253
    v_mfma_f32_16x16x32_bf16 v[144:147], a[96:99], v[64:67], 0
    global_load_lds_dwordx4 v247, s[12:13] offset:1920
    v_mfma_f32_16x16x32_bf16 v[144:147], a[100:103], v[88:91], v[144:147]
    v_exp_f32 v189, v189
    v_mfma_f32_16x16x32_bf16 v[144:147], a[104:107], v[96:99], v[144:147]
    v_exp_f32 v205, v205
    v_mfma_f32_16x16x32_bf16 v[144:147], a[108:111], v[104:107], v[144:147]
    v_exp_f32 v209, v209
    v_mfma_f32_16x16x32_bf16 v[156:159], a[156:159], v[104:107], 0
    v_add_f32 v239, v239, v214
    v_fma_f32 v222, v222, s31, v251
    v_mfma_f32_16x16x32_bf16 v[156:159], a[152:155], v[96:99], v[156:159]
    v_exp_f32 v221, v221
    v_mfma_f32_16x16x32_bf16 v[156:159], a[148:151], v[88:91], v[156:159]
    v_add_f32 v242, v242, v183
    v_fma_f32 v191, v191, s31, v238
    v_mfma_f32_16x16x32_bf16 v[156:159], a[144:147], v[64:67], v[156:159]
    v_exp_f32 v190, v190
    v_mfma_f32_16x16x32_bf16 v[88:91], v[148:151], a[192:195], 0
    v_add_f32 v241, v241, v203
    v_fma_f32 v207, v207, s31, v252
    v_mfma_f32_16x16x32_bf16 v[88:91], v[20:23], a[196:199], v[88:91]
    v_exp_f32 v206, v206
    v_mfma_f32_16x16x32_bf16 v[64:67], v[20:23], a[200:203], 0
    v_add_f32 v240, v240, v143
    v_fma_f32 v211, v211, s31, v253
    v_mfma_f32_16x16x32_bf16 v[64:67], v[148:151], a[204:207], v[64:67]
    v_exp_f32 v210, v210
    v_mfma_f32_16x16x32_bf16 v[96:99], v[148:151], a[208:211], 0
    v_add_f32 v239, v239, v215
    v_fma_f32 v223, v223, s31, v251
    v_mfma_f32_16x16x32_bf16 v[96:99], v[20:23], a[212:215], v[96:99]
    v_exp_f32 v222, v222
    v_mfma_f32_16x16x32_bf16 v[104:107], v[20:23], a[216:219], 0
    v_add_f32 v242, v242, v188
    v_add_f32 v241, v241, v204
    v_mfma_f32_16x16x32_bf16 v[104:107], v[148:151], a[220:223], v[104:107]
    s_waitcnt lgkmcnt(0)
    v_exp_f32 v191, v191
    v_mfma_f32_16x16x32_bf16 v[156:159], a[160:163], v[92:95], v[156:159]
    ds_read_b64_tr_b16 v[20:21], v254 offset:32768
    v_add_f32 v240, v240, v208
    v_mfma_f32_16x16x32_bf16 v[156:159], a[164:167], v[116:119], v[156:159]
    ds_read_b64_tr_b16 v[22:23], v254 offset:34816
    v_add_f32 v239, v239, v220
    v_mfma_f32_16x16x32_bf16 v[156:159], a[168:171], v[128:131], v[156:159]
    ds_read_b64_tr_b16 v[148:149], v254 offset:36864
    v_add_f32 v242, v242, v189
    v_mfma_f32_16x16x32_bf16 v[156:159], a[172:175], v[132:135], v[156:159]
    ds_read_b64_tr_b16 v[150:151], v254 offset:38912
    v_add_f32 v241, v241, v205
    v_mfma_f32_16x16x32_bf16 v[144:147], a[124:127], v[132:135], v[144:147]
    ds_read_b64_tr_b16 v[160:161], v254 offset:40960
    v_add_f32 v240, v240, v209
    v_mfma_f32_16x16x32_bf16 v[144:147], a[120:123], v[128:131], v[144:147]
    ds_read_b64_tr_b16 v[162:163], v254 offset:43008
    v_add_f32 v239, v239, v221
    v_mfma_f32_16x16x32_bf16 v[144:147], a[116:119], v[116:119], v[144:147]
    ds_read_b64_tr_b16 v[216:217], v254 offset:45056
    v_add_f32 v242, v242, v190
    v_mfma_f32_16x16x32_bf16 v[144:147], a[112:115], v[92:95], v[144:147]
    s_add_u32 m0, s29, 34944
    ds_read_b64_tr_b16 v[218:219], v254 offset:47104
    v_add_f32 v241, v241, v206
    v_mfma_f32_16x16x32_bf16 v[120:123], a[64:67], v[92:95], v[120:123]
    global_load_lds_dwordx4 v247, s[14:15] offset:1920
    v_mfma_f32_16x16x32_bf16 v[120:123], a[68:71], v[116:119], v[120:123]
    v_exp_f32 v207, v207
    v_mfma_f32_16x16x32_bf16 v[120:123], a[72:75], v[128:131], v[120:123]
    v_xor_b32 v254, 65600, v255
    v_add_f32 v240, v240, v210
    v_mfma_f32_16x16x32_bf16 v[120:123], a[76:79], v[132:135], v[120:123]
    v_exp_f32 v211, v211
    v_mfma_f32_16x16x32_bf16 v[8:11], a[28:31], v[132:135], v[8:11]
    v_exp_f32 v223, v223
    v_mfma_f32_16x16x32_bf16 v[8:11], a[24:27], v[128:131], v[8:11]
    v_add_f32 v239, v239, v222
    v_add_f32 v242, v242, v191
    v_mfma_f32_16x16x32_bf16 v[8:11], a[20:23], v[116:119], v[8:11]
    v_add_f32 v241, v241, v207
    v_add_f32 v240, v240, v211
    v_mfma_f32_16x16x32_bf16 v[8:11], a[16:19], v[92:95], v[8:11]
    s_waitcnt lgkmcnt(0)
    v_add_f32 v239, v239, v223
    v_cvt_pk_bf16_f32 v78, v4, v5
    v_mfma_f32_16x16x32_bf16 v[8:11], a[32:35], v[20:23], v[8:11]
    ds_read_b64_tr_b16 v[92:93], v254 offset:0
    v_cvt_pk_bf16_f32 v79, v6, v7
    v_mfma_f32_16x16x32_bf16 v[8:11], a[36:39], v[148:151], v[8:11]
    ds_read_b64_tr_b16 v[94:95], v254 offset:2048
    v_cvt_pk_bf16_f32 v116, v40, v41
    v_mfma_f32_16x16x32_bf16 v[8:11], a[40:43], v[160:163], v[8:11]
    ds_read_b64_tr_b16 v[4:5], v254 offset:4096
    v_cvt_pk_bf16_f32 v117, v42, v43
    v_mfma_f32_16x16x32_bf16 v[8:11], a[44:47], v[216:219], v[8:11]
    ds_read_b64_tr_b16 v[6:7], v254 offset:6144
    v_cvt_pk_bf16_f32 v118, v48, v49
    v_mfma_f32_16x16x32_bf16 v[120:123], a[92:95], v[216:219], v[120:123]
    ds_read_b64_tr_b16 v[40:41], v254 offset:8192
    v_cvt_pk_bf16_f32 v119, v50, v51
    v_mfma_f32_16x16x32_bf16 v[120:123], a[88:91], v[160:163], v[120:123]
    ds_read_b64_tr_b16 v[42:43], v254 offset:10240
    v_cvt_pk_bf16_f32 v128, v88, v89
    v_mfma_f32_16x16x32_bf16 v[120:123], a[84:87], v[148:151], v[120:123]
    ds_read_b64_tr_b16 v[48:49], v254 offset:12288
    v_cvt_pk_bf16_f32 v132, v8, v9
    v_mfma_f32_16x16x32_bf16 v[120:123], a[80:83], v[20:23], v[120:123]
    s_add_u32 m0, s29, 39040
    ds_read_b64_tr_b16 v[50:51], v254 offset:14336
    v_cvt_pk_bf16_f32 v133, v10, v11
    v_mfma_f32_16x16x32_bf16 v[144:147], a[128:131], v[20:23], v[144:147]
    global_load_lds_dwordx4 v247, s[16:17] offset:1920
    v_mfma_f32_16x16x32_bf16 v[144:147], a[132:135], v[148:151], v[144:147]
    v_permlane32_swap_b32 v242, v241
    v_mfma_f32_16x16x32_bf16 v[144:147], a[136:139], v[160:163], v[144:147]
    v_cvt_pk_bf16_f32 v134, v120, v121
    v_cvt_pk_bf16_f32 v135, v122, v123
    v_mfma_f32_16x16x32_bf16 v[144:147], a[140:143], v[216:219], v[144:147]
    v_permlane32_swap_b32 v240, v239
    v_mfma_f32_16x16x32_bf16 v[156:159], a[188:191], v[216:219], v[156:159]
    v_add_f32 v253, v242, v241
    v_add_f32 v252, v240, v239
    v_mfma_f32_16x16x32_bf16 v[156:159], a[184:187], v[160:163], v[156:159]
    v_cvt_pk_bf16_f32 v129, v90, v91
    v_cvt_pk_bf16_f32 v8, v64, v65
    v_mfma_f32_16x16x32_bf16 v[156:159], a[180:183], v[148:151], v[156:159]
    v_cvt_pk_bf16_f32 v120, v144, v145
    v_cvt_pk_bf16_f32 v121, v146, v147
    v_mfma_f32_16x16x32_bf16 v[156:159], a[176:179], v[20:23], v[156:159]
    s_waitcnt lgkmcnt(0)
    v_permlane16_swap_b32 v253, v252
    v_mfma_f32_16x16x32_bf16 v[88:91], a[0:3], v[92:95], 0
    ds_read_b64_tr_b16 v[20:21], v254 offset:16384
G_13:
    s_cbranch_vccnz G_17
    v_add_f32 v251, v253, v252
    v_mfma_f32_16x16x32_bf16 v[88:91], a[4:7], v[4:7], v[88:91]
    ds_read_b64_tr_b16 v[22:23], v254 offset:18432
    v_cvt_pk_bf16_f32 v9, v66, v67
    v_mfma_f32_16x16x32_bf16 v[88:91], a[8:11], v[40:43], v[88:91]
    ds_read_b64_tr_b16 v[144:145], v254 offset:20480
    v_cvt_pk_bf16_f32 v122, v156, v157
    v_mfma_f32_16x16x32_bf16 v[88:91], a[12:15], v[48:51], v[88:91]
    ds_read_b64_tr_b16 v[146:147], v254 offset:22528
    v_cvt_pk_bf16_f32 v123, v158, v159
    v_mfma_f32_16x16x32_bf16 v[64:67], a[60:63], v[48:51], 0
    ds_read_b64_tr_b16 v[148:149], v254 offset:24576
    v_cvt_pk_bf16_f32 v160, v32, v33
    v_mfma_f32_16x16x32_bf16 v[64:67], a[56:59], v[40:43], v[64:67]
    ds_read_b64_tr_b16 v[150:151], v254 offset:26624
    v_cvt_pk_bf16_f32 v161, v34, v35
    v_mfma_f32_16x16x32_bf16 v[64:67], a[52:55], v[4:7], v[64:67]
    ds_read_b64_tr_b16 v[156:157], v254 offset:28672
    v_cvt_pk_bf16_f32 v162, v28, v29
    v_mfma_f32_16x16x32_bf16 v[64:67], a[48:51], v[92:95], v[64:67]
    s_add_u32 m0, s29, 43136
    ds_read_b64_tr_b16 v[158:159], v254 offset:30720
    v_cvt_pk_bf16_f32 v163, v30, v31
    v_mfma_f32_16x16x32_bf16 v[32:35], a[96:99], v[92:95], 0
    global_load_lds_dwordx4 v247, s[18:19] offset:1920
    v_mfma_f32_16x16x32_bf16 v[32:35], a[100:103], v[4:7], v[32:35]
    v_rcp_f32 v251, v251
    v_mfma_f32_16x16x32_bf16 v[32:35], a[104:107], v[40:43], v[32:35]
    v_mov_b32 v253, v251
    v_cvt_pk_bf16_f32 v110, v0, v1
    v_mfma_f32_16x16x32_bf16 v[32:35], a[108:111], v[48:51], v[32:35]
    v_permlane32_swap_b32 v251, v253
    v_mfma_f32_16x16x32_bf16 v[28:31], a[156:159], v[48:51], 0
    v_mov_b32 v252, v251
    v_mov_b32 v250, v253
    v_mfma_f32_16x16x32_bf16 v[28:31], a[152:155], v[40:43], v[28:31]
    v_permlane16_swap_b32 v251, v252
    v_mfma_f32_16x16x32_bf16 v[28:31], a[148:151], v[4:7], v[28:31]
    v_mul_f32 v168, v168, v251
    v_mul_f32 v169, v169, v251
    v_mfma_f32_16x16x32_bf16 v[28:31], a[144:147], v[92:95], v[28:31]
    v_mul_f32 v170, v170, v251
    v_mul_f32 v171, v171, v251
    v_mfma_f32_16x16x32_bf16 v[4:7], v[132:135], a[192:195], 0
    v_mul_f32 v176, v176, v251
    v_mul_f32 v177, v177, v251
    v_mfma_f32_16x16x32_bf16 v[4:7], v[120:123], a[196:199], v[4:7]
    v_mul_f32 v178, v178, v251
    v_mul_f32 v179, v179, v251
    v_mfma_f32_16x16x32_bf16 v[40:43], v[120:123], a[200:203], 0
    v_cvt_pk_bf16_f32 v48, v168, v169
    v_cvt_pk_bf16_f32 v49, v170, v171
    v_mfma_f32_16x16x32_bf16 v[40:43], v[132:135], a[204:207], v[40:43]
    v_cvt_pk_bf16_f32 v50, v176, v177
    v_cvt_pk_bf16_f32 v51, v178, v179
    v_mfma_f32_16x16x32_bf16 v[92:95], v[132:135], a[208:211], 0
    v_permlane16_swap_b32 v253, v250
    v_mfma_f32_16x16x32_bf16 v[92:95], v[120:123], a[212:215], v[92:95]
    v_mul_f32 v180, v180, v251
    v_mul_f32 v181, v181, v251
    v_mfma_f32_16x16x32_bf16 v[168:171], v[120:123], a[216:219], 0
    v_mul_f32 v182, v182, v251
    v_mul_f32 v183, v183, v251
    v_mfma_f32_16x16x32_bf16 v[168:171], v[132:135], a[220:223], v[168:171]
    s_waitcnt lgkmcnt(0)
    v_mul_f32 v188, v188, v251
    v_mul_f32 v189, v189, v251
    v_mfma_f32_16x16x32_bf16 v[28:31], a[160:163], v[20:23], v[28:31]
    ds_read_b64_tr_b16 v[120:121], v254 offset:32768
    v_mul_f32 v190, v190, v251
    v_mfma_f32_16x16x32_bf16 v[28:31], a[164:167], v[144:147], v[28:31]
    ds_read_b64_tr_b16 v[122:123], v254 offset:34816
    v_mul_f32 v191, v191, v251
    v_mfma_f32_16x16x32_bf16 v[28:31], a[168:171], v[148:151], v[28:31]
    ds_read_b64_tr_b16 v[132:133], v254 offset:36864
    v_cvt_pk_bf16_f32 v176, v180, v181
    v_mfma_f32_16x16x32_bf16 v[28:31], a[172:175], v[156:159], v[28:31]
    ds_read_b64_tr_b16 v[134:135], v254 offset:38912
    v_cvt_pk_bf16_f32 v177, v182, v183
    v_mfma_f32_16x16x32_bf16 v[32:35], a[124:127], v[156:159], v[32:35]
    ds_read_b64_tr_b16 v[216:217], v254 offset:40960
    v_cvt_pk_bf16_f32 v178, v188, v189
    v_mfma_f32_16x16x32_bf16 v[32:35], a[120:123], v[148:151], v[32:35]
    ds_read_b64_tr_b16 v[218:219], v254 offset:43008
    v_cvt_pk_bf16_f32 v179, v190, v191
    v_mfma_f32_16x16x32_bf16 v[32:35], a[116:119], v[144:147], v[32:35]
    ds_read_b64_tr_b16 v[180:181], v254 offset:45056
    v_mul_f32 v200, v200, v253
    v_mfma_f32_16x16x32_bf16 v[32:35], a[112:115], v[20:23], v[32:35]
    s_add_u32 m0, s29, 47232
    ds_read_b64_tr_b16 v[182:183], v254 offset:47104
    v_mul_f32 v201, v201, v253
    v_mfma_f32_16x16x32_bf16 v[64:67], a[64:67], v[20:23], v[64:67]
    global_load_lds_dwordx4 v247, s[20:21] offset:1920
    v_mfma_f32_16x16x32_bf16 v[64:67], a[68:71], v[144:147], v[64:67]
    v_mul_f32 v202, v202, v253
    v_mul_f32 v203, v203, v253
    v_mfma_f32_16x16x32_bf16 v[64:67], a[72:75], v[148:151], v[64:67]
    v_xor_b32 v254, 65632, v255
    v_mul_f32 v204, v204, v253
    v_mfma_f32_16x16x32_bf16 v[64:67], a[76:79], v[156:159], v[64:67]
    v_mul_f32 v205, v205, v253
    v_mul_f32 v206, v206, v253
    v_mfma_f32_16x16x32_bf16 v[88:91], a[28:31], v[156:159], v[88:91]
    v_mul_f32 v207, v207, v253
    v_cvt_pk_bf16_f32 v188, v200, v201
    v_mfma_f32_16x16x32_bf16 v[88:91], a[24:27], v[148:151], v[88:91]
    v_cvt_pk_bf16_f32 v189, v202, v203
    v_cvt_pk_bf16_f32 v190, v204, v205
    v_mfma_f32_16x16x32_bf16 v[88:91], a[20:23], v[144:147], v[88:91]
    v_cvt_pk_bf16_f32 v191, v206, v207
    v_mul_f32 v192, v192, v253
    v_mfma_f32_16x16x32_bf16 v[88:91], a[16:19], v[20:23], v[88:91]
    s_waitcnt lgkmcnt(0)
    v_mul_f32 v193, v193, v253
    v_mul_f32 v194, v194, v253
    v_mfma_f32_16x16x32_bf16 v[88:91], a[32:35], v[120:123], v[88:91]
    ds_read_b64_tr_b16 v[20:21], v254 offset:0
    v_mul_f32 v195, v195, v253
    v_mfma_f32_16x16x32_bf16 v[88:91], a[36:39], v[132:135], v[88:91]
    ds_read_b64_tr_b16 v[22:23], v254 offset:2048
    v_mul_f32 v196, v196, v253
    v_mfma_f32_16x16x32_bf16 v[88:91], a[40:43], v[216:219], v[88:91]
    ds_read_b64_tr_b16 v[144:145], v254 offset:4096
    v_mul_f32 v197, v197, v253
    v_mfma_f32_16x16x32_bf16 v[88:91], a[44:47], v[180:183], v[88:91]
    ds_read_b64_tr_b16 v[146:147], v254 offset:6144
    v_mul_f32 v198, v198, v253
    v_mfma_f32_16x16x32_bf16 v[64:67], a[92:95], v[180:183], v[64:67]
    ds_read_b64_tr_b16 v[148:149], v254 offset:8192
    v_mul_f32 v199, v199, v253
    v_mfma_f32_16x16x32_bf16 v[64:67], a[88:91], v[216:219], v[64:67]
    ds_read_b64_tr_b16 v[150:151], v254 offset:10240
    v_cvt_pk_bf16_f32 v156, v192, v193
    v_mfma_f32_16x16x32_bf16 v[64:67], a[84:87], v[132:135], v[64:67]
    ds_read_b64_tr_b16 v[200:201], v254 offset:12288
    v_cvt_pk_bf16_f32 v204, v88, v89
    v_mfma_f32_16x16x32_bf16 v[64:67], a[80:83], v[120:123], v[64:67]
    s_add_u32 m0, s29, 51328
    ds_read_b64_tr_b16 v[202:203], v254 offset:14336
    v_cvt_pk_bf16_f32 v205, v90, v91
    v_mfma_f32_16x16x32_bf16 v[32:35], a[128:131], v[120:123], v[32:35]
    global_load_lds_dwordx4 v247, s[22:23] offset:1920
    v_mfma_f32_16x16x32_bf16 v[32:35], a[132:135], v[132:135], v[32:35]
    v_cvt_pk_bf16_f32 v157, v194, v195
    v_cvt_pk_bf16_f32 v158, v196, v197
    v_mfma_f32_16x16x32_bf16 v[32:35], a[136:139], v[216:219], v[32:35]
    v_cvt_pk_bf16_f32 v206, v64, v65
    v_cvt_pk_bf16_f32 v207, v66, v67
    v_mfma_f32_16x16x32_bf16 v[32:35], a[140:143], v[180:183], v[32:35]
    v_cvt_pk_bf16_f32 v159, v198, v199
    v_mul_f32 v24, v24, v252
    v_mfma_f32_16x16x32_bf16 v[28:31], a[188:191], v[180:183], v[28:31]
    v_mul_f32 v25, v25, v252
    v_mul_f32 v26, v26, v252
    v_mfma_f32_16x16x32_bf16 v[28:31], a[184:187], v[216:219], v[28:31]
    v_mul_f32 v27, v27, v252
    v_mul_f32 v124, v124, v252
    v_mfma_f32_16x16x32_bf16 v[28:31], a[180:183], v[132:135], v[28:31]
    v_cvt_pk_bf16_f32 v64, v32, v33
    v_cvt_pk_bf16_f32 v65, v34, v35
    v_mfma_f32_16x16x32_bf16 v[28:31], a[176:179], v[120:123], v[28:31]
    s_waitcnt lgkmcnt(0)
    v_mul_f32 v125, v125, v252
    v_mul_f32 v126, v126, v252
    v_mfma_f32_16x16x32_bf16 v[32:35], a[0:3], v[20:23], 0
    ds_read_b64_tr_b16 v[88:89], v254 offset:16384
    v_mul_f32 v127, v127, v252
    v_mfma_f32_16x16x32_bf16 v[32:35], a[4:7], v[144:147], v[32:35]
    ds_read_b64_tr_b16 v[90:91], v254 offset:18432
    v_cvt_pk_bf16_f32 v66, v28, v29
    v_mfma_f32_16x16x32_bf16 v[32:35], a[8:11], v[148:151], v[32:35]
    ds_read_b64_tr_b16 v[120:121], v254 offset:20480
    v_cvt_pk_bf16_f32 v67, v30, v31
    v_mfma_f32_16x16x32_bf16 v[32:35], a[12:15], v[200:203], v[32:35]
    ds_read_b64_tr_b16 v[122:123], v254 offset:22528
    v_cvt_pk_bf16_f32 v132, v24, v25
    v_mfma_f32_16x16x32_bf16 v[28:31], a[60:63], v[200:203], 0
    ds_read_b64_tr_b16 v[180:181], v254 offset:24576
    v_cvt_pk_bf16_f32 v133, v26, v27
    v_mfma_f32_16x16x32_bf16 v[28:31], a[56:59], v[148:151], v[28:31]
    ds_read_b64_tr_b16 v[182:183], v254 offset:26624
    v_cvt_pk_bf16_f32 v134, v124, v125
    v_mfma_f32_16x16x32_bf16 v[28:31], a[52:55], v[144:147], v[28:31]
    ds_read_b64_tr_b16 v[24:25], v254 offset:28672
    v_cvt_pk_bf16_f32 v135, v126, v127
    v_mfma_f32_16x16x32_bf16 v[28:31], a[48:51], v[20:23], v[28:31]
    s_add_u32 m0, s29, 55424
    ds_read_b64_tr_b16 v[26:27], v254 offset:30720
    v_mul_f32 v140, v140, v252
    v_mfma_f32_16x16x32_bf16 v[124:127], a[96:99], v[20:23], 0
    global_load_lds_dwordx4 v247, s[24:25] offset:1920
    v_mfma_f32_16x16x32_bf16 v[124:127], a[100:103], v[144:147], v[124:127]
    v_mul_f32 v141, v141, v252
    v_mul_f32 v142, v142, v252
    v_mfma_f32_16x16x32_bf16 v[124:127], a[104:107], v[148:151], v[124:127]
    v_mul_f32 v143, v143, v252
    v_mul_f32 v208, v208, v252
    v_mfma_f32_16x16x32_bf16 v[124:127], a[108:111], v[200:203], v[124:127]
    v_mul_f32 v209, v209, v252
    v_mul_f32 v210, v210, v252
    v_mfma_f32_16x16x32_bf16 v[192:195], a[156:159], v[200:203], 0
    v_mul_f32 v211, v211, v252
    v_cvt_pk_bf16_f32 v196, v140, v141
    v_mfma_f32_16x16x32_bf16 v[192:195], a[152:155], v[148:151], v[192:195]
    v_cvt_pk_bf16_f32 v197, v142, v143
    v_cvt_pk_bf16_f32 v198, v208, v209
    v_mfma_f32_16x16x32_bf16 v[192:195], a[148:151], v[144:147], v[192:195]
    v_cvt_pk_bf16_f32 v199, v210, v211
    v_mul_f32 v212, v212, v250
    v_mfma_f32_16x16x32_bf16 v[192:195], a[144:147], v[20:23], v[192:195]
    v_mul_f32 v213, v213, v250
    v_mul_f32 v214, v214, v250
    v_mfma_f32_16x16x32_bf16 v[140:143], v[204:207], a[224:227], 0
    v_mul_f32 v215, v215, v250
    v_mul_f32 v220, v220, v250
    v_mfma_f32_16x16x32_bf16 v[140:143], v[64:67], a[228:231], v[140:143]
    v_mul_f32 v221, v221, v250
    v_mul_f32 v222, v222, v250
    v_mfma_f32_16x16x32_bf16 v[20:23], v[64:67], a[232:235], 0
    v_mul_f32 v223, v223, v250
    v_cvt_pk_bf16_f32 v144, v212, v213
    v_mfma_f32_16x16x32_bf16 v[20:23], v[204:207], a[236:239], v[20:23]
    v_cvt_pk_bf16_f32 v145, v214, v215
    v_cvt_pk_bf16_f32 v146, v220, v221
    v_mfma_f32_16x16x32_bf16 v[148:151], v[204:207], a[240:243], 0
    v_cvt_pk_bf16_f32 v147, v222, v223
    v_mul_f32 v164, v164, v250
    v_mfma_f32_16x16x32_bf16 v[148:151], v[64:67], a[244:247], v[148:151]
    v_mul_f32 v165, v165, v250
    v_mul_f32 v166, v166, v250
    v_mfma_f32_16x16x32_bf16 v[200:203], v[64:67], a[248:251], 0
    v_mul_f32 v167, v167, v250
    v_mul_f32 v184, v184, v250
    v_mfma_f32_16x16x32_bf16 v[200:203], v[204:207], a[252:255], v[200:203]
    s_waitcnt lgkmcnt(0)
    v_mul_f32 v185, v185, v250
    v_mul_f32 v186, v186, v250
    v_mfma_f32_16x16x32_bf16 v[192:195], a[160:163], v[88:91], v[192:195]
    ds_read_b64_tr_b16 v[64:65], v254 offset:32768
    v_mul_f32 v187, v187, v250
    v_mfma_f32_16x16x32_bf16 v[192:195], a[164:167], v[120:123], v[192:195]
    ds_read_b64_tr_b16 v[66:67], v254 offset:34816
    v_cvt_pk_bf16_f32 v204, v164, v165
    v_mfma_f32_16x16x32_bf16 v[192:195], a[168:171], v[180:183], v[192:195]
    ds_read_b64_tr_b16 v[208:209], v254 offset:36864
    v_cvt_pk_bf16_f32 v205, v166, v167
    v_mfma_f32_16x16x32_bf16 v[192:195], a[172:175], v[24:27], v[192:195]
    ds_read_b64_tr_b16 v[210:211], v254 offset:38912
    v_cvt_pk_bf16_f32 v206, v184, v185
    v_mfma_f32_16x16x32_bf16 v[124:127], a[124:127], v[24:27], v[124:127]
    ds_read_b64_tr_b16 v[164:165], v254 offset:40960
    v_cvt_pk_bf16_f32 v207, v186, v187
    v_mfma_f32_16x16x32_bf16 v[124:127], a[120:123], v[180:183], v[124:127]
    ds_read_b64_tr_b16 v[166:167], v254 offset:43008
    v_cvt_pk_bf16_f32 v130, v4, v5
    v_mfma_f32_16x16x32_bf16 v[124:127], a[116:119], v[120:123], v[124:127]
    ds_read_b64_tr_b16 v[184:185], v254 offset:45056
    v_cvt_pk_bf16_f32 v131, v6, v7
    v_mfma_f32_16x16x32_bf16 v[124:127], a[112:115], v[88:91], v[124:127]
    s_add_u32 m0, s29, 59520
    ds_read_b64_tr_b16 v[186:187], v254 offset:47104
    v_cvt_pk_bf16_f32 v253, v140, v141
    v_mfma_f32_16x16x32_bf16 v[28:31], a[64:67], v[88:91], v[28:31]
    global_load_lds_dwordx4 v247, s[26:27] offset:1920
    v_mfma_f32_16x16x32_bf16 v[28:31], a[68:71], v[120:123], v[28:31]
    v_cvt_pk_bf16_f32 v254, v142, v143
    v_accvgpr_write_b32 a192, v253
    v_mfma_f32_16x16x32_bf16 v[28:31], a[72:75], v[180:183], v[28:31]
    v_xor_b32 v252, 114688, v255
    v_accvgpr_write_b32 a193, v254
    v_mfma_f32_16x16x32_bf16 v[28:31], a[76:79], v[24:27], v[28:31]
    v_cvt_pk_bf16_f32 v253, v20, v21
    v_cvt_pk_bf16_f32 v251, v22, v23
    v_mfma_f32_16x16x32_bf16 v[32:35], a[28:31], v[24:27], v[32:35]
    v_accvgpr_write_b32 a196, v253
    v_accvgpr_write_b32 a197, v251
    v_mfma_f32_16x16x32_bf16 v[32:35], a[24:27], v[180:183], v[32:35]
    v_cvt_pk_bf16_f32 v10, v40, v41
    v_cvt_pk_bf16_f32 v11, v42, v43
    v_mfma_f32_16x16x32_bf16 v[32:35], a[20:23], v[120:123], v[32:35]
    v_cvt_pk_bf16_f32 v111, v2, v3
    v_cvt_pk_bf16_f32 v38, v12, v13
    v_mfma_f32_16x16x32_bf16 v[32:35], a[16:19], v[88:91], v[32:35]
    s_waitcnt vmcnt(12) lgkmcnt(0)
    s_barrier
    v_cvt_pk_bf16_f32 v39, v14, v15
    v_mfma_f32_16x16x32_bf16 v[32:35], a[32:35], v[64:67], v[32:35]
    ds_read_b64_tr_b16 v[0:1], v252 offset:0
    v_cvt_pk_bf16_f32 v4, v56, v57
    v_mfma_f32_16x16x32_bf16 v[32:35], a[36:39], v[208:211], v[32:35]
    ds_read_b64_tr_b16 v[2:3], v252 offset:2048
    v_cvt_pk_bf16_f32 v5, v58, v59
    v_mfma_f32_16x16x32_bf16 v[32:35], a[40:43], v[164:167], v[32:35]
    ds_read_b64_tr_b16 v[12:13], v252 offset:4096
    v_cvt_pk_bf16_f32 v6, v72, v73
    v_mfma_f32_16x16x32_bf16 v[32:35], a[44:47], v[184:187], v[32:35]
    ds_read_b64_tr_b16 v[14:15], v252 offset:6144
    v_cvt_pk_bf16_f32 v7, v74, v75
    v_mfma_f32_16x16x32_bf16 v[28:31], a[92:95], v[184:187], v[28:31]
    ds_read_b64_tr_b16 v[20:21], v252 offset:8192
    v_cvt_pk_bf16_f32 v24, v96, v97
    v_mfma_f32_16x16x32_bf16 v[28:31], a[88:91], v[164:167], v[28:31]
    ds_read_b64_tr_b16 v[22:23], v252 offset:10240
    v_cvt_pk_bf16_f32 v25, v98, v99
    v_mfma_f32_16x16x32_bf16 v[28:31], a[84:87], v[208:211], v[28:31]
    ds_read_b64_tr_b16 v[40:41], v252 offset:12288
    v_cvt_pk_bf16_f32 v56, v32, v33
    v_mfma_f32_16x16x32_bf16 v[28:31], a[80:83], v[64:67], v[28:31]
    s_add_u32 m0, s29, 63488
    ds_read_b64_tr_b16 v[42:43], v252 offset:14336
    v_cvt_pk_bf16_f32 v57, v34, v35
    v_mfma_f32_16x16x32_bf16 v[124:127], a[128:131], v[64:67], v[124:127]
    global_load_lds_dwordx4 v247, s[4:5] offset:2048
    v_mfma_f32_16x16x32_bf16 v[124:127], a[132:135], v[208:211], v[124:127]
    v_cvt_pk_bf16_f32 v26, v92, v93
    v_cvt_pk_bf16_f32 v27, v94, v95
    v_mfma_f32_16x16x32_bf16 v[124:127], a[136:139], v[164:167], v[124:127]
    v_cvt_pk_bf16_f32 v58, v28, v29
    v_cvt_pk_bf16_f32 v59, v30, v31
    v_mfma_f32_16x16x32_bf16 v[124:127], a[140:143], v[184:187], v[124:127]
    v_cvt_pk_bf16_f32 v254, v148, v149
    v_cvt_pk_bf16_f32 v253, v150, v151
    v_mfma_f32_16x16x32_bf16 v[192:195], a[188:191], v[184:187], v[192:195]
    v_accvgpr_write_b32 a200, v254
    v_accvgpr_write_b32 a201, v253
    v_mfma_f32_16x16x32_bf16 v[192:195], a[184:187], v[164:167], v[192:195]
    v_cvt_pk_bf16_f32 v251, v200, v201
    v_cvt_pk_bf16_f32 v254, v202, v203
    v_mfma_f32_16x16x32_bf16 v[192:195], a[180:183], v[208:211], v[192:195]
    v_cvt_pk_bf16_f32 v28, v124, v125
    v_cvt_pk_bf16_f32 v29, v126, v127
    v_mfma_f32_16x16x32_bf16 v[192:195], a[176:179], v[64:67], v[192:195]
    s_waitcnt lgkmcnt(0)
    v_accvgpr_write_b32 a204, v251
    v_accvgpr_write_b32 a205, v254
    v_mfma_f32_16x16x32_bf16 v[32:35], a[0:3], v[0:3], 0
    ds_read_b64_tr_b16 v[64:65], v252 offset:16384
    v_cvt_pk_bf16_f32 v72, v104, v105
    v_mfma_f32_16x16x32_bf16 v[32:35], a[4:7], v[12:15], v[32:35]
    ds_read_b64_tr_b16 v[66:67], v252 offset:18432
    v_cvt_pk_bf16_f32 v30, v192, v193
    v_mfma_f32_16x16x32_bf16 v[32:35], a[8:11], v[20:23], v[32:35]
    ds_read_b64_tr_b16 v[88:89], v252 offset:20480
    v_cvt_pk_bf16_f32 v31, v194, v195
    v_mfma_f32_16x16x32_bf16 v[32:35], a[12:15], v[40:43], v[32:35]
    ds_read_b64_tr_b16 v[90:91], v252 offset:22528
    v_cvt_pk_bf16_f32 v73, v106, v107
    v_mfma_f32_16x16x32_bf16 v[92:95], a[60:63], v[40:43], 0
    ds_read_b64_tr_b16 v[96:97], v252 offset:24576
    v_cvt_pk_bf16_f32 v74, v168, v169
    v_mfma_f32_16x16x32_bf16 v[92:95], a[56:59], v[20:23], v[92:95]
    ds_read_b64_tr_b16 v[98:99], v252 offset:26624
    v_cvt_pk_bf16_f32 v75, v170, v171
    v_mfma_f32_16x16x32_bf16 v[92:95], a[52:55], v[12:15], v[92:95]
    ds_read_b64_tr_b16 v[104:105], v252 offset:28672
    v_cvt_pk_bf16_f32 v120, v60, v61
    v_mfma_f32_16x16x32_bf16 v[92:95], a[48:51], v[0:3], v[92:95]
    s_add_u32 m0, s29, 67584
    ds_read_b64_tr_b16 v[106:107], v252 offset:30720
    v_cvt_pk_bf16_f32 v121, v62, v63
    v_mfma_f32_16x16x32_bf16 v[124:127], a[96:99], v[0:3], 0
    global_load_lds_dwordx4 v247, s[6:7] offset:2048
    v_mfma_f32_16x16x32_bf16 v[124:127], a[100:103], v[12:15], v[124:127]
    v_cvt_pk_bf16_f32 v122, v84, v85
    v_cvt_pk_bf16_f32 v123, v86, v87
    v_mfma_f32_16x16x32_bf16 v[124:127], a[104:107], v[20:23], v[124:127]
    v_cvt_pk_bf16_f32 v46, v16, v17
    v_cvt_pk_bf16_f32 v47, v18, v19
    v_mfma_f32_16x16x32_bf16 v[124:127], a[108:111], v[40:43], v[124:127]
    v_mfma_f32_16x16x32_bf16 v[60:63], a[156:159], v[40:43], 0
    v_mfma_f32_16x16x32_bf16 v[60:63], a[152:155], v[20:23], v[60:63]
    v_mfma_f32_16x16x32_bf16 v[60:63], a[148:151], v[12:15], v[60:63]
    v_mfma_f32_16x16x32_bf16 v[60:63], a[144:147], v[0:3], v[60:63]
    v_mfma_f32_16x16x32_bf16 v[16:19], v[56:59], a[224:227], 0
    v_mfma_f32_16x16x32_bf16 v[16:19], v[28:31], a[228:231], v[16:19]
    v_mfma_f32_16x16x32_bf16 v[12:15], v[28:31], a[232:235], 0
    v_mfma_f32_16x16x32_bf16 v[12:15], v[56:59], a[236:239], v[12:15]
    v_mfma_f32_16x16x32_bf16 v[0:3], v[56:59], a[240:243], 0
    v_mfma_f32_16x16x32_bf16 v[0:3], v[28:31], a[244:247], v[0:3]
    v_mfma_f32_16x16x32_bf16 v[20:23], v[28:31], a[248:251], 0
    v_mfma_f32_16x16x32_bf16 v[20:23], v[56:59], a[252:255], v[20:23]
    s_waitcnt lgkmcnt(0)
    v_mfma_f32_16x16x32_bf16 v[60:63], a[160:163], v[64:67], v[60:63]
    ds_read_b64_tr_b16 v[28:29], v252 offset:32768
    v_cvt_pk_bf16_f32 v254, v16, v17
    v_mfma_f32_16x16x32_bf16 v[60:63], a[164:167], v[88:91], v[60:63]
    ds_read_b64_tr_b16 v[30:31], v252 offset:34816
    v_cvt_pk_bf16_f32 v253, v18, v19
    v_mfma_f32_16x16x32_bf16 v[60:63], a[168:171], v[96:99], v[60:63]
    ds_read_b64_tr_b16 v[40:41], v252 offset:36864
    v_accvgpr_write_b32 a194, v254
    v_mfma_f32_16x16x32_bf16 v[60:63], a[172:175], v[104:107], v[60:63]
    ds_read_b64_tr_b16 v[42:43], v252 offset:38912
    v_accvgpr_write_b32 a195, v253
    v_mfma_f32_16x16x32_bf16 v[124:127], a[124:127], v[104:107], v[124:127]
    ds_read_b64_tr_b16 v[16:17], v252 offset:40960
    v_cvt_pk_bf16_f32 v254, v12, v13
    v_mfma_f32_16x16x32_bf16 v[124:127], a[120:123], v[96:99], v[124:127]
    ds_read_b64_tr_b16 v[18:19], v252 offset:43008
    v_cvt_pk_bf16_f32 v253, v14, v15
    v_mfma_f32_16x16x32_bf16 v[124:127], a[116:119], v[88:91], v[124:127]
    ds_read_b64_tr_b16 v[56:57], v252 offset:45056
    v_accvgpr_write_b32 a198, v254
    v_mfma_f32_16x16x32_bf16 v[124:127], a[112:115], v[64:67], v[124:127]
    s_add_u32 m0, s29, 71680
    ds_read_b64_tr_b16 v[58:59], v252 offset:47104
    v_accvgpr_write_b32 a199, v253
    v_mfma_f32_16x16x32_bf16 v[92:95], a[64:67], v[64:67], v[92:95]
    global_load_lds_dwordx4 v247, s[8:9] offset:2048
    v_mfma_f32_16x16x32_bf16 v[92:95], a[68:71], v[88:91], v[92:95]
    v_cvt_pk_bf16_f32 v254, v0, v1
    v_cvt_pk_bf16_f32 v253, v2, v3
    v_mfma_f32_16x16x32_bf16 v[92:95], a[72:75], v[96:99], v[92:95]
    v_xor_b32 v252, 114720, v255
    v_accvgpr_write_b32 a202, v254
    v_mfma_f32_16x16x32_bf16 v[92:95], a[76:79], v[104:107], v[92:95]
    v_accvgpr_write_b32 a203, v253
    v_cvt_pk_bf16_f32 v251, v20, v21
    v_mfma_f32_16x16x32_bf16 v[32:35], a[28:31], v[104:107], v[32:35]
    v_cvt_pk_bf16_f32 v254, v22, v23
    v_accvgpr_write_b32 a206, v251
    v_mfma_f32_16x16x32_bf16 v[32:35], a[24:27], v[96:99], v[32:35]
    v_accvgpr_write_b32 a207, v254
    v_mfma_f32_16x16x32_bf16 v[32:35], a[20:23], v[88:91], v[32:35]
    v_mfma_f32_16x16x32_bf16 v[32:35], a[16:19], v[64:67], v[32:35]
    s_waitcnt lgkmcnt(0)
    v_mfma_f32_16x16x32_bf16 v[32:35], a[32:35], v[28:31], v[32:35]
    ds_read_b64_tr_b16 v[0:1], v252 offset:0
    v_mfma_f32_16x16x32_bf16 v[32:35], a[36:39], v[40:43], v[32:35]
    ds_read_b64_tr_b16 v[2:3], v252 offset:2048
    v_mfma_f32_16x16x32_bf16 v[32:35], a[40:43], v[16:19], v[32:35]
    ds_read_b64_tr_b16 v[12:13], v252 offset:4096
    v_mfma_f32_16x16x32_bf16 v[32:35], a[44:47], v[56:59], v[32:35]
    ds_read_b64_tr_b16 v[14:15], v252 offset:6144
    v_mfma_f32_16x16x32_bf16 v[92:95], a[92:95], v[56:59], v[92:95]
    ds_read_b64_tr_b16 v[20:21], v252 offset:8192
    v_mfma_f32_16x16x32_bf16 v[92:95], a[88:91], v[16:19], v[92:95]
    ds_read_b64_tr_b16 v[22:23], v252 offset:10240
    v_mfma_f32_16x16x32_bf16 v[92:95], a[84:87], v[40:43], v[92:95]
    ds_read_b64_tr_b16 v[64:65], v252 offset:12288
    v_mfma_f32_16x16x32_bf16 v[92:95], a[80:83], v[28:31], v[92:95]
    s_add_u32 m0, s29, 75776
    ds_read_b64_tr_b16 v[66:67], v252 offset:14336
    v_cvt_pk_bf16_f32 v84, v32, v33
    v_mfma_f32_16x16x32_bf16 v[124:127], a[128:131], v[28:31], v[124:127]
    global_load_lds_dwordx4 v247, s[10:11] offset:2048
    v_mfma_f32_16x16x32_bf16 v[124:127], a[132:135], v[40:43], v[124:127]
    v_cvt_pk_bf16_f32 v85, v34, v35
    v_mfma_f32_16x16x32_bf16 v[124:127], a[136:139], v[16:19], v[124:127]
    v_cvt_pk_bf16_f32 v86, v92, v93
    v_cvt_pk_bf16_f32 v87, v94, v95
    v_mfma_f32_16x16x32_bf16 v[124:127], a[140:143], v[56:59], v[124:127]
    v_mfma_f32_16x16x32_bf16 v[60:63], a[188:191], v[56:59], v[60:63]
    v_mfma_f32_16x16x32_bf16 v[60:63], a[184:187], v[16:19], v[60:63]
    v_mfma_f32_16x16x32_bf16 v[60:63], a[180:183], v[40:43], v[60:63]
    v_mfma_f32_16x16x32_bf16 v[60:63], a[176:179], v[28:31], v[60:63]
    s_waitcnt lgkmcnt(0)
    v_mfma_f32_16x16x32_bf16 v[16:19], a[0:3], v[0:3], 0
    ds_read_b64_tr_b16 v[32:33], v252 offset:16384
    v_mfma_f32_16x16x32_bf16 v[16:19], a[4:7], v[12:15], v[16:19]
    ds_read_b64_tr_b16 v[34:35], v252 offset:18432
    v_cvt_pk_bf16_f32 v28, v124, v125
    v_mfma_f32_16x16x32_bf16 v[16:19], a[8:11], v[20:23], v[16:19]
    ds_read_b64_tr_b16 v[40:41], v252 offset:20480
    v_cvt_pk_bf16_f32 v29, v126, v127
    v_mfma_f32_16x16x32_bf16 v[16:19], a[12:15], v[64:67], v[16:19]
    ds_read_b64_tr_b16 v[42:43], v252 offset:22528
    v_cvt_pk_bf16_f32 v30, v60, v61
    v_mfma_f32_16x16x32_bf16 v[56:59], a[60:63], v[64:67], 0
    ds_read_b64_tr_b16 v[88:89], v252 offset:24576
    v_cvt_pk_bf16_f32 v31, v62, v63
    v_mfma_f32_16x16x32_bf16 v[56:59], a[56:59], v[20:23], v[56:59]
    ds_read_b64_tr_b16 v[90:91], v252 offset:26624
    v_mfma_f32_16x16x32_bf16 v[56:59], a[52:55], v[12:15], v[56:59]
    ds_read_b64_tr_b16 v[60:61], v252 offset:28672
    v_mfma_f32_16x16x32_bf16 v[56:59], a[48:51], v[0:3], v[56:59]
    s_add_u32 m0, s29, 79872
    ds_read_b64_tr_b16 v[62:63], v252 offset:30720
    v_mfma_f32_16x16x32_bf16 v[92:95], a[96:99], v[0:3], 0
    global_load_lds_dwordx4 v247, s[12:13] offset:2048
    v_mfma_f32_16x16x32_bf16 v[92:95], a[100:103], v[12:15], v[92:95]
    v_mfma_f32_16x16x32_bf16 v[92:95], a[104:107], v[20:23], v[92:95]
    v_mfma_f32_16x16x32_bf16 v[92:95], a[108:111], v[64:67], v[92:95]
    v_mfma_f32_16x16x32_bf16 v[96:99], a[156:159], v[64:67], 0
    v_mfma_f32_16x16x32_bf16 v[96:99], a[152:155], v[20:23], v[96:99]
    v_mfma_f32_16x16x32_bf16 v[96:99], a[148:151], v[12:15], v[96:99]
    v_mfma_f32_16x16x32_bf16 v[96:99], a[144:147], v[0:3], v[96:99]
    v_mfma_f32_16x16x32_bf16 v[64:67], v[84:87], a[224:227], 0
    v_mfma_f32_16x16x32_bf16 v[64:67], v[28:31], a[228:231], v[64:67]
    v_mfma_f32_16x16x32_bf16 v[12:15], v[28:31], a[232:235], 0
    v_mfma_f32_16x16x32_bf16 v[12:15], v[84:87], a[236:239], v[12:15]
    v_mfma_f32_16x16x32_bf16 v[0:3], v[84:87], a[240:243], 0
    v_mfma_f32_16x16x32_bf16 v[0:3], v[28:31], a[244:247], v[0:3]
    v_mfma_f32_16x16x32_bf16 v[20:23], v[28:31], a[248:251], 0
    v_mfma_f32_16x16x32_bf16 v[20:23], v[84:87], a[252:255], v[20:23]
    s_waitcnt lgkmcnt(0)
    v_mfma_f32_16x16x32_bf16 v[96:99], a[160:163], v[32:35], v[96:99]
    ds_read_b64_tr_b16 v[28:29], v252 offset:32768
    v_cvt_pk_bf16_f32 v254, v64, v65
    v_mfma_f32_16x16x32_bf16 v[96:99], a[164:167], v[40:43], v[96:99]
    ds_read_b64_tr_b16 v[30:31], v252 offset:34816
    v_cvt_pk_bf16_f32 v253, v66, v67
    v_mfma_f32_16x16x32_bf16 v[96:99], a[168:171], v[88:91], v[96:99]
    ds_read_b64_tr_b16 v[84:85], v252 offset:36864
    v_accvgpr_write_b32 a208, v254
    v_mfma_f32_16x16x32_bf16 v[96:99], a[172:175], v[60:63], v[96:99]
    ds_read_b64_tr_b16 v[86:87], v252 offset:38912
    v_accvgpr_write_b32 a209, v253
    v_mfma_f32_16x16x32_bf16 v[92:95], a[124:127], v[60:63], v[92:95]
    ds_read_b64_tr_b16 v[64:65], v252 offset:40960
    v_cvt_pk_bf16_f32 v254, v12, v13
    v_mfma_f32_16x16x32_bf16 v[92:95], a[120:123], v[88:91], v[92:95]
    ds_read_b64_tr_b16 v[66:67], v252 offset:43008
    v_cvt_pk_bf16_f32 v253, v14, v15
    v_mfma_f32_16x16x32_bf16 v[92:95], a[116:119], v[40:43], v[92:95]
    ds_read_b64_tr_b16 v[104:105], v252 offset:45056
    v_accvgpr_write_b32 a212, v254
    v_mfma_f32_16x16x32_bf16 v[92:95], a[112:115], v[32:35], v[92:95]
    s_add_u32 m0, s29, 83968
    ds_read_b64_tr_b16 v[106:107], v252 offset:47104
    v_accvgpr_write_b32 a213, v253
    v_mfma_f32_16x16x32_bf16 v[56:59], a[64:67], v[32:35], v[56:59]
    global_load_lds_dwordx4 v247, s[14:15] offset:2048
    v_mfma_f32_16x16x32_bf16 v[56:59], a[68:71], v[40:43], v[56:59]
    v_cvt_pk_bf16_f32 v254, v0, v1
    v_cvt_pk_bf16_f32 v253, v2, v3
    v_mfma_f32_16x16x32_bf16 v[56:59], a[72:75], v[88:91], v[56:59]
    v_xor_b32 v252, 114752, v255
    v_accvgpr_write_b32 a216, v254
    v_mfma_f32_16x16x32_bf16 v[56:59], a[76:79], v[60:63], v[56:59]
    v_accvgpr_write_b32 a217, v253
    v_cvt_pk_bf16_f32 v251, v20, v21
    v_mfma_f32_16x16x32_bf16 v[16:19], a[28:31], v[60:63], v[16:19]
    v_cvt_pk_bf16_f32 v254, v22, v23
    v_accvgpr_write_b32 a220, v251
    v_mfma_f32_16x16x32_bf16 v[16:19], a[24:27], v[88:91], v[16:19]
    v_accvgpr_write_b32 a221, v254
    v_mfma_f32_16x16x32_bf16 v[16:19], a[20:23], v[40:43], v[16:19]
    v_mfma_f32_16x16x32_bf16 v[16:19], a[16:19], v[32:35], v[16:19]
    s_waitcnt lgkmcnt(0)
    v_mfma_f32_16x16x32_bf16 v[16:19], a[32:35], v[28:31], v[16:19]
    ds_read_b64_tr_b16 v[0:1], v252 offset:0
    v_mfma_f32_16x16x32_bf16 v[16:19], a[36:39], v[84:87], v[16:19]
    ds_read_b64_tr_b16 v[2:3], v252 offset:2048
    v_mfma_f32_16x16x32_bf16 v[16:19], a[40:43], v[64:67], v[16:19]
    ds_read_b64_tr_b16 v[12:13], v252 offset:4096
    v_mfma_f32_16x16x32_bf16 v[16:19], a[44:47], v[104:107], v[16:19]
    ds_read_b64_tr_b16 v[14:15], v252 offset:6144
    v_mfma_f32_16x16x32_bf16 v[56:59], a[92:95], v[104:107], v[56:59]
    ds_read_b64_tr_b16 v[20:21], v252 offset:8192
    v_mfma_f32_16x16x32_bf16 v[56:59], a[88:91], v[64:67], v[56:59]
    ds_read_b64_tr_b16 v[22:23], v252 offset:10240
G_14:
    s_cbranch_vccnz G_18
    v_mfma_f32_16x16x32_bf16 v[56:59], a[84:87], v[84:87], v[56:59]
    ds_read_b64_tr_b16 v[32:33], v252 offset:12288
    v_mfma_f32_16x16x32_bf16 v[56:59], a[80:83], v[28:31], v[56:59]
    s_add_u32 m0, s29, 88064
    ds_read_b64_tr_b16 v[34:35], v252 offset:14336
    v_cvt_pk_bf16_f32 v40, v16, v17
    v_mfma_f32_16x16x32_bf16 v[92:95], a[128:131], v[28:31], v[92:95]
    global_load_lds_dwordx4 v247, s[16:17] offset:2048
    v_mfma_f32_16x16x32_bf16 v[92:95], a[132:135], v[84:87], v[92:95]
    v_cvt_pk_bf16_f32 v41, v18, v19
    v_mfma_f32_16x16x32_bf16 v[92:95], a[136:139], v[64:67], v[92:95]
    v_cvt_pk_bf16_f32 v42, v56, v57
    v_cvt_pk_bf16_f32 v43, v58, v59
    v_mfma_f32_16x16x32_bf16 v[92:95], a[140:143], v[104:107], v[92:95]
    v_mfma_f32_16x16x32_bf16 v[96:99], a[188:191], v[104:107], v[96:99]
    v_mfma_f32_16x16x32_bf16 v[96:99], a[184:187], v[64:67], v[96:99]
    v_mfma_f32_16x16x32_bf16 v[96:99], a[180:183], v[84:87], v[96:99]
    v_mfma_f32_16x16x32_bf16 v[96:99], a[176:179], v[28:31], v[96:99]
    s_waitcnt lgkmcnt(0)
    v_mfma_f32_16x16x32_bf16 v[16:19], a[0:3], v[0:3], 0
    ds_read_b64_tr_b16 v[56:57], v252 offset:16384
    v_mfma_f32_16x16x32_bf16 v[16:19], a[4:7], v[12:15], v[16:19]
    ds_read_b64_tr_b16 v[58:59], v252 offset:18432
    v_cvt_pk_bf16_f32 v28, v92, v93
    v_mfma_f32_16x16x32_bf16 v[16:19], a[8:11], v[20:23], v[16:19]
    ds_read_b64_tr_b16 v[60:61], v252 offset:20480
    v_cvt_pk_bf16_f32 v29, v94, v95
    v_mfma_f32_16x16x32_bf16 v[16:19], a[12:15], v[32:35], v[16:19]
    ds_read_b64_tr_b16 v[62:63], v252 offset:22528
    v_cvt_pk_bf16_f32 v30, v96, v97
    v_mfma_f32_16x16x32_bf16 v[64:67], a[60:63], v[32:35], 0
    ds_read_b64_tr_b16 v[84:85], v252 offset:24576
    v_cvt_pk_bf16_f32 v31, v98, v99
    v_mfma_f32_16x16x32_bf16 v[64:67], a[56:59], v[20:23], v[64:67]
    ds_read_b64_tr_b16 v[86:87], v252 offset:26624
    v_mfma_f32_16x16x32_bf16 v[64:67], a[52:55], v[12:15], v[64:67]
    ds_read_b64_tr_b16 v[88:89], v252 offset:28672
    v_mfma_f32_16x16x32_bf16 v[64:67], a[48:51], v[0:3], v[64:67]
    s_add_u32 m0, s29, 92160
    ds_read_b64_tr_b16 v[90:91], v252 offset:30720
    v_mfma_f32_16x16x32_bf16 v[92:95], a[96:99], v[0:3], 0
    global_load_lds_dwordx4 v247, s[18:19] offset:2048
    v_mfma_f32_16x16x32_bf16 v[92:95], a[100:103], v[12:15], v[92:95]
    v_mfma_f32_16x16x32_bf16 v[92:95], a[104:107], v[20:23], v[92:95]
    v_mfma_f32_16x16x32_bf16 v[92:95], a[108:111], v[32:35], v[92:95]
    v_mfma_f32_16x16x32_bf16 v[96:99], a[156:159], v[32:35], 0
    v_mfma_f32_16x16x32_bf16 v[96:99], a[152:155], v[20:23], v[96:99]
    v_mfma_f32_16x16x32_bf16 v[96:99], a[148:151], v[12:15], v[96:99]
    v_mfma_f32_16x16x32_bf16 v[96:99], a[144:147], v[0:3], v[96:99]
    v_mfma_f32_16x16x32_bf16 v[32:35], v[40:43], a[224:227], 0
    v_mfma_f32_16x16x32_bf16 v[32:35], v[28:31], a[228:231], v[32:35]
    v_mfma_f32_16x16x32_bf16 v[12:15], v[28:31], a[232:235], 0
    v_mfma_f32_16x16x32_bf16 v[12:15], v[40:43], a[236:239], v[12:15]
    v_mfma_f32_16x16x32_bf16 v[0:3], v[40:43], a[240:243], 0
    v_mfma_f32_16x16x32_bf16 v[0:3], v[28:31], a[244:247], v[0:3]
    v_mfma_f32_16x16x32_bf16 v[20:23], v[28:31], a[248:251], 0
    v_mfma_f32_16x16x32_bf16 v[20:23], v[40:43], a[252:255], v[20:23]
    s_waitcnt lgkmcnt(0)
    v_mfma_f32_16x16x32_bf16 v[96:99], a[160:163], v[56:59], v[96:99]
    ds_read_b64_tr_b16 v[28:29], v252 offset:32768
    v_cvt_pk_bf16_f32 v254, v32, v33
    v_mfma_f32_16x16x32_bf16 v[96:99], a[164:167], v[60:63], v[96:99]
    ds_read_b64_tr_b16 v[30:31], v252 offset:34816
    v_cvt_pk_bf16_f32 v253, v34, v35
    v_mfma_f32_16x16x32_bf16 v[96:99], a[168:171], v[84:87], v[96:99]
    ds_read_b64_tr_b16 v[40:41], v252 offset:36864
    v_accvgpr_write_b32 a210, v254
    v_mfma_f32_16x16x32_bf16 v[96:99], a[172:175], v[88:91], v[96:99]
    ds_read_b64_tr_b16 v[42:43], v252 offset:38912
    v_accvgpr_write_b32 a211, v253
    v_mfma_f32_16x16x32_bf16 v[92:95], a[124:127], v[88:91], v[92:95]
    ds_read_b64_tr_b16 v[32:33], v252 offset:40960
    v_cvt_pk_bf16_f32 v254, v12, v13
    v_mfma_f32_16x16x32_bf16 v[92:95], a[120:123], v[84:87], v[92:95]
    ds_read_b64_tr_b16 v[34:35], v252 offset:43008
    v_cvt_pk_bf16_f32 v253, v14, v15
    v_mfma_f32_16x16x32_bf16 v[92:95], a[116:119], v[60:63], v[92:95]
    ds_read_b64_tr_b16 v[104:105], v252 offset:45056
    v_accvgpr_write_b32 a214, v254
    v_mfma_f32_16x16x32_bf16 v[92:95], a[112:115], v[56:59], v[92:95]
    s_add_u32 m0, s29, 96256
    ds_read_b64_tr_b16 v[106:107], v252 offset:47104
    v_accvgpr_write_b32 a215, v253
    v_mfma_f32_16x16x32_bf16 v[64:67], a[64:67], v[56:59], v[64:67]
    global_load_lds_dwordx4 v247, s[20:21] offset:2048
    v_mfma_f32_16x16x32_bf16 v[64:67], a[68:71], v[60:63], v[64:67]
    v_cvt_pk_bf16_f32 v254, v0, v1
    v_cvt_pk_bf16_f32 v253, v2, v3
    v_mfma_f32_16x16x32_bf16 v[64:67], a[72:75], v[84:87], v[64:67]
    v_xor_b32 v252, 114784, v255
    v_accvgpr_write_b32 a218, v254
    v_mfma_f32_16x16x32_bf16 v[64:67], a[76:79], v[88:91], v[64:67]
    v_accvgpr_write_b32 a219, v253
    v_cvt_pk_bf16_f32 v251, v20, v21
    v_mfma_f32_16x16x32_bf16 v[16:19], a[28:31], v[88:91], v[16:19]
    v_cvt_pk_bf16_f32 v254, v22, v23
    v_accvgpr_write_b32 a222, v251
    v_mfma_f32_16x16x32_bf16 v[16:19], a[24:27], v[84:87], v[16:19]
    v_accvgpr_write_b32 a223, v254
    v_mfma_f32_16x16x32_bf16 v[16:19], a[20:23], v[60:63], v[16:19]
    v_mfma_f32_16x16x32_bf16 v[16:19], a[16:19], v[56:59], v[16:19]
    s_waitcnt lgkmcnt(0)
    v_mfma_f32_16x16x32_bf16 v[16:19], a[32:35], v[28:31], v[16:19]
    ds_read_b64_tr_b16 v[0:1], v252 offset:0
    v_mfma_f32_16x16x32_bf16 v[16:19], a[36:39], v[40:43], v[16:19]
    ds_read_b64_tr_b16 v[2:3], v252 offset:2048
    v_mfma_f32_16x16x32_bf16 v[16:19], a[40:43], v[32:35], v[16:19]
    ds_read_b64_tr_b16 v[12:13], v252 offset:4096
    v_mfma_f32_16x16x32_bf16 v[16:19], a[44:47], v[104:107], v[16:19]
    ds_read_b64_tr_b16 v[14:15], v252 offset:6144
    v_mfma_f32_16x16x32_bf16 v[64:67], a[92:95], v[104:107], v[64:67]
    ds_read_b64_tr_b16 v[20:21], v252 offset:8192
    v_mfma_f32_16x16x32_bf16 v[64:67], a[88:91], v[32:35], v[64:67]
    ds_read_b64_tr_b16 v[22:23], v252 offset:10240
    v_mfma_f32_16x16x32_bf16 v[64:67], a[84:87], v[40:43], v[64:67]
    ds_read_b64_tr_b16 v[56:57], v252 offset:12288
    v_mfma_f32_16x16x32_bf16 v[64:67], a[80:83], v[28:31], v[64:67]
    s_add_u32 m0, s29, 100352
    ds_read_b64_tr_b16 v[58:59], v252 offset:14336
    v_cvt_pk_bf16_f32 v60, v16, v17
    v_mfma_f32_16x16x32_bf16 v[92:95], a[128:131], v[28:31], v[92:95]
    global_load_lds_dwordx4 v247, s[22:23] offset:2048
    v_mfma_f32_16x16x32_bf16 v[92:95], a[132:135], v[40:43], v[92:95]
    v_cvt_pk_bf16_f32 v61, v18, v19
    v_mfma_f32_16x16x32_bf16 v[92:95], a[136:139], v[32:35], v[92:95]
    v_cvt_pk_bf16_f32 v62, v64, v65
    v_cvt_pk_bf16_f32 v63, v66, v67
    v_mfma_f32_16x16x32_bf16 v[92:95], a[140:143], v[104:107], v[92:95]
    v_mfma_f32_16x16x32_bf16 v[96:99], a[188:191], v[104:107], v[96:99]
    v_mfma_f32_16x16x32_bf16 v[96:99], a[184:187], v[32:35], v[96:99]
    v_mfma_f32_16x16x32_bf16 v[96:99], a[180:183], v[40:43], v[96:99]
    v_mfma_f32_16x16x32_bf16 v[96:99], a[176:179], v[28:31], v[96:99]
    s_waitcnt lgkmcnt(0)
    v_mfma_f32_16x16x32_bf16 v[16:19], a[0:3], v[0:3], 0
    ds_read_b64_tr_b16 v[32:33], v252 offset:16384
    v_mfma_f32_16x16x32_bf16 v[16:19], a[4:7], v[12:15], v[16:19]
    ds_read_b64_tr_b16 v[34:35], v252 offset:18432
    v_cvt_pk_bf16_f32 v28, v92, v93
    v_mfma_f32_16x16x32_bf16 v[16:19], a[8:11], v[20:23], v[16:19]
    ds_read_b64_tr_b16 v[40:41], v252 offset:20480
    v_cvt_pk_bf16_f32 v29, v94, v95
    v_mfma_f32_16x16x32_bf16 v[16:19], a[12:15], v[56:59], v[16:19]
    ds_read_b64_tr_b16 v[42:43], v252 offset:22528
    v_cvt_pk_bf16_f32 v30, v96, v97
    v_mfma_f32_16x16x32_bf16 v[64:67], a[60:63], v[56:59], 0
    ds_read_b64_tr_b16 v[84:85], v252 offset:24576
    v_cvt_pk_bf16_f32 v31, v98, v99
    v_mfma_f32_16x16x32_bf16 v[64:67], a[56:59], v[20:23], v[64:67]
    ds_read_b64_tr_b16 v[86:87], v252 offset:26624
    v_mfma_f32_16x16x32_bf16 v[64:67], a[52:55], v[12:15], v[64:67]
    ds_read_b64_tr_b16 v[88:89], v252 offset:28672
    v_mfma_f32_16x16x32_bf16 v[64:67], a[48:51], v[0:3], v[64:67]
    s_add_u32 m0, s29, 104448
    ds_read_b64_tr_b16 v[90:91], v252 offset:30720
    v_mfma_f32_16x16x32_bf16 v[92:95], a[96:99], v[0:3], 0
    global_load_lds_dwordx4 v247, s[24:25] offset:2048
    v_mfma_f32_16x16x32_bf16 v[92:95], a[100:103], v[12:15], v[92:95]
    v_mfma_f32_16x16x32_bf16 v[92:95], a[104:107], v[20:23], v[92:95]
    v_mfma_f32_16x16x32_bf16 v[92:95], a[108:111], v[56:59], v[92:95]
    v_mfma_f32_16x16x32_bf16 v[96:99], a[156:159], v[56:59], 0
    v_mfma_f32_16x16x32_bf16 v[96:99], a[152:155], v[20:23], v[96:99]
    v_mfma_f32_16x16x32_bf16 v[96:99], a[148:151], v[12:15], v[96:99]
    v_mfma_f32_16x16x32_bf16 v[96:99], a[144:147], v[0:3], v[96:99]
    v_mfma_f32_16x16x32_bf16 v[56:59], v[60:63], a[224:227], 0
    v_mfma_f32_16x16x32_bf16 v[56:59], v[28:31], a[228:231], v[56:59]
    v_mfma_f32_16x16x32_bf16 v[12:15], v[28:31], a[232:235], 0
    v_mfma_f32_16x16x32_bf16 v[12:15], v[60:63], a[236:239], v[12:15]
    v_mfma_f32_16x16x32_bf16 v[0:3], v[60:63], a[240:243], 0
    v_mfma_f32_16x16x32_bf16 v[0:3], v[28:31], a[244:247], v[0:3]
    v_mfma_f32_16x16x32_bf16 v[20:23], v[28:31], a[248:251], 0
    v_mfma_f32_16x16x32_bf16 v[20:23], v[60:63], a[252:255], v[20:23]
    s_waitcnt lgkmcnt(0)
    v_mfma_f32_16x16x32_bf16 v[96:99], a[160:163], v[32:35], v[96:99]
    ds_read_b64_tr_b16 v[28:29], v252 offset:32768
    v_cvt_pk_bf16_f32 v60, v56, v57
    v_mfma_f32_16x16x32_bf16 v[96:99], a[164:167], v[40:43], v[96:99]
    ds_read_b64_tr_b16 v[30:31], v252 offset:34816
    v_cvt_pk_bf16_f32 v61, v58, v59
    v_mfma_f32_16x16x32_bf16 v[96:99], a[168:171], v[84:87], v[96:99]
    ds_read_b64_tr_b16 v[104:105], v252 offset:36864
    v_cvt_pk_bf16_f32 v124, v12, v13
    v_mfma_f32_16x16x32_bf16 v[96:99], a[172:175], v[88:91], v[96:99]
    ds_read_b64_tr_b16 v[106:107], v252 offset:38912
    v_cvt_pk_bf16_f32 v125, v14, v15
    v_mfma_f32_16x16x32_bf16 v[92:95], a[124:127], v[88:91], v[92:95]
    ds_read_b64_tr_b16 v[56:57], v252 offset:40960
    v_cvt_pk_bf16_f32 v140, v0, v1
    v_mfma_f32_16x16x32_bf16 v[92:95], a[120:123], v[84:87], v[92:95]
    ds_read_b64_tr_b16 v[58:59], v252 offset:43008
    v_cvt_pk_bf16_f32 v141, v2, v3
    v_mfma_f32_16x16x32_bf16 v[92:95], a[116:119], v[40:43], v[92:95]
    ds_read_b64_tr_b16 v[12:13], v252 offset:45056
    v_cvt_pk_bf16_f32 v148, v20, v21
    v_mfma_f32_16x16x32_bf16 v[92:95], a[112:115], v[32:35], v[92:95]
    s_add_u32 m0, s29, 108544
    ds_read_b64_tr_b16 v[14:15], v252 offset:47104
    v_cvt_pk_bf16_f32 v149, v22, v23
    v_mfma_f32_16x16x32_bf16 v[64:67], a[64:67], v[32:35], v[64:67]
    global_load_lds_dwordx4 v247, s[26:27] offset:2048
    v_mfma_f32_16x16x32_bf16 v[64:67], a[68:71], v[40:43], v[64:67]
    v_mfma_f32_16x16x32_bf16 v[64:67], a[72:75], v[84:87], v[64:67]
    v_xor_b32 v254, 16384, v255
    v_mfma_f32_16x16x32_bf16 v[64:67], a[76:79], v[88:91], v[64:67]
    v_mfma_f32_16x16x32_bf16 v[16:19], a[28:31], v[88:91], v[16:19]
    v_mfma_f32_16x16x32_bf16 v[16:19], a[24:27], v[84:87], v[16:19]
    v_mfma_f32_16x16x32_bf16 v[16:19], a[20:23], v[40:43], v[16:19]
    v_mfma_f32_16x16x32_bf16 v[16:19], a[16:19], v[32:35], v[16:19]
    s_waitcnt vmcnt(12) lgkmcnt(0)
    s_barrier
    v_mfma_f32_16x16x32_bf16 v[16:19], a[32:35], v[28:31], v[16:19]
    ds_read_b64_tr_b16 v[0:1], v254 offset:0
    v_mfma_f32_16x16x32_bf16 v[16:19], a[36:39], v[104:107], v[16:19]
    ds_read_b64_tr_b16 v[2:3], v254 offset:2048
    v_mfma_f32_16x16x32_bf16 v[16:19], a[40:43], v[56:59], v[16:19]
    ds_read_b64_tr_b16 v[20:21], v254 offset:4096
    v_mfma_f32_16x16x32_bf16 v[16:19], a[44:47], v[12:15], v[16:19]
    ds_read_b64_tr_b16 v[22:23], v254 offset:6144
    v_mfma_f32_16x16x32_bf16 v[64:67], a[92:95], v[12:15], v[64:67]
    ds_read_b64_tr_b16 v[32:33], v254 offset:8192
    v_mfma_f32_16x16x32_bf16 v[64:67], a[88:91], v[56:59], v[64:67]
    ds_read_b64_tr_b16 v[34:35], v254 offset:10240
    v_mfma_f32_16x16x32_bf16 v[64:67], a[84:87], v[104:107], v[64:67]
    ds_read_b64_tr_b16 v[40:41], v254 offset:12288
    v_mfma_f32_16x16x32_bf16 v[64:67], a[80:83], v[28:31], v[64:67]
    s_add_u32 m0, s29, 112512
    ds_read_b64_tr_b16 v[42:43], v254 offset:14336
    v_cvt_pk_bf16_f32 v84, v16, v17
    v_mfma_f32_16x16x32_bf16 v[92:95], a[128:131], v[28:31], v[92:95]
    global_load_lds_dwordx4 v247, s[4:5] offset:2176
    v_mfma_f32_16x16x32_bf16 v[92:95], a[132:135], v[104:107], v[92:95]
    v_cvt_pk_bf16_f32 v85, v18, v19
    v_mfma_f32_16x16x32_bf16 v[92:95], a[136:139], v[56:59], v[92:95]
    v_cvt_pk_bf16_f32 v86, v64, v65
    v_cvt_pk_bf16_f32 v87, v66, v67
    v_mfma_f32_16x16x32_bf16 v[92:95], a[140:143], v[12:15], v[92:95]
    v_mfma_f32_16x16x32_bf16 v[96:99], a[188:191], v[12:15], v[96:99]
    v_mfma_f32_16x16x32_bf16 v[96:99], a[184:187], v[56:59], v[96:99]
    v_mfma_f32_16x16x32_bf16 v[96:99], a[180:183], v[104:107], v[96:99]
    v_mfma_f32_16x16x32_bf16 v[96:99], a[176:179], v[28:31], v[96:99]
    s_waitcnt lgkmcnt(0)
    v_mfma_f32_16x16x32_bf16 v[12:15], a[0:3], v[0:3], 0
    ds_read_b64_tr_b16 v[16:17], v254 offset:16384
    v_mfma_f32_16x16x32_bf16 v[12:15], a[4:7], v[20:23], v[12:15]
    ds_read_b64_tr_b16 v[18:19], v254 offset:18432
    v_cvt_pk_bf16_f32 v28, v92, v93
    v_mfma_f32_16x16x32_bf16 v[12:15], a[8:11], v[32:35], v[12:15]
    ds_read_b64_tr_b16 v[56:57], v254 offset:20480
    v_cvt_pk_bf16_f32 v29, v94, v95
    v_mfma_f32_16x16x32_bf16 v[12:15], a[12:15], v[40:43], v[12:15]
    ds_read_b64_tr_b16 v[58:59], v254 offset:22528
    v_cvt_pk_bf16_f32 v30, v96, v97
    v_mfma_f32_16x16x32_bf16 v[64:67], a[60:63], v[40:43], 0
    ds_read_b64_tr_b16 v[88:89], v254 offset:24576
    v_cvt_pk_bf16_f32 v31, v98, v99
    v_mfma_f32_16x16x32_bf16 v[64:67], a[56:59], v[32:35], v[64:67]
    ds_read_b64_tr_b16 v[90:91], v254 offset:26624
    v_mfma_f32_16x16x32_bf16 v[64:67], a[52:55], v[20:23], v[64:67]
    ds_read_b64_tr_b16 v[92:93], v254 offset:28672
    v_mfma_f32_16x16x32_bf16 v[64:67], a[48:51], v[0:3], v[64:67]
    s_add_u32 m0, s29, 116608
    ds_read_b64_tr_b16 v[94:95], v254 offset:30720
    v_mfma_f32_16x16x32_bf16 v[96:99], a[96:99], v[0:3], 0
    global_load_lds_dwordx4 v247, s[6:7] offset:2176
    v_mfma_f32_16x16x32_bf16 v[96:99], a[100:103], v[20:23], v[96:99]
    v_mfma_f32_16x16x32_bf16 v[96:99], a[104:107], v[32:35], v[96:99]
    v_mfma_f32_16x16x32_bf16 v[96:99], a[108:111], v[40:43], v[96:99]
    v_mfma_f32_16x16x32_bf16 v[104:107], a[156:159], v[40:43], 0
    v_mfma_f32_16x16x32_bf16 v[104:107], a[152:155], v[32:35], v[104:107]
    v_mfma_f32_16x16x32_bf16 v[104:107], a[148:151], v[20:23], v[104:107]
    v_mfma_f32_16x16x32_bf16 v[104:107], a[144:147], v[0:3], v[104:107]
    v_mfma_f32_16x16x32_bf16 v[40:43], v[84:87], a[224:227], 0
    v_mfma_f32_16x16x32_bf16 v[40:43], v[28:31], a[228:231], v[40:43]
    v_mfma_f32_16x16x32_bf16 v[20:23], v[28:31], a[232:235], 0
    v_mfma_f32_16x16x32_bf16 v[20:23], v[84:87], a[236:239], v[20:23]
    v_mfma_f32_16x16x32_bf16 v[0:3], v[84:87], a[240:243], 0
    v_mfma_f32_16x16x32_bf16 v[0:3], v[28:31], a[244:247], v[0:3]
    v_mfma_f32_16x16x32_bf16 v[32:35], v[28:31], a[248:251], 0
    v_mfma_f32_16x16x32_bf16 v[32:35], v[84:87], a[252:255], v[32:35]
    s_waitcnt lgkmcnt(0)
    v_mfma_f32_16x16x32_bf16 v[104:107], a[160:163], v[16:19], v[104:107]
    ds_read_b64_tr_b16 v[28:29], v254 offset:32768
    v_cvt_pk_bf16_f32 v62, v40, v41
    v_mfma_f32_16x16x32_bf16 v[104:107], a[164:167], v[56:59], v[104:107]
    ds_read_b64_tr_b16 v[30:31], v254 offset:34816
    v_cvt_pk_bf16_f32 v63, v42, v43
    v_mfma_f32_16x16x32_bf16 v[104:107], a[168:171], v[88:91], v[104:107]
    ds_read_b64_tr_b16 v[84:85], v254 offset:36864
    v_cvt_pk_bf16_f32 v126, v20, v21
    v_mfma_f32_16x16x32_bf16 v[104:107], a[172:175], v[92:95], v[104:107]
    ds_read_b64_tr_b16 v[86:87], v254 offset:38912
    v_cvt_pk_bf16_f32 v127, v22, v23
    v_mfma_f32_16x16x32_bf16 v[96:99], a[124:127], v[92:95], v[96:99]
    ds_read_b64_tr_b16 v[40:41], v254 offset:40960
    v_cvt_pk_bf16_f32 v142, v0, v1
    v_mfma_f32_16x16x32_bf16 v[96:99], a[120:123], v[88:91], v[96:99]
    ds_read_b64_tr_b16 v[42:43], v254 offset:43008
    v_cvt_pk_bf16_f32 v143, v2, v3
    v_mfma_f32_16x16x32_bf16 v[96:99], a[116:119], v[56:59], v[96:99]
    ds_read_b64_tr_b16 v[20:21], v254 offset:45056
    v_cvt_pk_bf16_f32 v150, v32, v33
    v_mfma_f32_16x16x32_bf16 v[96:99], a[112:115], v[16:19], v[96:99]
    s_add_u32 m0, s29, 120704
    ds_read_b64_tr_b16 v[22:23], v254 offset:47104
    v_cvt_pk_bf16_f32 v151, v34, v35
    v_mfma_f32_16x16x32_bf16 v[64:67], a[64:67], v[16:19], v[64:67]
    global_load_lds_dwordx4 v247, s[8:9] offset:2176
    v_mfma_f32_16x16x32_bf16 v[64:67], a[68:71], v[56:59], v[64:67]
    v_mfma_f32_16x16x32_bf16 v[64:67], a[72:75], v[88:91], v[64:67]
    v_xor_b32 v254, 16416, v255
    v_mfma_f32_16x16x32_bf16 v[64:67], a[76:79], v[92:95], v[64:67]
    v_mfma_f32_16x16x32_bf16 v[12:15], a[28:31], v[92:95], v[12:15]
    v_mfma_f32_16x16x32_bf16 v[12:15], a[24:27], v[88:91], v[12:15]
    v_mfma_f32_16x16x32_bf16 v[12:15], a[20:23], v[56:59], v[12:15]
    v_mfma_f32_16x16x32_bf16 v[12:15], a[16:19], v[16:19], v[12:15]
    s_waitcnt lgkmcnt(0)
    v_mfma_f32_16x16x32_bf16 v[12:15], a[32:35], v[28:31], v[12:15]
    ds_read_b64_tr_b16 v[0:1], v254 offset:0
    v_mfma_f32_16x16x32_bf16 v[12:15], a[36:39], v[84:87], v[12:15]
    ds_read_b64_tr_b16 v[2:3], v254 offset:2048
    v_mfma_f32_16x16x32_bf16 v[12:15], a[40:43], v[40:43], v[12:15]
    ds_read_b64_tr_b16 v[16:17], v254 offset:4096
    v_mfma_f32_16x16x32_bf16 v[12:15], a[44:47], v[20:23], v[12:15]
    ds_read_b64_tr_b16 v[18:19], v254 offset:6144
    v_mfma_f32_16x16x32_bf16 v[64:67], a[92:95], v[20:23], v[64:67]
    ds_read_b64_tr_b16 v[32:33], v254 offset:8192
    v_mfma_f32_16x16x32_bf16 v[64:67], a[88:91], v[40:43], v[64:67]
    ds_read_b64_tr_b16 v[34:35], v254 offset:10240
    v_mfma_f32_16x16x32_bf16 v[64:67], a[84:87], v[84:87], v[64:67]
    ds_read_b64_tr_b16 v[56:57], v254 offset:12288
    v_mfma_f32_16x16x32_bf16 v[64:67], a[80:83], v[28:31], v[64:67]
    s_add_u32 m0, s29, 124800
    ds_read_b64_tr_b16 v[58:59], v254 offset:14336
    v_cvt_pk_bf16_f32 v88, v12, v13
    v_mfma_f32_16x16x32_bf16 v[96:99], a[128:131], v[28:31], v[96:99]
    global_load_lds_dwordx4 v247, s[10:11] offset:2176
    v_mfma_f32_16x16x32_bf16 v[96:99], a[132:135], v[84:87], v[96:99]
    v_cvt_pk_bf16_f32 v89, v14, v15
    v_mfma_f32_16x16x32_bf16 v[96:99], a[136:139], v[40:43], v[96:99]
    v_cvt_pk_bf16_f32 v90, v64, v65
    v_cvt_pk_bf16_f32 v91, v66, v67
    v_mfma_f32_16x16x32_bf16 v[96:99], a[140:143], v[20:23], v[96:99]
    v_mfma_f32_16x16x32_bf16 v[104:107], a[188:191], v[20:23], v[104:107]
    v_mfma_f32_16x16x32_bf16 v[104:107], a[184:187], v[40:43], v[104:107]
    v_mfma_f32_16x16x32_bf16 v[104:107], a[180:183], v[84:87], v[104:107]
    v_mfma_f32_16x16x32_bf16 v[104:107], a[176:179], v[28:31], v[104:107]
    s_waitcnt lgkmcnt(0)
    v_mfma_f32_16x16x32_bf16 v[12:15], a[0:3], v[0:3], 0
    ds_read_b64_tr_b16 v[20:21], v254 offset:16384
    v_mfma_f32_16x16x32_bf16 v[12:15], a[4:7], v[16:19], v[12:15]
    ds_read_b64_tr_b16 v[22:23], v254 offset:18432
    v_cvt_pk_bf16_f32 v28, v96, v97
    v_mfma_f32_16x16x32_bf16 v[12:15], a[8:11], v[32:35], v[12:15]
    ds_read_b64_tr_b16 v[40:41], v254 offset:20480
    v_cvt_pk_bf16_f32 v29, v98, v99
    v_mfma_f32_16x16x32_bf16 v[12:15], a[12:15], v[56:59], v[12:15]
    ds_read_b64_tr_b16 v[42:43], v254 offset:22528
    v_cvt_pk_bf16_f32 v30, v104, v105
    v_mfma_f32_16x16x32_bf16 v[64:67], a[60:63], v[56:59], 0
    ds_read_b64_tr_b16 v[84:85], v254 offset:24576
    v_cvt_pk_bf16_f32 v31, v106, v107
    v_mfma_f32_16x16x32_bf16 v[64:67], a[56:59], v[32:35], v[64:67]
    ds_read_b64_tr_b16 v[86:87], v254 offset:26624
    v_mfma_f32_16x16x32_bf16 v[64:67], a[52:55], v[16:19], v[64:67]
    ds_read_b64_tr_b16 v[92:93], v254 offset:28672
    v_mfma_f32_16x16x32_bf16 v[64:67], a[48:51], v[0:3], v[64:67]
    s_add_u32 m0, s29, 128896
    ds_read_b64_tr_b16 v[94:95], v254 offset:30720
    v_mfma_f32_16x16x32_bf16 v[96:99], a[96:99], v[0:3], 0
    global_load_lds_dwordx4 v247, s[12:13] offset:2176
    v_mfma_f32_16x16x32_bf16 v[96:99], a[100:103], v[16:19], v[96:99]
    v_mfma_f32_16x16x32_bf16 v[96:99], a[104:107], v[32:35], v[96:99]
    v_mfma_f32_16x16x32_bf16 v[96:99], a[108:111], v[56:59], v[96:99]
    v_mfma_f32_16x16x32_bf16 v[104:107], a[156:159], v[56:59], 0
    v_mfma_f32_16x16x32_bf16 v[104:107], a[152:155], v[32:35], v[104:107]
    v_mfma_f32_16x16x32_bf16 v[104:107], a[148:151], v[16:19], v[104:107]
    v_mfma_f32_16x16x32_bf16 v[104:107], a[144:147], v[0:3], v[104:107]
    v_mfma_f32_16x16x32_bf16 v[56:59], v[88:91], v[100:103], 0
    v_mfma_f32_16x16x32_bf16 v[56:59], v[28:31], v[68:71], v[56:59]
    v_mfma_f32_16x16x32_bf16 v[16:19], v[28:31], v[136:139], 0
    v_mfma_f32_16x16x32_bf16 v[16:19], v[88:91], v[80:83], v[16:19]
    v_mfma_f32_16x16x32_bf16 v[0:3], v[88:91], v[152:155], 0
    v_mfma_f32_16x16x32_bf16 v[0:3], v[28:31], v[52:55], v[0:3]
    v_mfma_f32_16x16x32_bf16 v[32:35], v[28:31], v[112:115], 0
    v_mfma_f32_16x16x32_bf16 v[32:35], v[88:91], v[172:175], v[32:35]
    s_waitcnt lgkmcnt(0)
    v_mfma_f32_16x16x32_bf16 v[104:107], a[160:163], v[20:23], v[104:107]
    ds_read_b64_tr_b16 v[28:29], v254 offset:32768
    v_cvt_pk_bf16_f32 v253, v56, v57
    v_mfma_f32_16x16x32_bf16 v[104:107], a[164:167], v[40:43], v[104:107]
    ds_read_b64_tr_b16 v[30:31], v254 offset:34816
    v_cvt_pk_bf16_f32 v252, v58, v59
    v_mfma_f32_16x16x32_bf16 v[104:107], a[168:171], v[84:87], v[104:107]
    ds_read_b64_tr_b16 v[88:89], v254 offset:36864
    v_accvgpr_write_b32 a224, v253
    v_mfma_f32_16x16x32_bf16 v[104:107], a[172:175], v[92:95], v[104:107]
    ds_read_b64_tr_b16 v[90:91], v254 offset:38912
    v_accvgpr_write_b32 a225, v252
    v_mfma_f32_16x16x32_bf16 v[96:99], a[124:127], v[92:95], v[96:99]
    ds_read_b64_tr_b16 v[56:57], v254 offset:40960
    v_cvt_pk_bf16_f32 v253, v16, v17
    v_mfma_f32_16x16x32_bf16 v[96:99], a[120:123], v[84:87], v[96:99]
    ds_read_b64_tr_b16 v[58:59], v254 offset:43008
    v_cvt_pk_bf16_f32 v252, v18, v19
    v_mfma_f32_16x16x32_bf16 v[96:99], a[116:119], v[40:43], v[96:99]
    ds_read_b64_tr_b16 v[164:165], v254 offset:45056
    v_accvgpr_write_b32 a228, v253
    v_mfma_f32_16x16x32_bf16 v[96:99], a[112:115], v[20:23], v[96:99]
    s_add_u32 m0, s29, 132992
    ds_read_b64_tr_b16 v[166:167], v254 offset:47104
    v_accvgpr_write_b32 a229, v252
    v_mfma_f32_16x16x32_bf16 v[64:67], a[64:67], v[20:23], v[64:67]
    global_load_lds_dwordx4 v247, s[14:15] offset:2176
    v_mfma_f32_16x16x32_bf16 v[64:67], a[68:71], v[40:43], v[64:67]
    v_cvt_pk_bf16_f32 v254, v0, v1
    v_cvt_pk_bf16_f32 v253, v2, v3
    v_mfma_f32_16x16x32_bf16 v[64:67], a[72:75], v[84:87], v[64:67]
    v_xor_b32 v252, 16448, v255
    v_accvgpr_write_b32 a232, v254
    v_mfma_f32_16x16x32_bf16 v[64:67], a[76:79], v[92:95], v[64:67]
    v_accvgpr_write_b32 a233, v253
    v_cvt_pk_bf16_f32 v251, v32, v33
    v_mfma_f32_16x16x32_bf16 v[12:15], a[28:31], v[92:95], v[12:15]
    v_cvt_pk_bf16_f32 v254, v34, v35
    v_accvgpr_write_b32 a236, v251
    v_mfma_f32_16x16x32_bf16 v[12:15], a[24:27], v[84:87], v[12:15]
    v_accvgpr_write_b32 a237, v254
    v_mfma_f32_16x16x32_bf16 v[12:15], a[20:23], v[40:43], v[12:15]
    v_mfma_f32_16x16x32_bf16 v[12:15], a[16:19], v[20:23], v[12:15]
    s_waitcnt lgkmcnt(0)
    v_mfma_f32_16x16x32_bf16 v[12:15], a[32:35], v[28:31], v[12:15]
    ds_read_b64_tr_b16 v[0:1], v252 offset:0
    v_mfma_f32_16x16x32_bf16 v[12:15], a[36:39], v[88:91], v[12:15]
    ds_read_b64_tr_b16 v[2:3], v252 offset:2048
    v_mfma_f32_16x16x32_bf16 v[12:15], a[40:43], v[56:59], v[12:15]
    ds_read_b64_tr_b16 v[16:17], v252 offset:4096
    v_mfma_f32_16x16x32_bf16 v[12:15], a[44:47], v[164:167], v[12:15]
    ds_read_b64_tr_b16 v[18:19], v252 offset:6144
    v_mfma_f32_16x16x32_bf16 v[64:67], a[92:95], v[164:167], v[64:67]
    ds_read_b64_tr_b16 v[20:21], v252 offset:8192
    v_mfma_f32_16x16x32_bf16 v[64:67], a[88:91], v[56:59], v[64:67]
    ds_read_b64_tr_b16 v[22:23], v252 offset:10240
    v_mfma_f32_16x16x32_bf16 v[64:67], a[84:87], v[88:91], v[64:67]
    ds_read_b64_tr_b16 v[32:33], v252 offset:12288
    v_mfma_f32_16x16x32_bf16 v[64:67], a[80:83], v[28:31], v[64:67]
    s_add_u32 m0, s29, 137088
    ds_read_b64_tr_b16 v[34:35], v252 offset:14336
    v_cvt_pk_bf16_f32 v40, v12, v13
    v_mfma_f32_16x16x32_bf16 v[96:99], a[128:131], v[28:31], v[96:99]
    global_load_lds_dwordx4 v247, s[16:17] offset:2176
    v_mfma_f32_16x16x32_bf16 v[96:99], a[132:135], v[88:91], v[96:99]
    v_cvt_pk_bf16_f32 v41, v14, v15
    v_mfma_f32_16x16x32_bf16 v[96:99], a[136:139], v[56:59], v[96:99]
    v_cvt_pk_bf16_f32 v42, v64, v65
    v_cvt_pk_bf16_f32 v43, v66, v67
    v_mfma_f32_16x16x32_bf16 v[96:99], a[140:143], v[164:167], v[96:99]
    v_mfma_f32_16x16x32_bf16 v[104:107], a[188:191], v[164:167], v[104:107]
    v_mfma_f32_16x16x32_bf16 v[104:107], a[184:187], v[56:59], v[104:107]
    v_mfma_f32_16x16x32_bf16 v[104:107], a[180:183], v[88:91], v[104:107]
    v_mfma_f32_16x16x32_bf16 v[104:107], a[176:179], v[28:31], v[104:107]
    s_waitcnt lgkmcnt(0)
    v_mfma_f32_16x16x32_bf16 v[12:15], a[0:3], v[0:3], 0
    ds_read_b64_tr_b16 v[56:57], v252 offset:16384
    v_mfma_f32_16x16x32_bf16 v[12:15], a[4:7], v[16:19], v[12:15]
    ds_read_b64_tr_b16 v[58:59], v252 offset:18432
    v_cvt_pk_bf16_f32 v28, v96, v97
    v_mfma_f32_16x16x32_bf16 v[12:15], a[8:11], v[20:23], v[12:15]
    ds_read_b64_tr_b16 v[64:65], v252 offset:20480
    v_cvt_pk_bf16_f32 v29, v98, v99
    v_mfma_f32_16x16x32_bf16 v[12:15], a[12:15], v[32:35], v[12:15]
    ds_read_b64_tr_b16 v[66:67], v252 offset:22528
    v_cvt_pk_bf16_f32 v30, v104, v105
    v_mfma_f32_16x16x32_bf16 v[84:87], a[60:63], v[32:35], 0
    ds_read_b64_tr_b16 v[88:89], v252 offset:24576
    v_cvt_pk_bf16_f32 v31, v106, v107
    v_mfma_f32_16x16x32_bf16 v[84:87], a[56:59], v[20:23], v[84:87]
    ds_read_b64_tr_b16 v[90:91], v252 offset:26624
    v_mfma_f32_16x16x32_bf16 v[84:87], a[52:55], v[16:19], v[84:87]
    ds_read_b64_tr_b16 v[92:93], v252 offset:28672
    v_mfma_f32_16x16x32_bf16 v[84:87], a[48:51], v[0:3], v[84:87]
    s_add_u32 m0, s29, 141184
    ds_read_b64_tr_b16 v[94:95], v252 offset:30720
    v_mfma_f32_16x16x32_bf16 v[96:99], a[96:99], v[0:3], 0
    global_load_lds_dwordx4 v247, s[18:19] offset:2176
    v_mfma_f32_16x16x32_bf16 v[96:99], a[100:103], v[16:19], v[96:99]
    v_mfma_f32_16x16x32_bf16 v[96:99], a[104:107], v[20:23], v[96:99]
    v_mfma_f32_16x16x32_bf16 v[96:99], a[108:111], v[32:35], v[96:99]
    v_mfma_f32_16x16x32_bf16 v[104:107], a[156:159], v[32:35], 0
    v_mfma_f32_16x16x32_bf16 v[104:107], a[152:155], v[20:23], v[104:107]
    v_mfma_f32_16x16x32_bf16 v[104:107], a[148:151], v[16:19], v[104:107]
    v_mfma_f32_16x16x32_bf16 v[104:107], a[144:147], v[0:3], v[104:107]
    v_mfma_f32_16x16x32_bf16 v[32:35], v[40:43], v[100:103], 0
    v_mfma_f32_16x16x32_bf16 v[32:35], v[28:31], v[68:71], v[32:35]
    v_mfma_f32_16x16x32_bf16 v[16:19], v[28:31], v[136:139], 0
    v_mfma_f32_16x16x32_bf16 v[16:19], v[40:43], v[80:83], v[16:19]
    v_mfma_f32_16x16x32_bf16 v[0:3], v[40:43], v[152:155], 0
    v_mfma_f32_16x16x32_bf16 v[0:3], v[28:31], v[52:55], v[0:3]
    v_mfma_f32_16x16x32_bf16 v[20:23], v[28:31], v[112:115], 0
    v_mfma_f32_16x16x32_bf16 v[20:23], v[40:43], v[172:175], v[20:23]
    s_waitcnt lgkmcnt(0)
    v_mfma_f32_16x16x32_bf16 v[104:107], a[160:163], v[56:59], v[104:107]
    ds_read_b64_tr_b16 v[28:29], v252 offset:32768
    v_cvt_pk_bf16_f32 v254, v32, v33
    v_mfma_f32_16x16x32_bf16 v[104:107], a[164:167], v[64:67], v[104:107]
    ds_read_b64_tr_b16 v[30:31], v252 offset:34816
    v_cvt_pk_bf16_f32 v253, v34, v35
    v_mfma_f32_16x16x32_bf16 v[104:107], a[168:171], v[88:91], v[104:107]
    ds_read_b64_tr_b16 v[40:41], v252 offset:36864
    v_accvgpr_write_b32 a226, v254
    v_mfma_f32_16x16x32_bf16 v[104:107], a[172:175], v[92:95], v[104:107]
    ds_read_b64_tr_b16 v[42:43], v252 offset:38912
    v_accvgpr_write_b32 a227, v253
    v_mfma_f32_16x16x32_bf16 v[96:99], a[124:127], v[92:95], v[96:99]
    ds_read_b64_tr_b16 v[32:33], v252 offset:40960
    v_cvt_pk_bf16_f32 v254, v16, v17
    v_mfma_f32_16x16x32_bf16 v[96:99], a[120:123], v[88:91], v[96:99]
    ds_read_b64_tr_b16 v[34:35], v252 offset:43008
    v_cvt_pk_bf16_f32 v253, v18, v19
    v_mfma_f32_16x16x32_bf16 v[96:99], a[116:119], v[64:67], v[96:99]
    ds_read_b64_tr_b16 v[164:165], v252 offset:45056
G_15:
    s_cbranch_vccnz G_19
    v_accvgpr_write_b32 a230, v254
    v_mfma_f32_16x16x32_bf16 v[96:99], a[112:115], v[56:59], v[96:99]
    s_add_u32 m0, s29, 145280
    ds_read_b64_tr_b16 v[166:167], v252 offset:47104
    v_accvgpr_write_b32 a231, v253
    v_mfma_f32_16x16x32_bf16 v[84:87], a[64:67], v[56:59], v[84:87]
    global_load_lds_dwordx4 v247, s[20:21] offset:2176
    v_mfma_f32_16x16x32_bf16 v[84:87], a[68:71], v[64:67], v[84:87]
    v_cvt_pk_bf16_f32 v254, v0, v1
    v_cvt_pk_bf16_f32 v253, v2, v3
    v_mfma_f32_16x16x32_bf16 v[84:87], a[72:75], v[88:91], v[84:87]
    v_xor_b32 v252, 16480, v255
    v_accvgpr_write_b32 a234, v254
    v_mfma_f32_16x16x32_bf16 v[84:87], a[76:79], v[92:95], v[84:87]
    v_accvgpr_write_b32 a235, v253
    v_cvt_pk_bf16_f32 v251, v20, v21
    v_mfma_f32_16x16x32_bf16 v[12:15], a[28:31], v[92:95], v[12:15]
    v_cvt_pk_bf16_f32 v254, v22, v23
    v_accvgpr_write_b32 a238, v251
    v_mfma_f32_16x16x32_bf16 v[12:15], a[24:27], v[88:91], v[12:15]
    v_accvgpr_write_b32 a239, v254
    v_mfma_f32_16x16x32_bf16 v[12:15], a[20:23], v[64:67], v[12:15]
    v_mfma_f32_16x16x32_bf16 v[12:15], a[16:19], v[56:59], v[12:15]
    s_waitcnt lgkmcnt(0)
    v_mfma_f32_16x16x32_bf16 v[12:15], a[32:35], v[28:31], v[12:15]
    ds_read_b64_tr_b16 v[0:1], v252 offset:0
    v_mfma_f32_16x16x32_bf16 v[12:15], a[36:39], v[40:43], v[12:15]
    ds_read_b64_tr_b16 v[2:3], v252 offset:2048
    v_mfma_f32_16x16x32_bf16 v[12:15], a[40:43], v[32:35], v[12:15]
    ds_read_b64_tr_b16 v[16:17], v252 offset:4096
    v_mfma_f32_16x16x32_bf16 v[12:15], a[44:47], v[164:167], v[12:15]
    ds_read_b64_tr_b16 v[18:19], v252 offset:6144
    v_mfma_f32_16x16x32_bf16 v[84:87], a[92:95], v[164:167], v[84:87]
    ds_read_b64_tr_b16 v[20:21], v252 offset:8192
    v_mfma_f32_16x16x32_bf16 v[84:87], a[88:91], v[32:35], v[84:87]
    ds_read_b64_tr_b16 v[22:23], v252 offset:10240
    v_mfma_f32_16x16x32_bf16 v[84:87], a[84:87], v[40:43], v[84:87]
    ds_read_b64_tr_b16 v[56:57], v252 offset:12288
    v_mfma_f32_16x16x32_bf16 v[84:87], a[80:83], v[28:31], v[84:87]
    s_add_u32 m0, s29, 149376
    ds_read_b64_tr_b16 v[58:59], v252 offset:14336
    v_cvt_pk_bf16_f32 v64, v12, v13
    v_mfma_f32_16x16x32_bf16 v[96:99], a[128:131], v[28:31], v[96:99]
    global_load_lds_dwordx4 v247, s[22:23] offset:2176
    v_mfma_f32_16x16x32_bf16 v[96:99], a[132:135], v[40:43], v[96:99]
    v_cvt_pk_bf16_f32 v65, v14, v15
    v_mfma_f32_16x16x32_bf16 v[96:99], a[136:139], v[32:35], v[96:99]
    v_cvt_pk_bf16_f32 v66, v84, v85
    v_cvt_pk_bf16_f32 v67, v86, v87
    v_mfma_f32_16x16x32_bf16 v[96:99], a[140:143], v[164:167], v[96:99]
    v_mfma_f32_16x16x32_bf16 v[104:107], a[188:191], v[164:167], v[104:107]
    v_mfma_f32_16x16x32_bf16 v[104:107], a[184:187], v[32:35], v[104:107]
    v_mfma_f32_16x16x32_bf16 v[104:107], a[180:183], v[40:43], v[104:107]
    v_mfma_f32_16x16x32_bf16 v[104:107], a[176:179], v[28:31], v[104:107]
    s_waitcnt lgkmcnt(0)
    v_mfma_f32_16x16x32_bf16 v[12:15], a[0:3], v[0:3], 0
    ds_read_b64_tr_b16 v[32:33], v252 offset:16384
    v_mfma_f32_16x16x32_bf16 v[12:15], a[4:7], v[16:19], v[12:15]
    ds_read_b64_tr_b16 v[34:35], v252 offset:18432
    v_cvt_pk_bf16_f32 v28, v96, v97
    v_mfma_f32_16x16x32_bf16 v[12:15], a[8:11], v[20:23], v[12:15]
    ds_read_b64_tr_b16 v[40:41], v252 offset:20480
    v_cvt_pk_bf16_f32 v29, v98, v99
    v_mfma_f32_16x16x32_bf16 v[12:15], a[12:15], v[56:59], v[12:15]
    ds_read_b64_tr_b16 v[42:43], v252 offset:22528
    v_cvt_pk_bf16_f32 v30, v104, v105
    v_mfma_f32_16x16x32_bf16 v[84:87], a[60:63], v[56:59], 0
    ds_read_b64_tr_b16 v[88:89], v252 offset:24576
    v_cvt_pk_bf16_f32 v31, v106, v107
    v_mfma_f32_16x16x32_bf16 v[84:87], a[56:59], v[20:23], v[84:87]
    ds_read_b64_tr_b16 v[90:91], v252 offset:26624
    v_mfma_f32_16x16x32_bf16 v[84:87], a[52:55], v[16:19], v[84:87]
    ds_read_b64_tr_b16 v[92:93], v252 offset:28672
    v_mfma_f32_16x16x32_bf16 v[84:87], a[48:51], v[0:3], v[84:87]
    s_add_u32 m0, s29, 153472
    ds_read_b64_tr_b16 v[94:95], v252 offset:30720
    v_mfma_f32_16x16x32_bf16 v[96:99], a[96:99], v[0:3], 0
    global_load_lds_dwordx4 v247, s[24:25] offset:2176
    v_mfma_f32_16x16x32_bf16 v[96:99], a[100:103], v[16:19], v[96:99]
    v_mbcnt_lo_u32_b32 v254, -1, 0
    v_mbcnt_hi_u32_b32 v253, -1, v254
    v_mfma_f32_16x16x32_bf16 v[96:99], a[104:107], v[20:23], v[96:99]
    v_lshrrev_b32 v251, 3, v253
    v_bfe_u32 v250, v253, 1, 2
    v_mfma_f32_16x16x32_bf16 v[96:99], a[108:111], v[56:59], v[96:99]
    v_lshrrev_b32 v254, 4, v253
    v_and_b32 v249, 1, v253
    v_mfma_f32_16x16x32_bf16 v[104:107], a[156:159], v[56:59], 0
    v_lshl_add_u32 v248, s28, 3, v251
    v_xor_b32 v246, v250, v254
    v_mfma_f32_16x16x32_bf16 v[104:107], a[152:155], v[20:23], v[104:107]
    v_lshlrev_b32 v253, 4, v249
    v_lshl_add_u32 v251, v246, 5, v253
    v_mfma_f32_16x16x32_bf16 v[104:107], a[148:151], v[16:19], v[104:107]
    v_mul_u32_u24 v254, 768, v248
    v_add_u32 v250, v254, v251
    v_mfma_f32_16x16x32_bf16 v[104:107], a[144:147], v[0:3], v[104:107]
    v_mfma_f32_16x16x32_bf16 v[16:19], v[64:67], v[100:103], 0
    v_mfma_f32_16x16x32_bf16 v[16:19], v[28:31], v[68:71], v[16:19]
    v_mfma_f32_16x16x32_bf16 v[20:23], v[28:31], v[136:139], 0
    v_mfma_f32_16x16x32_bf16 v[20:23], v[64:67], v[80:83], v[20:23]
    v_mfma_f32_16x16x32_bf16 v[0:3], v[64:67], v[152:155], 0
    v_mfma_f32_16x16x32_bf16 v[0:3], v[28:31], v[52:55], v[0:3]
    v_mfma_f32_16x16x32_bf16 v[56:59], v[28:31], v[112:115], 0
    v_mfma_f32_16x16x32_bf16 v[56:59], v[64:67], v[172:175], v[56:59]
    s_waitcnt lgkmcnt(0)
    v_mfma_f32_16x16x32_bf16 v[104:107], a[160:163], v[32:35], v[104:107]
    ds_read_b64_tr_b16 v[28:29], v252 offset:32768
    v_cvt_pk_bf16_f32 v254, v16, v17
    v_mfma_f32_16x16x32_bf16 v[104:107], a[164:167], v[40:43], v[104:107]
    ds_read_b64_tr_b16 v[30:31], v252 offset:34816
    v_cvt_pk_bf16_f32 v253, v18, v19
    v_mfma_f32_16x16x32_bf16 v[104:107], a[168:171], v[88:91], v[104:107]
    ds_read_b64_tr_b16 v[64:65], v252 offset:36864
    v_accvgpr_write_b32 a240, v254
    v_mfma_f32_16x16x32_bf16 v[104:107], a[172:175], v[92:95], v[104:107]
    ds_read_b64_tr_b16 v[66:67], v252 offset:38912
    v_accvgpr_write_b32 a241, v253
    v_mfma_f32_16x16x32_bf16 v[96:99], a[124:127], v[92:95], v[96:99]
    ds_read_b64_tr_b16 v[16:17], v252 offset:40960
    v_cvt_pk_bf16_f32 v254, v20, v21
    v_mfma_f32_16x16x32_bf16 v[96:99], a[120:123], v[88:91], v[96:99]
    ds_read_b64_tr_b16 v[18:19], v252 offset:43008
    v_cvt_pk_bf16_f32 v253, v22, v23
    v_mfma_f32_16x16x32_bf16 v[96:99], a[116:119], v[40:43], v[96:99]
    ds_read_b64_tr_b16 v[164:165], v252 offset:45056
    v_accvgpr_write_b32 a244, v254
    v_mfma_f32_16x16x32_bf16 v[96:99], a[112:115], v[32:35], v[96:99]
    s_add_u32 m0, s29, 157568
    ds_read_b64_tr_b16 v[166:167], v252 offset:47104
    v_accvgpr_write_b32 a245, v253
    v_mfma_f32_16x16x32_bf16 v[84:87], a[64:67], v[32:35], v[84:87]
    global_load_lds_dwordx4 v247, s[26:27] offset:2176
    v_mfma_f32_16x16x32_bf16 v[84:87], a[68:71], v[40:43], v[84:87]
    s_add_u32 s4, s44, 0
    s_addc_u32 s5, s45, 0
    v_cvt_pk_bf16_f32 v254, v0, v1
    v_mfma_f32_16x16x32_bf16 v[84:87], a[72:75], v[88:91], v[84:87]
    s_add_u32 s6, s44, 24576
    s_addc_u32 s7, s45, 0
    v_xor_b32 v253, 65536, v255
    v_mfma_f32_16x16x32_bf16 v[84:87], a[76:79], v[92:95], v[84:87]
    s_add_u32 s8, s44, 49152
    s_addc_u32 s9, s45, 0
    v_cvt_pk_bf16_f32 v252, v2, v3
    v_mfma_f32_16x16x32_bf16 v[12:15], a[28:31], v[92:95], v[12:15]
    s_add_u32 s10, s44, 73728
    s_addc_u32 s11, s45, 0
    v_accvgpr_write_b32 a248, v254
    v_mfma_f32_16x16x32_bf16 v[12:15], a[24:27], v[88:91], v[12:15]
    s_add_u32 s12, s44, 98304
    s_addc_u32 s13, s45, 0
    v_accvgpr_write_b32 a249, v252
    v_mfma_f32_16x16x32_bf16 v[12:15], a[20:23], v[40:43], v[12:15]
    s_add_u32 s14, s44, 122880
    s_addc_u32 s15, s45, 0
    v_cvt_pk_bf16_f32 v254, v56, v57
    v_mfma_f32_16x16x32_bf16 v[12:15], a[16:19], v[32:35], v[12:15]
    s_waitcnt vmcnt(12) lgkmcnt(0)
    s_barrier
    v_cvt_pk_bf16_f32 v252, v58, v59
    v_mfma_f32_16x16x32_bf16 v[12:15], a[32:35], v[28:31], v[12:15]
    s_add_u32 s16, s44, 147456
    s_addc_u32 s17, s45, 0
    ds_read_b64_tr_b16 v[0:1], v253 offset:0
    v_mfma_f32_16x16x32_bf16 v[12:15], a[36:39], v[64:67], v[12:15]
    s_add_u32 s18, s44, 172032
    s_addc_u32 s19, s45, 0
    ds_read_b64_tr_b16 v[2:3], v253 offset:2048
    v_mfma_f32_16x16x32_bf16 v[12:15], a[40:43], v[16:19], v[12:15]
    s_add_u32 s20, s44, 196608
    s_addc_u32 s21, s45, 0
    ds_read_b64_tr_b16 v[20:21], v253 offset:4096
    v_mfma_f32_16x16x32_bf16 v[12:15], a[44:47], v[164:167], v[12:15]
    s_add_u32 s22, s44, 221184
    s_addc_u32 s23, s45, 0
    ds_read_b64_tr_b16 v[22:23], v253 offset:6144
    v_mfma_f32_16x16x32_bf16 v[84:87], a[92:95], v[164:167], v[84:87]
    s_add_u32 s24, s44, 245760
    s_addc_u32 s25, s45, 0
    ds_read_b64_tr_b16 v[32:33], v253 offset:8192
    v_mfma_f32_16x16x32_bf16 v[84:87], a[88:91], v[16:19], v[84:87]
    s_add_u32 s26, s44, 270336
    s_addc_u32 s27, s45, 0
    ds_read_b64_tr_b16 v[34:35], v253 offset:10240
    v_mfma_f32_16x16x32_bf16 v[84:87], a[84:87], v[64:67], v[84:87]
    ds_read_b64_tr_b16 v[40:41], v253 offset:12288
    v_cvt_pk_bf16_f32 v56, v12, v13
    v_mfma_f32_16x16x32_bf16 v[84:87], a[80:83], v[28:31], v[84:87]
    s_add_u32 m0, s29, 16384
    ds_read_b64_tr_b16 v[42:43], v253 offset:14336
    v_cvt_pk_bf16_f32 v57, v14, v15
    v_mfma_f32_16x16x32_bf16 v[96:99], a[128:131], v[28:31], v[96:99]
    global_load_lds_dwordx4 v250, s[4:5]
    v_mfma_f32_16x16x32_bf16 v[96:99], a[132:135], v[64:67], v[96:99]
    v_accvgpr_write_b32 a252, v254
    v_accvgpr_write_b32 a253, v252
    v_mfma_f32_16x16x32_bf16 v[96:99], a[136:139], v[16:19], v[96:99]
    v_cvt_pk_bf16_f32 v58, v84, v85
    v_cvt_pk_bf16_f32 v59, v86, v87
    v_mfma_f32_16x16x32_bf16 v[96:99], a[140:143], v[164:167], v[96:99]
    v_mfma_f32_16x16x32_bf16 v[104:107], a[188:191], v[164:167], v[104:107]
    v_mfma_f32_16x16x32_bf16 v[104:107], a[184:187], v[16:19], v[104:107]
    v_mfma_f32_16x16x32_bf16 v[104:107], a[180:183], v[64:67], v[104:107]
    v_mfma_f32_16x16x32_bf16 v[104:107], a[176:179], v[28:31], v[104:107]
    s_waitcnt lgkmcnt(0)
    v_mfma_f32_16x16x32_bf16 v[12:15], a[0:3], v[0:3], 0
    ds_read_b64_tr_b16 v[16:17], v253 offset:16384
    v_mfma_f32_16x16x32_bf16 v[12:15], a[4:7], v[20:23], v[12:15]
    ds_read_b64_tr_b16 v[18:19], v253 offset:18432
    v_cvt_pk_bf16_f32 v28, v96, v97
    v_mfma_f32_16x16x32_bf16 v[12:15], a[8:11], v[32:35], v[12:15]
    ds_read_b64_tr_b16 v[64:65], v253 offset:20480
    v_cvt_pk_bf16_f32 v29, v98, v99
    v_mfma_f32_16x16x32_bf16 v[12:15], a[12:15], v[40:43], v[12:15]
    ds_read_b64_tr_b16 v[66:67], v253 offset:22528
    v_cvt_pk_bf16_f32 v30, v104, v105
    v_mfma_f32_16x16x32_bf16 v[84:87], a[60:63], v[40:43], 0
    ds_read_b64_tr_b16 v[88:89], v253 offset:24576
    v_cvt_pk_bf16_f32 v31, v106, v107
    v_mfma_f32_16x16x32_bf16 v[84:87], a[56:59], v[32:35], v[84:87]
    ds_read_b64_tr_b16 v[90:91], v253 offset:26624
    v_mfma_f32_16x16x32_bf16 v[84:87], a[52:55], v[20:23], v[84:87]
    ds_read_b64_tr_b16 v[92:93], v253 offset:28672
    v_mfma_f32_16x16x32_bf16 v[84:87], a[48:51], v[0:3], v[84:87]
    s_add_u32 m0, s29, 20480
    ds_read_b64_tr_b16 v[94:95], v253 offset:30720
    v_mfma_f32_16x16x32_bf16 v[96:99], a[96:99], v[0:3], 0
    global_load_lds_dwordx4 v250, s[6:7]
    v_mfma_f32_16x16x32_bf16 v[96:99], a[100:103], v[20:23], v[96:99]
    v_mfma_f32_16x16x32_bf16 v[96:99], a[104:107], v[32:35], v[96:99]
    v_mfma_f32_16x16x32_bf16 v[96:99], a[108:111], v[40:43], v[96:99]
    v_mfma_f32_16x16x32_bf16 v[104:107], a[156:159], v[40:43], 0
    v_mfma_f32_16x16x32_bf16 v[104:107], a[152:155], v[32:35], v[104:107]
    v_mfma_f32_16x16x32_bf16 v[104:107], a[148:151], v[20:23], v[104:107]
    v_mfma_f32_16x16x32_bf16 v[104:107], a[144:147], v[0:3], v[104:107]
    v_mfma_f32_16x16x32_bf16 v[40:43], v[56:59], v[100:103], 0
    v_mfma_f32_16x16x32_bf16 v[40:43], v[28:31], v[68:71], v[40:43]
    v_mfma_f32_16x16x32_bf16 v[20:23], v[28:31], v[136:139], 0
    v_mfma_f32_16x16x32_bf16 v[20:23], v[56:59], v[80:83], v[20:23]
    v_mfma_f32_16x16x32_bf16 v[0:3], v[56:59], v[152:155], 0
    v_mfma_f32_16x16x32_bf16 v[0:3], v[28:31], v[52:55], v[0:3]
    v_mfma_f32_16x16x32_bf16 v[32:35], v[28:31], v[112:115], 0
    v_mfma_f32_16x16x32_bf16 v[32:35], v[56:59], v[172:175], v[32:35]
    s_waitcnt lgkmcnt(0)
    v_mfma_f32_16x16x32_bf16 v[104:107], a[160:163], v[16:19], v[104:107]
    ds_read_b64_tr_b16 v[28:29], v253 offset:32768
    v_cvt_pk_bf16_f32 v254, v40, v41
    v_mfma_f32_16x16x32_bf16 v[104:107], a[164:167], v[64:67], v[104:107]
    ds_read_b64_tr_b16 v[30:31], v253 offset:34816
    v_cvt_pk_bf16_f32 v252, v42, v43
    v_mfma_f32_16x16x32_bf16 v[104:107], a[168:171], v[88:91], v[104:107]
    ds_read_b64_tr_b16 v[56:57], v253 offset:36864
    v_accvgpr_write_b32 a242, v254
    v_mfma_f32_16x16x32_bf16 v[104:107], a[172:175], v[92:95], v[104:107]
    ds_read_b64_tr_b16 v[58:59], v253 offset:38912
    v_accvgpr_write_b32 a243, v252
    v_mfma_f32_16x16x32_bf16 v[96:99], a[124:127], v[92:95], v[96:99]
    ds_read_b64_tr_b16 v[40:41], v253 offset:40960
    v_cvt_pk_bf16_f32 v254, v20, v21
    v_mfma_f32_16x16x32_bf16 v[96:99], a[120:123], v[88:91], v[96:99]
    ds_read_b64_tr_b16 v[42:43], v253 offset:43008
    v_cvt_pk_bf16_f32 v252, v22, v23
    v_mfma_f32_16x16x32_bf16 v[96:99], a[116:119], v[64:67], v[96:99]
    ds_read_b64_tr_b16 v[164:165], v253 offset:45056
    v_accvgpr_write_b32 a246, v254
    v_mfma_f32_16x16x32_bf16 v[96:99], a[112:115], v[16:19], v[96:99]
    s_add_u32 m0, s29, 24576
    ds_read_b64_tr_b16 v[166:167], v253 offset:47104
    v_accvgpr_write_b32 a247, v252
    v_mfma_f32_16x16x32_bf16 v[84:87], a[64:67], v[16:19], v[84:87]
    global_load_lds_dwordx4 v250, s[8:9]
    v_mfma_f32_16x16x32_bf16 v[84:87], a[68:71], v[64:67], v[84:87]
    v_cvt_pk_bf16_f32 v254, v0, v1
    v_cvt_pk_bf16_f32 v253, v2, v3
    v_mfma_f32_16x16x32_bf16 v[84:87], a[72:75], v[88:91], v[84:87]
    v_xor_b32 v252, 65568, v255
    v_accvgpr_write_b32 a250, v254
    v_mfma_f32_16x16x32_bf16 v[84:87], a[76:79], v[92:95], v[84:87]
    v_accvgpr_write_b32 a251, v253
    v_cvt_pk_bf16_f32 v251, v32, v33
    v_mfma_f32_16x16x32_bf16 v[12:15], a[28:31], v[92:95], v[12:15]
    v_cvt_pk_bf16_f32 v254, v34, v35
    v_accvgpr_write_b32 a254, v251
    v_mfma_f32_16x16x32_bf16 v[12:15], a[24:27], v[88:91], v[12:15]
    v_accvgpr_write_b32 a255, v254
    v_mfma_f32_16x16x32_bf16 v[12:15], a[20:23], v[64:67], v[12:15]
    v_mfma_f32_16x16x32_bf16 v[12:15], a[16:19], v[16:19], v[12:15]
    s_waitcnt lgkmcnt(0)
    v_mfma_f32_16x16x32_bf16 v[12:15], a[32:35], v[28:31], v[12:15]
    ds_read_b64_tr_b16 v[0:1], v252 offset:0
    v_mfma_f32_16x16x32_bf16 v[12:15], a[36:39], v[56:59], v[12:15]
    ds_read_b64_tr_b16 v[2:3], v252 offset:2048
    v_mfma_f32_16x16x32_bf16 v[12:15], a[40:43], v[40:43], v[12:15]
    ds_read_b64_tr_b16 v[16:17], v252 offset:4096
    v_mfma_f32_16x16x32_bf16 v[12:15], a[44:47], v[164:167], v[12:15]
    ds_read_b64_tr_b16 v[18:19], v252 offset:6144
    v_mfma_f32_16x16x32_bf16 v[84:87], a[92:95], v[164:167], v[84:87]
    ds_read_b64_tr_b16 v[20:21], v252 offset:8192
    v_mfma_f32_16x16x32_bf16 v[84:87], a[88:91], v[40:43], v[84:87]
    ds_read_b64_tr_b16 v[22:23], v252 offset:10240
    v_mfma_f32_16x16x32_bf16 v[84:87], a[84:87], v[56:59], v[84:87]
    ds_read_b64_tr_b16 v[32:33], v252 offset:12288
    v_mfma_f32_16x16x32_bf16 v[84:87], a[80:83], v[28:31], v[84:87]
    s_add_u32 m0, s29, 28672
    ds_read_b64_tr_b16 v[34:35], v252 offset:14336
    v_cvt_pk_bf16_f32 v64, v12, v13
    v_mfma_f32_16x16x32_bf16 v[96:99], a[128:131], v[28:31], v[96:99]
    global_load_lds_dwordx4 v250, s[10:11]
    v_mfma_f32_16x16x32_bf16 v[96:99], a[132:135], v[56:59], v[96:99]
    v_cvt_pk_bf16_f32 v65, v14, v15
    v_mfma_f32_16x16x32_bf16 v[96:99], a[136:139], v[40:43], v[96:99]
    v_cvt_pk_bf16_f32 v66, v84, v85
    v_cvt_pk_bf16_f32 v67, v86, v87
    v_mfma_f32_16x16x32_bf16 v[96:99], a[140:143], v[164:167], v[96:99]
    v_mfma_f32_16x16x32_bf16 v[104:107], a[188:191], v[164:167], v[104:107]
    v_mfma_f32_16x16x32_bf16 v[104:107], a[184:187], v[40:43], v[104:107]
    v_mfma_f32_16x16x32_bf16 v[104:107], a[180:183], v[56:59], v[104:107]
    v_mfma_f32_16x16x32_bf16 v[104:107], a[176:179], v[28:31], v[104:107]
    s_waitcnt lgkmcnt(0)
    v_mfma_f32_16x16x32_bf16 v[12:15], a[0:3], v[0:3], 0
    ds_read_b64_tr_b16 v[40:41], v252 offset:16384
    v_mfma_f32_16x16x32_bf16 v[12:15], a[4:7], v[16:19], v[12:15]
    ds_read_b64_tr_b16 v[42:43], v252 offset:18432
    v_cvt_pk_bf16_f32 v28, v96, v97
    v_mfma_f32_16x16x32_bf16 v[12:15], a[8:11], v[20:23], v[12:15]
    ds_read_b64_tr_b16 v[56:57], v252 offset:20480
    v_cvt_pk_bf16_f32 v29, v98, v99
    v_mfma_f32_16x16x32_bf16 v[12:15], a[12:15], v[32:35], v[12:15]
    ds_read_b64_tr_b16 v[58:59], v252 offset:22528
    v_cvt_pk_bf16_f32 v30, v104, v105
    v_mfma_f32_16x16x32_bf16 v[84:87], a[60:63], v[32:35], 0
    ds_read_b64_tr_b16 v[88:89], v252 offset:24576
    v_cvt_pk_bf16_f32 v31, v106, v107
    v_mfma_f32_16x16x32_bf16 v[84:87], a[56:59], v[20:23], v[84:87]
    ds_read_b64_tr_b16 v[90:91], v252 offset:26624
    v_mfma_f32_16x16x32_bf16 v[84:87], a[52:55], v[16:19], v[84:87]
    ds_read_b64_tr_b16 v[92:93], v252 offset:28672
    v_mfma_f32_16x16x32_bf16 v[84:87], a[48:51], v[0:3], v[84:87]
    s_add_u32 m0, s29, 32768
    ds_read_b64_tr_b16 v[94:95], v252 offset:30720
    v_mfma_f32_16x16x32_bf16 v[96:99], a[96:99], v[0:3], 0
    global_load_lds_dwordx4 v250, s[12:13]
    v_mfma_f32_16x16x32_bf16 v[96:99], a[100:103], v[16:19], v[96:99]
    v_mfma_f32_16x16x32_bf16 v[96:99], a[104:107], v[20:23], v[96:99]
    v_mfma_f32_16x16x32_bf16 v[96:99], a[108:111], v[32:35], v[96:99]
    v_mfma_f32_16x16x32_bf16 v[104:107], a[156:159], v[32:35], 0
    v_mfma_f32_16x16x32_bf16 v[104:107], a[152:155], v[20:23], v[104:107]
    v_mfma_f32_16x16x32_bf16 v[104:107], a[148:151], v[16:19], v[104:107]
    v_mfma_f32_16x16x32_bf16 v[104:107], a[144:147], v[0:3], v[104:107]
    v_mfma_f32_16x16x32_bf16 v[32:35], v[64:67], v[100:103], 0
    v_mfma_f32_16x16x32_bf16 v[32:35], v[28:31], v[68:71], v[32:35]
    v_mfma_f32_16x16x32_bf16 v[16:19], v[28:31], v[136:139], 0
    v_mfma_f32_16x16x32_bf16 v[16:19], v[64:67], v[80:83], v[16:19]
    v_mfma_f32_16x16x32_bf16 v[0:3], v[64:67], v[152:155], 0
    v_mfma_f32_16x16x32_bf16 v[0:3], v[28:31], v[52:55], v[0:3]
    v_mfma_f32_16x16x32_bf16 v[20:23], v[28:31], v[112:115], 0
    v_mfma_f32_16x16x32_bf16 v[20:23], v[64:67], v[172:175], v[20:23]
    s_waitcnt lgkmcnt(0)
    v_mfma_f32_16x16x32_bf16 v[104:107], a[160:163], v[40:43], v[104:107]
    ds_read_b64_tr_b16 v[28:29], v252 offset:32768
    v_cvt_pk_bf16_f32 v64, v32, v33
    v_mfma_f32_16x16x32_bf16 v[104:107], a[164:167], v[56:59], v[104:107]
    ds_read_b64_tr_b16 v[30:31], v252 offset:34816
    v_cvt_pk_bf16_f32 v65, v34, v35
    v_mfma_f32_16x16x32_bf16 v[104:107], a[168:171], v[88:91], v[104:107]
    ds_read_b64_tr_b16 v[164:165], v252 offset:36864
    v_cvt_pk_bf16_f32 v168, v16, v17
    v_mfma_f32_16x16x32_bf16 v[104:107], a[172:175], v[92:95], v[104:107]
    ds_read_b64_tr_b16 v[166:167], v252 offset:38912
    v_cvt_pk_bf16_f32 v169, v18, v19
    v_mfma_f32_16x16x32_bf16 v[96:99], a[124:127], v[92:95], v[96:99]
    ds_read_b64_tr_b16 v[32:33], v252 offset:40960
    v_cvt_pk_bf16_f32 v180, v0, v1
    v_mfma_f32_16x16x32_bf16 v[96:99], a[120:123], v[88:91], v[96:99]
    ds_read_b64_tr_b16 v[34:35], v252 offset:43008
    v_cvt_pk_bf16_f32 v181, v2, v3
    v_mfma_f32_16x16x32_bf16 v[96:99], a[116:119], v[56:59], v[96:99]
    ds_read_b64_tr_b16 v[16:17], v252 offset:45056
    v_cvt_pk_bf16_f32 v184, v20, v21
    v_mfma_f32_16x16x32_bf16 v[96:99], a[112:115], v[40:43], v[96:99]
    s_add_u32 m0, s29, 36864
    ds_read_b64_tr_b16 v[18:19], v252 offset:47104
    v_cvt_pk_bf16_f32 v185, v22, v23
    v_mfma_f32_16x16x32_bf16 v[84:87], a[64:67], v[40:43], v[84:87]
    global_load_lds_dwordx4 v250, s[14:15]
    v_mfma_f32_16x16x32_bf16 v[84:87], a[68:71], v[56:59], v[84:87]
    v_mfma_f32_16x16x32_bf16 v[84:87], a[72:75], v[88:91], v[84:87]
    v_xor_b32 v254, 65600, v255
    v_mfma_f32_16x16x32_bf16 v[84:87], a[76:79], v[92:95], v[84:87]
    v_mfma_f32_16x16x32_bf16 v[12:15], a[28:31], v[92:95], v[12:15]
    v_mfma_f32_16x16x32_bf16 v[12:15], a[24:27], v[88:91], v[12:15]
    v_mfma_f32_16x16x32_bf16 v[12:15], a[20:23], v[56:59], v[12:15]
    v_mfma_f32_16x16x32_bf16 v[12:15], a[16:19], v[40:43], v[12:15]
    s_waitcnt lgkmcnt(0)
    v_mfma_f32_16x16x32_bf16 v[12:15], a[32:35], v[28:31], v[12:15]
    ds_read_b64_tr_b16 v[0:1], v254 offset:0
    v_mfma_f32_16x16x32_bf16 v[12:15], a[36:39], v[164:167], v[12:15]
    ds_read_b64_tr_b16 v[2:3], v254 offset:2048
    v_mfma_f32_16x16x32_bf16 v[12:15], a[40:43], v[32:35], v[12:15]
    ds_read_b64_tr_b16 v[20:21], v254 offset:4096
    v_mfma_f32_16x16x32_bf16 v[12:15], a[44:47], v[16:19], v[12:15]
    ds_read_b64_tr_b16 v[22:23], v254 offset:6144
    v_mfma_f32_16x16x32_bf16 v[84:87], a[92:95], v[16:19], v[84:87]
    ds_read_b64_tr_b16 v[40:41], v254 offset:8192
    v_mfma_f32_16x16x32_bf16 v[84:87], a[88:91], v[32:35], v[84:87]
    ds_read_b64_tr_b16 v[42:43], v254 offset:10240
    v_mfma_f32_16x16x32_bf16 v[84:87], a[84:87], v[164:167], v[84:87]
    ds_read_b64_tr_b16 v[56:57], v254 offset:12288
    v_mfma_f32_16x16x32_bf16 v[84:87], a[80:83], v[28:31], v[84:87]
    s_add_u32 m0, s29, 40960
    ds_read_b64_tr_b16 v[58:59], v254 offset:14336
    v_cvt_pk_bf16_f32 v88, v12, v13
    v_mfma_f32_16x16x32_bf16 v[96:99], a[128:131], v[28:31], v[96:99]
    global_load_lds_dwordx4 v250, s[16:17]
    v_mfma_f32_16x16x32_bf16 v[96:99], a[132:135], v[164:167], v[96:99]
    v_cvt_pk_bf16_f32 v89, v14, v15
    v_mfma_f32_16x16x32_bf16 v[96:99], a[136:139], v[32:35], v[96:99]
    v_cvt_pk_bf16_f32 v90, v84, v85
    v_cvt_pk_bf16_f32 v91, v86, v87
    v_mfma_f32_16x16x32_bf16 v[96:99], a[140:143], v[16:19], v[96:99]
    v_mfma_f32_16x16x32_bf16 v[104:107], a[188:191], v[16:19], v[104:107]
    v_mfma_f32_16x16x32_bf16 v[104:107], a[184:187], v[32:35], v[104:107]
    v_mfma_f32_16x16x32_bf16 v[104:107], a[180:183], v[164:167], v[104:107]
    v_mfma_f32_16x16x32_bf16 v[104:107], a[176:179], v[28:31], v[104:107]
    s_waitcnt lgkmcnt(0)
    v_mfma_f32_16x16x32_bf16 v[12:15], a[0:3], v[0:3], 0
    ds_read_b64_tr_b16 v[16:17], v254 offset:16384
    v_mfma_f32_16x16x32_bf16 v[12:15], a[4:7], v[20:23], v[12:15]
    ds_read_b64_tr_b16 v[18:19], v254 offset:18432
    v_cvt_pk_bf16_f32 v28, v96, v97
    v_mfma_f32_16x16x32_bf16 v[12:15], a[8:11], v[40:43], v[12:15]
    ds_read_b64_tr_b16 v[32:33], v254 offset:20480
    v_cvt_pk_bf16_f32 v29, v98, v99
    v_mfma_f32_16x16x32_bf16 v[12:15], a[12:15], v[56:59], v[12:15]
    ds_read_b64_tr_b16 v[34:35], v254 offset:22528
    v_cvt_pk_bf16_f32 v30, v104, v105
    v_mfma_f32_16x16x32_bf16 v[84:87], a[60:63], v[56:59], 0
    ds_read_b64_tr_b16 v[92:93], v254 offset:24576
    v_cvt_pk_bf16_f32 v31, v106, v107
    v_mfma_f32_16x16x32_bf16 v[84:87], a[56:59], v[40:43], v[84:87]
    ds_read_b64_tr_b16 v[94:95], v254 offset:26624
    v_mfma_f32_16x16x32_bf16 v[84:87], a[52:55], v[20:23], v[84:87]
    ds_read_b64_tr_b16 v[96:97], v254 offset:28672
    v_mfma_f32_16x16x32_bf16 v[84:87], a[48:51], v[0:3], v[84:87]
    s_add_u32 m0, s29, 45056
    ds_read_b64_tr_b16 v[98:99], v254 offset:30720
    v_mfma_f32_16x16x32_bf16 v[104:107], a[96:99], v[0:3], 0
    global_load_lds_dwordx4 v250, s[18:19]
    v_mfma_f32_16x16x32_bf16 v[104:107], a[100:103], v[20:23], v[104:107]
    v_mfma_f32_16x16x32_bf16 v[104:107], a[104:107], v[40:43], v[104:107]
    v_mfma_f32_16x16x32_bf16 v[104:107], a[108:111], v[56:59], v[104:107]
    v_mfma_f32_16x16x32_bf16 v[164:167], a[156:159], v[56:59], 0
    v_mfma_f32_16x16x32_bf16 v[164:167], a[152:155], v[40:43], v[164:167]
    v_mfma_f32_16x16x32_bf16 v[164:167], a[148:151], v[20:23], v[164:167]
    v_mfma_f32_16x16x32_bf16 v[164:167], a[144:147], v[0:3], v[164:167]
    v_mfma_f32_16x16x32_bf16 v[56:59], v[88:91], v[100:103], 0
    v_mfma_f32_16x16x32_bf16 v[56:59], v[28:31], v[68:71], v[56:59]
    v_mfma_f32_16x16x32_bf16 v[20:23], v[28:31], v[136:139], 0
    v_mfma_f32_16x16x32_bf16 v[20:23], v[88:91], v[80:83], v[20:23]
    v_mfma_f32_16x16x32_bf16 v[0:3], v[88:91], v[152:155], 0
    v_mfma_f32_16x16x32_bf16 v[0:3], v[28:31], v[52:55], v[0:3]
    v_mfma_f32_16x16x32_bf16 v[40:43], v[28:31], v[112:115], 0
    v_mfma_f32_16x16x32_bf16 v[40:43], v[88:91], v[172:175], v[40:43]
    s_waitcnt lgkmcnt(0)
    v_mfma_f32_16x16x32_bf16 v[164:167], a[160:163], v[16:19], v[164:167]
    ds_read_b64_tr_b16 v[28:29], v254 offset:32768
    v_cvt_pk_bf16_f32 v66, v56, v57
    v_mfma_f32_16x16x32_bf16 v[164:167], a[164:167], v[32:35], v[164:167]
    ds_read_b64_tr_b16 v[30:31], v254 offset:34816
    v_cvt_pk_bf16_f32 v67, v58, v59
    v_mfma_f32_16x16x32_bf16 v[164:167], a[168:171], v[92:95], v[164:167]
    ds_read_b64_tr_b16 v[52:53], v254 offset:36864
    v_cvt_pk_bf16_f32 v170, v20, v21
    v_mfma_f32_16x16x32_bf16 v[164:167], a[172:175], v[96:99], v[164:167]
    ds_read_b64_tr_b16 v[54:55], v254 offset:38912
    v_cvt_pk_bf16_f32 v171, v22, v23
    v_mfma_f32_16x16x32_bf16 v[104:107], a[124:127], v[96:99], v[104:107]
    ds_read_b64_tr_b16 v[56:57], v254 offset:40960
    v_cvt_pk_bf16_f32 v182, v0, v1
    v_mfma_f32_16x16x32_bf16 v[104:107], a[120:123], v[92:95], v[104:107]
    ds_read_b64_tr_b16 v[58:59], v254 offset:43008
    v_cvt_pk_bf16_f32 v183, v2, v3
    v_mfma_f32_16x16x32_bf16 v[104:107], a[116:119], v[32:35], v[104:107]
    ds_read_b64_tr_b16 v[20:21], v254 offset:45056
    v_cvt_pk_bf16_f32 v186, v40, v41
    v_mfma_f32_16x16x32_bf16 v[104:107], a[112:115], v[16:19], v[104:107]
    s_add_u32 m0, s29, 49152
    ds_read_b64_tr_b16 v[22:23], v254 offset:47104
    v_cvt_pk_bf16_f32 v187, v42, v43
    v_mfma_f32_16x16x32_bf16 v[84:87], a[64:67], v[16:19], v[84:87]
    global_load_lds_dwordx4 v250, s[20:21]
    v_mfma_f32_16x16x32_bf16 v[84:87], a[68:71], v[32:35], v[84:87]
    v_mfma_f32_16x16x32_bf16 v[84:87], a[72:75], v[92:95], v[84:87]
    v_xor_b32 v254, 65632, v255
    v_mfma_f32_16x16x32_bf16 v[84:87], a[76:79], v[96:99], v[84:87]
    v_mfma_f32_16x16x32_bf16 v[12:15], a[28:31], v[96:99], v[12:15]
    v_mfma_f32_16x16x32_bf16 v[12:15], a[24:27], v[92:95], v[12:15]
    v_mfma_f32_16x16x32_bf16 v[12:15], a[20:23], v[32:35], v[12:15]
    v_mfma_f32_16x16x32_bf16 v[12:15], a[16:19], v[16:19], v[12:15]
    s_waitcnt lgkmcnt(0)
    v_mfma_f32_16x16x32_bf16 v[12:15], a[32:35], v[28:31], v[12:15]
    ds_read_b64_tr_b16 v[0:1], v254 offset:0
    v_mfma_f32_16x16x32_bf16 v[12:15], a[36:39], v[52:55], v[12:15]
    ds_read_b64_tr_b16 v[2:3], v254 offset:2048
    v_mfma_f32_16x16x32_bf16 v[12:15], a[40:43], v[56:59], v[12:15]
    ds_read_b64_tr_b16 v[16:17], v254 offset:4096
    v_mfma_f32_16x16x32_bf16 v[12:15], a[44:47], v[20:23], v[12:15]
    ds_read_b64_tr_b16 v[18:19], v254 offset:6144
    v_mfma_f32_16x16x32_bf16 v[84:87], a[92:95], v[20:23], v[84:87]
    ds_read_b64_tr_b16 v[32:33], v254 offset:8192
    v_mfma_f32_16x16x32_bf16 v[84:87], a[88:91], v[56:59], v[84:87]
    ds_read_b64_tr_b16 v[34:35], v254 offset:10240
    v_mfma_f32_16x16x32_bf16 v[84:87], a[84:87], v[52:55], v[84:87]
    ds_read_b64_tr_b16 v[40:41], v254 offset:12288
    v_mfma_f32_16x16x32_bf16 v[84:87], a[80:83], v[28:31], v[84:87]
    s_add_u32 m0, s29, 53248
    ds_read_b64_tr_b16 v[42:43], v254 offset:14336
    v_cvt_pk_bf16_f32 v68, v12, v13
    v_mfma_f32_16x16x32_bf16 v[104:107], a[128:131], v[28:31], v[104:107]
    global_load_lds_dwordx4 v250, s[22:23]
    v_mfma_f32_16x16x32_bf16 v[104:107], a[132:135], v[52:55], v[104:107]
    v_cvt_pk_bf16_f32 v69, v14, v15
    v_mfma_f32_16x16x32_bf16 v[104:107], a[136:139], v[56:59], v[104:107]
    v_cvt_pk_bf16_f32 v70, v84, v85
    v_cvt_pk_bf16_f32 v71, v86, v87
    v_mfma_f32_16x16x32_bf16 v[104:107], a[140:143], v[20:23], v[104:107]
    v_mfma_f32_16x16x32_bf16 v[164:167], a[188:191], v[20:23], v[164:167]
G_16:
    s_cbranch_vccnz G_20
    v_mfma_f32_16x16x32_bf16 v[164:167], a[184:187], v[56:59], v[164:167]
    v_mfma_f32_16x16x32_bf16 v[164:167], a[180:183], v[52:55], v[164:167]
    v_mfma_f32_16x16x32_bf16 v[164:167], a[176:179], v[28:31], v[164:167]
    s_waitcnt lgkmcnt(0)
    v_mfma_f32_16x16x32_bf16 v[12:15], a[0:3], v[0:3], 0
    ds_read_b64_tr_b16 v[20:21], v254 offset:16384
    v_mfma_f32_16x16x32_bf16 v[12:15], a[4:7], v[16:19], v[12:15]
    ds_read_b64_tr_b16 v[22:23], v254 offset:18432
    v_cvt_pk_bf16_f32 v28, v104, v105
    v_mfma_f32_16x16x32_bf16 v[12:15], a[8:11], v[32:35], v[12:15]
    ds_read_b64_tr_b16 v[52:53], v254 offset:20480
    v_cvt_pk_bf16_f32 v29, v106, v107
    v_mfma_f32_16x16x32_bf16 v[12:15], a[12:15], v[40:43], v[12:15]
    ds_read_b64_tr_b16 v[54:55], v254 offset:22528
    v_cvt_pk_bf16_f32 v30, v164, v165
    v_mfma_f32_16x16x32_bf16 v[56:59], a[60:63], v[40:43], 0
    ds_read_b64_tr_b16 v[80:81], v254 offset:24576
    v_cvt_pk_bf16_f32 v31, v166, v167
    v_mfma_f32_16x16x32_bf16 v[56:59], a[56:59], v[32:35], v[56:59]
    ds_read_b64_tr_b16 v[82:83], v254 offset:26624
    v_mfma_f32_16x16x32_bf16 v[56:59], a[52:55], v[16:19], v[56:59]
    ds_read_b64_tr_b16 v[84:85], v254 offset:28672
    v_mfma_f32_16x16x32_bf16 v[56:59], a[48:51], v[0:3], v[56:59]
    s_add_u32 m0, s29, 57344
    ds_read_b64_tr_b16 v[86:87], v254 offset:30720
    v_mfma_f32_16x16x32_bf16 v[88:91], a[96:99], v[0:3], 0
    global_load_lds_dwordx4 v250, s[24:25]
    v_mfma_f32_16x16x32_bf16 v[88:91], a[100:103], v[16:19], v[88:91]
    v_mfma_f32_16x16x32_bf16 v[88:91], a[104:107], v[32:35], v[88:91]
    v_mfma_f32_16x16x32_bf16 v[88:91], a[108:111], v[40:43], v[88:91]
    v_mfma_f32_16x16x32_bf16 v[92:95], a[156:159], v[40:43], 0
    v_mfma_f32_16x16x32_bf16 v[92:95], a[152:155], v[32:35], v[92:95]
    v_mfma_f32_16x16x32_bf16 v[92:95], a[148:151], v[16:19], v[92:95]
    v_mfma_f32_16x16x32_bf16 v[92:95], a[144:147], v[0:3], v[92:95]
    s_waitcnt lgkmcnt(0)
    v_mfma_f32_16x16x32_bf16 v[92:95], a[160:163], v[20:23], v[92:95]
    ds_read_b64_tr_b16 v[16:17], v254 offset:32768
    v_mfma_f32_16x16x32_bf16 v[92:95], a[164:167], v[52:55], v[92:95]
    ds_read_b64_tr_b16 v[18:19], v254 offset:34816
    v_mfma_f32_16x16x32_bf16 v[92:95], a[168:171], v[80:83], v[92:95]
    ds_read_b64_tr_b16 v[0:1], v254 offset:36864
    v_mfma_f32_16x16x32_bf16 v[92:95], a[172:175], v[84:87], v[92:95]
    ds_read_b64_tr_b16 v[2:3], v254 offset:38912
    v_mfma_f32_16x16x32_bf16 v[88:91], a[124:127], v[84:87], v[88:91]
    ds_read_b64_tr_b16 v[32:33], v254 offset:40960
    v_mfma_f32_16x16x32_bf16 v[88:91], a[120:123], v[80:83], v[88:91]
    ds_read_b64_tr_b16 v[34:35], v254 offset:43008
    v_mfma_f32_16x16x32_bf16 v[88:91], a[116:119], v[52:55], v[88:91]
    ds_read_b64_tr_b16 v[40:41], v254 offset:45056
    v_mfma_f32_16x16x32_bf16 v[88:91], a[112:115], v[20:23], v[88:91]
    s_add_u32 m0, s29, 61440
    ds_read_b64_tr_b16 v[42:43], v254 offset:47104
    v_mfma_f32_16x16x32_bf16 v[56:59], a[64:67], v[20:23], v[56:59]
    global_load_lds_dwordx4 v250, s[26:27]
    v_mfma_f32_16x16x32_bf16 v[56:59], a[68:71], v[52:55], v[56:59]
    v_mfma_f32_16x16x32_bf16 v[56:59], a[72:75], v[80:83], v[56:59]
    v_xor_b32 v254, 114688, v255
    v_mfma_f32_16x16x32_bf16 v[56:59], a[76:79], v[84:87], v[56:59]
    v_mfma_f32_16x16x32_bf16 v[12:15], a[28:31], v[84:87], v[12:15]
    v_mfma_f32_16x16x32_bf16 v[12:15], a[24:27], v[80:83], v[12:15]
    v_mfma_f32_16x16x32_bf16 v[12:15], a[20:23], v[52:55], v[12:15]
    v_mfma_f32_16x16x32_bf16 v[12:15], a[16:19], v[20:23], v[12:15]
    s_waitcnt vmcnt(12) lgkmcnt(0)
    s_barrier
    v_mfma_f32_16x16x32_bf16 v[12:15], a[32:35], v[16:19], v[12:15]
    ds_read_b64_tr_b16 v[20:21], v254 offset:0
    v_mfma_f32_16x16x32_bf16 v[12:15], a[36:39], v[0:3], v[12:15]
    ds_read_b64_tr_b16 v[22:23], v254 offset:2048
    v_mfma_f32_16x16x32_bf16 v[12:15], a[40:43], v[32:35], v[12:15]
    ds_read_b64_tr_b16 v[52:53], v254 offset:4096
    v_mfma_f32_16x16x32_bf16 v[12:15], a[44:47], v[40:43], v[12:15]
    ds_read_b64_tr_b16 v[54:55], v254 offset:6144
    v_mfma_f32_16x16x32_bf16 v[56:59], a[92:95], v[40:43], v[56:59]
    ds_read_b64_tr_b16 v[80:81], v254 offset:8192
    v_mfma_f32_16x16x32_bf16 v[56:59], a[88:91], v[32:35], v[56:59]
    ds_read_b64_tr_b16 v[82:83], v254 offset:10240
    v_mfma_f32_16x16x32_bf16 v[56:59], a[84:87], v[0:3], v[56:59]
    ds_read_b64_tr_b16 v[84:85], v254 offset:12288
    v_mfma_f32_16x16x32_bf16 v[56:59], a[80:83], v[16:19], v[56:59]
    s_add_u32 m0, s29, 65408
    ds_read_b64_tr_b16 v[86:87], v254 offset:14336
    v_cvt_pk_bf16_f32 v96, v12, v13
    v_mfma_f32_16x16x32_bf16 v[88:91], a[128:131], v[16:19], v[88:91]
    global_load_lds_dwordx4 v250, s[4:5] offset:128
    v_mfma_f32_16x16x32_bf16 v[88:91], a[132:135], v[0:3], v[88:91]
    v_cvt_pk_bf16_f32 v97, v14, v15
    v_mfma_f32_16x16x32_bf16 v[88:91], a[136:139], v[32:35], v[88:91]
    v_cvt_pk_bf16_f32 v98, v56, v57
    v_cvt_pk_bf16_f32 v99, v58, v59
    v_mfma_f32_16x16x32_bf16 v[88:91], a[140:143], v[40:43], v[88:91]
    v_mfma_f32_16x16x32_bf16 v[92:95], a[188:191], v[40:43], v[92:95]
    v_mfma_f32_16x16x32_bf16 v[92:95], a[184:187], v[32:35], v[92:95]
    v_mfma_f32_16x16x32_bf16 v[92:95], a[180:183], v[0:3], v[92:95]
    v_mfma_f32_16x16x32_bf16 v[92:95], a[176:179], v[16:19], v[92:95]
    s_waitcnt lgkmcnt(0)
    v_mfma_f32_16x16x32_bf16 v[12:15], a[0:3], v[20:23], 0
    ds_read_b64_tr_b16 v[0:1], v254 offset:16384
    v_mfma_f32_16x16x32_bf16 v[12:15], a[4:7], v[52:55], v[12:15]
    ds_read_b64_tr_b16 v[2:3], v254 offset:18432
    v_cvt_pk_bf16_f32 v16, v88, v89
    v_mfma_f32_16x16x32_bf16 v[12:15], a[8:11], v[80:83], v[12:15]
    ds_read_b64_tr_b16 v[32:33], v254 offset:20480
    v_cvt_pk_bf16_f32 v17, v90, v91
    v_mfma_f32_16x16x32_bf16 v[12:15], a[12:15], v[84:87], v[12:15]
    ds_read_b64_tr_b16 v[34:35], v254 offset:22528
    v_cvt_pk_bf16_f32 v18, v92, v93
    v_mfma_f32_16x16x32_bf16 v[40:43], a[60:63], v[84:87], 0
    ds_read_b64_tr_b16 v[56:57], v254 offset:24576
    v_cvt_pk_bf16_f32 v19, v94, v95
    v_mfma_f32_16x16x32_bf16 v[40:43], a[56:59], v[80:83], v[40:43]
    ds_read_b64_tr_b16 v[58:59], v254 offset:26624
    v_mfma_f32_16x16x32_bf16 v[40:43], a[52:55], v[52:55], v[40:43]
    ds_read_b64_tr_b16 v[88:89], v254 offset:28672
    v_mfma_f32_16x16x32_bf16 v[40:43], a[48:51], v[20:23], v[40:43]
    s_add_u32 m0, s29, 69504
    ds_read_b64_tr_b16 v[90:91], v254 offset:30720
    v_mfma_f32_16x16x32_bf16 v[92:95], a[96:99], v[20:23], 0
    global_load_lds_dwordx4 v250, s[6:7] offset:128
    v_mfma_f32_16x16x32_bf16 v[92:95], a[100:103], v[52:55], v[92:95]
    v_mfma_f32_16x16x32_bf16 v[92:95], a[104:107], v[80:83], v[92:95]
    v_mfma_f32_16x16x32_bf16 v[92:95], a[108:111], v[84:87], v[92:95]
    v_mfma_f32_16x16x32_bf16 v[100:103], a[156:159], v[84:87], 0
    v_mfma_f32_16x16x32_bf16 v[100:103], a[152:155], v[80:83], v[100:103]
    v_mfma_f32_16x16x32_bf16 v[100:103], a[148:151], v[52:55], v[100:103]
    v_mfma_f32_16x16x32_bf16 v[100:103], a[144:147], v[20:23], v[100:103]
    s_waitcnt lgkmcnt(0)
    v_mfma_f32_16x16x32_bf16 v[100:103], a[160:163], v[0:3], v[100:103]
    ds_read_b64_tr_b16 v[52:53], v254 offset:32768
    v_mfma_f32_16x16x32_bf16 v[100:103], a[164:167], v[32:35], v[100:103]
    ds_read_b64_tr_b16 v[54:55], v254 offset:34816
    v_mfma_f32_16x16x32_bf16 v[100:103], a[168:171], v[56:59], v[100:103]
    ds_read_b64_tr_b16 v[20:21], v254 offset:36864
    v_mfma_f32_16x16x32_bf16 v[100:103], a[172:175], v[88:91], v[100:103]
    ds_read_b64_tr_b16 v[22:23], v254 offset:38912
    v_mfma_f32_16x16x32_bf16 v[92:95], a[124:127], v[88:91], v[92:95]
    ds_read_b64_tr_b16 v[80:81], v254 offset:40960
    v_mfma_f32_16x16x32_bf16 v[92:95], a[120:123], v[56:59], v[92:95]
    ds_read_b64_tr_b16 v[82:83], v254 offset:43008
    v_mfma_f32_16x16x32_bf16 v[92:95], a[116:119], v[32:35], v[92:95]
    ds_read_b64_tr_b16 v[84:85], v254 offset:45056
    v_mfma_f32_16x16x32_bf16 v[92:95], a[112:115], v[0:3], v[92:95]
    s_add_u32 m0, s29, 73600
    ds_read_b64_tr_b16 v[86:87], v254 offset:47104
    v_mfma_f32_16x16x32_bf16 v[40:43], a[64:67], v[0:3], v[40:43]
    global_load_lds_dwordx4 v250, s[8:9] offset:128
    v_mfma_f32_16x16x32_bf16 v[40:43], a[68:71], v[32:35], v[40:43]
    v_mfma_f32_16x16x32_bf16 v[40:43], a[72:75], v[56:59], v[40:43]
    v_xor_b32 v254, 114720, v255
    v_mfma_f32_16x16x32_bf16 v[40:43], a[76:79], v[88:91], v[40:43]
    v_mfma_f32_16x16x32_bf16 v[12:15], a[28:31], v[88:91], v[12:15]
    v_mfma_f32_16x16x32_bf16 v[12:15], a[24:27], v[56:59], v[12:15]
    v_mfma_f32_16x16x32_bf16 v[12:15], a[20:23], v[32:35], v[12:15]
    v_mfma_f32_16x16x32_bf16 v[12:15], a[16:19], v[0:3], v[12:15]
    s_waitcnt lgkmcnt(0)
    v_mfma_f32_16x16x32_bf16 v[12:15], a[32:35], v[52:55], v[12:15]
    ds_read_b64_tr_b16 v[32:33], v254 offset:0
    v_mfma_f32_16x16x32_bf16 v[12:15], a[36:39], v[20:23], v[12:15]
    ds_read_b64_tr_b16 v[34:35], v254 offset:2048
    v_mfma_f32_16x16x32_bf16 v[12:15], a[40:43], v[80:83], v[12:15]
    ds_read_b64_tr_b16 v[0:1], v254 offset:4096
    v_mfma_f32_16x16x32_bf16 v[12:15], a[44:47], v[84:87], v[12:15]
    ds_read_b64_tr_b16 v[2:3], v254 offset:6144
    v_mfma_f32_16x16x32_bf16 v[40:43], a[92:95], v[84:87], v[40:43]
    ds_read_b64_tr_b16 v[56:57], v254 offset:8192
    v_mfma_f32_16x16x32_bf16 v[40:43], a[88:91], v[80:83], v[40:43]
    ds_read_b64_tr_b16 v[58:59], v254 offset:10240
    v_mfma_f32_16x16x32_bf16 v[40:43], a[84:87], v[20:23], v[40:43]
    ds_read_b64_tr_b16 v[88:89], v254 offset:12288
    v_mfma_f32_16x16x32_bf16 v[40:43], a[80:83], v[52:55], v[40:43]
    s_add_u32 m0, s29, 77696
    ds_read_b64_tr_b16 v[90:91], v254 offset:14336
    v_cvt_pk_bf16_f32 v104, v12, v13
    v_mfma_f32_16x16x32_bf16 v[92:95], a[128:131], v[52:55], v[92:95]
    global_load_lds_dwordx4 v250, s[10:11] offset:128
    v_mfma_f32_16x16x32_bf16 v[92:95], a[132:135], v[20:23], v[92:95]
    v_cvt_pk_bf16_f32 v105, v14, v15
    v_mfma_f32_16x16x32_bf16 v[92:95], a[136:139], v[80:83], v[92:95]
    v_cvt_pk_bf16_f32 v106, v40, v41
    v_cvt_pk_bf16_f32 v107, v42, v43
    v_mfma_f32_16x16x32_bf16 v[92:95], a[140:143], v[84:87], v[92:95]
    v_mfma_f32_16x16x32_bf16 v[100:103], a[188:191], v[84:87], v[100:103]
    v_mfma_f32_16x16x32_bf16 v[100:103], a[184:187], v[80:83], v[100:103]
    v_mfma_f32_16x16x32_bf16 v[100:103], a[180:183], v[20:23], v[100:103]
    v_mfma_f32_16x16x32_bf16 v[100:103], a[176:179], v[52:55], v[100:103]
    s_waitcnt lgkmcnt(0)
    v_mfma_f32_16x16x32_bf16 v[12:15], a[0:3], v[32:35], 0
    ds_read_b64_tr_b16 v[20:21], v254 offset:16384
    v_mfma_f32_16x16x32_bf16 v[12:15], a[4:7], v[0:3], v[12:15]
    ds_read_b64_tr_b16 v[22:23], v254 offset:18432
    v_cvt_pk_bf16_f32 v40, v92, v93
    v_mfma_f32_16x16x32_bf16 v[12:15], a[8:11], v[56:59], v[12:15]
    ds_read_b64_tr_b16 v[52:53], v254 offset:20480
    v_cvt_pk_bf16_f32 v41, v94, v95
    v_mfma_f32_16x16x32_bf16 v[12:15], a[12:15], v[88:91], v[12:15]
    ds_read_b64_tr_b16 v[54:55], v254 offset:22528
    v_cvt_pk_bf16_f32 v42, v100, v101
    v_mfma_f32_16x16x32_bf16 v[80:83], a[60:63], v[88:91], 0
    ds_read_b64_tr_b16 v[84:85], v254 offset:24576
    v_cvt_pk_bf16_f32 v43, v102, v103
    v_mfma_f32_16x16x32_bf16 v[80:83], a[56:59], v[56:59], v[80:83]
    ds_read_b64_tr_b16 v[86:87], v254 offset:26624
    v_mfma_f32_16x16x32_bf16 v[80:83], a[52:55], v[0:3], v[80:83]
    ds_read_b64_tr_b16 v[92:93], v254 offset:28672
    v_mfma_f32_16x16x32_bf16 v[80:83], a[48:51], v[32:35], v[80:83]
    s_add_u32 m0, s29, 81792
    ds_read_b64_tr_b16 v[94:95], v254 offset:30720
    v_mfma_f32_16x16x32_bf16 v[100:103], a[96:99], v[32:35], 0
    global_load_lds_dwordx4 v250, s[12:13] offset:128
    v_mfma_f32_16x16x32_bf16 v[100:103], a[100:103], v[0:3], v[100:103]
    v_mfma_f32_16x16x32_bf16 v[100:103], a[104:107], v[56:59], v[100:103]
    v_mfma_f32_16x16x32_bf16 v[100:103], a[108:111], v[88:91], v[100:103]
    v_mfma_f32_16x16x32_bf16 v[112:115], a[156:159], v[88:91], 0
    v_mfma_f32_16x16x32_bf16 v[112:115], a[152:155], v[56:59], v[112:115]
    v_mfma_f32_16x16x32_bf16 v[112:115], a[148:151], v[0:3], v[112:115]
    v_mfma_f32_16x16x32_bf16 v[112:115], a[144:147], v[32:35], v[112:115]
    s_waitcnt lgkmcnt(0)
    v_mfma_f32_16x16x32_bf16 v[112:115], a[160:163], v[20:23], v[112:115]
    ds_read_b64_tr_b16 v[0:1], v254 offset:32768
    v_mfma_f32_16x16x32_bf16 v[112:115], a[164:167], v[52:55], v[112:115]
    ds_read_b64_tr_b16 v[2:3], v254 offset:34816
    v_mfma_f32_16x16x32_bf16 v[112:115], a[168:171], v[84:87], v[112:115]
    ds_read_b64_tr_b16 v[32:33], v254 offset:36864
    v_mfma_f32_16x16x32_bf16 v[112:115], a[172:175], v[92:95], v[112:115]
    ds_read_b64_tr_b16 v[34:35], v254 offset:38912
    v_mfma_f32_16x16x32_bf16 v[100:103], a[124:127], v[92:95], v[100:103]
    ds_read_b64_tr_b16 v[56:57], v254 offset:40960
    v_mfma_f32_16x16x32_bf16 v[100:103], a[120:123], v[84:87], v[100:103]
    ds_read_b64_tr_b16 v[58:59], v254 offset:43008
    v_mfma_f32_16x16x32_bf16 v[100:103], a[116:119], v[52:55], v[100:103]
    ds_read_b64_tr_b16 v[88:89], v254 offset:45056
    v_mfma_f32_16x16x32_bf16 v[100:103], a[112:115], v[20:23], v[100:103]
    s_add_u32 m0, s29, 85888
    ds_read_b64_tr_b16 v[90:91], v254 offset:47104
    v_mfma_f32_16x16x32_bf16 v[80:83], a[64:67], v[20:23], v[80:83]
    global_load_lds_dwordx4 v250, s[14:15] offset:128
    v_mfma_f32_16x16x32_bf16 v[80:83], a[68:71], v[52:55], v[80:83]
    v_mfma_f32_16x16x32_bf16 v[80:83], a[72:75], v[84:87], v[80:83]
    v_xor_b32 v254, 114752, v255
    v_mfma_f32_16x16x32_bf16 v[80:83], a[76:79], v[92:95], v[80:83]
    v_mfma_f32_16x16x32_bf16 v[12:15], a[28:31], v[92:95], v[12:15]
    v_mfma_f32_16x16x32_bf16 v[12:15], a[24:27], v[84:87], v[12:15]
    v_mfma_f32_16x16x32_bf16 v[12:15], a[20:23], v[52:55], v[12:15]
    v_mfma_f32_16x16x32_bf16 v[12:15], a[16:19], v[20:23], v[12:15]
    s_waitcnt lgkmcnt(0)
    v_mfma_f32_16x16x32_bf16 v[12:15], a[32:35], v[0:3], v[12:15]
    ds_read_b64_tr_b16 v[52:53], v254 offset:0
    v_mfma_f32_16x16x32_bf16 v[12:15], a[36:39], v[32:35], v[12:15]
    ds_read_b64_tr_b16 v[54:55], v254 offset:2048
    v_mfma_f32_16x16x32_bf16 v[12:15], a[40:43], v[56:59], v[12:15]
    ds_read_b64_tr_b16 v[20:21], v254 offset:4096
    v_mfma_f32_16x16x32_bf16 v[12:15], a[44:47], v[88:91], v[12:15]
    ds_read_b64_tr_b16 v[22:23], v254 offset:6144
    v_mfma_f32_16x16x32_bf16 v[80:83], a[92:95], v[88:91], v[80:83]
    ds_read_b64_tr_b16 v[84:85], v254 offset:8192
    v_mfma_f32_16x16x32_bf16 v[80:83], a[88:91], v[56:59], v[80:83]
    ds_read_b64_tr_b16 v[86:87], v254 offset:10240
    v_mfma_f32_16x16x32_bf16 v[80:83], a[84:87], v[32:35], v[80:83]
    ds_read_b64_tr_b16 v[92:93], v254 offset:12288
    v_mfma_f32_16x16x32_bf16 v[80:83], a[80:83], v[0:3], v[80:83]
    s_add_u32 m0, s29, 89984
    ds_read_b64_tr_b16 v[94:95], v254 offset:14336
    v_cvt_pk_bf16_f32 v136, v12, v13
    v_mfma_f32_16x16x32_bf16 v[100:103], a[128:131], v[0:3], v[100:103]
    global_load_lds_dwordx4 v250, s[16:17] offset:128
    v_mfma_f32_16x16x32_bf16 v[100:103], a[132:135], v[32:35], v[100:103]
    v_cvt_pk_bf16_f32 v137, v14, v15
    v_mfma_f32_16x16x32_bf16 v[100:103], a[136:139], v[56:59], v[100:103]
    v_cvt_pk_bf16_f32 v138, v80, v81
    v_cvt_pk_bf16_f32 v139, v82, v83
    v_mfma_f32_16x16x32_bf16 v[100:103], a[140:143], v[88:91], v[100:103]
    v_mfma_f32_16x16x32_bf16 v[112:115], a[188:191], v[88:91], v[112:115]
    v_mfma_f32_16x16x32_bf16 v[112:115], a[184:187], v[56:59], v[112:115]
    v_mfma_f32_16x16x32_bf16 v[112:115], a[180:183], v[32:35], v[112:115]
    v_mfma_f32_16x16x32_bf16 v[112:115], a[176:179], v[0:3], v[112:115]
    s_waitcnt lgkmcnt(0)
    v_mfma_f32_16x16x32_bf16 v[12:15], a[0:3], v[52:55], 0
    ds_read_b64_tr_b16 v[32:33], v254 offset:16384
    v_mfma_f32_16x16x32_bf16 v[12:15], a[4:7], v[20:23], v[12:15]
    ds_read_b64_tr_b16 v[34:35], v254 offset:18432
    v_cvt_pk_bf16_f32 v0, v100, v101
    v_mfma_f32_16x16x32_bf16 v[12:15], a[8:11], v[84:87], v[12:15]
    ds_read_b64_tr_b16 v[56:57], v254 offset:20480
    v_cvt_pk_bf16_f32 v1, v102, v103
    v_mfma_f32_16x16x32_bf16 v[12:15], a[12:15], v[92:95], v[12:15]
    ds_read_b64_tr_b16 v[58:59], v254 offset:22528
    v_cvt_pk_bf16_f32 v2, v112, v113
    v_mfma_f32_16x16x32_bf16 v[80:83], a[60:63], v[92:95], 0
    ds_read_b64_tr_b16 v[88:89], v254 offset:24576
    v_cvt_pk_bf16_f32 v3, v114, v115
    v_mfma_f32_16x16x32_bf16 v[80:83], a[56:59], v[84:87], v[80:83]
    ds_read_b64_tr_b16 v[90:91], v254 offset:26624
    v_mfma_f32_16x16x32_bf16 v[80:83], a[52:55], v[20:23], v[80:83]
    ds_read_b64_tr_b16 v[100:101], v254 offset:28672
    v_mfma_f32_16x16x32_bf16 v[80:83], a[48:51], v[52:55], v[80:83]
    s_add_u32 m0, s29, 94080
    ds_read_b64_tr_b16 v[102:103], v254 offset:30720
    v_mfma_f32_16x16x32_bf16 v[112:115], a[96:99], v[52:55], 0
    global_load_lds_dwordx4 v250, s[18:19] offset:128
    v_mfma_f32_16x16x32_bf16 v[112:115], a[100:103], v[20:23], v[112:115]
    v_mfma_f32_16x16x32_bf16 v[112:115], a[104:107], v[84:87], v[112:115]
    v_mfma_f32_16x16x32_bf16 v[112:115], a[108:111], v[92:95], v[112:115]
    v_mfma_f32_16x16x32_bf16 v[152:155], a[156:159], v[92:95], 0
    v_mfma_f32_16x16x32_bf16 v[152:155], a[152:155], v[84:87], v[152:155]
    v_mfma_f32_16x16x32_bf16 v[152:155], a[148:151], v[20:23], v[152:155]
    v_mfma_f32_16x16x32_bf16 v[152:155], a[144:147], v[52:55], v[152:155]
    s_waitcnt lgkmcnt(0)
    v_mfma_f32_16x16x32_bf16 v[152:155], a[160:163], v[32:35], v[152:155]
    ds_read_b64_tr_b16 v[20:21], v254 offset:32768
    v_mfma_f32_16x16x32_bf16 v[152:155], a[164:167], v[56:59], v[152:155]
    ds_read_b64_tr_b16 v[22:23], v254 offset:34816
    v_mfma_f32_16x16x32_bf16 v[152:155], a[168:171], v[88:91], v[152:155]
    ds_read_b64_tr_b16 v[52:53], v254 offset:36864
    v_mfma_f32_16x16x32_bf16 v[152:155], a[172:175], v[100:103], v[152:155]
    ds_read_b64_tr_b16 v[54:55], v254 offset:38912
    v_mfma_f32_16x16x32_bf16 v[112:115], a[124:127], v[100:103], v[112:115]
    ds_read_b64_tr_b16 v[84:85], v254 offset:40960
    v_mfma_f32_16x16x32_bf16 v[112:115], a[120:123], v[88:91], v[112:115]
    ds_read_b64_tr_b16 v[86:87], v254 offset:43008
    v_mfma_f32_16x16x32_bf16 v[112:115], a[116:119], v[56:59], v[112:115]
    ds_read_b64_tr_b16 v[92:93], v254 offset:45056
    v_mfma_f32_16x16x32_bf16 v[112:115], a[112:115], v[32:35], v[112:115]
    s_add_u32 m0, s29, 98176
    ds_read_b64_tr_b16 v[94:95], v254 offset:47104
    v_mfma_f32_16x16x32_bf16 v[80:83], a[64:67], v[32:35], v[80:83]
    global_load_lds_dwordx4 v250, s[20:21] offset:128
    v_mfma_f32_16x16x32_bf16 v[80:83], a[68:71], v[56:59], v[80:83]
    v_mfma_f32_16x16x32_bf16 v[80:83], a[72:75], v[88:91], v[80:83]
    v_xor_b32 v254, 114784, v255
    v_mfma_f32_16x16x32_bf16 v[80:83], a[76:79], v[100:103], v[80:83]
    v_mfma_f32_16x16x32_bf16 v[12:15], a[28:31], v[100:103], v[12:15]
    v_mfma_f32_16x16x32_bf16 v[12:15], a[24:27], v[88:91], v[12:15]
    v_mfma_f32_16x16x32_bf16 v[12:15], a[20:23], v[56:59], v[12:15]
    v_mfma_f32_16x16x32_bf16 v[12:15], a[16:19], v[32:35], v[12:15]
    s_waitcnt lgkmcnt(0)
    v_mfma_f32_16x16x32_bf16 v[12:15], a[32:35], v[20:23], v[12:15]
    ds_read_b64_tr_b16 v[56:57], v254 offset:0
    v_mfma_f32_16x16x32_bf16 v[12:15], a[36:39], v[52:55], v[12:15]
    ds_read_b64_tr_b16 v[58:59], v254 offset:2048
    v_mfma_f32_16x16x32_bf16 v[12:15], a[40:43], v[84:87], v[12:15]
    ds_read_b64_tr_b16 v[32:33], v254 offset:4096
    v_mfma_f32_16x16x32_bf16 v[12:15], a[44:47], v[92:95], v[12:15]
    ds_read_b64_tr_b16 v[34:35], v254 offset:6144
    v_mfma_f32_16x16x32_bf16 v[80:83], a[92:95], v[92:95], v[80:83]
    ds_read_b64_tr_b16 v[88:89], v254 offset:8192
    v_mfma_f32_16x16x32_bf16 v[80:83], a[88:91], v[84:87], v[80:83]
    ds_read_b64_tr_b16 v[90:91], v254 offset:10240
    v_mfma_f32_16x16x32_bf16 v[80:83], a[84:87], v[52:55], v[80:83]
    ds_read_b64_tr_b16 v[100:101], v254 offset:12288
    v_mfma_f32_16x16x32_bf16 v[80:83], a[80:83], v[20:23], v[80:83]
    s_add_u32 m0, s29, 102272
    ds_read_b64_tr_b16 v[102:103], v254 offset:14336
    v_mbcnt_lo_u32_b32 v255, -1, 0
    v_mfma_f32_16x16x32_bf16 v[112:115], a[128:131], v[20:23], v[112:115]
    global_load_lds_dwordx4 v250, s[22:23] offset:128
    v_mfma_f32_16x16x32_bf16 v[112:115], a[132:135], v[52:55], v[112:115]
    v_mbcnt_hi_u32_b32 v253, -1, v255
    v_lshrrev_b32 v252, 4, v253
    v_mfma_f32_16x16x32_bf16 v[112:115], a[136:139], v[84:87], v[112:115]
    v_bfe_u32 v251, v253, 2, 2
    v_lshl_add_u32 v255, v252, 2, v251
    v_mfma_f32_16x16x32_bf16 v[112:115], a[140:143], v[92:95], v[112:115]
    v_bfe_u32 v249, v255, 1, 2
    v_bfe_u32 v248, v253, 1, 1
    v_mfma_f32_16x16x32_bf16 v[152:155], a[188:191], v[92:95], v[152:155]
    v_xor_b32 v252, v248, v249
    v_lshlrev_b32 v251, 7, v255
    v_mfma_f32_16x16x32_bf16 v[152:155], a[184:187], v[84:87], v[152:155]
    v_and_b32 v247, 1, v253
    v_lshl_add_u32 v249, v252, 5, v251
    v_mfma_f32_16x16x32_bf16 v[152:155], a[180:183], v[52:55], v[152:155]
    v_lshl_add_u32 v255, v247, 4, v249
    v_cvt_pk_bf16_f32 v84, v12, v13
    v_mfma_f32_16x16x32_bf16 v[152:155], a[176:179], v[20:23], v[152:155]
    s_waitcnt lgkmcnt(0)
    v_cvt_pk_bf16_f32 v85, v14, v15
    v_cvt_pk_bf16_f32 v86, v80, v81
    v_mfma_f32_16x16x32_bf16 v[20:23], a[0:3], v[56:59], 0
    ds_read_b64_tr_b16 v[52:53], v254 offset:16384
    v_cvt_pk_bf16_f32 v87, v82, v83
    v_mfma_f32_16x16x32_bf16 v[20:23], a[4:7], v[32:35], v[20:23]
    ds_read_b64_tr_b16 v[54:55], v254 offset:18432
    v_cvt_pk_bf16_f32 v12, v112, v113
    v_mfma_f32_16x16x32_bf16 v[20:23], a[8:11], v[88:91], v[20:23]
    ds_read_b64_tr_b16 v[80:81], v254 offset:20480
    v_cvt_pk_bf16_f32 v13, v114, v115
    v_mfma_f32_16x16x32_bf16 v[20:23], a[12:15], v[100:103], v[20:23]
    ds_read_b64_tr_b16 v[82:83], v254 offset:22528
    v_cvt_pk_bf16_f32 v14, v152, v153
    v_mfma_f32_16x16x32_bf16 v[92:95], a[60:63], v[100:103], 0
    ds_read_b64_tr_b16 v[112:113], v254 offset:24576
    v_cvt_pk_bf16_f32 v15, v154, v155
    v_mfma_f32_16x16x32_bf16 v[92:95], a[56:59], v[88:91], v[92:95]
    ds_read_b64_tr_b16 v[114:115], v254 offset:26624
    v_mfma_f32_16x16x32_bf16 v[92:95], a[52:55], v[32:35], v[92:95]
    ds_read_b64_tr_b16 v[152:153], v254 offset:28672
    v_mfma_f32_16x16x32_bf16 v[92:95], a[48:51], v[56:59], v[92:95]
    s_add_u32 m0, s29, 106368
    ds_read_b64_tr_b16 v[154:155], v254 offset:30720
    v_mfma_f32_16x16x32_bf16 v[164:167], a[96:99], v[56:59], 0
    global_load_lds_dwordx4 v250, s[24:25] offset:128
    v_mfma_f32_16x16x32_bf16 v[164:167], a[100:103], v[32:35], v[164:167]
    v_mfma_f32_16x16x32_bf16 v[164:167], a[104:107], v[88:91], v[164:167]
    v_mfma_f32_16x16x32_bf16 v[164:167], a[108:111], v[100:103], v[164:167]
    v_mfma_f32_16x16x32_bf16 v[172:175], a[156:159], v[100:103], 0
    v_mfma_f32_16x16x32_bf16 v[172:175], a[152:155], v[88:91], v[172:175]
    v_mfma_f32_16x16x32_bf16 v[172:175], a[148:151], v[32:35], v[172:175]
    v_mfma_f32_16x16x32_bf16 v[172:175], a[144:147], v[56:59], v[172:175]
    s_waitcnt lgkmcnt(0)
    v_mfma_f32_16x16x32_bf16 v[172:175], a[160:163], v[52:55], v[172:175]
    ds_read_b64_tr_b16 v[32:33], v254 offset:32768
    v_mfma_f32_16x16x32_bf16 v[172:175], a[164:167], v[80:83], v[172:175]
    ds_read_b64_tr_b16 v[34:35], v254 offset:34816
    v_mfma_f32_16x16x32_bf16 v[172:175], a[168:171], v[112:115], v[172:175]
    ds_read_b64_tr_b16 v[56:57], v254 offset:36864
    v_mfma_f32_16x16x32_bf16 v[172:175], a[172:175], v[152:155], v[172:175]
    ds_read_b64_tr_b16 v[58:59], v254 offset:38912
    v_mfma_f32_16x16x32_bf16 v[164:167], a[124:127], v[152:155], v[164:167]
    ds_read_b64_tr_b16 v[88:89], v254 offset:40960
    v_mfma_f32_16x16x32_bf16 v[164:167], a[120:123], v[112:115], v[164:167]
    ds_read_b64_tr_b16 v[90:91], v254 offset:43008
    v_mfma_f32_16x16x32_bf16 v[164:167], a[116:119], v[80:83], v[164:167]
    ds_read_b64_tr_b16 v[100:101], v254 offset:45056
    v_mfma_f32_16x16x32_bf16 v[164:167], a[112:115], v[52:55], v[164:167]
    s_add_u32 m0, s29, 110464
    ds_read_b64_tr_b16 v[102:103], v254 offset:47104
    v_mfma_f32_16x16x32_bf16 v[92:95], a[64:67], v[52:55], v[92:95]
    global_load_lds_dwordx4 v250, s[26:27] offset:128
    v_mfma_f32_16x16x32_bf16 v[92:95], a[68:71], v[80:83], v[92:95]
    v_mfma_f32_16x16x32_bf16 v[92:95], a[72:75], v[112:115], v[92:95]
    v_xor_b32 v254, 16384, v255
    v_mfma_f32_16x16x32_bf16 v[92:95], a[76:79], v[152:155], v[92:95]
    v_mfma_f32_16x16x32_bf16 v[20:23], a[28:31], v[152:155], v[20:23]
    v_mfma_f32_16x16x32_bf16 v[20:23], a[24:27], v[112:115], v[20:23]
    v_mfma_f32_16x16x32_bf16 v[20:23], a[20:23], v[80:83], v[20:23]
    v_mfma_f32_16x16x32_bf16 v[20:23], a[16:19], v[52:55], v[20:23]
    s_waitcnt vmcnt(12) lgkmcnt(0)
    s_barrier
    v_mfma_f32_16x16x32_bf16 v[20:23], a[32:35], v[32:35], v[20:23]
    ds_read_b64_tr_b16 v[52:53], v254 offset:0
    v_mfma_f32_16x16x32_bf16 v[20:23], a[36:39], v[56:59], v[20:23]
    ds_read_b64_tr_b16 v[54:55], v254 offset:2048
    v_mfma_f32_16x16x32_bf16 v[20:23], a[40:43], v[88:91], v[20:23]
    ds_read_b64_tr_b16 v[80:81], v254 offset:4096
    v_mfma_f32_16x16x32_bf16 v[20:23], a[44:47], v[100:103], v[20:23]
    ds_read_b64_tr_b16 v[82:83], v254 offset:6144
    v_mfma_f32_16x16x32_bf16 v[92:95], a[92:95], v[100:103], v[92:95]
    ds_read_b64_tr_b16 v[112:113], v254 offset:8192
    v_mfma_f32_16x16x32_bf16 v[92:95], a[88:91], v[88:91], v[92:95]
    ds_read_b64_tr_b16 v[114:115], v254 offset:10240
    v_mfma_f32_16x16x32_bf16 v[92:95], a[84:87], v[56:59], v[92:95]
    ds_read_b64_tr_b16 v[152:153], v254 offset:12288
    v_mfma_f32_16x16x32_bf16 v[92:95], a[80:83], v[32:35], v[92:95]
    ds_read_b64_tr_b16 v[154:155], v254 offset:14336
    v_cvt_pk_bf16_f32 v192, v20, v21
    v_mfma_f32_16x16x32_bf16 v[164:167], a[128:131], v[32:35], v[164:167]
    ds_read_b64_tr_b16 v[200:201], v254 offset:16384
    v_cvt_pk_bf16_f32 v193, v22, v23
    v_mfma_f32_16x16x32_bf16 v[164:167], a[132:135], v[56:59], v[164:167]
    ds_read_b64_tr_b16 v[202:203], v254 offset:18432
    v_mfma_f32_16x16x32_bf16 v[164:167], a[136:139], v[88:91], v[164:167]
    ds_read_b64_tr_b16 v[20:21], v254 offset:20480
    v_cvt_pk_bf16_f32 v194, v92, v93
    v_mfma_f32_16x16x32_bf16 v[164:167], a[140:143], v[100:103], v[164:167]
    ds_read_b64_tr_b16 v[22:23], v254 offset:22528
    v_cvt_pk_bf16_f32 v195, v94, v95
    v_mfma_f32_16x16x32_bf16 v[172:175], a[188:191], v[100:103], v[172:175]
    ds_read_b64_tr_b16 v[208:209], v254 offset:24576
    v_mfma_f32_16x16x32_bf16 v[172:175], a[184:187], v[88:91], v[172:175]
    ds_read_b64_tr_b16 v[210:211], v254 offset:26624
    v_mfma_f32_16x16x32_bf16 v[172:175], a[180:183], v[56:59], v[172:175]
    ds_read_b64_tr_b16 v[92:93], v254 offset:28672
    v_cvt_pk_bf16_f32 v88, v164, v165
    v_mfma_f32_16x16x32_bf16 v[172:175], a[176:179], v[32:35], v[172:175]
    ds_read_b64_tr_b16 v[94:95], v254 offset:30720
    v_cvt_pk_bf16_f32 v89, v166, v167
    v_mfma_f32_16x16x32_bf16 v[56:59], v[68:71], v[48:51], 0
    ds_read_b64_tr_b16 v[32:33], v254 offset:32768
    v_mfma_f32_16x16x32_bf16 v[56:59], v[28:31], v[176:179], v[56:59]
    ds_read_b64_tr_b16 v[34:35], v254 offset:34816
    v_mfma_f32_16x16x32_bf16 v[100:103], v[28:31], v[188:191], 0
    ds_read_b64_tr_b16 v[164:165], v254 offset:36864
    v_cvt_pk_bf16_f32 v90, v172, v173
    v_mfma_f32_16x16x32_bf16 v[100:103], v[68:71], v[156:159], v[100:103]
    ds_read_b64_tr_b16 v[166:167], v254 offset:38912
    v_cvt_pk_bf16_f32 v91, v174, v175
    v_mfma_f32_16x16x32_bf16 v[212:215], v[68:71], v[132:135], 0
    ds_read_b64_tr_b16 v[216:217], v254 offset:40960
    v_cvt_pk_bf16_f32 v220, v56, v57
    v_mfma_f32_16x16x32_bf16 v[212:215], v[28:31], v[196:199], v[212:215]
    ds_read_b64_tr_b16 v[218:219], v254 offset:43008
    v_cvt_pk_bf16_f32 v221, v58, v59
    v_mfma_f32_16x16x32_bf16 v[172:175], v[28:31], v[144:147], 0
    ds_read_b64_tr_b16 v[224:225], v254 offset:45056
    v_cvt_pk_bf16_f32 v228, v100, v101
    v_mfma_f32_16x16x32_bf16 v[172:175], v[68:71], v[204:207], v[172:175]
    s_add_u32 m0, s29, 114432
    ds_read_b64_tr_b16 v[226:227], v254 offset:47104
    v_cvt_pk_bf16_f32 v229, v102, v103
    v_mfma_f32_16x16x32_bf16 v[28:31], v[96:99], v[48:51], 0
    global_load_lds_dwordx4 v250, s[4:5] offset:256
    v_mfma_f32_16x16x32_bf16 v[28:31], v[16:19], v[176:179], v[28:31]
    s_add_u32 m0, s29, 118528
    v_cvt_pk_bf16_f32 v56, v212, v213
    v_cvt_pk_bf16_f32 v57, v214, v215
    v_mfma_f32_16x16x32_bf16 v[68:71], v[16:19], v[188:191], 0
    global_load_lds_dwordx4 v250, s[6:7] offset:256
    v_mfma_f32_16x16x32_bf16 v[68:71], v[96:99], v[156:159], v[68:71]
    s_add_u32 m0, s29, 122624
    v_cvt_pk_bf16_f32 v100, v172, v173
    v_cvt_pk_bf16_f32 v101, v174, v175
    v_mfma_f32_16x16x32_bf16 v[212:215], v[96:99], v[132:135], 0
    global_load_lds_dwordx4 v250, s[8:9] offset:256
    v_mfma_f32_16x16x32_bf16 v[212:215], v[16:19], v[196:199], v[212:215]
    v_cvt_pk_bf16_f32 v222, v28, v29
    v_cvt_pk_bf16_f32 v223, v30, v31
    v_mfma_f32_16x16x32_bf16 v[172:175], v[16:19], v[144:147], 0
    v_cvt_pk_bf16_f32 v230, v68, v69
    v_cvt_pk_bf16_f32 v231, v70, v71
    v_mfma_f32_16x16x32_bf16 v[172:175], v[96:99], v[204:207], v[172:175]
    v_mfma_f32_16x16x32_bf16 v[16:19], v[104:107], v[48:51], 0
    v_mfma_f32_16x16x32_bf16 v[16:19], v[40:43], v[176:179], v[16:19]
    v_cvt_pk_bf16_f32 v58, v212, v213
G_17:
    s_cbranch_vccnz G_21
    v_cvt_pk_bf16_f32 v59, v214, v215
    v_mfma_f32_16x16x32_bf16 v[28:31], v[40:43], v[188:191], 0
    v_mfma_f32_16x16x32_bf16 v[28:31], v[104:107], v[156:159], v[28:31]
    v_mfma_f32_16x16x32_bf16 v[68:71], v[104:107], v[132:135], 0
    v_mfma_f32_16x16x32_bf16 v[68:71], v[40:43], v[196:199], v[68:71]
    v_cvt_pk_bf16_f32 v102, v172, v173
    v_cvt_pk_bf16_f32 v103, v174, v175
    v_mfma_f32_16x16x32_bf16 v[96:99], v[40:43], v[144:147], 0
    v_cvt_pk_bf16_f32 v212, v16, v17
    v_cvt_pk_bf16_f32 v213, v18, v19
    v_mfma_f32_16x16x32_bf16 v[96:99], v[104:107], v[204:207], v[96:99]
    v_cvt_pk_bf16_f32 v40, v28, v29
    v_cvt_pk_bf16_f32 v41, v30, v31
    v_mfma_f32_16x16x32_bf16 v[16:19], v[136:139], v[48:51], 0
    v_cvt_pk_bf16_f32 v104, v68, v69
    v_cvt_pk_bf16_f32 v105, v70, v71
    v_mfma_f32_16x16x32_bf16 v[16:19], v[0:3], v[176:179], v[16:19]
    v_mfma_f32_16x16x32_bf16 v[28:31], v[0:3], v[188:191], 0
    v_mfma_f32_16x16x32_bf16 v[28:31], v[136:139], v[156:159], v[28:31]
    v_cvt_pk_bf16_f32 v68, v96, v97
    v_cvt_pk_bf16_f32 v69, v98, v99
    v_mfma_f32_16x16x32_bf16 v[172:175], v[136:139], v[132:135], 0
    v_mfma_f32_16x16x32_bf16 v[172:175], v[0:3], v[196:199], v[172:175]
    v_mfma_f32_16x16x32_bf16 v[232:235], v[0:3], v[144:147], 0
    v_mfma_f32_16x16x32_bf16 v[232:235], v[136:139], v[204:207], v[232:235]
    v_cvt_pk_bf16_f32 v214, v16, v17
    v_cvt_pk_bf16_f32 v215, v18, v19
    v_mfma_f32_16x16x32_bf16 v[0:3], v[84:87], v[48:51], 0
    v_cvt_pk_bf16_f32 v42, v28, v29
    v_cvt_pk_bf16_f32 v43, v30, v31
    v_mfma_f32_16x16x32_bf16 v[0:3], v[12:15], v[176:179], v[0:3]
    v_cvt_pk_bf16_f32 v106, v172, v173
    v_cvt_pk_bf16_f32 v107, v174, v175
    v_mfma_f32_16x16x32_bf16 v[16:19], v[12:15], v[188:191], 0
    v_cvt_pk_bf16_f32 v70, v232, v233
    v_cvt_pk_bf16_f32 v71, v234, v235
    v_mfma_f32_16x16x32_bf16 v[16:19], v[84:87], v[156:159], v[16:19]
    v_mfma_f32_16x16x32_bf16 v[28:31], v[84:87], v[132:135], 0
    v_mfma_f32_16x16x32_bf16 v[28:31], v[12:15], v[196:199], v[28:31]
    v_cvt_pk_bf16_f32 v96, v0, v1
    v_cvt_pk_bf16_f32 v97, v2, v3
    v_mfma_f32_16x16x32_bf16 v[136:139], v[12:15], v[144:147], 0
    v_mfma_f32_16x16x32_bf16 v[136:139], v[84:87], v[204:207], v[136:139]
    v_mfma_f32_16x16x32_bf16 v[172:175], v[192:195], v[48:51], 0
    v_mfma_f32_16x16x32_bf16 v[172:175], v[88:91], v[176:179], v[172:175]
    v_cvt_pk_bf16_f32 v0, v16, v17
    v_cvt_pk_bf16_f32 v1, v18, v19
    v_mfma_f32_16x16x32_bf16 v[12:15], v[88:91], v[188:191], 0
    v_xor_b32 v254, 16392, v255
    v_cvt_pk_bf16_f32 v48, v28, v29
    v_mfma_f32_16x16x32_bf16 v[12:15], v[192:195], v[156:159], v[12:15]
    v_cvt_pk_bf16_f32 v49, v30, v31
    v_cvt_pk_bf16_f32 v16, v136, v137
    v_mfma_f32_16x16x32_bf16 v[84:87], v[192:195], v[132:135], 0
    v_cvt_pk_bf16_f32 v98, v172, v173
    v_cvt_pk_bf16_f32 v99, v174, v175
    v_mfma_f32_16x16x32_bf16 v[84:87], v[88:91], v[196:199], v[84:87]
    v_cvt_pk_bf16_f32 v17, v138, v139
    v_mfma_f32_16x16x32_bf16 v[28:31], v[88:91], v[144:147], 0
    v_cvt_pk_bf16_f32 v2, v12, v13
    v_cvt_pk_bf16_f32 v3, v14, v15
    v_mfma_f32_16x16x32_bf16 v[28:31], v[192:195], v[204:207], v[28:31]
    s_waitcnt lgkmcnt(0)
    v_mbcnt_lo_u32_b32 v253, -1, 0
    v_mbcnt_hi_u32_b32 v252, -1, v253
    v_mfma_f32_16x16x32_bf16 v[12:15], v[52:55], v[76:79], 0
    ds_read_b64_tr_b16 a[0:1], v254 offset:0
    v_cvt_pk_bf16_f32 v50, v84, v85
    v_mfma_f32_16x16x32_bf16 v[12:15], v[80:83], v[116:119], v[12:15]
    ds_read_b64_tr_b16 a[2:3], v254 offset:2048
    v_cvt_pk_bf16_f32 v51, v86, v87
    v_mfma_f32_16x16x32_bf16 v[12:15], v[112:115], v[128:131], v[12:15]
    ds_read_b64_tr_b16 a[4:5], v254 offset:4096
    v_cvt_pk_bf16_f32 v18, v28, v29
    v_mfma_f32_16x16x32_bf16 v[12:15], v[152:155], a[192:195], v[12:15]
    ds_read_b64_tr_b16 a[6:7], v254 offset:6144
    v_cvt_pk_bf16_f32 v19, v30, v31
    v_mfma_f32_16x16x32_bf16 v[12:15], v[200:203], a[208:211], v[12:15]
    ds_read_b64_tr_b16 a[8:9], v254 offset:8192
    v_and_b32 v253, 7, v252
    v_mfma_f32_16x16x32_bf16 v[12:15], v[20:23], v[60:63], v[12:15]
    ds_read_b64_tr_b16 a[10:11], v254 offset:10240
    v_add_u32 v251, s34, v253
    v_mfma_f32_16x16x32_bf16 v[12:15], v[208:211], a[224:227], v[12:15]
    ds_read_b64_tr_b16 a[12:13], v254 offset:12288
    v_and_b32 v249, 255, v251
    v_mfma_f32_16x16x32_bf16 v[12:15], v[92:95], a[240:243], v[12:15]
    ds_read_b64_tr_b16 a[14:15], v254 offset:14336
    v_mul_u32_u24 v253, 768, v249
    v_mfma_f32_16x16x32_bf16 v[12:15], v[32:35], v[64:67], v[12:15]
    ds_read_b64_tr_b16 a[16:17], v254 offset:16384
    v_lshrrev_b32 v251, 4, v252
    v_mfma_f32_16x16x32_bf16 v[12:15], v[164:167], v[220:223], v[12:15]
    ds_read_b64_tr_b16 a[18:19], v254 offset:18432
    v_lshl_add_u32 v249, v251, 4, v253
    v_mfma_f32_16x16x32_bf16 v[12:15], v[216:219], v[212:215], v[12:15]
    ds_read_b64_tr_b16 a[20:21], v254 offset:20480
    v_bfe_u32 v248, v252, 3, 1
    v_mfma_f32_16x16x32_bf16 v[12:15], v[224:227], v[96:99], v[12:15]
    ds_read_b64_tr_b16 a[22:23], v254 offset:22528
    v_lshl_add_u32 v253, v248, 6, v249
    v_mfma_f32_16x16x32_bf16 v[28:31], v[224:227], v[0:3], 0
    ds_read_b64_tr_b16 a[24:25], v254 offset:24576
    v_mfma_f32_16x16x32_bf16 v[28:31], v[216:219], v[40:43], v[28:31]
    ds_read_b64_tr_b16 a[26:27], v254 offset:26624
    v_mfma_f32_16x16x32_bf16 v[28:31], v[164:167], v[228:231], v[28:31]
    ds_read_b64_tr_b16 a[28:29], v254 offset:28672
    v_cvt_pk_bf16_f32 v84, v12, v13
    v_mfma_f32_16x16x32_bf16 v[28:31], v[32:35], v[168:171], v[28:31]
    ds_read_b64_tr_b16 a[30:31], v254 offset:30720
    v_cvt_pk_bf16_f32 v85, v14, v15
    v_mfma_f32_16x16x32_bf16 v[28:31], v[92:95], a[244:247], v[28:31]
    ds_read_b64_tr_b16 a[32:33], v254 offset:32768
    v_mov_b32 v252, v84
    v_mfma_f32_16x16x32_bf16 v[28:31], v[208:211], a[228:231], v[28:31]
    ds_read_b64_tr_b16 a[34:35], v254 offset:34816
    v_mov_b32 v251, v85
    v_mfma_f32_16x16x32_bf16 v[28:31], v[20:23], v[124:127], v[28:31]
    ds_read_b64_tr_b16 a[36:37], v254 offset:36864
    v_mfma_f32_16x16x32_bf16 v[28:31], v[200:203], a[212:215], v[28:31]
    ds_read_b64_tr_b16 a[38:39], v254 offset:38912
    v_mfma_f32_16x16x32_bf16 v[28:31], v[152:155], a[196:199], v[28:31]
    ds_read_b64_tr_b16 a[40:41], v254 offset:40960
    v_mfma_f32_16x16x32_bf16 v[28:31], v[112:115], v[8:11], v[28:31]
    ds_read_b64_tr_b16 a[42:43], v254 offset:43008
    v_mfma_f32_16x16x32_bf16 v[28:31], v[80:83], v[160:163], v[28:31]
    ds_read_b64_tr_b16 a[44:45], v254 offset:45056
    v_mfma_f32_16x16x32_bf16 v[28:31], v[52:55], v[108:111], v[28:31]
    s_add_u32 m0, s29, 126720
    ds_read_b64_tr_b16 a[46:47], v254 offset:47104
    v_mfma_f32_16x16x32_bf16 v[12:15], v[52:55], v[36:39], 0
    global_load_lds_dwordx4 v250, s[10:11] offset:256
    v_mfma_f32_16x16x32_bf16 v[12:15], v[80:83], v[4:7], v[12:15]
    s_add_u32 m0, s29, 130816
    v_mfma_f32_16x16x32_bf16 v[12:15], v[112:115], v[24:27], v[12:15]
    global_load_lds_dwordx4 v250, s[12:13] offset:256
    v_mfma_f32_16x16x32_bf16 v[12:15], v[152:155], a[200:203], v[12:15]
    s_add_u32 m0, s29, 134912
    v_cvt_pk_bf16_f32 v88, v28, v29
    v_cvt_pk_bf16_f32 v89, v30, v31
    v_mfma_f32_16x16x32_bf16 v[12:15], v[200:203], a[216:219], v[12:15]
    global_load_lds_dwordx4 v250, s[14:15] offset:256
    v_mfma_f32_16x16x32_bf16 v[12:15], v[20:23], v[140:143], v[12:15]
    v_mov_b32 v254, v88
    v_mov_b32 v249, v89
    v_mfma_f32_16x16x32_bf16 v[12:15], v[208:211], a[232:235], v[12:15]
    v_mfma_f32_16x16x32_bf16 v[12:15], v[92:95], a[248:251], v[12:15]
    v_mfma_f32_16x16x32_bf16 v[12:15], v[32:35], v[180:183], v[12:15]
    v_mfma_f32_16x16x32_bf16 v[12:15], v[164:167], v[56:59], v[12:15]
    v_mfma_f32_16x16x32_bf16 v[12:15], v[216:219], v[104:107], v[12:15]
    v_mfma_f32_16x16x32_bf16 v[12:15], v[224:227], v[48:51], v[12:15]
    v_mfma_f32_16x16x32_bf16 v[28:31], v[224:227], v[16:19], 0
    v_mfma_f32_16x16x32_bf16 v[28:31], v[216:219], v[68:71], v[28:31]
    v_mfma_f32_16x16x32_bf16 v[28:31], v[164:167], v[100:103], v[28:31]
    v_mfma_f32_16x16x32_bf16 v[28:31], v[32:35], v[184:187], v[28:31]
    v_mfma_f32_16x16x32_bf16 v[28:31], v[92:95], a[252:255], v[28:31]
    v_mfma_f32_16x16x32_bf16 v[28:31], v[208:211], a[236:239], v[28:31]
    v_mfma_f32_16x16x32_bf16 v[28:31], v[20:23], v[148:151], v[28:31]
    v_xor_b32 v248, 16448, v255
    v_cvt_pk_bf16_f32 v32, v12, v13
    v_mfma_f32_16x16x32_bf16 v[28:31], v[200:203], a[220:223], v[28:31]
    v_cvt_pk_bf16_f32 v33, v14, v15
    v_mov_b32 v247, v32
    v_mfma_f32_16x16x32_bf16 v[28:31], v[152:155], a[204:207], v[28:31]
    v_mov_b32 v246, v33
    v_mfma_f32_16x16x32_bf16 v[28:31], v[112:115], v[72:75], v[28:31]
    v_mfma_f32_16x16x32_bf16 v[28:31], v[80:83], v[120:123], v[28:31]
    v_mfma_f32_16x16x32_bf16 v[28:31], v[52:55], v[44:47], v[28:31]
    s_waitcnt lgkmcnt(0)
    v_mfma_f32_16x16x32_bf16 v[12:15], a[0:3], v[76:79], 0
    ds_read_b64_tr_b16 a[48:49], v248 offset:0
    v_mfma_f32_16x16x32_bf16 v[12:15], a[4:7], v[116:119], v[12:15]
    ds_read_b64_tr_b16 a[50:51], v248 offset:2048
    v_mfma_f32_16x16x32_bf16 v[12:15], a[8:11], v[128:131], v[12:15]
    ds_read_b64_tr_b16 a[52:53], v248 offset:4096
    v_mfma_f32_16x16x32_bf16 v[12:15], a[12:15], a[192:195], v[12:15]
    ds_read_b64_tr_b16 a[54:55], v248 offset:6144
    v_cvt_pk_bf16_f32 v20, v28, v29
    v_mfma_f32_16x16x32_bf16 v[12:15], a[16:19], a[208:211], v[12:15]
    ds_read_b64_tr_b16 a[56:57], v248 offset:8192
    v_cvt_pk_bf16_f32 v21, v30, v31
    v_mfma_f32_16x16x32_bf16 v[12:15], a[20:23], v[60:63], v[12:15]
    ds_read_b64_tr_b16 a[58:59], v248 offset:10240
    v_mov_b32 v245, v20
    v_mfma_f32_16x16x32_bf16 v[12:15], a[24:27], a[224:227], v[12:15]
    ds_read_b64_tr_b16 a[60:61], v248 offset:12288
    v_mov_b32 v244, v21
    v_mfma_f32_16x16x32_bf16 v[12:15], a[28:31], a[240:243], v[12:15]
    ds_read_b64_tr_b16 a[62:63], v248 offset:14336
    v_mfma_f32_16x16x32_bf16 v[12:15], a[32:35], v[64:67], v[12:15]
    ds_read_b64_tr_b16 a[64:65], v248 offset:16384
    v_mfma_f32_16x16x32_bf16 v[12:15], a[36:39], v[220:223], v[12:15]
    ds_read_b64_tr_b16 a[66:67], v248 offset:18432
    v_mfma_f32_16x16x32_bf16 v[12:15], a[40:43], v[212:215], v[12:15]
    ds_read_b64_tr_b16 a[68:69], v248 offset:20480
    v_mfma_f32_16x16x32_bf16 v[12:15], a[44:47], v[96:99], v[12:15]
    ds_read_b64_tr_b16 a[70:71], v248 offset:22528
    v_mfma_f32_16x16x32_bf16 v[28:31], a[44:47], v[0:3], 0
    ds_read_b64_tr_b16 a[72:73], v248 offset:24576
    v_mfma_f32_16x16x32_bf16 v[28:31], a[40:43], v[40:43], v[28:31]
    ds_read_b64_tr_b16 a[74:75], v248 offset:26624
    v_mfma_f32_16x16x32_bf16 v[28:31], a[36:39], v[228:231], v[28:31]
    ds_read_b64_tr_b16 a[76:77], v248 offset:28672
    v_mfma_f32_16x16x32_bf16 v[28:31], a[32:35], v[168:171], v[28:31]
    ds_read_b64_tr_b16 a[78:79], v248 offset:30720
    v_cvt_pk_bf16_f32 v86, v12, v13
    v_mfma_f32_16x16x32_bf16 v[28:31], a[28:31], a[244:247], v[28:31]
    ds_read_b64_tr_b16 a[80:81], v248 offset:32768
    v_cvt_pk_bf16_f32 v87, v14, v15
    v_mfma_f32_16x16x32_bf16 v[28:31], a[24:27], a[228:231], v[28:31]
    ds_read_b64_tr_b16 a[82:83], v248 offset:34816
    v_mov_b32 v243, v86
    v_mfma_f32_16x16x32_bf16 v[28:31], a[20:23], v[124:127], v[28:31]
    ds_read_b64_tr_b16 a[84:85], v248 offset:36864
    v_mov_b32 v242, v87
    v_mfma_f32_16x16x32_bf16 v[28:31], a[16:19], a[212:215], v[28:31]
    ds_read_b64_tr_b16 a[86:87], v248 offset:38912
    v_mfma_f32_16x16x32_bf16 v[28:31], a[12:15], a[196:199], v[28:31]
    ds_read_b64_tr_b16 a[88:89], v248 offset:40960
    v_mfma_f32_16x16x32_bf16 v[28:31], a[8:11], v[8:11], v[28:31]
    ds_read_b64_tr_b16 a[90:91], v248 offset:43008
    v_mfma_f32_16x16x32_bf16 v[28:31], a[4:7], v[160:163], v[28:31]
    ds_read_b64_tr_b16 a[92:93], v248 offset:45056
    v_mfma_f32_16x16x32_bf16 v[28:31], a[0:3], v[108:111], v[28:31]
    s_add_u32 m0, s29, 139008
    ds_read_b64_tr_b16 a[94:95], v248 offset:47104
    v_mfma_f32_16x16x32_bf16 v[12:15], a[0:3], v[36:39], 0
    global_load_lds_dwordx4 v250, s[16:17] offset:256
    v_mfma_f32_16x16x32_bf16 v[12:15], a[4:7], v[4:7], v[12:15]
    s_add_u32 m0, s29, 143104
    v_mfma_f32_16x16x32_bf16 v[12:15], a[8:11], v[24:27], v[12:15]
    global_load_lds_dwordx4 v250, s[18:19] offset:256
    v_mfma_f32_16x16x32_bf16 v[12:15], a[12:15], a[200:203], v[12:15]
    s_add_u32 m0, s29, 147200
    v_cvt_pk_bf16_f32 v90, v28, v29
    v_cvt_pk_bf16_f32 v91, v30, v31
    v_mfma_f32_16x16x32_bf16 v[12:15], a[16:19], a[216:219], v[12:15]
    global_load_lds_dwordx4 v250, s[20:21] offset:256
    v_mfma_f32_16x16x32_bf16 v[12:15], a[20:23], v[140:143], v[12:15]
    v_mov_b32 v248, v90
    v_mov_b32 v241, v91
    v_mfma_f32_16x16x32_bf16 v[12:15], a[24:27], a[232:235], v[12:15]
    v_mfma_f32_16x16x32_bf16 v[12:15], a[28:31], a[248:251], v[12:15]
    v_mfma_f32_16x16x32_bf16 v[12:15], a[32:35], v[180:183], v[12:15]
    v_mfma_f32_16x16x32_bf16 v[12:15], a[36:39], v[56:59], v[12:15]
    v_mfma_f32_16x16x32_bf16 v[12:15], a[40:43], v[104:107], v[12:15]
    v_mfma_f32_16x16x32_bf16 v[12:15], a[44:47], v[48:51], v[12:15]
    v_mfma_f32_16x16x32_bf16 v[28:31], a[44:47], v[16:19], 0
    v_mfma_f32_16x16x32_bf16 v[28:31], a[40:43], v[68:71], v[28:31]
    v_mfma_f32_16x16x32_bf16 v[28:31], a[36:39], v[100:103], v[28:31]
    v_mfma_f32_16x16x32_bf16 v[28:31], a[32:35], v[184:187], v[28:31]
    v_mfma_f32_16x16x32_bf16 v[28:31], a[28:31], a[252:255], v[28:31]
    v_mfma_f32_16x16x32_bf16 v[28:31], a[24:27], a[236:239], v[28:31]
    v_mfma_f32_16x16x32_bf16 v[28:31], a[20:23], v[148:151], v[28:31]
    v_xor_b32 v240, 16456, v255
    v_cvt_pk_bf16_f32 v34, v12, v13
    v_mfma_f32_16x16x32_bf16 v[28:31], a[16:19], a[220:223], v[28:31]
    v_cvt_pk_bf16_f32 v35, v14, v15
    v_mov_b32 v239, v34
    v_mfma_f32_16x16x32_bf16 v[28:31], a[12:15], a[204:207], v[28:31]
    v_mov_b32 v238, v35
    v_mfma_f32_16x16x32_bf16 v[28:31], a[8:11], v[72:75], v[28:31]
    v_mfma_f32_16x16x32_bf16 v[28:31], a[4:7], v[120:123], v[28:31]
    v_mfma_f32_16x16x32_bf16 v[28:31], a[0:3], v[44:47], v[28:31]
    s_waitcnt lgkmcnt(0)
    v_mfma_f32_16x16x32_bf16 v[12:15], a[48:51], v[76:79], 0
    ds_read_b64_tr_b16 a[4:5], v240 offset:0
    v_mfma_f32_16x16x32_bf16 v[12:15], a[52:55], v[116:119], v[12:15]
    ds_read_b64_tr_b16 a[6:7], v240 offset:2048
    v_mfma_f32_16x16x32_bf16 v[12:15], a[56:59], v[128:131], v[12:15]
    ds_read_b64_tr_b16 a[0:1], v240 offset:4096
    v_mfma_f32_16x16x32_bf16 v[12:15], a[60:63], a[192:195], v[12:15]
    ds_read_b64_tr_b16 a[2:3], v240 offset:6144
    v_cvt_pk_bf16_f32 v22, v28, v29
    v_mfma_f32_16x16x32_bf16 v[12:15], a[64:67], a[208:211], v[12:15]
    ds_read_b64_tr_b16 a[8:9], v240 offset:8192
    v_cvt_pk_bf16_f32 v23, v30, v31
    v_mfma_f32_16x16x32_bf16 v[12:15], a[68:71], v[60:63], v[12:15]
    ds_read_b64_tr_b16 a[10:11], v240 offset:10240
    v_mov_b32 v237, v22
    v_mfma_f32_16x16x32_bf16 v[12:15], a[72:75], a[224:227], v[12:15]
    ds_read_b64_tr_b16 a[12:13], v240 offset:12288
    v_mov_b32 v236, v23
    v_mfma_f32_16x16x32_bf16 v[12:15], a[76:79], a[240:243], v[12:15]
    ds_read_b64_tr_b16 a[14:15], v240 offset:14336
    v_mfma_f32_16x16x32_bf16 v[12:15], a[80:83], v[64:67], v[12:15]
    ds_read_b64_tr_b16 a[16:17], v240 offset:16384
    v_mfma_f32_16x16x32_bf16 v[12:15], a[84:87], v[220:223], v[12:15]
    ds_read_b64_tr_b16 a[18:19], v240 offset:18432
    v_mfma_f32_16x16x32_bf16 v[12:15], a[88:91], v[212:215], v[12:15]
    ds_read_b64_tr_b16 a[20:21], v240 offset:20480
    v_mfma_f32_16x16x32_bf16 v[12:15], a[92:95], v[96:99], v[12:15]
    ds_read_b64_tr_b16 a[22:23], v240 offset:22528
    v_mfma_f32_16x16x32_bf16 v[28:31], a[92:95], v[0:3], 0
    ds_read_b64_tr_b16 a[24:25], v240 offset:24576
    v_mfma_f32_16x16x32_bf16 v[28:31], a[88:91], v[40:43], v[28:31]
    ds_read_b64_tr_b16 a[26:27], v240 offset:26624
    v_mfma_f32_16x16x32_bf16 v[28:31], a[84:87], v[228:231], v[28:31]
    ds_read_b64_tr_b16 a[28:29], v240 offset:28672
    v_mfma_f32_16x16x32_bf16 v[28:31], a[80:83], v[168:171], v[28:31]
    ds_read_b64_tr_b16 a[30:31], v240 offset:30720
    v_cvt_pk_bf16_f32 v52, v12, v13
    v_mfma_f32_16x16x32_bf16 v[28:31], a[76:79], a[244:247], v[28:31]
    ds_read_b64_tr_b16 a[32:33], v240 offset:32768
    v_cvt_pk_bf16_f32 v53, v14, v15
    v_mfma_f32_16x16x32_bf16 v[28:31], a[72:75], a[228:231], v[28:31]
    ds_read_b64_tr_b16 a[34:35], v240 offset:34816
    v_mov_b32_dpp v84, v52 row_ror:8 row_mask:0xf bank_mask:0xc
    v_mfma_f32_16x16x32_bf16 v[28:31], a[68:71], v[124:127], v[28:31]
    ds_read_b64_tr_b16 a[36:37], v240 offset:36864
    v_mov_b32_dpp v85, v53 row_ror:8 row_mask:0xf bank_mask:0xc
    v_mfma_f32_16x16x32_bf16 v[28:31], a[64:67], a[212:215], v[28:31]
    ds_read_b64_tr_b16 a[38:39], v240 offset:38912
    v_mov_b32_dpp v52, v252 row_ror:8 row_mask:0xf bank_mask:0x3
    v_mfma_f32_16x16x32_bf16 v[28:31], a[60:63], a[196:199], v[28:31]
    ds_read_b64_tr_b16 a[40:41], v240 offset:40960
    v_mov_b32_dpp v53, v251 row_ror:8 row_mask:0xf bank_mask:0x3
    v_mfma_f32_16x16x32_bf16 v[28:31], a[56:59], v[8:11], v[28:31]
    ds_read_b64_tr_b16 a[42:43], v240 offset:43008
    v_mfma_f32_16x16x32_bf16 v[28:31], a[52:55], v[160:163], v[28:31]
    ds_read_b64_tr_b16 a[44:45], v240 offset:45056
    v_mfma_f32_16x16x32_bf16 v[28:31], a[48:51], v[108:111], v[28:31]
    s_add_u32 m0, s29, 151296
    ds_read_b64_tr_b16 a[46:47], v240 offset:47104
    v_mfma_f32_16x16x32_bf16 v[12:15], a[48:51], v[36:39], 0
    global_load_lds_dwordx4 v250, s[22:23] offset:256
    v_mfma_f32_16x16x32_bf16 v[12:15], a[52:55], v[4:7], v[12:15]
    s_add_u32 m0, s29, 155392
    v_mfma_f32_16x16x32_bf16 v[12:15], a[56:59], v[24:27], v[12:15]
    global_load_lds_dwordx4 v250, s[24:25] offset:256
    v_mfma_f32_16x16x32_bf16 v[12:15], a[60:63], a[200:203], v[12:15]
    s_add_u32 m0, s29, 159488
    v_cvt_pk_bf16_f32 v80, v28, v29
    v_cvt_pk_bf16_f32 v81, v30, v31
    v_mfma_f32_16x16x32_bf16 v[12:15], a[64:67], a[216:219], v[12:15]
    global_load_lds_dwordx4 v250, s[26:27] offset:256
    v_mfma_f32_16x16x32_bf16 v[12:15], a[68:71], v[140:143], v[12:15]
    v_mov_b32_dpp v88, v80 row_ror:8 row_mask:0xf bank_mask:0xc
    v_mov_b32_dpp v89, v81 row_ror:8 row_mask:0xf bank_mask:0xc
    v_mfma_f32_16x16x32_bf16 v[12:15], a[72:75], a[232:235], v[12:15]
    v_mov_b32_dpp v80, v254 row_ror:8 row_mask:0xf bank_mask:0x3
    v_mov_b32_dpp v81, v249 row_ror:8 row_mask:0xf bank_mask:0x3
    v_mfma_f32_16x16x32_bf16 v[12:15], a[76:79], a[248:251], v[12:15]
    v_mfma_f32_16x16x32_bf16 v[12:15], a[80:83], v[180:183], v[12:15]
    v_mfma_f32_16x16x32_bf16 v[12:15], a[84:87], v[56:59], v[12:15]
    v_mfma_f32_16x16x32_bf16 v[12:15], a[88:91], v[104:107], v[12:15]
    v_mfma_f32_16x16x32_bf16 v[12:15], a[92:95], v[48:51], v[12:15]
    v_mfma_f32_16x16x32_bf16 v[28:31], a[92:95], v[16:19], 0
    v_mfma_f32_16x16x32_bf16 v[28:31], a[88:91], v[68:71], v[28:31]
    v_mfma_f32_16x16x32_bf16 v[28:31], a[84:87], v[100:103], v[28:31]
    v_mfma_f32_16x16x32_bf16 v[28:31], a[80:83], v[184:187], v[28:31]
    v_mfma_f32_16x16x32_bf16 v[28:31], a[76:79], a[252:255], v[28:31]
    v_mfma_f32_16x16x32_bf16 v[28:31], a[72:75], a[236:239], v[28:31]
    v_mfma_f32_16x16x32_bf16 v[28:31], a[68:71], v[148:151], v[28:31]
    v_xor_b32 v254, 65536, v255
    v_cvt_pk_bf16_f32 v92, v12, v13
    v_mfma_f32_16x16x32_bf16 v[28:31], a[64:67], a[220:223], v[28:31]
    v_cvt_pk_bf16_f32 v93, v14, v15
    v_mov_b32_dpp v32, v92 row_ror:8 row_mask:0xf bank_mask:0xc
    v_mfma_f32_16x16x32_bf16 v[28:31], a[60:63], a[204:207], v[28:31]
    v_mov_b32_dpp v33, v93 row_ror:8 row_mask:0xf bank_mask:0xc
    v_mov_b32_dpp v92, v247 row_ror:8 row_mask:0xf bank_mask:0x3
    v_mfma_f32_16x16x32_bf16 v[28:31], a[56:59], v[72:75], v[28:31]
    v_mov_b32_dpp v93, v246 row_ror:8 row_mask:0xf bank_mask:0x3
    v_mfma_f32_16x16x32_bf16 v[28:31], a[52:55], v[120:123], v[28:31]
    v_mfma_f32_16x16x32_bf16 v[28:31], a[48:51], v[44:47], v[28:31]
    s_waitcnt vmcnt(12) lgkmcnt(0)
    s_barrier
    v_mfma_f32_16x16x32_bf16 v[12:15], a[4:7], v[76:79], 0
    ds_read_b64_tr_b16 a[48:49], v254 offset:0
    v_mfma_f32_16x16x32_bf16 v[12:15], a[0:3], v[116:119], v[12:15]
    ds_read_b64_tr_b16 a[50:51], v254 offset:2048
    v_mfma_f32_16x16x32_bf16 v[12:15], a[8:11], v[128:131], v[12:15]
    ds_read_b64_tr_b16 a[52:53], v254 offset:4096
    v_cvt_pk_bf16_f32 v112, v28, v29
    v_mfma_f32_16x16x32_bf16 v[12:15], a[12:15], a[192:195], v[12:15]
    ds_read_b64_tr_b16 a[54:55], v254 offset:6144
    v_cvt_pk_bf16_f32 v113, v30, v31
    v_mfma_f32_16x16x32_bf16 v[12:15], a[16:19], a[208:211], v[12:15]
    ds_read_b64_tr_b16 a[56:57], v254 offset:8192
    v_mov_b32_dpp v20, v112 row_ror:8 row_mask:0xf bank_mask:0xc
    v_mfma_f32_16x16x32_bf16 v[12:15], a[20:23], v[60:63], v[12:15]
    ds_read_b64_tr_b16 a[58:59], v254 offset:10240
    v_mov_b32_dpp v21, v113 row_ror:8 row_mask:0xf bank_mask:0xc
    v_mfma_f32_16x16x32_bf16 v[12:15], a[24:27], a[224:227], v[12:15]
    ds_read_b64_tr_b16 a[60:61], v254 offset:12288
    v_mov_b32_dpp v112, v245 row_ror:8 row_mask:0xf bank_mask:0x3
    v_mfma_f32_16x16x32_bf16 v[12:15], a[28:31], a[240:243], v[12:15]
    ds_read_b64_tr_b16 a[62:63], v254 offset:14336
    v_mov_b32_dpp v113, v244 row_ror:8 row_mask:0xf bank_mask:0x3
    v_mfma_f32_16x16x32_bf16 v[12:15], a[32:35], v[64:67], v[12:15]
    ds_read_b64_tr_b16 a[64:65], v254 offset:16384
    v_mfma_f32_16x16x32_bf16 v[12:15], a[36:39], v[220:223], v[12:15]
    ds_read_b64_tr_b16 a[66:67], v254 offset:18432
    v_mfma_f32_16x16x32_bf16 v[12:15], a[40:43], v[212:215], v[12:15]
    ds_read_b64_tr_b16 a[68:69], v254 offset:20480
    v_mfma_f32_16x16x32_bf16 v[12:15], a[44:47], v[96:99], v[12:15]
    ds_read_b64_tr_b16 a[70:71], v254 offset:22528
    v_mfma_f32_16x16x32_bf16 v[28:31], a[44:47], v[0:3], 0
    ds_read_b64_tr_b16 a[72:73], v254 offset:24576
    v_mfma_f32_16x16x32_bf16 v[28:31], a[40:43], v[40:43], v[28:31]
    ds_read_b64_tr_b16 a[74:75], v254 offset:26624
    v_mfma_f32_16x16x32_bf16 v[28:31], a[36:39], v[228:231], v[28:31]
    ds_read_b64_tr_b16 a[76:77], v254 offset:28672
    v_mfma_f32_16x16x32_bf16 v[28:31], a[32:35], v[168:171], v[28:31]
    ds_read_b64_tr_b16 a[78:79], v254 offset:30720
    v_cvt_pk_bf16_f32 v54, v12, v13
    v_mfma_f32_16x16x32_bf16 v[28:31], a[28:31], a[244:247], v[28:31]
    ds_read_b64_tr_b16 a[80:81], v254 offset:32768
    v_cvt_pk_bf16_f32 v55, v14, v15
    v_mfma_f32_16x16x32_bf16 v[28:31], a[24:27], a[228:231], v[28:31]
    ds_read_b64_tr_b16 a[82:83], v254 offset:34816
    v_mov_b32_dpp v86, v54 row_ror:8 row_mask:0xf bank_mask:0xc
    v_mfma_f32_16x16x32_bf16 v[28:31], a[20:23], v[124:127], v[28:31]
    ds_read_b64_tr_b16 a[84:85], v254 offset:36864
    v_mov_b32_dpp v87, v55 row_ror:8 row_mask:0xf bank_mask:0xc
    v_mfma_f32_16x16x32_bf16 v[28:31], a[16:19], a[212:215], v[28:31]
    ds_read_b64_tr_b16 a[86:87], v254 offset:38912
    v_mov_b32_dpp v54, v243 row_ror:8 row_mask:0xf bank_mask:0x3
    v_mfma_f32_16x16x32_bf16 v[28:31], a[12:15], a[196:199], v[28:31]
    ds_read_b64_tr_b16 a[88:89], v254 offset:40960
    v_mov_b32_dpp v55, v242 row_ror:8 row_mask:0xf bank_mask:0x3
    v_mfma_f32_16x16x32_bf16 v[28:31], a[8:11], v[8:11], v[28:31]
    ds_read_b64_tr_b16 a[90:91], v254 offset:43008
    v_mfma_f32_16x16x32_bf16 v[28:31], a[0:3], v[160:163], v[28:31]
    ds_read_b64_tr_b16 a[92:93], v254 offset:45056
    v_mfma_f32_16x16x32_bf16 v[28:31], a[4:7], v[108:111], v[28:31]
    s_add_u32 m0, s29, 16000
    ds_read_b64_tr_b16 a[94:95], v254 offset:47104
    v_mfma_f32_16x16x32_bf16 v[12:15], a[4:7], v[36:39], 0
    global_load_lds_dwordx4 v250, s[4:5] offset:384
    v_mfma_f32_16x16x32_bf16 v[12:15], a[0:3], v[4:7], v[12:15]
    s_add_u32 m0, s29, 20096
    v_mfma_f32_16x16x32_bf16 v[12:15], a[8:11], v[24:27], v[12:15]
    global_load_lds_dwordx4 v250, s[6:7] offset:384
    v_mfma_f32_16x16x32_bf16 v[12:15], a[12:15], a[200:203], v[12:15]
    s_add_u32 m0, s29, 24192
    v_cvt_pk_bf16_f32 v82, v28, v29
    v_cvt_pk_bf16_f32 v83, v30, v31
    v_mfma_f32_16x16x32_bf16 v[12:15], a[16:19], a[216:219], v[12:15]
    global_load_lds_dwordx4 v250, s[8:9] offset:384
    v_mfma_f32_16x16x32_bf16 v[12:15], a[20:23], v[140:143], v[12:15]
    v_mov_b32_dpp v90, v82 row_ror:8 row_mask:0xf bank_mask:0xc
    v_mov_b32_dpp v91, v83 row_ror:8 row_mask:0xf bank_mask:0xc
    v_mfma_f32_16x16x32_bf16 v[12:15], a[24:27], a[232:235], v[12:15]
    v_mov_b32_dpp v82, v248 row_ror:8 row_mask:0xf bank_mask:0x3
    v_mov_b32_dpp v83, v241 row_ror:8 row_mask:0xf bank_mask:0x3
    v_mfma_f32_16x16x32_bf16 v[12:15], a[28:31], a[248:251], v[12:15]
    v_mfma_f32_16x16x32_bf16 v[12:15], a[32:35], v[180:183], v[12:15]
    v_mfma_f32_16x16x32_bf16 v[12:15], a[36:39], v[56:59], v[12:15]
    v_mfma_f32_16x16x32_bf16 v[12:15], a[40:43], v[104:107], v[12:15]
    v_mfma_f32_16x16x32_bf16 v[12:15], a[44:47], v[48:51], v[12:15]
    v_mfma_f32_16x16x32_bf16 v[28:31], a[44:47], v[16:19], 0
    v_mfma_f32_16x16x32_bf16 v[28:31], a[40:43], v[68:71], v[28:31]
    v_mfma_f32_16x16x32_bf16 v[28:31], a[36:39], v[100:103], v[28:31]
    v_mfma_f32_16x16x32_bf16 v[28:31], a[32:35], v[184:187], v[28:31]
    v_mfma_f32_16x16x32_bf16 v[28:31], a[28:31], a[252:255], v[28:31]
    v_mfma_f32_16x16x32_bf16 v[28:31], a[24:27], a[236:239], v[28:31]
    v_mfma_f32_16x16x32_bf16 v[28:31], a[20:23], v[148:151], v[28:31]
    v_xor_b32 v254, 65544, v255
    v_cvt_pk_bf16_f32 v94, v12, v13
    v_mfma_f32_16x16x32_bf16 v[28:31], a[16:19], a[220:223], v[28:31]
    v_cvt_pk_bf16_f32 v95, v14, v15
    v_mov_b32_dpp v34, v94 row_ror:8 row_mask:0xf bank_mask:0xc
    v_mfma_f32_16x16x32_bf16 v[28:31], a[12:15], a[204:207], v[28:31]
    v_mov_b32_dpp v35, v95 row_ror:8 row_mask:0xf bank_mask:0xc
    v_mov_b32_dpp v94, v239 row_ror:8 row_mask:0xf bank_mask:0x3
    v_mfma_f32_16x16x32_bf16 v[28:31], a[8:11], v[72:75], v[28:31]
    v_mov_b32_dpp v95, v238 row_ror:8 row_mask:0xf bank_mask:0x3
    v_mfma_f32_16x16x32_bf16 v[28:31], a[0:3], v[120:123], v[28:31]
    v_mfma_f32_16x16x32_bf16 v[28:31], a[4:7], v[44:47], v[28:31]
    s_waitcnt lgkmcnt(0)
    buffer_store_dwordx4 v[84:87], v253, s[56:59], s92 offen offset:0 nt
    v_mfma_f32_16x16x32_bf16 v[12:15], a[48:51], v[76:79], 0
    ds_read_b64_tr_b16 a[0:1], v254 offset:0
    v_mfma_f32_16x16x32_bf16 v[12:15], a[52:55], v[116:119], v[12:15]
    ds_read_b64_tr_b16 a[2:3], v254 offset:2048
    v_mfma_f32_16x16x32_bf16 v[12:15], a[56:59], v[128:131], v[12:15]
    ds_read_b64_tr_b16 a[4:5], v254 offset:4096
    v_cvt_pk_bf16_f32 v114, v28, v29
    v_mfma_f32_16x16x32_bf16 v[12:15], a[60:63], a[192:195], v[12:15]
    ds_read_b64_tr_b16 a[6:7], v254 offset:6144
    v_cvt_pk_bf16_f32 v115, v30, v31
    v_mfma_f32_16x16x32_bf16 v[12:15], a[64:67], a[208:211], v[12:15]
    ds_read_b64_tr_b16 a[8:9], v254 offset:8192
    v_mov_b32_dpp v22, v114 row_ror:8 row_mask:0xf bank_mask:0xc
    v_mfma_f32_16x16x32_bf16 v[12:15], a[68:71], v[60:63], v[12:15]
    ds_read_b64_tr_b16 a[10:11], v254 offset:10240
    v_mov_b32_dpp v23, v115 row_ror:8 row_mask:0xf bank_mask:0xc
    v_mfma_f32_16x16x32_bf16 v[12:15], a[72:75], a[224:227], v[12:15]
    ds_read_b64_tr_b16 a[12:13], v254 offset:12288
    v_mov_b32_dpp v114, v237 row_ror:8 row_mask:0xf bank_mask:0x3
    v_mfma_f32_16x16x32_bf16 v[12:15], a[76:79], a[240:243], v[12:15]
    ds_read_b64_tr_b16 a[14:15], v254 offset:14336
    v_mov_b32_dpp v115, v236 row_ror:8 row_mask:0xf bank_mask:0x3
    v_mfma_f32_16x16x32_bf16 v[12:15], a[80:83], v[64:67], v[12:15]
    ds_read_b64_tr_b16 a[16:17], v254 offset:16384
    v_mfma_f32_16x16x32_bf16 v[12:15], a[84:87], v[220:223], v[12:15]
    ds_read_b64_tr_b16 a[18:19], v254 offset:18432
    v_mfma_f32_16x16x32_bf16 v[12:15], a[88:91], v[212:215], v[12:15]
    ds_read_b64_tr_b16 a[20:21], v254 offset:20480
    v_mfma_f32_16x16x32_bf16 v[12:15], a[92:95], v[96:99], v[12:15]
    ds_read_b64_tr_b16 a[22:23], v254 offset:22528
    v_mfma_f32_16x16x32_bf16 v[28:31], a[92:95], v[0:3], 0
    ds_read_b64_tr_b16 a[24:25], v254 offset:24576
    v_mfma_f32_16x16x32_bf16 v[28:31], a[88:91], v[40:43], v[28:31]
    ds_read_b64_tr_b16 a[26:27], v254 offset:26624
    v_mfma_f32_16x16x32_bf16 v[28:31], a[84:87], v[228:231], v[28:31]
    ds_read_b64_tr_b16 a[28:29], v254 offset:28672
    v_mfma_f32_16x16x32_bf16 v[28:31], a[80:83], v[168:171], v[28:31]
    ds_read_b64_tr_b16 a[30:31], v254 offset:30720
    v_cvt_pk_bf16_f32 v84, v12, v13
    v_mfma_f32_16x16x32_bf16 v[28:31], a[76:79], a[244:247], v[28:31]
    ds_read_b64_tr_b16 a[32:33], v254 offset:32768
    v_cvt_pk_bf16_f32 v85, v14, v15
    v_mfma_f32_16x16x32_bf16 v[28:31], a[72:75], a[228:231], v[28:31]
    ds_read_b64_tr_b16 a[34:35], v254 offset:34816
    v_mov_b32 v252, v84
    v_mfma_f32_16x16x32_bf16 v[28:31], a[68:71], v[124:127], v[28:31]
    ds_read_b64_tr_b16 a[36:37], v254 offset:36864
    v_mov_b32 v251, v85
    v_mfma_f32_16x16x32_bf16 v[28:31], a[64:67], a[212:215], v[28:31]
    ds_read_b64_tr_b16 a[38:39], v254 offset:38912
    v_mfma_f32_16x16x32_bf16 v[28:31], a[60:63], a[196:199], v[28:31]
    ds_read_b64_tr_b16 a[40:41], v254 offset:40960
G_18:
    s_cbranch_vccnz R_ret1
    v_mfma_f32_16x16x32_bf16 v[28:31], a[56:59], v[8:11], v[28:31]
    ds_read_b64_tr_b16 a[42:43], v254 offset:43008
    v_mfma_f32_16x16x32_bf16 v[28:31], a[52:55], v[160:163], v[28:31]
    ds_read_b64_tr_b16 a[44:45], v254 offset:45056
    v_mfma_f32_16x16x32_bf16 v[28:31], a[48:51], v[108:111], v[28:31]
    s_add_u32 m0, s29, 28288
    ds_read_b64_tr_b16 a[46:47], v254 offset:47104
    v_mfma_f32_16x16x32_bf16 v[12:15], a[48:51], v[36:39], 0
    global_load_lds_dwordx4 v250, s[10:11] offset:384
    v_mfma_f32_16x16x32_bf16 v[12:15], a[52:55], v[4:7], v[12:15]
    s_add_u32 m0, s29, 32384
    buffer_store_dwordx4 v[52:55], v253, s[56:59], s93 offen offset:0 nt
    v_mfma_f32_16x16x32_bf16 v[12:15], a[56:59], v[24:27], v[12:15]
    global_load_lds_dwordx4 v250, s[12:13] offset:384
    v_mfma_f32_16x16x32_bf16 v[12:15], a[60:63], a[200:203], v[12:15]
    s_add_u32 m0, s29, 36480
    v_cvt_pk_bf16_f32 v52, v28, v29
    v_cvt_pk_bf16_f32 v53, v30, v31
    v_mfma_f32_16x16x32_bf16 v[12:15], a[64:67], a[216:219], v[12:15]
    global_load_lds_dwordx4 v250, s[14:15] offset:384
    v_mfma_f32_16x16x32_bf16 v[12:15], a[68:71], v[140:143], v[12:15]
    v_mov_b32 v254, v52
    v_mov_b32 v249, v53
    v_mfma_f32_16x16x32_bf16 v[12:15], a[72:75], a[232:235], v[12:15]
    v_mfma_f32_16x16x32_bf16 v[12:15], a[76:79], a[248:251], v[12:15]
    v_mfma_f32_16x16x32_bf16 v[12:15], a[80:83], v[180:183], v[12:15]
    v_mfma_f32_16x16x32_bf16 v[12:15], a[84:87], v[56:59], v[12:15]
    v_mfma_f32_16x16x32_bf16 v[12:15], a[88:91], v[104:107], v[12:15]
    v_mfma_f32_16x16x32_bf16 v[12:15], a[92:95], v[48:51], v[12:15]
    v_mfma_f32_16x16x32_bf16 v[28:31], a[92:95], v[16:19], 0
    v_mfma_f32_16x16x32_bf16 v[28:31], a[88:91], v[68:71], v[28:31]
    v_mfma_f32_16x16x32_bf16 v[28:31], a[84:87], v[100:103], v[28:31]
    v_mfma_f32_16x16x32_bf16 v[28:31], a[80:83], v[184:187], v[28:31]
    v_mfma_f32_16x16x32_bf16 v[28:31], a[76:79], a[252:255], v[28:31]
    v_mfma_f32_16x16x32_bf16 v[28:31], a[72:75], a[236:239], v[28:31]
    v_mfma_f32_16x16x32_bf16 v[28:31], a[68:71], v[148:151], v[28:31]
    v_xor_b32 v248, 65600, v255
    v_cvt_pk_bf16_f32 v132, v12, v13
    v_mfma_f32_16x16x32_bf16 v[28:31], a[64:67], a[220:223], v[28:31]
    v_cvt_pk_bf16_f32 v133, v14, v15
    v_mov_b32 v247, v132
    v_mfma_f32_16x16x32_bf16 v[28:31], a[60:63], a[204:207], v[28:31]
    v_mov_b32 v246, v133
    v_mfma_f32_16x16x32_bf16 v[28:31], a[56:59], v[72:75], v[28:31]
    buffer_store_dwordx4 v[88:91], v253, s[56:59], s94 offen offset:0 nt
    v_mfma_f32_16x16x32_bf16 v[28:31], a[52:55], v[120:123], v[28:31]
    v_mfma_f32_16x16x32_bf16 v[28:31], a[48:51], v[44:47], v[28:31]
    s_waitcnt lgkmcnt(0)
    v_mfma_f32_16x16x32_bf16 v[12:15], a[0:3], v[76:79], 0
    ds_read_b64_tr_b16 a[52:53], v248 offset:0
    v_mfma_f32_16x16x32_bf16 v[12:15], a[4:7], v[116:119], v[12:15]
    ds_read_b64_tr_b16 a[54:55], v248 offset:2048
    v_mfma_f32_16x16x32_bf16 v[12:15], a[8:11], v[128:131], v[12:15]
    ds_read_b64_tr_b16 a[48:49], v248 offset:4096
    v_mfma_f32_16x16x32_bf16 v[12:15], a[12:15], a[192:195], v[12:15]
    ds_read_b64_tr_b16 a[50:51], v248 offset:6144
    v_cvt_pk_bf16_f32 v88, v28, v29
    v_mfma_f32_16x16x32_bf16 v[12:15], a[16:19], a[208:211], v[12:15]
    ds_read_b64_tr_b16 a[56:57], v248 offset:8192
    v_cvt_pk_bf16_f32 v89, v30, v31
    v_mfma_f32_16x16x32_bf16 v[12:15], a[20:23], v[60:63], v[12:15]
    ds_read_b64_tr_b16 a[58:59], v248 offset:10240
    v_mov_b32 v245, v88
    v_mfma_f32_16x16x32_bf16 v[12:15], a[24:27], a[224:227], v[12:15]
    ds_read_b64_tr_b16 a[60:61], v248 offset:12288
    v_mov_b32 v244, v89
    v_mfma_f32_16x16x32_bf16 v[12:15], a[28:31], a[240:243], v[12:15]
    ds_read_b64_tr_b16 a[62:63], v248 offset:14336
    v_mfma_f32_16x16x32_bf16 v[12:15], a[32:35], v[64:67], v[12:15]
    ds_read_b64_tr_b16 a[64:65], v248 offset:16384
    v_mfma_f32_16x16x32_bf16 v[12:15], a[36:39], v[220:223], v[12:15]
    ds_read_b64_tr_b16 a[66:67], v248 offset:18432
    v_mfma_f32_16x16x32_bf16 v[12:15], a[40:43], v[212:215], v[12:15]
    ds_read_b64_tr_b16 a[68:69], v248 offset:20480
    v_mfma_f32_16x16x32_bf16 v[12:15], a[44:47], v[96:99], v[12:15]
    ds_read_b64_tr_b16 a[70:71], v248 offset:22528
    v_mfma_f32_16x16x32_bf16 v[28:31], a[44:47], v[0:3], 0
    ds_read_b64_tr_b16 a[72:73], v248 offset:24576
    v_mfma_f32_16x16x32_bf16 v[28:31], a[40:43], v[40:43], v[28:31]
    ds_read_b64_tr_b16 a[74:75], v248 offset:26624
    v_mfma_f32_16x16x32_bf16 v[28:31], a[36:39], v[228:231], v[28:31]
    ds_read_b64_tr_b16 a[76:77], v248 offset:28672
    v_mfma_f32_16x16x32_bf16 v[28:31], a[32:35], v[168:171], v[28:31]
    ds_read_b64_tr_b16 a[78:79], v248 offset:30720
    v_cvt_pk_bf16_f32 v86, v12, v13
    v_mfma_f32_16x16x32_bf16 v[28:31], a[28:31], a[244:247], v[28:31]
    ds_read_b64_tr_b16 a[80:81], v248 offset:32768
    v_cvt_pk_bf16_f32 v87, v14, v15
    v_mfma_f32_16x16x32_bf16 v[28:31], a[24:27], a[228:231], v[28:31]
    ds_read_b64_tr_b16 a[82:83], v248 offset:34816
    v_mov_b32 v243, v86
    v_mfma_f32_16x16x32_bf16 v[28:31], a[20:23], v[124:127], v[28:31]
    ds_read_b64_tr_b16 a[84:85], v248 offset:36864
    v_mov_b32 v242, v87
    v_mfma_f32_16x16x32_bf16 v[28:31], a[16:19], a[212:215], v[28:31]
    ds_read_b64_tr_b16 a[86:87], v248 offset:38912
    v_mfma_f32_16x16x32_bf16 v[28:31], a[12:15], a[196:199], v[28:31]
    ds_read_b64_tr_b16 a[88:89], v248 offset:40960
    v_mfma_f32_16x16x32_bf16 v[28:31], a[8:11], v[8:11], v[28:31]
    ds_read_b64_tr_b16 a[90:91], v248 offset:43008
    v_mfma_f32_16x16x32_bf16 v[28:31], a[4:7], v[160:163], v[28:31]
    ds_read_b64_tr_b16 a[92:93], v248 offset:45056
    v_mfma_f32_16x16x32_bf16 v[28:31], a[0:3], v[108:111], v[28:31]
    s_add_u32 m0, s29, 40576
    ds_read_b64_tr_b16 a[94:95], v248 offset:47104
    v_mfma_f32_16x16x32_bf16 v[12:15], a[0:3], v[36:39], 0
    global_load_lds_dwordx4 v250, s[16:17] offset:384
    v_mfma_f32_16x16x32_bf16 v[12:15], a[4:7], v[4:7], v[12:15]
    s_add_u32 m0, s29, 44672
    buffer_store_dwordx4 v[80:83], v253, s[56:59], s95 offen offset:0 nt
    v_mfma_f32_16x16x32_bf16 v[12:15], a[8:11], v[24:27], v[12:15]
    global_load_lds_dwordx4 v250, s[18:19] offset:384
    v_mfma_f32_16x16x32_bf16 v[12:15], a[12:15], a[200:203], v[12:15]
    s_add_u32 m0, s29, 48768
    v_cvt_pk_bf16_f32 v54, v28, v29
    v_cvt_pk_bf16_f32 v55, v30, v31
    v_mfma_f32_16x16x32_bf16 v[12:15], a[16:19], a[216:219], v[12:15]
    global_load_lds_dwordx4 v250, s[20:21] offset:384
    v_mfma_f32_16x16x32_bf16 v[12:15], a[20:23], v[140:143], v[12:15]
    v_mov_b32 v248, v54
    v_mov_b32 v241, v55
    v_mfma_f32_16x16x32_bf16 v[12:15], a[24:27], a[232:235], v[12:15]
    v_mfma_f32_16x16x32_bf16 v[12:15], a[28:31], a[248:251], v[12:15]
    v_mfma_f32_16x16x32_bf16 v[12:15], a[32:35], v[180:183], v[12:15]
    v_mfma_f32_16x16x32_bf16 v[12:15], a[36:39], v[56:59], v[12:15]
    v_mfma_f32_16x16x32_bf16 v[12:15], a[40:43], v[104:107], v[12:15]
    v_mfma_f32_16x16x32_bf16 v[12:15], a[44:47], v[48:51], v[12:15]
    v_mfma_f32_16x16x32_bf16 v[28:31], a[44:47], v[16:19], 0
    v_mfma_f32_16x16x32_bf16 v[28:31], a[40:43], v[68:71], v[28:31]
    v_mfma_f32_16x16x32_bf16 v[28:31], a[36:39], v[100:103], v[28:31]
    v_mfma_f32_16x16x32_bf16 v[28:31], a[32:35], v[184:187], v[28:31]
    buffer_store_dwordx4 v[32:35], v253, s[56:59], s96 offen offset:0 nt
    v_mfma_f32_16x16x32_bf16 v[28:31], a[28:31], a[252:255], v[28:31]
    v_mfma_f32_16x16x32_bf16 v[28:31], a[24:27], a[236:239], v[28:31]
    v_mfma_f32_16x16x32_bf16 v[28:31], a[20:23], v[148:151], v[28:31]
    v_xor_b32 v240, 65608, v255
    v_cvt_pk_bf16_f32 v134, v12, v13
    v_mfma_f32_16x16x32_bf16 v[28:31], a[16:19], a[220:223], v[28:31]
    v_cvt_pk_bf16_f32 v135, v14, v15
    v_mov_b32 v239, v134
    v_mfma_f32_16x16x32_bf16 v[28:31], a[12:15], a[204:207], v[28:31]
    v_mov_b32 v238, v135
    v_mfma_f32_16x16x32_bf16 v[28:31], a[8:11], v[72:75], v[28:31]
    v_mfma_f32_16x16x32_bf16 v[28:31], a[4:7], v[120:123], v[28:31]
    v_mfma_f32_16x16x32_bf16 v[28:31], a[0:3], v[44:47], v[28:31]
    s_waitcnt lgkmcnt(0)
    v_mfma_f32_16x16x32_bf16 v[12:15], a[52:55], v[76:79], 0
    ds_read_b64_tr_b16 a[4:5], v240 offset:0
    v_mfma_f32_16x16x32_bf16 v[12:15], a[48:51], v[116:119], v[12:15]
    ds_read_b64_tr_b16 a[6:7], v240 offset:2048
    v_mfma_f32_16x16x32_bf16 v[12:15], a[56:59], v[128:131], v[12:15]
    ds_read_b64_tr_b16 a[0:1], v240 offset:4096
    v_mfma_f32_16x16x32_bf16 v[12:15], a[60:63], a[192:195], v[12:15]
    ds_read_b64_tr_b16 a[2:3], v240 offset:6144
    v_cvt_pk_bf16_f32 v90, v28, v29
    v_mfma_f32_16x16x32_bf16 v[12:15], a[64:67], a[208:211], v[12:15]
    ds_read_b64_tr_b16 a[8:9], v240 offset:8192
    v_cvt_pk_bf16_f32 v91, v30, v31
    v_mfma_f32_16x16x32_bf16 v[12:15], a[68:71], v[60:63], v[12:15]
    ds_read_b64_tr_b16 a[10:11], v240 offset:10240
    v_mov_b32 v237, v90
    v_mfma_f32_16x16x32_bf16 v[12:15], a[72:75], a[224:227], v[12:15]
    ds_read_b64_tr_b16 a[12:13], v240 offset:12288
    v_mov_b32 v236, v91
    v_mfma_f32_16x16x32_bf16 v[12:15], a[76:79], a[240:243], v[12:15]
    ds_read_b64_tr_b16 a[14:15], v240 offset:14336
    v_mfma_f32_16x16x32_bf16 v[12:15], a[80:83], v[64:67], v[12:15]
    ds_read_b64_tr_b16 a[16:17], v240 offset:16384
    v_mfma_f32_16x16x32_bf16 v[12:15], a[84:87], v[220:223], v[12:15]
    ds_read_b64_tr_b16 a[18:19], v240 offset:18432
    v_mfma_f32_16x16x32_bf16 v[12:15], a[88:91], v[212:215], v[12:15]
    ds_read_b64_tr_b16 a[20:21], v240 offset:20480
    v_mfma_f32_16x16x32_bf16 v[12:15], a[92:95], v[96:99], v[12:15]
    ds_read_b64_tr_b16 a[22:23], v240 offset:22528
    v_mfma_f32_16x16x32_bf16 v[28:31], a[92:95], v[0:3], 0
    ds_read_b64_tr_b16 a[24:25], v240 offset:24576
    v_mfma_f32_16x16x32_bf16 v[28:31], a[88:91], v[40:43], v[28:31]
    ds_read_b64_tr_b16 a[26:27], v240 offset:26624
    v_mfma_f32_16x16x32_bf16 v[28:31], a[84:87], v[228:231], v[28:31]
    ds_read_b64_tr_b16 a[28:29], v240 offset:28672
    v_mfma_f32_16x16x32_bf16 v[28:31], a[80:83], v[168:171], v[28:31]
    ds_read_b64_tr_b16 a[30:31], v240 offset:30720
    v_cvt_pk_bf16_f32 v32, v12, v13
    v_mfma_f32_16x16x32_bf16 v[28:31], a[76:79], a[244:247], v[28:31]
    ds_read_b64_tr_b16 a[32:33], v240 offset:32768
    v_cvt_pk_bf16_f32 v33, v14, v15
    v_mfma_f32_16x16x32_bf16 v[28:31], a[72:75], a[228:231], v[28:31]
    ds_read_b64_tr_b16 a[34:35], v240 offset:34816
    v_mov_b32_dpp v84, v32 row_ror:8 row_mask:0xf bank_mask:0xc
    v_mfma_f32_16x16x32_bf16 v[28:31], a[68:71], v[124:127], v[28:31]
    ds_read_b64_tr_b16 a[36:37], v240 offset:36864
    v_mov_b32_dpp v85, v33 row_ror:8 row_mask:0xf bank_mask:0xc
    v_mfma_f32_16x16x32_bf16 v[28:31], a[64:67], a[212:215], v[28:31]
    ds_read_b64_tr_b16 a[38:39], v240 offset:38912
    v_mov_b32_dpp v32, v252 row_ror:8 row_mask:0xf bank_mask:0x3
    v_mfma_f32_16x16x32_bf16 v[28:31], a[60:63], a[196:199], v[28:31]
    ds_read_b64_tr_b16 a[40:41], v240 offset:40960
    v_mov_b32_dpp v33, v251 row_ror:8 row_mask:0xf bank_mask:0x3
    v_mfma_f32_16x16x32_bf16 v[28:31], a[56:59], v[8:11], v[28:31]
    ds_read_b64_tr_b16 a[42:43], v240 offset:43008
    v_mfma_f32_16x16x32_bf16 v[28:31], a[48:51], v[160:163], v[28:31]
    ds_read_b64_tr_b16 a[44:45], v240 offset:45056
    v_mfma_f32_16x16x32_bf16 v[28:31], a[52:55], v[108:111], v[28:31]
    s_add_u32 m0, s29, 52864
    ds_read_b64_tr_b16 a[46:47], v240 offset:47104
    v_mfma_f32_16x16x32_bf16 v[12:15], a[52:55], v[36:39], 0
    global_load_lds_dwordx4 v250, s[22:23] offset:384
    v_mfma_f32_16x16x32_bf16 v[12:15], a[48:51], v[4:7], v[12:15]
    s_add_u32 m0, s29, 56960
    buffer_store_dwordx4 v[92:95], v253, s[56:59], s97 offen offset:0 nt
    v_mfma_f32_16x16x32_bf16 v[12:15], a[56:59], v[24:27], v[12:15]
    global_load_lds_dwordx4 v250, s[24:25] offset:384
    v_mfma_f32_16x16x32_bf16 v[12:15], a[60:63], a[200:203], v[12:15]
    s_add_u32 m0, s29, 61056
    v_cvt_pk_bf16_f32 v80, v28, v29
    v_cvt_pk_bf16_f32 v81, v30, v31
    v_mfma_f32_16x16x32_bf16 v[12:15], a[64:67], a[216:219], v[12:15]
    global_load_lds_dwordx4 v250, s[26:27] offset:384
    v_mfma_f32_16x16x32_bf16 v[12:15], a[68:71], v[140:143], v[12:15]
    v_mov_b32_dpp v52, v80 row_ror:8 row_mask:0xf bank_mask:0xc
    v_mov_b32_dpp v53, v81 row_ror:8 row_mask:0xf bank_mask:0xc
    v_mfma_f32_16x16x32_bf16 v[12:15], a[72:75], a[232:235], v[12:15]
    v_mov_b32_dpp v80, v254 row_ror:8 row_mask:0xf bank_mask:0x3
    v_mov_b32_dpp v81, v249 row_ror:8 row_mask:0xf bank_mask:0x3
    v_mfma_f32_16x16x32_bf16 v[12:15], a[76:79], a[248:251], v[12:15]
    v_mfma_f32_16x16x32_bf16 v[12:15], a[80:83], v[180:183], v[12:15]
    v_mfma_f32_16x16x32_bf16 v[12:15], a[84:87], v[56:59], v[12:15]
    v_mfma_f32_16x16x32_bf16 v[12:15], a[88:91], v[104:107], v[12:15]
    v_mfma_f32_16x16x32_bf16 v[12:15], a[92:95], v[48:51], v[12:15]
    buffer_store_dwordx4 v[20:23], v253, s[56:59], s98 offen offset:0 nt
    v_mfma_f32_16x16x32_bf16 v[28:31], a[92:95], v[16:19], 0
    v_mfma_f32_16x16x32_bf16 v[28:31], a[88:91], v[68:71], v[28:31]
    v_mfma_f32_16x16x32_bf16 v[28:31], a[84:87], v[100:103], v[28:31]
    v_mfma_f32_16x16x32_bf16 v[28:31], a[80:83], v[184:187], v[28:31]
    v_mfma_f32_16x16x32_bf16 v[28:31], a[76:79], a[252:255], v[28:31]
    v_mfma_f32_16x16x32_bf16 v[28:31], a[72:75], a[236:239], v[28:31]
    v_mfma_f32_16x16x32_bf16 v[28:31], a[68:71], v[148:151], v[28:31]
    v_xor_b32 v254, 114688, v255
    v_cvt_pk_bf16_f32 v20, v12, v13
    v_mfma_f32_16x16x32_bf16 v[28:31], a[64:67], a[220:223], v[28:31]
    v_cvt_pk_bf16_f32 v21, v14, v15
    v_mov_b32_dpp v132, v20 row_ror:8 row_mask:0xf bank_mask:0xc
    v_mfma_f32_16x16x32_bf16 v[28:31], a[60:63], a[204:207], v[28:31]
    v_mov_b32_dpp v133, v21 row_ror:8 row_mask:0xf bank_mask:0xc
    v_mov_b32_dpp v20, v247 row_ror:8 row_mask:0xf bank_mask:0x3
    v_mfma_f32_16x16x32_bf16 v[28:31], a[56:59], v[72:75], v[28:31]
    v_mov_b32_dpp v21, v246 row_ror:8 row_mask:0xf bank_mask:0x3
    v_mfma_f32_16x16x32_bf16 v[28:31], a[48:51], v[120:123], v[28:31]
    v_mfma_f32_16x16x32_bf16 v[28:31], a[52:55], v[44:47], v[28:31]
    s_waitcnt vmcnt(19) lgkmcnt(0)
    s_barrier
    v_mfma_f32_16x16x32_bf16 v[12:15], a[4:7], v[76:79], 0
    ds_read_b64_tr_b16 a[48:49], v254 offset:0
    v_mfma_f32_16x16x32_bf16 v[12:15], a[0:3], v[116:119], v[12:15]
    ds_read_b64_tr_b16 a[50:51], v254 offset:2048
    v_mfma_f32_16x16x32_bf16 v[12:15], a[8:11], v[128:131], v[12:15]
    ds_read_b64_tr_b16 a[52:53], v254 offset:4096
    v_cvt_pk_bf16_f32 v92, v28, v29
    v_mfma_f32_16x16x32_bf16 v[12:15], a[12:15], a[192:195], v[12:15]
    ds_read_b64_tr_b16 a[54:55], v254 offset:6144
    v_cvt_pk_bf16_f32 v93, v30, v31
    v_mfma_f32_16x16x32_bf16 v[12:15], a[16:19], a[208:211], v[12:15]
    ds_read_b64_tr_b16 a[56:57], v254 offset:8192
    v_mov_b32_dpp v88, v92 row_ror:8 row_mask:0xf bank_mask:0xc
    v_mfma_f32_16x16x32_bf16 v[12:15], a[20:23], v[60:63], v[12:15]
    ds_read_b64_tr_b16 a[58:59], v254 offset:10240
    v_mov_b32_dpp v89, v93 row_ror:8 row_mask:0xf bank_mask:0xc
    v_mfma_f32_16x16x32_bf16 v[12:15], a[24:27], a[224:227], v[12:15]
    ds_read_b64_tr_b16 a[60:61], v254 offset:12288
    v_mov_b32_dpp v92, v245 row_ror:8 row_mask:0xf bank_mask:0x3
    v_mfma_f32_16x16x32_bf16 v[12:15], a[28:31], a[240:243], v[12:15]
    ds_read_b64_tr_b16 a[62:63], v254 offset:14336
    v_mov_b32_dpp v93, v244 row_ror:8 row_mask:0xf bank_mask:0x3
    v_mfma_f32_16x16x32_bf16 v[12:15], a[32:35], v[64:67], v[12:15]
    ds_read_b64_tr_b16 a[64:65], v254 offset:16384
    v_mfma_f32_16x16x32_bf16 v[12:15], a[36:39], v[220:223], v[12:15]
    ds_read_b64_tr_b16 a[66:67], v254 offset:18432
    v_mfma_f32_16x16x32_bf16 v[12:15], a[40:43], v[212:215], v[12:15]
    ds_read_b64_tr_b16 a[68:69], v254 offset:20480
    v_mfma_f32_16x16x32_bf16 v[12:15], a[44:47], v[96:99], v[12:15]
    ds_read_b64_tr_b16 a[70:71], v254 offset:22528
    v_mfma_f32_16x16x32_bf16 v[28:31], a[44:47], v[0:3], 0
    ds_read_b64_tr_b16 a[72:73], v254 offset:24576
    v_mfma_f32_16x16x32_bf16 v[28:31], a[40:43], v[40:43], v[28:31]
    ds_read_b64_tr_b16 a[74:75], v254 offset:26624
    v_mfma_f32_16x16x32_bf16 v[28:31], a[36:39], v[228:231], v[28:31]
    ds_read_b64_tr_b16 a[76:77], v254 offset:28672
    v_mfma_f32_16x16x32_bf16 v[28:31], a[32:35], v[168:171], v[28:31]
    ds_read_b64_tr_b16 a[78:79], v254 offset:30720
    v_cvt_pk_bf16_f32 v34, v12, v13
    v_mfma_f32_16x16x32_bf16 v[28:31], a[28:31], a[244:247], v[28:31]
    ds_read_b64_tr_b16 a[80:81], v254 offset:32768
    v_cvt_pk_bf16_f32 v35, v14, v15
    v_mfma_f32_16x16x32_bf16 v[28:31], a[24:27], a[228:231], v[28:31]
    ds_read_b64_tr_b16 a[82:83], v254 offset:34816
    v_mov_b32_dpp v86, v34 row_ror:8 row_mask:0xf bank_mask:0xc
    v_mfma_f32_16x16x32_bf16 v[28:31], a[20:23], v[124:127], v[28:31]
    ds_read_b64_tr_b16 a[84:85], v254 offset:36864
    v_mov_b32_dpp v87, v35 row_ror:8 row_mask:0xf bank_mask:0xc
    v_mfma_f32_16x16x32_bf16 v[28:31], a[16:19], a[212:215], v[28:31]
    ds_read_b64_tr_b16 a[86:87], v254 offset:38912
    v_mov_b32_dpp v34, v243 row_ror:8 row_mask:0xf bank_mask:0x3
    v_mfma_f32_16x16x32_bf16 v[28:31], a[12:15], a[196:199], v[28:31]
    ds_read_b64_tr_b16 a[88:89], v254 offset:40960
    v_mov_b32_dpp v35, v242 row_ror:8 row_mask:0xf bank_mask:0x3
    v_mfma_f32_16x16x32_bf16 v[28:31], a[8:11], v[8:11], v[28:31]
    ds_read_b64_tr_b16 a[90:91], v254 offset:43008
    v_mfma_f32_16x16x32_bf16 v[28:31], a[0:3], v[160:163], v[28:31]
    ds_read_b64_tr_b16 a[92:93], v254 offset:45056
    v_mfma_f32_16x16x32_bf16 v[28:31], a[4:7], v[108:111], v[28:31]
    s_add_u32 m0, s29, 65024
    ds_read_b64_tr_b16 a[94:95], v254 offset:47104
    v_mfma_f32_16x16x32_bf16 v[12:15], a[4:7], v[36:39], 0
    global_load_lds_dwordx4 v250, s[4:5] offset:512
    v_mfma_f32_16x16x32_bf16 v[12:15], a[0:3], v[4:7], v[12:15]
    s_add_u32 m0, s29, 69120
    buffer_store_dwordx4 v[112:115], v253, s[56:59], s99 offen offset:0 nt
    v_mfma_f32_16x16x32_bf16 v[12:15], a[8:11], v[24:27], v[12:15]
    global_load_lds_dwordx4 v250, s[6:7] offset:512
    v_mfma_f32_16x16x32_bf16 v[12:15], a[12:15], a[200:203], v[12:15]
    s_add_u32 m0, s29, 73216
    v_cvt_pk_bf16_f32 v82, v28, v29
    v_cvt_pk_bf16_f32 v83, v30, v31
    v_mfma_f32_16x16x32_bf16 v[12:15], a[16:19], a[216:219], v[12:15]
    global_load_lds_dwordx4 v250, s[8:9] offset:512
    v_mfma_f32_16x16x32_bf16 v[12:15], a[20:23], v[140:143], v[12:15]
    v_mov_b32_dpp v54, v82 row_ror:8 row_mask:0xf bank_mask:0xc
    v_mov_b32_dpp v55, v83 row_ror:8 row_mask:0xf bank_mask:0xc
    v_mfma_f32_16x16x32_bf16 v[12:15], a[24:27], a[232:235], v[12:15]
    v_mov_b32_dpp v82, v248 row_ror:8 row_mask:0xf bank_mask:0x3
    v_mov_b32_dpp v83, v241 row_ror:8 row_mask:0xf bank_mask:0x3
    v_mfma_f32_16x16x32_bf16 v[12:15], a[28:31], a[248:251], v[12:15]
    v_mfma_f32_16x16x32_bf16 v[12:15], a[32:35], v[180:183], v[12:15]
    v_mfma_f32_16x16x32_bf16 v[12:15], a[36:39], v[56:59], v[12:15]
    v_mfma_f32_16x16x32_bf16 v[12:15], a[40:43], v[104:107], v[12:15]
    v_mfma_f32_16x16x32_bf16 v[12:15], a[44:47], v[48:51], v[12:15]
    v_mfma_f32_16x16x32_bf16 v[28:31], a[44:47], v[16:19], 0
    v_mfma_f32_16x16x32_bf16 v[28:31], a[40:43], v[68:71], v[28:31]
    v_mfma_f32_16x16x32_bf16 v[28:31], a[36:39], v[100:103], v[28:31]
    v_mfma_f32_16x16x32_bf16 v[28:31], a[32:35], v[184:187], v[28:31]
    v_mfma_f32_16x16x32_bf16 v[28:31], a[28:31], a[252:255], v[28:31]
    v_mfma_f32_16x16x32_bf16 v[28:31], a[24:27], a[236:239], v[28:31]
    v_mfma_f32_16x16x32_bf16 v[28:31], a[20:23], v[148:151], v[28:31]
    v_xor_b32 v254, 114696, v255
    v_cvt_pk_bf16_f32 v22, v12, v13
    v_mfma_f32_16x16x32_bf16 v[28:31], a[16:19], a[220:223], v[28:31]
    v_cvt_pk_bf16_f32 v23, v14, v15
    v_mov_b32_dpp v134, v22 row_ror:8 row_mask:0xf bank_mask:0xc
    v_mfma_f32_16x16x32_bf16 v[28:31], a[12:15], a[204:207], v[28:31]
    v_mov_b32_dpp v135, v23 row_ror:8 row_mask:0xf bank_mask:0xc
    v_mov_b32_dpp v22, v239 row_ror:8 row_mask:0xf bank_mask:0x3
    v_mfma_f32_16x16x32_bf16 v[28:31], a[8:11], v[72:75], v[28:31]
    v_mov_b32_dpp v23, v238 row_ror:8 row_mask:0xf bank_mask:0x3
    v_mfma_f32_16x16x32_bf16 v[28:31], a[0:3], v[120:123], v[28:31]
    v_mfma_f32_16x16x32_bf16 v[28:31], a[4:7], v[44:47], v[28:31]
    s_waitcnt lgkmcnt(0)
    buffer_store_dwordx4 v[84:87], v253, s[56:59], s92 offen offset:128 nt
    v_mfma_f32_16x16x32_bf16 v[12:15], a[48:51], v[76:79], 0
    ds_read_b64_tr_b16 a[0:1], v254 offset:0
    v_mfma_f32_16x16x32_bf16 v[12:15], a[52:55], v[116:119], v[12:15]
    ds_read_b64_tr_b16 a[2:3], v254 offset:2048
    v_mfma_f32_16x16x32_bf16 v[12:15], a[56:59], v[128:131], v[12:15]
    ds_read_b64_tr_b16 a[4:5], v254 offset:4096
    v_cvt_pk_bf16_f32 v94, v28, v29
    v_mfma_f32_16x16x32_bf16 v[12:15], a[60:63], a[192:195], v[12:15]
    ds_read_b64_tr_b16 a[6:7], v254 offset:6144
    v_cvt_pk_bf16_f32 v95, v30, v31
    v_mfma_f32_16x16x32_bf16 v[12:15], a[64:67], a[208:211], v[12:15]
    ds_read_b64_tr_b16 a[8:9], v254 offset:8192
    v_mov_b32_dpp v90, v94 row_ror:8 row_mask:0xf bank_mask:0xc
    v_mfma_f32_16x16x32_bf16 v[12:15], a[68:71], v[60:63], v[12:15]
    ds_read_b64_tr_b16 a[10:11], v254 offset:10240
    v_mov_b32_dpp v91, v95 row_ror:8 row_mask:0xf bank_mask:0xc
    v_mfma_f32_16x16x32_bf16 v[12:15], a[72:75], a[224:227], v[12:15]
    ds_read_b64_tr_b16 a[12:13], v254 offset:12288
    v_mov_b32_dpp v94, v237 row_ror:8 row_mask:0xf bank_mask:0x3
    v_mfma_f32_16x16x32_bf16 v[12:15], a[76:79], a[240:243], v[12:15]
    ds_read_b64_tr_b16 a[14:15], v254 offset:14336
    v_mov_b32_dpp v95, v236 row_ror:8 row_mask:0xf bank_mask:0x3
    v_mfma_f32_16x16x32_bf16 v[12:15], a[80:83], v[64:67], v[12:15]
    ds_read_b64_tr_b16 a[16:17], v254 offset:16384
    v_mfma_f32_16x16x32_bf16 v[12:15], a[84:87], v[220:223], v[12:15]
    ds_read_b64_tr_b16 a[18:19], v254 offset:18432
    v_mfma_f32_16x16x32_bf16 v[12:15], a[88:91], v[212:215], v[12:15]
    ds_read_b64_tr_b16 a[20:21], v254 offset:20480
    v_mfma_f32_16x16x32_bf16 v[12:15], a[92:95], v[96:99], v[12:15]
    ds_read_b64_tr_b16 a[22:23], v254 offset:22528
    v_mfma_f32_16x16x32_bf16 v[28:31], a[92:95], v[0:3], 0
    ds_read_b64_tr_b16 a[24:25], v254 offset:24576
    v_mfma_f32_16x16x32_bf16 v[28:31], a[88:91], v[40:43], v[28:31]
    ds_read_b64_tr_b16 a[26:27], v254 offset:26624
    v_mfma_f32_16x16x32_bf16 v[28:31], a[84:87], v[228:231], v[28:31]
    ds_read_b64_tr_b16 a[28:29], v254 offset:28672
    v_mfma_f32_16x16x32_bf16 v[28:31], a[80:83], v[168:171], v[28:31]
    ds_read_b64_tr_b16 a[30:31], v254 offset:30720
    v_cvt_pk_bf16_f32 v84, v12, v13
    v_mfma_f32_16x16x32_bf16 v[28:31], a[76:79], a[244:247], v[28:31]
    ds_read_b64_tr_b16 a[32:33], v254 offset:32768
    v_cvt_pk_bf16_f32 v85, v14, v15
    v_mfma_f32_16x16x32_bf16 v[28:31], a[72:75], a[228:231], v[28:31]
    ds_read_b64_tr_b16 a[34:35], v254 offset:34816
    v_mov_b32 v252, v84
    v_mfma_f32_16x16x32_bf16 v[28:31], a[68:71], v[124:127], v[28:31]
    ds_read_b64_tr_b16 a[36:37], v254 offset:36864
    v_mov_b32 v251, v85
    v_mfma_f32_16x16x32_bf16 v[28:31], a[64:67], a[212:215], v[28:31]
    ds_read_b64_tr_b16 a[38:39], v254 offset:38912
    v_mfma_f32_16x16x32_bf16 v[28:31], a[60:63], a[196:199], v[28:31]
    ds_read_b64_tr_b16 a[40:41], v254 offset:40960
    v_mfma_f32_16x16x32_bf16 v[28:31], a[56:59], v[8:11], v[28:31]
    ds_read_b64_tr_b16 a[42:43], v254 offset:43008
    v_mfma_f32_16x16x32_bf16 v[28:31], a[52:55], v[160:163], v[28:31]
    ds_read_b64_tr_b16 a[44:45], v254 offset:45056
    v_mfma_f32_16x16x32_bf16 v[28:31], a[48:51], v[108:111], v[28:31]
    s_add_u32 m0, s29, 77312
    ds_read_b64_tr_b16 a[46:47], v254 offset:47104
    v_mfma_f32_16x16x32_bf16 v[12:15], a[48:51], v[36:39], 0
    global_load_lds_dwordx4 v250, s[10:11] offset:512
    v_mfma_f32_16x16x32_bf16 v[12:15], a[52:55], v[4:7], v[12:15]
    s_add_u32 m0, s29, 81408
    buffer_store_dwordx4 v[32:35], v253, s[56:59], s93 offen offset:128 nt
    v_mfma_f32_16x16x32_bf16 v[12:15], a[56:59], v[24:27], v[12:15]
    global_load_lds_dwordx4 v250, s[12:13] offset:512
    v_mfma_f32_16x16x32_bf16 v[12:15], a[60:63], a[200:203], v[12:15]
    s_add_u32 m0, s29, 85504
    v_cvt_pk_bf16_f32 v32, v28, v29
    v_cvt_pk_bf16_f32 v33, v30, v31
    v_mfma_f32_16x16x32_bf16 v[12:15], a[64:67], a[216:219], v[12:15]
    global_load_lds_dwordx4 v250, s[14:15] offset:512
    v_mfma_f32_16x16x32_bf16 v[12:15], a[68:71], v[140:143], v[12:15]
    v_mov_b32 v254, v32
    v_mov_b32 v249, v33
    v_mfma_f32_16x16x32_bf16 v[12:15], a[72:75], a[232:235], v[12:15]
    v_mfma_f32_16x16x32_bf16 v[12:15], a[76:79], a[248:251], v[12:15]
    v_mfma_f32_16x16x32_bf16 v[12:15], a[80:83], v[180:183], v[12:15]
    v_mfma_f32_16x16x32_bf16 v[12:15], a[84:87], v[56:59], v[12:15]
    v_mfma_f32_16x16x32_bf16 v[12:15], a[88:91], v[104:107], v[12:15]
    v_mfma_f32_16x16x32_bf16 v[12:15], a[92:95], v[48:51], v[12:15]
    v_mfma_f32_16x16x32_bf16 v[28:31], a[92:95], v[16:19], 0
    v_mfma_f32_16x16x32_bf16 v[28:31], a[88:91], v[68:71], v[28:31]
    v_mfma_f32_16x16x32_bf16 v[28:31], a[84:87], v[100:103], v[28:31]
    v_mfma_f32_16x16x32_bf16 v[28:31], a[80:83], v[184:187], v[28:31]
    v_mfma_f32_16x16x32_bf16 v[28:31], a[76:79], a[252:255], v[28:31]
    v_mfma_f32_16x16x32_bf16 v[28:31], a[72:75], a[236:239], v[28:31]
    v_mfma_f32_16x16x32_bf16 v[28:31], a[68:71], v[148:151], v[28:31]
    v_xor_b32 v248, 114752, v255
    v_cvt_pk_bf16_f32 v112, v12, v13
    v_mfma_f32_16x16x32_bf16 v[28:31], a[64:67], a[220:223], v[28:31]
    v_cvt_pk_bf16_f32 v113, v14, v15
    v_mov_b32 v247, v112
    v_mfma_f32_16x16x32_bf16 v[28:31], a[60:63], a[204:207], v[28:31]
    v_mov_b32 v246, v113
    v_mfma_f32_16x16x32_bf16 v[28:31], a[56:59], v[72:75], v[28:31]
    buffer_store_dwordx4 v[52:55], v253, s[56:59], s94 offen offset:128 nt
    v_mfma_f32_16x16x32_bf16 v[28:31], a[52:55], v[120:123], v[28:31]
    v_mfma_f32_16x16x32_bf16 v[28:31], a[48:51], v[44:47], v[28:31]
    s_waitcnt lgkmcnt(0)
    v_mfma_f32_16x16x32_bf16 v[12:15], a[0:3], v[76:79], 0
    ds_read_b64_tr_b16 a[52:53], v248 offset:0
    v_mfma_f32_16x16x32_bf16 v[12:15], a[4:7], v[116:119], v[12:15]
    ds_read_b64_tr_b16 a[54:55], v248 offset:2048
    v_mfma_f32_16x16x32_bf16 v[12:15], a[8:11], v[128:131], v[12:15]
    ds_read_b64_tr_b16 a[48:49], v248 offset:4096
    v_mfma_f32_16x16x32_bf16 v[12:15], a[12:15], a[192:195], v[12:15]
    ds_read_b64_tr_b16 a[50:51], v248 offset:6144
    v_cvt_pk_bf16_f32 v52, v28, v29
    v_mfma_f32_16x16x32_bf16 v[12:15], a[16:19], a[208:211], v[12:15]
    ds_read_b64_tr_b16 a[56:57], v248 offset:8192
    v_cvt_pk_bf16_f32 v53, v30, v31
    v_mfma_f32_16x16x32_bf16 v[12:15], a[20:23], v[60:63], v[12:15]
    ds_read_b64_tr_b16 a[58:59], v248 offset:10240
    v_mov_b32 v245, v52
    v_mfma_f32_16x16x32_bf16 v[12:15], a[24:27], a[224:227], v[12:15]
    ds_read_b64_tr_b16 a[60:61], v248 offset:12288
    v_mov_b32 v244, v53
    v_mfma_f32_16x16x32_bf16 v[12:15], a[28:31], a[240:243], v[12:15]
    ds_read_b64_tr_b16 a[62:63], v248 offset:14336
    v_mfma_f32_16x16x32_bf16 v[12:15], a[32:35], v[64:67], v[12:15]
    ds_read_b64_tr_b16 a[64:65], v248 offset:16384
    v_mfma_f32_16x16x32_bf16 v[12:15], a[36:39], v[220:223], v[12:15]
    ds_read_b64_tr_b16 a[66:67], v248 offset:18432
    v_mfma_f32_16x16x32_bf16 v[12:15], a[40:43], v[212:215], v[12:15]
    ds_read_b64_tr_b16 a[68:69], v248 offset:20480
    v_mfma_f32_16x16x32_bf16 v[12:15], a[44:47], v[96:99], v[12:15]
    ds_read_b64_tr_b16 a[70:71], v248 offset:22528
    v_mfma_f32_16x16x32_bf16 v[28:31], a[44:47], v[0:3], 0
    ds_read_b64_tr_b16 a[72:73], v248 offset:24576
    v_mfma_f32_16x16x32_bf16 v[28:31], a[40:43], v[40:43], v[28:31]
    ds_read_b64_tr_b16 a[74:75], v248 offset:26624
    v_mfma_f32_16x16x32_bf16 v[28:31], a[36:39], v[228:231], v[28:31]
    ds_read_b64_tr_b16 a[76:77], v248 offset:28672
    v_mfma_f32_16x16x32_bf16 v[28:31], a[32:35], v[168:171], v[28:31]
    ds_read_b64_tr_b16 a[78:79], v248 offset:30720
    v_cvt_pk_bf16_f32 v86, v12, v13
    v_mfma_f32_16x16x32_bf16 v[28:31], a[28:31], a[244:247], v[28:31]
    ds_read_b64_tr_b16 a[80:81], v248 offset:32768
    v_cvt_pk_bf16_f32 v87, v14, v15
    v_mfma_f32_16x16x32_bf16 v[28:31], a[24:27], a[228:231], v[28:31]
    ds_read_b64_tr_b16 a[82:83], v248 offset:34816
    v_mov_b32 v243, v86
    v_mfma_f32_16x16x32_bf16 v[28:31], a[20:23], v[124:127], v[28:31]
    ds_read_b64_tr_b16 a[84:85], v248 offset:36864
    v_mov_b32 v242, v87
    v_mfma_f32_16x16x32_bf16 v[28:31], a[16:19], a[212:215], v[28:31]
    ds_read_b64_tr_b16 a[86:87], v248 offset:38912
    v_mfma_f32_16x16x32_bf16 v[28:31], a[12:15], a[196:199], v[28:31]
    ds_read_b64_tr_b16 a[88:89], v248 offset:40960
    v_mfma_f32_16x16x32_bf16 v[28:31], a[8:11], v[8:11], v[28:31]
    ds_read_b64_tr_b16 a[90:91], v248 offset:43008
    v_mfma_f32_16x16x32_bf16 v[28:31], a[4:7], v[160:163], v[28:31]
    ds_read_b64_tr_b16 a[92:93], v248 offset:45056
    v_mfma_f32_16x16x32_bf16 v[28:31], a[0:3], v[108:111], v[28:31]
    s_add_u32 m0, s29, 89600
    ds_read_b64_tr_b16 a[94:95], v248 offset:47104
    v_mfma_f32_16x16x32_bf16 v[12:15], a[0:3], v[36:39], 0
    global_load_lds_dwordx4 v250, s[16:17] offset:512
    v_mfma_f32_16x16x32_bf16 v[12:15], a[4:7], v[4:7], v[12:15]
    s_add_u32 m0, s29, 93696
    buffer_store_dwordx4 v[80:83], v253, s[56:59], s95 offen offset:128 nt
    v_mfma_f32_16x16x32_bf16 v[12:15], a[8:11], v[24:27], v[12:15]
    global_load_lds_dwordx4 v250, s[18:19] offset:512
    v_mfma_f32_16x16x32_bf16 v[12:15], a[12:15], a[200:203], v[12:15]
    s_add_u32 m0, s29, 97792
    v_cvt_pk_bf16_f32 v34, v28, v29
    v_cvt_pk_bf16_f32 v35, v30, v31
    v_mfma_f32_16x16x32_bf16 v[12:15], a[16:19], a[216:219], v[12:15]
    global_load_lds_dwordx4 v250, s[20:21] offset:512
G_19:
    s_cbranch_vccnz R_ret1
    v_mfma_f32_16x16x32_bf16 v[12:15], a[20:23], v[140:143], v[12:15]
    v_mov_b32 v248, v34
    v_mov_b32 v241, v35
    v_mfma_f32_16x16x32_bf16 v[12:15], a[24:27], a[232:235], v[12:15]
    v_mfma_f32_16x16x32_bf16 v[12:15], a[28:31], a[248:251], v[12:15]
    v_mfma_f32_16x16x32_bf16 v[12:15], a[32:35], v[180:183], v[12:15]
    v_mfma_f32_16x16x32_bf16 v[12:15], a[36:39], v[56:59], v[12:15]
    v_mfma_f32_16x16x32_bf16 v[12:15], a[40:43], v[104:107], v[12:15]
    v_mfma_f32_16x16x32_bf16 v[12:15], a[44:47], v[48:51], v[12:15]
    v_mfma_f32_16x16x32_bf16 v[28:31], a[44:47], v[16:19], 0
    v_mfma_f32_16x16x32_bf16 v[28:31], a[40:43], v[68:71], v[28:31]
    v_mfma_f32_16x16x32_bf16 v[28:31], a[36:39], v[100:103], v[28:31]
    v_mfma_f32_16x16x32_bf16 v[28:31], a[32:35], v[184:187], v[28:31]
    buffer_store_dwordx4 v[132:135], v253, s[56:59], s96 offen offset:128 nt
    v_mfma_f32_16x16x32_bf16 v[28:31], a[28:31], a[252:255], v[28:31]
    v_mfma_f32_16x16x32_bf16 v[28:31], a[24:27], a[236:239], v[28:31]
    v_mfma_f32_16x16x32_bf16 v[28:31], a[20:23], v[148:151], v[28:31]
    v_xor_b32 v240, 114760, v255
    v_cvt_pk_bf16_f32 v114, v12, v13
    v_mfma_f32_16x16x32_bf16 v[28:31], a[16:19], a[220:223], v[28:31]
    v_cvt_pk_bf16_f32 v115, v14, v15
    v_mov_b32 v239, v114
    v_mfma_f32_16x16x32_bf16 v[28:31], a[12:15], a[204:207], v[28:31]
    v_mov_b32 v238, v115
    v_mfma_f32_16x16x32_bf16 v[28:31], a[8:11], v[72:75], v[28:31]
    v_mfma_f32_16x16x32_bf16 v[28:31], a[4:7], v[120:123], v[28:31]
    v_mfma_f32_16x16x32_bf16 v[28:31], a[0:3], v[44:47], v[28:31]
    s_waitcnt lgkmcnt(0)
    v_mfma_f32_16x16x32_bf16 v[12:15], a[52:55], v[76:79], 0
    ds_read_b64_tr_b16 a[4:5], v240 offset:0
    v_mfma_f32_16x16x32_bf16 v[12:15], a[48:51], v[116:119], v[12:15]
    ds_read_b64_tr_b16 a[6:7], v240 offset:2048
    v_mfma_f32_16x16x32_bf16 v[12:15], a[56:59], v[128:131], v[12:15]
    ds_read_b64_tr_b16 a[0:1], v240 offset:4096
    v_mfma_f32_16x16x32_bf16 v[12:15], a[60:63], a[192:195], v[12:15]
    ds_read_b64_tr_b16 a[2:3], v240 offset:6144
    v_cvt_pk_bf16_f32 v54, v28, v29
    v_mfma_f32_16x16x32_bf16 v[12:15], a[64:67], a[208:211], v[12:15]
    ds_read_b64_tr_b16 a[8:9], v240 offset:8192
    v_cvt_pk_bf16_f32 v55, v30, v31
    v_mfma_f32_16x16x32_bf16 v[12:15], a[68:71], v[60:63], v[12:15]
    ds_read_b64_tr_b16 a[10:11], v240 offset:10240
    v_mov_b32 v237, v54
    v_mfma_f32_16x16x32_bf16 v[12:15], a[72:75], a[224:227], v[12:15]
    ds_read_b64_tr_b16 a[12:13], v240 offset:12288
    v_mov_b32 v236, v55
    v_mfma_f32_16x16x32_bf16 v[12:15], a[76:79], a[240:243], v[12:15]
    ds_read_b64_tr_b16 a[14:15], v240 offset:14336
    v_mfma_f32_16x16x32_bf16 v[12:15], a[80:83], v[64:67], v[12:15]
    ds_read_b64_tr_b16 a[16:17], v240 offset:16384
    v_mfma_f32_16x16x32_bf16 v[12:15], a[84:87], v[220:223], v[12:15]
    ds_read_b64_tr_b16 a[18:19], v240 offset:18432
    v_mfma_f32_16x16x32_bf16 v[12:15], a[88:91], v[212:215], v[12:15]
    ds_read_b64_tr_b16 a[20:21], v240 offset:20480
    v_mfma_f32_16x16x32_bf16 v[12:15], a[92:95], v[96:99], v[12:15]
    ds_read_b64_tr_b16 a[22:23], v240 offset:22528
    v_mfma_f32_16x16x32_bf16 v[28:31], a[92:95], v[0:3], 0
    ds_read_b64_tr_b16 a[24:25], v240 offset:24576
    v_mfma_f32_16x16x32_bf16 v[28:31], a[88:91], v[40:43], v[28:31]
    ds_read_b64_tr_b16 a[26:27], v240 offset:26624
    v_mfma_f32_16x16x32_bf16 v[28:31], a[84:87], v[228:231], v[28:31]
    ds_read_b64_tr_b16 a[28:29], v240 offset:28672
    v_mfma_f32_16x16x32_bf16 v[28:31], a[80:83], v[168:171], v[28:31]
    ds_read_b64_tr_b16 a[30:31], v240 offset:30720
    v_cvt_pk_bf16_f32 v80, v12, v13
    v_mfma_f32_16x16x32_bf16 v[28:31], a[76:79], a[244:247], v[28:31]
    ds_read_b64_tr_b16 a[32:33], v240 offset:32768
    v_cvt_pk_bf16_f32 v81, v14, v15
    v_mfma_f32_16x16x32_bf16 v[28:31], a[72:75], a[228:231], v[28:31]
    ds_read_b64_tr_b16 a[34:35], v240 offset:34816
    v_mov_b32_dpp v84, v80 row_ror:8 row_mask:0xf bank_mask:0xc
    v_mfma_f32_16x16x32_bf16 v[28:31], a[68:71], v[124:127], v[28:31]
    ds_read_b64_tr_b16 a[36:37], v240 offset:36864
    v_mov_b32_dpp v85, v81 row_ror:8 row_mask:0xf bank_mask:0xc
    v_mfma_f32_16x16x32_bf16 v[28:31], a[64:67], a[212:215], v[28:31]
    ds_read_b64_tr_b16 a[38:39], v240 offset:38912
    v_mov_b32_dpp v80, v252 row_ror:8 row_mask:0xf bank_mask:0x3
    v_mfma_f32_16x16x32_bf16 v[28:31], a[60:63], a[196:199], v[28:31]
    ds_read_b64_tr_b16 a[40:41], v240 offset:40960
    v_mov_b32_dpp v81, v251 row_ror:8 row_mask:0xf bank_mask:0x3
    v_mfma_f32_16x16x32_bf16 v[28:31], a[56:59], v[8:11], v[28:31]
    ds_read_b64_tr_b16 a[42:43], v240 offset:43008
    v_mfma_f32_16x16x32_bf16 v[28:31], a[48:51], v[160:163], v[28:31]
    ds_read_b64_tr_b16 a[44:45], v240 offset:45056
    v_mfma_f32_16x16x32_bf16 v[28:31], a[52:55], v[108:111], v[28:31]
    s_add_u32 m0, s29, 101888
    ds_read_b64_tr_b16 a[46:47], v240 offset:47104
    v_mfma_f32_16x16x32_bf16 v[12:15], a[52:55], v[36:39], 0
    global_load_lds_dwordx4 v250, s[22:23] offset:512
    v_mfma_f32_16x16x32_bf16 v[12:15], a[48:51], v[4:7], v[12:15]
    s_add_u32 m0, s29, 105984
    buffer_store_dwordx4 v[20:23], v253, s[56:59], s97 offen offset:128 nt
    v_mfma_f32_16x16x32_bf16 v[12:15], a[56:59], v[24:27], v[12:15]
    global_load_lds_dwordx4 v250, s[24:25] offset:512
    v_mfma_f32_16x16x32_bf16 v[12:15], a[60:63], a[200:203], v[12:15]
    s_add_u32 m0, s29, 110080
    v_cvt_pk_bf16_f32 v20, v28, v29
    v_cvt_pk_bf16_f32 v21, v30, v31
    v_mfma_f32_16x16x32_bf16 v[12:15], a[64:67], a[216:219], v[12:15]
    global_load_lds_dwordx4 v250, s[26:27] offset:512
    v_mfma_f32_16x16x32_bf16 v[12:15], a[68:71], v[140:143], v[12:15]
    v_mov_b32_dpp v32, v20 row_ror:8 row_mask:0xf bank_mask:0xc
    v_mov_b32_dpp v33, v21 row_ror:8 row_mask:0xf bank_mask:0xc
    v_mfma_f32_16x16x32_bf16 v[12:15], a[72:75], a[232:235], v[12:15]
    v_mov_b32_dpp v20, v254 row_ror:8 row_mask:0xf bank_mask:0x3
    v_mov_b32_dpp v21, v249 row_ror:8 row_mask:0xf bank_mask:0x3
    v_mfma_f32_16x16x32_bf16 v[12:15], a[76:79], a[248:251], v[12:15]
    v_mfma_f32_16x16x32_bf16 v[12:15], a[80:83], v[180:183], v[12:15]
    v_mfma_f32_16x16x32_bf16 v[12:15], a[84:87], v[56:59], v[12:15]
    v_mfma_f32_16x16x32_bf16 v[12:15], a[88:91], v[104:107], v[12:15]
    v_mfma_f32_16x16x32_bf16 v[12:15], a[92:95], v[48:51], v[12:15]
    buffer_store_dwordx4 v[88:91], v253, s[56:59], s98 offen offset:128 nt
    v_mfma_f32_16x16x32_bf16 v[28:31], a[92:95], v[16:19], 0
    v_mfma_f32_16x16x32_bf16 v[28:31], a[88:91], v[68:71], v[28:31]
    v_mfma_f32_16x16x32_bf16 v[28:31], a[84:87], v[100:103], v[28:31]
    v_mfma_f32_16x16x32_bf16 v[28:31], a[80:83], v[184:187], v[28:31]
    v_mfma_f32_16x16x32_bf16 v[28:31], a[76:79], a[252:255], v[28:31]
    v_mfma_f32_16x16x32_bf16 v[28:31], a[72:75], a[236:239], v[28:31]
    v_mfma_f32_16x16x32_bf16 v[28:31], a[68:71], v[148:151], v[28:31]
    v_xor_b32 v254, 16384, v255
    v_cvt_pk_bf16_f32 v88, v12, v13
    v_mfma_f32_16x16x32_bf16 v[28:31], a[64:67], a[220:223], v[28:31]
    v_cvt_pk_bf16_f32 v89, v14, v15
    v_mov_b32_dpp v112, v88 row_ror:8 row_mask:0xf bank_mask:0xc
    v_mfma_f32_16x16x32_bf16 v[28:31], a[60:63], a[204:207], v[28:31]
    v_mov_b32_dpp v113, v89 row_ror:8 row_mask:0xf bank_mask:0xc
    v_mov_b32_dpp v88, v247 row_ror:8 row_mask:0xf bank_mask:0x3
    v_mfma_f32_16x16x32_bf16 v[28:31], a[56:59], v[72:75], v[28:31]
    v_mov_b32_dpp v89, v246 row_ror:8 row_mask:0xf bank_mask:0x3
    v_mfma_f32_16x16x32_bf16 v[28:31], a[48:51], v[120:123], v[28:31]
    v_mfma_f32_16x16x32_bf16 v[28:31], a[52:55], v[44:47], v[28:31]
    s_waitcnt vmcnt(21) lgkmcnt(0)
    s_barrier
    v_mfma_f32_16x16x32_bf16 v[12:15], a[4:7], v[76:79], 0
    ds_read_b64_tr_b16 a[48:49], v254 offset:0
    v_mfma_f32_16x16x32_bf16 v[12:15], a[0:3], v[116:119], v[12:15]
    ds_read_b64_tr_b16 a[50:51], v254 offset:2048
    v_mfma_f32_16x16x32_bf16 v[12:15], a[8:11], v[128:131], v[12:15]
    ds_read_b64_tr_b16 a[52:53], v254 offset:4096
    v_cvt_pk_bf16_f32 v132, v28, v29
    v_mfma_f32_16x16x32_bf16 v[12:15], a[12:15], a[192:195], v[12:15]
    ds_read_b64_tr_b16 a[54:55], v254 offset:6144
    v_cvt_pk_bf16_f32 v133, v30, v31
    v_mfma_f32_16x16x32_bf16 v[12:15], a[16:19], a[208:211], v[12:15]
    ds_read_b64_tr_b16 a[56:57], v254 offset:8192
    v_mov_b32_dpp v52, v132 row_ror:8 row_mask:0xf bank_mask:0xc
    v_mfma_f32_16x16x32_bf16 v[12:15], a[20:23], v[60:63], v[12:15]
    ds_read_b64_tr_b16 a[58:59], v254 offset:10240
    v_mov_b32_dpp v53, v133 row_ror:8 row_mask:0xf bank_mask:0xc
    v_mfma_f32_16x16x32_bf16 v[12:15], a[24:27], a[224:227], v[12:15]
    ds_read_b64_tr_b16 a[60:61], v254 offset:12288
    v_mov_b32_dpp v132, v245 row_ror:8 row_mask:0xf bank_mask:0x3
    v_mfma_f32_16x16x32_bf16 v[12:15], a[28:31], a[240:243], v[12:15]
    ds_read_b64_tr_b16 a[62:63], v254 offset:14336
    v_mov_b32_dpp v133, v244 row_ror:8 row_mask:0xf bank_mask:0x3
    v_mfma_f32_16x16x32_bf16 v[12:15], a[32:35], v[64:67], v[12:15]
    ds_read_b64_tr_b16 a[64:65], v254 offset:16384
    v_mfma_f32_16x16x32_bf16 v[12:15], a[36:39], v[220:223], v[12:15]
    ds_read_b64_tr_b16 a[66:67], v254 offset:18432
    v_mfma_f32_16x16x32_bf16 v[12:15], a[40:43], v[212:215], v[12:15]
    ds_read_b64_tr_b16 a[68:69], v254 offset:20480
    v_mfma_f32_16x16x32_bf16 v[12:15], a[44:47], v[96:99], v[12:15]
    ds_read_b64_tr_b16 a[70:71], v254 offset:22528
    v_mfma_f32_16x16x32_bf16 v[28:31], a[44:47], v[0:3], 0
    ds_read_b64_tr_b16 a[72:73], v254 offset:24576
    v_mfma_f32_16x16x32_bf16 v[28:31], a[40:43], v[40:43], v[28:31]
    ds_read_b64_tr_b16 a[74:75], v254 offset:26624
    v_mfma_f32_16x16x32_bf16 v[28:31], a[36:39], v[228:231], v[28:31]
    ds_read_b64_tr_b16 a[76:77], v254 offset:28672
    v_mfma_f32_16x16x32_bf16 v[28:31], a[32:35], v[168:171], v[28:31]
    ds_read_b64_tr_b16 a[78:79], v254 offset:30720
    v_cvt_pk_bf16_f32 v82, v12, v13
    v_mfma_f32_16x16x32_bf16 v[28:31], a[28:31], a[244:247], v[28:31]
    ds_read_b64_tr_b16 a[80:81], v254 offset:32768
    v_cvt_pk_bf16_f32 v83, v14, v15
    v_mfma_f32_16x16x32_bf16 v[28:31], a[24:27], a[228:231], v[28:31]
    ds_read_b64_tr_b16 a[82:83], v254 offset:34816
    v_mov_b32_dpp v86, v82 row_ror:8 row_mask:0xf bank_mask:0xc
    v_mfma_f32_16x16x32_bf16 v[28:31], a[20:23], v[124:127], v[28:31]
    ds_read_b64_tr_b16 a[84:85], v254 offset:36864
    v_mov_b32_dpp v87, v83 row_ror:8 row_mask:0xf bank_mask:0xc
    v_mfma_f32_16x16x32_bf16 v[28:31], a[16:19], a[212:215], v[28:31]
    ds_read_b64_tr_b16 a[86:87], v254 offset:38912
    v_mov_b32_dpp v82, v243 row_ror:8 row_mask:0xf bank_mask:0x3
    v_mfma_f32_16x16x32_bf16 v[28:31], a[12:15], a[196:199], v[28:31]
    ds_read_b64_tr_b16 a[88:89], v254 offset:40960
    v_mov_b32_dpp v83, v242 row_ror:8 row_mask:0xf bank_mask:0x3
    v_mfma_f32_16x16x32_bf16 v[28:31], a[8:11], v[8:11], v[28:31]
    ds_read_b64_tr_b16 a[90:91], v254 offset:43008
    v_mfma_f32_16x16x32_bf16 v[28:31], a[0:3], v[160:163], v[28:31]
    ds_read_b64_tr_b16 a[92:93], v254 offset:45056
    v_mfma_f32_16x16x32_bf16 v[28:31], a[4:7], v[108:111], v[28:31]
    s_add_u32 m0, s29, 114048
    ds_read_b64_tr_b16 a[94:95], v254 offset:47104
    v_mfma_f32_16x16x32_bf16 v[12:15], a[4:7], v[36:39], 0
    global_load_lds_dwordx4 v250, s[4:5] offset:640
    v_mfma_f32_16x16x32_bf16 v[12:15], a[0:3], v[4:7], v[12:15]
    s_add_u32 m0, s29, 118144
    buffer_store_dwordx4 v[92:95], v253, s[56:59], s99 offen offset:128 nt
    v_mfma_f32_16x16x32_bf16 v[12:15], a[8:11], v[24:27], v[12:15]
    global_load_lds_dwordx4 v250, s[6:7] offset:640
    v_mfma_f32_16x16x32_bf16 v[12:15], a[12:15], a[200:203], v[12:15]
    s_add_u32 m0, s29, 122240
    v_cvt_pk_bf16_f32 v22, v28, v29
    v_cvt_pk_bf16_f32 v23, v30, v31
    v_mfma_f32_16x16x32_bf16 v[12:15], a[16:19], a[216:219], v[12:15]
    global_load_lds_dwordx4 v250, s[8:9] offset:640
    v_mfma_f32_16x16x32_bf16 v[12:15], a[20:23], v[140:143], v[12:15]
    v_mov_b32_dpp v34, v22 row_ror:8 row_mask:0xf bank_mask:0xc
    v_mov_b32_dpp v35, v23 row_ror:8 row_mask:0xf bank_mask:0xc
    v_mfma_f32_16x16x32_bf16 v[12:15], a[24:27], a[232:235], v[12:15]
    v_mov_b32_dpp v22, v248 row_ror:8 row_mask:0xf bank_mask:0x3
    v_mov_b32_dpp v23, v241 row_ror:8 row_mask:0xf bank_mask:0x3
    v_mfma_f32_16x16x32_bf16 v[12:15], a[28:31], a[248:251], v[12:15]
    v_mfma_f32_16x16x32_bf16 v[12:15], a[32:35], v[180:183], v[12:15]
    v_mfma_f32_16x16x32_bf16 v[12:15], a[36:39], v[56:59], v[12:15]
    v_mfma_f32_16x16x32_bf16 v[12:15], a[40:43], v[104:107], v[12:15]
    v_mfma_f32_16x16x32_bf16 v[12:15], a[44:47], v[48:51], v[12:15]
    v_mfma_f32_16x16x32_bf16 v[28:31], a[44:47], v[16:19], 0
    v_mfma_f32_16x16x32_bf16 v[28:31], a[40:43], v[68:71], v[28:31]
    v_mfma_f32_16x16x32_bf16 v[28:31], a[36:39], v[100:103], v[28:31]
    v_mfma_f32_16x16x32_bf16 v[28:31], a[32:35], v[184:187], v[28:31]
    v_mfma_f32_16x16x32_bf16 v[28:31], a[28:31], a[252:255], v[28:31]
    v_mfma_f32_16x16x32_bf16 v[28:31], a[24:27], a[236:239], v[28:31]
    v_mfma_f32_16x16x32_bf16 v[28:31], a[20:23], v[148:151], v[28:31]
    v_xor_b32 v254, 16392, v255
    v_cvt_pk_bf16_f32 v90, v12, v13
    v_mfma_f32_16x16x32_bf16 v[28:31], a[16:19], a[220:223], v[28:31]
    v_cvt_pk_bf16_f32 v91, v14, v15
    v_mov_b32_dpp v114, v90 row_ror:8 row_mask:0xf bank_mask:0xc
    v_mfma_f32_16x16x32_bf16 v[28:31], a[12:15], a[204:207], v[28:31]
    v_mov_b32_dpp v115, v91 row_ror:8 row_mask:0xf bank_mask:0xc
    v_mov_b32_dpp v90, v239 row_ror:8 row_mask:0xf bank_mask:0x3
    v_mfma_f32_16x16x32_bf16 v[28:31], a[8:11], v[72:75], v[28:31]
    v_mov_b32_dpp v91, v238 row_ror:8 row_mask:0xf bank_mask:0x3
    v_mfma_f32_16x16x32_bf16 v[28:31], a[0:3], v[120:123], v[28:31]
    v_mfma_f32_16x16x32_bf16 v[28:31], a[4:7], v[44:47], v[28:31]
    s_waitcnt lgkmcnt(0)
    buffer_store_dwordx4 v[84:87], v253, s[56:59], s92 offen offset:256 nt
    v_mfma_f32_16x16x32_bf16 v[12:15], a[48:51], v[76:79], 0
    ds_read_b64_tr_b16 a[0:1], v254 offset:0
    v_mfma_f32_16x16x32_bf16 v[12:15], a[52:55], v[116:119], v[12:15]
    ds_read_b64_tr_b16 a[2:3], v254 offset:2048
    v_mfma_f32_16x16x32_bf16 v[12:15], a[56:59], v[128:131], v[12:15]
    ds_read_b64_tr_b16 a[4:5], v254 offset:4096
    v_cvt_pk_bf16_f32 v134, v28, v29
    v_mfma_f32_16x16x32_bf16 v[12:15], a[60:63], a[192:195], v[12:15]
    ds_read_b64_tr_b16 a[6:7], v254 offset:6144
    v_cvt_pk_bf16_f32 v135, v30, v31
    v_mfma_f32_16x16x32_bf16 v[12:15], a[64:67], a[208:211], v[12:15]
    ds_read_b64_tr_b16 a[8:9], v254 offset:8192
    v_mov_b32_dpp v54, v134 row_ror:8 row_mask:0xf bank_mask:0xc
    v_mfma_f32_16x16x32_bf16 v[12:15], a[68:71], v[60:63], v[12:15]
    ds_read_b64_tr_b16 a[10:11], v254 offset:10240
    v_mov_b32_dpp v55, v135 row_ror:8 row_mask:0xf bank_mask:0xc
    v_mfma_f32_16x16x32_bf16 v[12:15], a[72:75], a[224:227], v[12:15]
    ds_read_b64_tr_b16 a[12:13], v254 offset:12288
    v_mov_b32_dpp v134, v237 row_ror:8 row_mask:0xf bank_mask:0x3
    v_mfma_f32_16x16x32_bf16 v[12:15], a[76:79], a[240:243], v[12:15]
    ds_read_b64_tr_b16 a[14:15], v254 offset:14336
    v_mov_b32_dpp v135, v236 row_ror:8 row_mask:0xf bank_mask:0x3
    v_mfma_f32_16x16x32_bf16 v[12:15], a[80:83], v[64:67], v[12:15]
    ds_read_b64_tr_b16 a[16:17], v254 offset:16384
    v_mfma_f32_16x16x32_bf16 v[12:15], a[84:87], v[220:223], v[12:15]
    ds_read_b64_tr_b16 a[18:19], v254 offset:18432
    v_mfma_f32_16x16x32_bf16 v[12:15], a[88:91], v[212:215], v[12:15]
    ds_read_b64_tr_b16 a[20:21], v254 offset:20480
    v_mfma_f32_16x16x32_bf16 v[12:15], a[92:95], v[96:99], v[12:15]
    ds_read_b64_tr_b16 a[22:23], v254 offset:22528
    v_mfma_f32_16x16x32_bf16 v[28:31], a[92:95], v[0:3], 0
    ds_read_b64_tr_b16 a[24:25], v254 offset:24576
    v_mfma_f32_16x16x32_bf16 v[28:31], a[88:91], v[40:43], v[28:31]
    ds_read_b64_tr_b16 a[26:27], v254 offset:26624
    v_mfma_f32_16x16x32_bf16 v[28:31], a[84:87], v[228:231], v[28:31]
    ds_read_b64_tr_b16 a[28:29], v254 offset:28672
    v_mfma_f32_16x16x32_bf16 v[28:31], a[80:83], v[168:171], v[28:31]
    ds_read_b64_tr_b16 a[30:31], v254 offset:30720
    v_cvt_pk_bf16_f32 v84, v12, v13
    v_mfma_f32_16x16x32_bf16 v[28:31], a[76:79], a[244:247], v[28:31]
    ds_read_b64_tr_b16 a[32:33], v254 offset:32768
    v_cvt_pk_bf16_f32 v85, v14, v15
    v_mfma_f32_16x16x32_bf16 v[28:31], a[72:75], a[228:231], v[28:31]
    ds_read_b64_tr_b16 a[34:35], v254 offset:34816
    v_mov_b32 v252, v84
    v_mfma_f32_16x16x32_bf16 v[28:31], a[68:71], v[124:127], v[28:31]
    ds_read_b64_tr_b16 a[36:37], v254 offset:36864
    v_mov_b32 v251, v85
    v_mfma_f32_16x16x32_bf16 v[28:31], a[64:67], a[212:215], v[28:31]
    ds_read_b64_tr_b16 a[38:39], v254 offset:38912
    v_mfma_f32_16x16x32_bf16 v[28:31], a[60:63], a[196:199], v[28:31]
    ds_read_b64_tr_b16 a[40:41], v254 offset:40960
    v_mfma_f32_16x16x32_bf16 v[28:31], a[56:59], v[8:11], v[28:31]
    ds_read_b64_tr_b16 a[42:43], v254 offset:43008
    v_mfma_f32_16x16x32_bf16 v[28:31], a[52:55], v[160:163], v[28:31]
    ds_read_b64_tr_b16 a[44:45], v254 offset:45056
    v_mfma_f32_16x16x32_bf16 v[28:31], a[48:51], v[108:111], v[28:31]
    s_add_u32 m0, s29, 126336
    ds_read_b64_tr_b16 a[46:47], v254 offset:47104
    v_mfma_f32_16x16x32_bf16 v[12:15], a[48:51], v[36:39], 0
    global_load_lds_dwordx4 v250, s[10:11] offset:640
    v_mfma_f32_16x16x32_bf16 v[12:15], a[52:55], v[4:7], v[12:15]
    s_add_u32 m0, s29, 130432
    buffer_store_dwordx4 v[80:83], v253, s[56:59], s93 offen offset:256 nt
    v_mfma_f32_16x16x32_bf16 v[12:15], a[56:59], v[24:27], v[12:15]
    global_load_lds_dwordx4 v250, s[12:13] offset:640
    v_mfma_f32_16x16x32_bf16 v[12:15], a[60:63], a[200:203], v[12:15]
    s_add_u32 m0, s29, 134528
    v_cvt_pk_bf16_f32 v80, v28, v29
    v_cvt_pk_bf16_f32 v81, v30, v31
    v_mfma_f32_16x16x32_bf16 v[12:15], a[64:67], a[216:219], v[12:15]
    global_load_lds_dwordx4 v250, s[14:15] offset:640
    v_mfma_f32_16x16x32_bf16 v[12:15], a[68:71], v[140:143], v[12:15]
    v_mov_b32 v254, v80
    v_mov_b32 v249, v81
    v_mfma_f32_16x16x32_bf16 v[12:15], a[72:75], a[232:235], v[12:15]
    v_mfma_f32_16x16x32_bf16 v[12:15], a[76:79], a[248:251], v[12:15]
    v_mfma_f32_16x16x32_bf16 v[12:15], a[80:83], v[180:183], v[12:15]
    v_mfma_f32_16x16x32_bf16 v[12:15], a[84:87], v[56:59], v[12:15]
    v_mfma_f32_16x16x32_bf16 v[12:15], a[88:91], v[104:107], v[12:15]
    v_mfma_f32_16x16x32_bf16 v[12:15], a[92:95], v[48:51], v[12:15]
    v_mfma_f32_16x16x32_bf16 v[28:31], a[92:95], v[16:19], 0
    v_mfma_f32_16x16x32_bf16 v[28:31], a[88:91], v[68:71], v[28:31]
    v_mfma_f32_16x16x32_bf16 v[28:31], a[84:87], v[100:103], v[28:31]
    v_mfma_f32_16x16x32_bf16 v[28:31], a[80:83], v[184:187], v[28:31]
    v_mfma_f32_16x16x32_bf16 v[28:31], a[76:79], a[252:255], v[28:31]
    v_mfma_f32_16x16x32_bf16 v[28:31], a[72:75], a[236:239], v[28:31]
    v_mfma_f32_16x16x32_bf16 v[28:31], a[68:71], v[148:151], v[28:31]
    v_xor_b32 v248, 16448, v255
    v_cvt_pk_bf16_f32 v92, v12, v13
    v_mfma_f32_16x16x32_bf16 v[28:31], a[64:67], a[220:223], v[28:31]
    v_cvt_pk_bf16_f32 v93, v14, v15
    v_mov_b32 v247, v92
    v_mfma_f32_16x16x32_bf16 v[28:31], a[60:63], a[204:207], v[28:31]
    v_mov_b32 v246, v93
    v_mfma_f32_16x16x32_bf16 v[28:31], a[56:59], v[72:75], v[28:31]
    buffer_store_dwordx4 v[32:35], v253, s[56:59], s94 offen offset:256 nt
    v_mfma_f32_16x16x32_bf16 v[28:31], a[52:55], v[120:123], v[28:31]
    v_mfma_f32_16x16x32_bf16 v[28:31], a[48:51], v[44:47], v[28:31]
    s_waitcnt lgkmcnt(0)
    v_mfma_f32_16x16x32_bf16 v[12:15], a[0:3], v[76:79], 0
    ds_read_b64_tr_b16 a[52:53], v248 offset:0
    v_mfma_f32_16x16x32_bf16 v[12:15], a[4:7], v[116:119], v[12:15]
    ds_read_b64_tr_b16 a[54:55], v248 offset:2048
    v_mfma_f32_16x16x32_bf16 v[12:15], a[8:11], v[128:131], v[12:15]
    ds_read_b64_tr_b16 a[48:49], v248 offset:4096
    v_mfma_f32_16x16x32_bf16 v[12:15], a[12:15], a[192:195], v[12:15]
    ds_read_b64_tr_b16 a[50:51], v248 offset:6144
    v_cvt_pk_bf16_f32 v32, v28, v29
    v_mfma_f32_16x16x32_bf16 v[12:15], a[16:19], a[208:211], v[12:15]
    ds_read_b64_tr_b16 a[56:57], v248 offset:8192
    v_cvt_pk_bf16_f32 v33, v30, v31
    v_mfma_f32_16x16x32_bf16 v[12:15], a[20:23], v[60:63], v[12:15]
    ds_read_b64_tr_b16 a[58:59], v248 offset:10240
    v_mov_b32 v245, v32
    v_mfma_f32_16x16x32_bf16 v[12:15], a[24:27], a[224:227], v[12:15]
    ds_read_b64_tr_b16 a[60:61], v248 offset:12288
    v_mov_b32 v244, v33
    v_mfma_f32_16x16x32_bf16 v[12:15], a[28:31], a[240:243], v[12:15]
    ds_read_b64_tr_b16 a[62:63], v248 offset:14336
    v_mfma_f32_16x16x32_bf16 v[12:15], a[32:35], v[64:67], v[12:15]
    ds_read_b64_tr_b16 a[64:65], v248 offset:16384
    v_mfma_f32_16x16x32_bf16 v[12:15], a[36:39], v[220:223], v[12:15]
    ds_read_b64_tr_b16 a[66:67], v248 offset:18432
    v_mfma_f32_16x16x32_bf16 v[12:15], a[40:43], v[212:215], v[12:15]
    ds_read_b64_tr_b16 a[68:69], v248 offset:20480
    v_mfma_f32_16x16x32_bf16 v[12:15], a[44:47], v[96:99], v[12:15]
    ds_read_b64_tr_b16 a[70:71], v248 offset:22528
    v_mfma_f32_16x16x32_bf16 v[28:31], a[44:47], v[0:3], 0
    ds_read_b64_tr_b16 a[72:73], v248 offset:24576
    v_mfma_f32_16x16x32_bf16 v[28:31], a[40:43], v[40:43], v[28:31]
    ds_read_b64_tr_b16 a[74:75], v248 offset:26624
    v_mfma_f32_16x16x32_bf16 v[28:31], a[36:39], v[228:231], v[28:31]
    ds_read_b64_tr_b16 a[76:77], v248 offset:28672
    v_mfma_f32_16x16x32_bf16 v[28:31], a[32:35], v[168:171], v[28:31]
    ds_read_b64_tr_b16 a[78:79], v248 offset:30720
    v_cvt_pk_bf16_f32 v86, v12, v13
    v_mfma_f32_16x16x32_bf16 v[28:31], a[28:31], a[244:247], v[28:31]
    ds_read_b64_tr_b16 a[80:81], v248 offset:32768
    v_cvt_pk_bf16_f32 v87, v14, v15
    v_mfma_f32_16x16x32_bf16 v[28:31], a[24:27], a[228:231], v[28:31]
    ds_read_b64_tr_b16 a[82:83], v248 offset:34816
    v_mov_b32 v243, v86
    v_mfma_f32_16x16x32_bf16 v[28:31], a[20:23], v[124:127], v[28:31]
    ds_read_b64_tr_b16 a[84:85], v248 offset:36864
    v_mov_b32 v242, v87
    v_mfma_f32_16x16x32_bf16 v[28:31], a[16:19], a[212:215], v[28:31]
    ds_read_b64_tr_b16 a[86:87], v248 offset:38912
    v_mfma_f32_16x16x32_bf16 v[28:31], a[12:15], a[196:199], v[28:31]
    ds_read_b64_tr_b16 a[88:89], v248 offset:40960
    v_mfma_f32_16x16x32_bf16 v[28:31], a[8:11], v[8:11], v[28:31]
    ds_read_b64_tr_b16 a[90:91], v248 offset:43008
    v_mfma_f32_16x16x32_bf16 v[28:31], a[4:7], v[160:163], v[28:31]
    ds_read_b64_tr_b16 a[92:93], v248 offset:45056
    v_mfma_f32_16x16x32_bf16 v[28:31], a[0:3], v[108:111], v[28:31]
    s_add_u32 m0, s29, 138624
    ds_read_b64_tr_b16 a[94:95], v248 offset:47104
    v_mfma_f32_16x16x32_bf16 v[12:15], a[0:3], v[36:39], 0
    global_load_lds_dwordx4 v250, s[16:17] offset:640
    v_mfma_f32_16x16x32_bf16 v[12:15], a[4:7], v[4:7], v[12:15]
    s_add_u32 m0, s29, 142720
    buffer_store_dwordx4 v[20:23], v253, s[56:59], s95 offen offset:256 nt
    v_mfma_f32_16x16x32_bf16 v[12:15], a[8:11], v[24:27], v[12:15]
    global_load_lds_dwordx4 v250, s[18:19] offset:640
    v_mfma_f32_16x16x32_bf16 v[12:15], a[12:15], a[200:203], v[12:15]
    s_add_u32 m0, s29, 146816
    v_cvt_pk_bf16_f32 v82, v28, v29
    v_cvt_pk_bf16_f32 v83, v30, v31
    v_mfma_f32_16x16x32_bf16 v[12:15], a[16:19], a[216:219], v[12:15]
    global_load_lds_dwordx4 v250, s[20:21] offset:640
    v_mfma_f32_16x16x32_bf16 v[12:15], a[20:23], v[140:143], v[12:15]
    v_mov_b32 v248, v82
    v_mov_b32 v241, v83
    v_mfma_f32_16x16x32_bf16 v[12:15], a[24:27], a[232:235], v[12:15]
    v_mfma_f32_16x16x32_bf16 v[12:15], a[28:31], a[248:251], v[12:15]
    v_mfma_f32_16x16x32_bf16 v[12:15], a[32:35], v[180:183], v[12:15]
    v_mfma_f32_16x16x32_bf16 v[12:15], a[36:39], v[56:59], v[12:15]
    v_mfma_f32_16x16x32_bf16 v[12:15], a[40:43], v[104:107], v[12:15]
    v_mfma_f32_16x16x32_bf16 v[12:15], a[44:47], v[48:51], v[12:15]
    v_mfma_f32_16x16x32_bf16 v[20:23], a[44:47], v[16:19], 0
    v_mfma_f32_16x16x32_bf16 v[20:23], a[40:43], v[68:71], v[20:23]
    v_mfma_f32_16x16x32_bf16 v[20:23], a[36:39], v[100:103], v[20:23]
    v_mfma_f32_16x16x32_bf16 v[20:23], a[32:35], v[184:187], v[20:23]
    buffer_store_dwordx4 v[112:115], v253, s[56:59], s96 offen offset:256 nt
    v_mfma_f32_16x16x32_bf16 v[20:23], a[28:31], a[252:255], v[20:23]
    v_mfma_f32_16x16x32_bf16 v[20:23], a[24:27], a[236:239], v[20:23]
    v_mfma_f32_16x16x32_bf16 v[20:23], a[20:23], v[148:151], v[20:23]
    v_xor_b32 v240, 16456, v255
    v_cvt_pk_bf16_f32 v94, v12, v13
    v_mfma_f32_16x16x32_bf16 v[20:23], a[16:19], a[220:223], v[20:23]
    v_cvt_pk_bf16_f32 v95, v14, v15
    v_mov_b32 v239, v94
    v_mfma_f32_16x16x32_bf16 v[20:23], a[12:15], a[204:207], v[20:23]
    v_mov_b32 v238, v95
    v_mfma_f32_16x16x32_bf16 v[20:23], a[8:11], v[72:75], v[20:23]
    v_mfma_f32_16x16x32_bf16 v[20:23], a[4:7], v[120:123], v[20:23]
    v_mfma_f32_16x16x32_bf16 v[20:23], a[0:3], v[44:47], v[20:23]
    s_waitcnt lgkmcnt(0)
    v_mfma_f32_16x16x32_bf16 v[12:15], a[52:55], v[76:79], 0
    ds_read_b64_tr_b16 a[4:5], v240 offset:0
    v_mfma_f32_16x16x32_bf16 v[12:15], a[48:51], v[116:119], v[12:15]
    ds_read_b64_tr_b16 a[6:7], v240 offset:2048
    v_mfma_f32_16x16x32_bf16 v[12:15], a[56:59], v[128:131], v[12:15]
    ds_read_b64_tr_b16 a[0:1], v240 offset:4096
    v_mfma_f32_16x16x32_bf16 v[12:15], a[60:63], a[192:195], v[12:15]
    ds_read_b64_tr_b16 a[2:3], v240 offset:6144
    v_cvt_pk_bf16_f32 v34, v20, v21
    v_mfma_f32_16x16x32_bf16 v[12:15], a[64:67], a[208:211], v[12:15]
    ds_read_b64_tr_b16 a[8:9], v240 offset:8192
    v_cvt_pk_bf16_f32 v35, v22, v23
    v_mfma_f32_16x16x32_bf16 v[12:15], a[68:71], v[60:63], v[12:15]
    ds_read_b64_tr_b16 a[10:11], v240 offset:10240
    v_mov_b32 v237, v34
    v_mfma_f32_16x16x32_bf16 v[12:15], a[72:75], a[224:227], v[12:15]
    ds_read_b64_tr_b16 a[12:13], v240 offset:12288
    v_mov_b32 v236, v35
    v_mfma_f32_16x16x32_bf16 v[12:15], a[76:79], a[240:243], v[12:15]
    ds_read_b64_tr_b16 a[14:15], v240 offset:14336
    v_mfma_f32_16x16x32_bf16 v[12:15], a[80:83], v[64:67], v[12:15]
    ds_read_b64_tr_b16 a[16:17], v240 offset:16384
    v_mfma_f32_16x16x32_bf16 v[12:15], a[84:87], v[220:223], v[12:15]
    ds_read_b64_tr_b16 a[18:19], v240 offset:18432
    v_mfma_f32_16x16x32_bf16 v[12:15], a[88:91], v[212:215], v[12:15]
    ds_read_b64_tr_b16 a[20:21], v240 offset:20480
    v_mfma_f32_16x16x32_bf16 v[12:15], a[92:95], v[96:99], v[12:15]
    ds_read_b64_tr_b16 a[22:23], v240 offset:22528
    v_mfma_f32_16x16x32_bf16 v[20:23], a[92:95], v[0:3], 0
    ds_read_b64_tr_b16 a[24:25], v240 offset:24576
    v_mfma_f32_16x16x32_bf16 v[20:23], a[88:91], v[40:43], v[20:23]
    ds_read_b64_tr_b16 a[26:27], v240 offset:26624
    v_mfma_f32_16x16x32_bf16 v[20:23], a[84:87], v[228:231], v[20:23]
    ds_read_b64_tr_b16 a[28:29], v240 offset:28672
    v_mfma_f32_16x16x32_bf16 v[20:23], a[80:83], v[168:171], v[20:23]
    ds_read_b64_tr_b16 a[30:31], v240 offset:30720
    v_cvt_pk_bf16_f32 v28, v12, v13
    v_mfma_f32_16x16x32_bf16 v[20:23], a[76:79], a[244:247], v[20:23]
    ds_read_b64_tr_b16 a[32:33], v240 offset:32768
    v_cvt_pk_bf16_f32 v29, v14, v15
    v_mfma_f32_16x16x32_bf16 v[20:23], a[72:75], a[228:231], v[20:23]
    ds_read_b64_tr_b16 a[34:35], v240 offset:34816
    v_mov_b32_dpp v84, v28 row_ror:8 row_mask:0xf bank_mask:0xc
    v_mfma_f32_16x16x32_bf16 v[20:23], a[68:71], v[124:127], v[20:23]
    ds_read_b64_tr_b16 a[36:37], v240 offset:36864
    v_mov_b32_dpp v85, v29 row_ror:8 row_mask:0xf bank_mask:0xc
    v_mfma_f32_16x16x32_bf16 v[20:23], a[64:67], a[212:215], v[20:23]
    ds_read_b64_tr_b16 a[38:39], v240 offset:38912
    v_mov_b32_dpp v28, v252 row_ror:8 row_mask:0xf bank_mask:0x3
    v_mfma_f32_16x16x32_bf16 v[20:23], a[60:63], a[196:199], v[20:23]
    ds_read_b64_tr_b16 a[40:41], v240 offset:40960
    v_mov_b32_dpp v29, v251 row_ror:8 row_mask:0xf bank_mask:0x3
    v_mfma_f32_16x16x32_bf16 v[20:23], a[56:59], v[8:11], v[20:23]
    ds_read_b64_tr_b16 a[42:43], v240 offset:43008
    v_mfma_f32_16x16x32_bf16 v[20:23], a[48:51], v[160:163], v[20:23]
    ds_read_b64_tr_b16 a[44:45], v240 offset:45056
    v_mfma_f32_16x16x32_bf16 v[20:23], a[52:55], v[108:111], v[20:23]
    s_add_u32 m0, s29, 150912
    ds_read_b64_tr_b16 a[46:47], v240 offset:47104
    v_mfma_f32_16x16x32_bf16 v[12:15], a[52:55], v[36:39], 0
    global_load_lds_dwordx4 v250, s[22:23] offset:640
    v_mfma_f32_16x16x32_bf16 v[12:15], a[48:51], v[4:7], v[12:15]
    s_add_u32 m0, s29, 155008
    buffer_store_dwordx4 v[88:91], v253, s[56:59], s97 offen offset:256 nt
    v_mfma_f32_16x16x32_bf16 v[12:15], a[56:59], v[24:27], v[12:15]
    global_load_lds_dwordx4 v250, s[24:25] offset:640
    v_mfma_f32_16x16x32_bf16 v[12:15], a[60:63], a[200:203], v[12:15]
    s_add_u32 m0, s29, 159104
    v_cvt_pk_bf16_f32 v88, v20, v21
    v_cvt_pk_bf16_f32 v89, v22, v23
    v_mfma_f32_16x16x32_bf16 v[12:15], a[64:67], a[216:219], v[12:15]
    global_load_lds_dwordx4 v250, s[26:27] offset:640
    v_mfma_f32_16x16x32_bf16 v[12:15], a[68:71], v[140:143], v[12:15]
    v_mov_b32_dpp v80, v88 row_ror:8 row_mask:0xf bank_mask:0xc
    v_mov_b32_dpp v81, v89 row_ror:8 row_mask:0xf bank_mask:0xc
    v_mfma_f32_16x16x32_bf16 v[12:15], a[72:75], a[232:235], v[12:15]
    v_mov_b32_dpp v88, v254 row_ror:8 row_mask:0xf bank_mask:0x3
    v_mov_b32_dpp v89, v249 row_ror:8 row_mask:0xf bank_mask:0x3
    v_mfma_f32_16x16x32_bf16 v[12:15], a[76:79], a[248:251], v[12:15]
    v_mfma_f32_16x16x32_bf16 v[12:15], a[80:83], v[180:183], v[12:15]
    v_mfma_f32_16x16x32_bf16 v[12:15], a[84:87], v[56:59], v[12:15]
    v_mfma_f32_16x16x32_bf16 v[12:15], a[88:91], v[104:107], v[12:15]
    v_mfma_f32_16x16x32_bf16 v[12:15], a[92:95], v[48:51], v[12:15]
    buffer_store_dwordx4 v[52:55], v253, s[56:59], s98 offen offset:256 nt
    v_mfma_f32_16x16x32_bf16 v[20:23], a[92:95], v[16:19], 0
    v_mfma_f32_16x16x32_bf16 v[20:23], a[88:91], v[68:71], v[20:23]
    v_mfma_f32_16x16x32_bf16 v[20:23], a[84:87], v[100:103], v[20:23]
    v_mfma_f32_16x16x32_bf16 v[20:23], a[80:83], v[184:187], v[20:23]
G_20:
    s_cbranch_vccnz R_ret1
    v_mfma_f32_16x16x32_bf16 v[20:23], a[76:79], a[252:255], v[20:23]
    v_mfma_f32_16x16x32_bf16 v[20:23], a[72:75], a[236:239], v[20:23]
    v_mfma_f32_16x16x32_bf16 v[20:23], a[68:71], v[148:151], v[20:23]
    v_xor_b32 v254, 65536, v255
    v_cvt_pk_bf16_f32 v52, v12, v13
    v_mfma_f32_16x16x32_bf16 v[20:23], a[64:67], a[220:223], v[20:23]
    v_cvt_pk_bf16_f32 v53, v14, v15
    v_mov_b32_dpp v92, v52 row_ror:8 row_mask:0xf bank_mask:0xc
    v_mfma_f32_16x16x32_bf16 v[20:23], a[60:63], a[204:207], v[20:23]
    v_mov_b32_dpp v93, v53 row_ror:8 row_mask:0xf bank_mask:0xc
    v_mov_b32_dpp v52, v247 row_ror:8 row_mask:0xf bank_mask:0x3
    v_mfma_f32_16x16x32_bf16 v[20:23], a[56:59], v[72:75], v[20:23]
    v_mov_b32_dpp v53, v246 row_ror:8 row_mask:0xf bank_mask:0x3
    v_mfma_f32_16x16x32_bf16 v[20:23], a[48:51], v[120:123], v[20:23]
    v_mfma_f32_16x16x32_bf16 v[20:23], a[52:55], v[44:47], v[20:23]
    s_waitcnt vmcnt(21) lgkmcnt(0)
    s_barrier
    v_mfma_f32_16x16x32_bf16 v[12:15], a[4:7], v[76:79], 0
    ds_read_b64_tr_b16 a[48:49], v254 offset:0
    v_mfma_f32_16x16x32_bf16 v[12:15], a[0:3], v[116:119], v[12:15]
    ds_read_b64_tr_b16 a[50:51], v254 offset:2048
    v_mfma_f32_16x16x32_bf16 v[12:15], a[8:11], v[128:131], v[12:15]
    ds_read_b64_tr_b16 a[52:53], v254 offset:4096
    v_cvt_pk_bf16_f32 v112, v20, v21
    v_mfma_f32_16x16x32_bf16 v[12:15], a[12:15], a[192:195], v[12:15]
    ds_read_b64_tr_b16 a[54:55], v254 offset:6144
    v_cvt_pk_bf16_f32 v113, v22, v23
    v_mfma_f32_16x16x32_bf16 v[12:15], a[16:19], a[208:211], v[12:15]
    ds_read_b64_tr_b16 a[56:57], v254 offset:8192
    v_mov_b32_dpp v32, v112 row_ror:8 row_mask:0xf bank_mask:0xc
    v_mfma_f32_16x16x32_bf16 v[12:15], a[20:23], v[60:63], v[12:15]
    ds_read_b64_tr_b16 a[58:59], v254 offset:10240
    v_mov_b32_dpp v33, v113 row_ror:8 row_mask:0xf bank_mask:0xc
    v_mfma_f32_16x16x32_bf16 v[12:15], a[24:27], a[224:227], v[12:15]
    ds_read_b64_tr_b16 a[60:61], v254 offset:12288
    v_mov_b32_dpp v112, v245 row_ror:8 row_mask:0xf bank_mask:0x3
    v_mfma_f32_16x16x32_bf16 v[12:15], a[28:31], a[240:243], v[12:15]
    ds_read_b64_tr_b16 a[62:63], v254 offset:14336
    v_mov_b32_dpp v113, v244 row_ror:8 row_mask:0xf bank_mask:0x3
    v_mfma_f32_16x16x32_bf16 v[12:15], a[32:35], v[64:67], v[12:15]
    ds_read_b64_tr_b16 a[64:65], v254 offset:16384
    v_mfma_f32_16x16x32_bf16 v[12:15], a[36:39], v[220:223], v[12:15]
    ds_read_b64_tr_b16 a[66:67], v254 offset:18432
    v_mfma_f32_16x16x32_bf16 v[12:15], a[40:43], v[212:215], v[12:15]
    ds_read_b64_tr_b16 a[68:69], v254 offset:20480
    v_mfma_f32_16x16x32_bf16 v[12:15], a[44:47], v[96:99], v[12:15]
    ds_read_b64_tr_b16 a[70:71], v254 offset:22528
    v_mfma_f32_16x16x32_bf16 v[20:23], a[44:47], v[0:3], 0
    ds_read_b64_tr_b16 a[72:73], v254 offset:24576
    v_mfma_f32_16x16x32_bf16 v[20:23], a[40:43], v[40:43], v[20:23]
    ds_read_b64_tr_b16 a[74:75], v254 offset:26624
    v_mfma_f32_16x16x32_bf16 v[20:23], a[36:39], v[228:231], v[20:23]
    ds_read_b64_tr_b16 a[76:77], v254 offset:28672
    v_mfma_f32_16x16x32_bf16 v[20:23], a[32:35], v[168:171], v[20:23]
    ds_read_b64_tr_b16 a[78:79], v254 offset:30720
    v_cvt_pk_bf16_f32 v30, v12, v13
    v_mfma_f32_16x16x32_bf16 v[20:23], a[28:31], a[244:247], v[20:23]
    ds_read_b64_tr_b16 a[80:81], v254 offset:32768
    v_cvt_pk_bf16_f32 v31, v14, v15
    v_mfma_f32_16x16x32_bf16 v[20:23], a[24:27], a[228:231], v[20:23]
    ds_read_b64_tr_b16 a[82:83], v254 offset:34816
    v_mov_b32_dpp v86, v30 row_ror:8 row_mask:0xf bank_mask:0xc
    v_mfma_f32_16x16x32_bf16 v[20:23], a[20:23], v[124:127], v[20:23]
    ds_read_b64_tr_b16 a[84:85], v254 offset:36864
    v_mov_b32_dpp v87, v31 row_ror:8 row_mask:0xf bank_mask:0xc
    v_mfma_f32_16x16x32_bf16 v[20:23], a[16:19], a[212:215], v[20:23]
    ds_read_b64_tr_b16 a[86:87], v254 offset:38912
    v_mov_b32_dpp v30, v243 row_ror:8 row_mask:0xf bank_mask:0x3
    v_mfma_f32_16x16x32_bf16 v[20:23], a[12:15], a[196:199], v[20:23]
    ds_read_b64_tr_b16 a[88:89], v254 offset:40960
    v_mov_b32_dpp v31, v242 row_ror:8 row_mask:0xf bank_mask:0x3
    v_mfma_f32_16x16x32_bf16 v[20:23], a[8:11], v[8:11], v[20:23]
    ds_read_b64_tr_b16 a[90:91], v254 offset:43008
    v_mfma_f32_16x16x32_bf16 v[20:23], a[0:3], v[160:163], v[20:23]
    ds_read_b64_tr_b16 a[92:93], v254 offset:45056
    v_mfma_f32_16x16x32_bf16 v[20:23], a[4:7], v[108:111], v[20:23]
    ds_read_b64_tr_b16 a[94:95], v254 offset:47104
    v_mfma_f32_16x16x32_bf16 v[12:15], a[4:7], v[36:39], 0
    buffer_store_dwordx4 v[132:135], v253, s[56:59], s99 offen offset:256 nt
    v_mfma_f32_16x16x32_bf16 v[12:15], a[0:3], v[4:7], v[12:15]
    v_mfma_f32_16x16x32_bf16 v[12:15], a[8:11], v[24:27], v[12:15]
    v_mfma_f32_16x16x32_bf16 v[12:15], a[12:15], a[200:203], v[12:15]
    v_mfma_f32_16x16x32_bf16 v[12:15], a[16:19], a[216:219], v[12:15]
    v_mfma_f32_16x16x32_bf16 v[12:15], a[20:23], v[140:143], v[12:15]
    v_cvt_pk_bf16_f32 v90, v20, v21
    v_cvt_pk_bf16_f32 v91, v22, v23
    v_mfma_f32_16x16x32_bf16 v[12:15], a[24:27], a[232:235], v[12:15]
    v_mov_b32_dpp v82, v90 row_ror:8 row_mask:0xf bank_mask:0xc
    v_mov_b32_dpp v83, v91 row_ror:8 row_mask:0xf bank_mask:0xc
    v_mfma_f32_16x16x32_bf16 v[12:15], a[28:31], a[248:251], v[12:15]
    v_mov_b32_dpp v90, v248 row_ror:8 row_mask:0xf bank_mask:0x3
    v_mov_b32_dpp v91, v241 row_ror:8 row_mask:0xf bank_mask:0x3
    v_mfma_f32_16x16x32_bf16 v[12:15], a[32:35], v[180:183], v[12:15]
    v_mfma_f32_16x16x32_bf16 v[12:15], a[36:39], v[56:59], v[12:15]
    v_mfma_f32_16x16x32_bf16 v[12:15], a[40:43], v[104:107], v[12:15]
    v_mfma_f32_16x16x32_bf16 v[12:15], a[44:47], v[48:51], v[12:15]
    v_mfma_f32_16x16x32_bf16 v[20:23], a[44:47], v[16:19], 0
    v_mfma_f32_16x16x32_bf16 v[20:23], a[40:43], v[68:71], v[20:23]
    v_mfma_f32_16x16x32_bf16 v[20:23], a[36:39], v[100:103], v[20:23]
    v_mfma_f32_16x16x32_bf16 v[20:23], a[32:35], v[184:187], v[20:23]
    v_mfma_f32_16x16x32_bf16 v[20:23], a[28:31], a[252:255], v[20:23]
    v_mfma_f32_16x16x32_bf16 v[20:23], a[24:27], a[236:239], v[20:23]
    v_mfma_f32_16x16x32_bf16 v[20:23], a[20:23], v[148:151], v[20:23]
    v_xor_b32 v254, 65544, v255
    v_cvt_pk_bf16_f32 v54, v12, v13
    v_mfma_f32_16x16x32_bf16 v[20:23], a[16:19], a[220:223], v[20:23]
    v_cvt_pk_bf16_f32 v55, v14, v15
    v_mov_b32_dpp v94, v54 row_ror:8 row_mask:0xf bank_mask:0xc
    v_mfma_f32_16x16x32_bf16 v[20:23], a[12:15], a[204:207], v[20:23]
    v_mov_b32_dpp v95, v55 row_ror:8 row_mask:0xf bank_mask:0xc
    v_mov_b32_dpp v54, v239 row_ror:8 row_mask:0xf bank_mask:0x3
    v_mfma_f32_16x16x32_bf16 v[20:23], a[8:11], v[72:75], v[20:23]
    v_mov_b32_dpp v55, v238 row_ror:8 row_mask:0xf bank_mask:0x3
    v_mfma_f32_16x16x32_bf16 v[20:23], a[0:3], v[120:123], v[20:23]
    v_mfma_f32_16x16x32_bf16 v[20:23], a[4:7], v[44:47], v[20:23]
    s_waitcnt lgkmcnt(0)
    buffer_store_dwordx4 v[84:87], v253, s[56:59], s92 offen offset:384 nt
    v_mfma_f32_16x16x32_bf16 v[12:15], a[48:51], v[76:79], 0
    ds_read_b64_tr_b16 a[0:1], v254 offset:0
    v_mfma_f32_16x16x32_bf16 v[12:15], a[52:55], v[116:119], v[12:15]
    ds_read_b64_tr_b16 a[2:3], v254 offset:2048
    v_mfma_f32_16x16x32_bf16 v[12:15], a[56:59], v[128:131], v[12:15]
    ds_read_b64_tr_b16 a[4:5], v254 offset:4096
    v_cvt_pk_bf16_f32 v114, v20, v21
    v_mfma_f32_16x16x32_bf16 v[12:15], a[60:63], a[192:195], v[12:15]
    ds_read_b64_tr_b16 a[6:7], v254 offset:6144
    v_cvt_pk_bf16_f32 v115, v22, v23
    v_mfma_f32_16x16x32_bf16 v[12:15], a[64:67], a[208:211], v[12:15]
    ds_read_b64_tr_b16 a[8:9], v254 offset:8192
    v_mov_b32_dpp v34, v114 row_ror:8 row_mask:0xf bank_mask:0xc
    v_mfma_f32_16x16x32_bf16 v[12:15], a[68:71], v[60:63], v[12:15]
    ds_read_b64_tr_b16 a[10:11], v254 offset:10240
    v_mov_b32_dpp v35, v115 row_ror:8 row_mask:0xf bank_mask:0xc
    v_mfma_f32_16x16x32_bf16 v[12:15], a[72:75], a[224:227], v[12:15]
    ds_read_b64_tr_b16 a[12:13], v254 offset:12288
    v_mov_b32_dpp v114, v237 row_ror:8 row_mask:0xf bank_mask:0x3
    v_mfma_f32_16x16x32_bf16 v[12:15], a[76:79], a[240:243], v[12:15]
    ds_read_b64_tr_b16 a[14:15], v254 offset:14336
    v_mov_b32_dpp v115, v236 row_ror:8 row_mask:0xf bank_mask:0x3
    v_mfma_f32_16x16x32_bf16 v[12:15], a[80:83], v[64:67], v[12:15]
    ds_read_b64_tr_b16 a[16:17], v254 offset:16384
    v_mfma_f32_16x16x32_bf16 v[12:15], a[84:87], v[220:223], v[12:15]
    ds_read_b64_tr_b16 a[18:19], v254 offset:18432
    v_mfma_f32_16x16x32_bf16 v[12:15], a[88:91], v[212:215], v[12:15]
    ds_read_b64_tr_b16 a[20:21], v254 offset:20480
    v_mfma_f32_16x16x32_bf16 v[12:15], a[92:95], v[96:99], v[12:15]
    ds_read_b64_tr_b16 a[22:23], v254 offset:22528
    v_mfma_f32_16x16x32_bf16 v[20:23], a[92:95], v[0:3], 0
    ds_read_b64_tr_b16 a[24:25], v254 offset:24576
    v_mfma_f32_16x16x32_bf16 v[20:23], a[88:91], v[40:43], v[20:23]
    ds_read_b64_tr_b16 a[26:27], v254 offset:26624
    v_mfma_f32_16x16x32_bf16 v[20:23], a[84:87], v[228:231], v[20:23]
    ds_read_b64_tr_b16 a[28:29], v254 offset:28672
    v_mfma_f32_16x16x32_bf16 v[20:23], a[80:83], v[168:171], v[20:23]
    ds_read_b64_tr_b16 a[30:31], v254 offset:30720
    v_cvt_pk_bf16_f32 v84, v12, v13
    v_mfma_f32_16x16x32_bf16 v[20:23], a[76:79], a[244:247], v[20:23]
    ds_read_b64_tr_b16 a[32:33], v254 offset:32768
    v_cvt_pk_bf16_f32 v85, v14, v15
    v_mfma_f32_16x16x32_bf16 v[20:23], a[72:75], a[228:231], v[20:23]
    ds_read_b64_tr_b16 a[34:35], v254 offset:34816
    v_mov_b32 v252, v84
    v_mfma_f32_16x16x32_bf16 v[20:23], a[68:71], v[124:127], v[20:23]
    ds_read_b64_tr_b16 a[36:37], v254 offset:36864
    v_mov_b32 v251, v85
    v_mfma_f32_16x16x32_bf16 v[20:23], a[64:67], a[212:215], v[20:23]
    ds_read_b64_tr_b16 a[38:39], v254 offset:38912
    v_mfma_f32_16x16x32_bf16 v[20:23], a[60:63], a[196:199], v[20:23]
    ds_read_b64_tr_b16 a[40:41], v254 offset:40960
    v_mfma_f32_16x16x32_bf16 v[20:23], a[56:59], v[8:11], v[20:23]
    ds_read_b64_tr_b16 a[42:43], v254 offset:43008
    v_mfma_f32_16x16x32_bf16 v[20:23], a[52:55], v[160:163], v[20:23]
    ds_read_b64_tr_b16 a[44:45], v254 offset:45056
    v_mfma_f32_16x16x32_bf16 v[20:23], a[48:51], v[108:111], v[20:23]
    ds_read_b64_tr_b16 a[46:47], v254 offset:47104
    v_mfma_f32_16x16x32_bf16 v[12:15], a[48:51], v[36:39], 0
    buffer_store_dwordx4 v[28:31], v253, s[56:59], s93 offen offset:384 nt
    v_mfma_f32_16x16x32_bf16 v[12:15], a[52:55], v[4:7], v[12:15]
    v_mfma_f32_16x16x32_bf16 v[12:15], a[56:59], v[24:27], v[12:15]
    v_mfma_f32_16x16x32_bf16 v[12:15], a[60:63], a[200:203], v[12:15]
    v_mfma_f32_16x16x32_bf16 v[12:15], a[64:67], a[216:219], v[12:15]
    v_mfma_f32_16x16x32_bf16 v[12:15], a[68:71], v[140:143], v[12:15]
    v_cvt_pk_bf16_f32 v28, v20, v21
    v_cvt_pk_bf16_f32 v29, v22, v23
    v_mfma_f32_16x16x32_bf16 v[12:15], a[72:75], a[232:235], v[12:15]
    v_mov_b32 v254, v28
    v_mov_b32 v250, v29
    v_mfma_f32_16x16x32_bf16 v[12:15], a[76:79], a[248:251], v[12:15]
    v_mfma_f32_16x16x32_bf16 v[12:15], a[80:83], v[180:183], v[12:15]
    v_mfma_f32_16x16x32_bf16 v[12:15], a[84:87], v[56:59], v[12:15]
    v_mfma_f32_16x16x32_bf16 v[12:15], a[88:91], v[104:107], v[12:15]
    v_mfma_f32_16x16x32_bf16 v[12:15], a[92:95], v[48:51], v[12:15]
    v_mfma_f32_16x16x32_bf16 v[20:23], a[92:95], v[16:19], 0
    v_mfma_f32_16x16x32_bf16 v[20:23], a[88:91], v[68:71], v[20:23]
    v_mfma_f32_16x16x32_bf16 v[20:23], a[84:87], v[100:103], v[20:23]
    v_mfma_f32_16x16x32_bf16 v[20:23], a[80:83], v[184:187], v[20:23]
    v_mfma_f32_16x16x32_bf16 v[20:23], a[76:79], a[252:255], v[20:23]
    v_mfma_f32_16x16x32_bf16 v[20:23], a[72:75], a[236:239], v[20:23]
    v_mfma_f32_16x16x32_bf16 v[20:23], a[68:71], v[148:151], v[20:23]
    v_xor_b32 v249, 65600, v255
    v_cvt_pk_bf16_f32 v132, v12, v13
    v_mfma_f32_16x16x32_bf16 v[20:23], a[64:67], a[220:223], v[20:23]
    v_cvt_pk_bf16_f32 v133, v14, v15
    v_mov_b32 v248, v132
    v_mfma_f32_16x16x32_bf16 v[20:23], a[60:63], a[204:207], v[20:23]
    v_mov_b32 v247, v133
    v_mfma_f32_16x16x32_bf16 v[20:23], a[56:59], v[72:75], v[20:23]
    buffer_store_dwordx4 v[80:83], v253, s[56:59], s94 offen offset:384 nt
    v_mfma_f32_16x16x32_bf16 v[20:23], a[52:55], v[120:123], v[20:23]
    v_mfma_f32_16x16x32_bf16 v[20:23], a[48:51], v[44:47], v[20:23]
    s_waitcnt lgkmcnt(0)
    v_mfma_f32_16x16x32_bf16 v[12:15], a[0:3], v[76:79], 0
    ds_read_b64_tr_b16 a[52:53], v249 offset:0
    v_mfma_f32_16x16x32_bf16 v[12:15], a[4:7], v[116:119], v[12:15]
    ds_read_b64_tr_b16 a[54:55], v249 offset:2048
    v_mfma_f32_16x16x32_bf16 v[12:15], a[8:11], v[128:131], v[12:15]
    ds_read_b64_tr_b16 a[48:49], v249 offset:4096
    v_mfma_f32_16x16x32_bf16 v[12:15], a[12:15], a[192:195], v[12:15]
    ds_read_b64_tr_b16 a[50:51], v249 offset:6144
    v_cvt_pk_bf16_f32 v80, v20, v21
    v_mfma_f32_16x16x32_bf16 v[12:15], a[16:19], a[208:211], v[12:15]
    ds_read_b64_tr_b16 a[56:57], v249 offset:8192
    v_cvt_pk_bf16_f32 v81, v22, v23
    v_mfma_f32_16x16x32_bf16 v[12:15], a[20:23], v[60:63], v[12:15]
    ds_read_b64_tr_b16 a[58:59], v249 offset:10240
    v_mov_b32 v246, v80
    v_mfma_f32_16x16x32_bf16 v[12:15], a[24:27], a[224:227], v[12:15]
    ds_read_b64_tr_b16 a[60:61], v249 offset:12288
    v_mov_b32 v245, v81
    v_mfma_f32_16x16x32_bf16 v[12:15], a[28:31], a[240:243], v[12:15]
    ds_read_b64_tr_b16 a[62:63], v249 offset:14336
    v_mfma_f32_16x16x32_bf16 v[12:15], a[32:35], v[64:67], v[12:15]
    ds_read_b64_tr_b16 a[64:65], v249 offset:16384
    v_mfma_f32_16x16x32_bf16 v[12:15], a[36:39], v[220:223], v[12:15]
    ds_read_b64_tr_b16 a[66:67], v249 offset:18432
    v_mfma_f32_16x16x32_bf16 v[12:15], a[40:43], v[212:215], v[12:15]
    ds_read_b64_tr_b16 a[68:69], v249 offset:20480
    v_mfma_f32_16x16x32_bf16 v[12:15], a[44:47], v[96:99], v[12:15]
    ds_read_b64_tr_b16 a[70:71], v249 offset:22528
    v_mfma_f32_16x16x32_bf16 v[20:23], a[44:47], v[0:3], 0
    ds_read_b64_tr_b16 a[72:73], v249 offset:24576
    v_mfma_f32_16x16x32_bf16 v[20:23], a[40:43], v[40:43], v[20:23]
    ds_read_b64_tr_b16 a[74:75], v249 offset:26624
    v_mfma_f32_16x16x32_bf16 v[20:23], a[36:39], v[228:231], v[20:23]
    ds_read_b64_tr_b16 a[76:77], v249 offset:28672
    v_mfma_f32_16x16x32_bf16 v[20:23], a[32:35], v[168:171], v[20:23]
    ds_read_b64_tr_b16 a[78:79], v249 offset:30720
    v_cvt_pk_bf16_f32 v86, v12, v13
    v_mfma_f32_16x16x32_bf16 v[20:23], a[28:31], a[244:247], v[20:23]
    ds_read_b64_tr_b16 a[80:81], v249 offset:32768
    v_cvt_pk_bf16_f32 v87, v14, v15
    v_mfma_f32_16x16x32_bf16 v[20:23], a[24:27], a[228:231], v[20:23]
    ds_read_b64_tr_b16 a[82:83], v249 offset:34816
    v_mov_b32 v244, v86
    v_mfma_f32_16x16x32_bf16 v[20:23], a[20:23], v[124:127], v[20:23]
    ds_read_b64_tr_b16 a[84:85], v249 offset:36864
    v_mov_b32 v243, v87
    v_mfma_f32_16x16x32_bf16 v[20:23], a[16:19], a[212:215], v[20:23]
    ds_read_b64_tr_b16 a[86:87], v249 offset:38912
    v_mfma_f32_16x16x32_bf16 v[20:23], a[12:15], a[196:199], v[20:23]
    ds_read_b64_tr_b16 a[88:89], v249 offset:40960
    v_mfma_f32_16x16x32_bf16 v[20:23], a[8:11], v[8:11], v[20:23]
    ds_read_b64_tr_b16 a[90:91], v249 offset:43008
    v_mfma_f32_16x16x32_bf16 v[20:23], a[4:7], v[160:163], v[20:23]
    ds_read_b64_tr_b16 a[92:93], v249 offset:45056
    v_mfma_f32_16x16x32_bf16 v[20:23], a[0:3], v[108:111], v[20:23]
    ds_read_b64_tr_b16 a[94:95], v249 offset:47104
    v_mfma_f32_16x16x32_bf16 v[12:15], a[0:3], v[36:39], 0
    buffer_store_dwordx4 v[88:91], v253, s[56:59], s95 offen offset:384 nt
    v_mfma_f32_16x16x32_bf16 v[12:15], a[4:7], v[4:7], v[12:15]
    v_mfma_f32_16x16x32_bf16 v[12:15], a[8:11], v[24:27], v[12:15]
    v_mfma_f32_16x16x32_bf16 v[12:15], a[12:15], a[200:203], v[12:15]
    v_mfma_f32_16x16x32_bf16 v[12:15], a[16:19], a[216:219], v[12:15]
    v_mfma_f32_16x16x32_bf16 v[12:15], a[20:23], v[140:143], v[12:15]
    v_cvt_pk_bf16_f32 v30, v20, v21
    v_cvt_pk_bf16_f32 v31, v22, v23
    v_mfma_f32_16x16x32_bf16 v[12:15], a[24:27], a[232:235], v[12:15]
    v_mov_b32 v249, v30
    v_mov_b32 v242, v31
    v_mfma_f32_16x16x32_bf16 v[12:15], a[28:31], a[248:251], v[12:15]
    v_mfma_f32_16x16x32_bf16 v[12:15], a[32:35], v[180:183], v[12:15]
    v_mfma_f32_16x16x32_bf16 v[12:15], a[36:39], v[56:59], v[12:15]
    v_mfma_f32_16x16x32_bf16 v[12:15], a[40:43], v[104:107], v[12:15]
    v_mfma_f32_16x16x32_bf16 v[12:15], a[44:47], v[48:51], v[12:15]
    v_mfma_f32_16x16x32_bf16 v[20:23], a[44:47], v[16:19], 0
    v_mfma_f32_16x16x32_bf16 v[20:23], a[40:43], v[68:71], v[20:23]
    v_mfma_f32_16x16x32_bf16 v[20:23], a[36:39], v[100:103], v[20:23]
    v_mfma_f32_16x16x32_bf16 v[20:23], a[32:35], v[184:187], v[20:23]
    buffer_store_dwordx4 v[92:95], v253, s[56:59], s96 offen offset:384 nt
    v_mfma_f32_16x16x32_bf16 v[20:23], a[28:31], a[252:255], v[20:23]
    v_mfma_f32_16x16x32_bf16 v[20:23], a[24:27], a[236:239], v[20:23]
    v_mfma_f32_16x16x32_bf16 v[20:23], a[20:23], v[148:151], v[20:23]
    v_xor_b32 v241, 65608, v255
    v_cvt_pk_bf16_f32 v134, v12, v13
    v_mfma_f32_16x16x32_bf16 v[20:23], a[16:19], a[220:223], v[20:23]
    v_cvt_pk_bf16_f32 v135, v14, v15
    v_mov_b32 v240, v134
    v_mfma_f32_16x16x32_bf16 v[20:23], a[12:15], a[204:207], v[20:23]
    v_mov_b32 v239, v135
    v_mfma_f32_16x16x32_bf16 v[20:23], a[8:11], v[72:75], v[20:23]
    v_mfma_f32_16x16x32_bf16 v[20:23], a[4:7], v[120:123], v[20:23]
    v_mfma_f32_16x16x32_bf16 v[20:23], a[0:3], v[44:47], v[20:23]
    s_waitcnt lgkmcnt(0)
    v_mfma_f32_16x16x32_bf16 v[12:15], a[52:55], v[76:79], 0
    ds_read_b64_tr_b16 a[4:5], v241 offset:0
    v_mfma_f32_16x16x32_bf16 v[12:15], a[48:51], v[116:119], v[12:15]
    ds_read_b64_tr_b16 a[6:7], v241 offset:2048
    v_mfma_f32_16x16x32_bf16 v[12:15], a[56:59], v[128:131], v[12:15]
    ds_read_b64_tr_b16 a[0:1], v241 offset:4096
    v_mfma_f32_16x16x32_bf16 v[12:15], a[60:63], a[192:195], v[12:15]
    ds_read_b64_tr_b16 a[2:3], v241 offset:6144
    v_cvt_pk_bf16_f32 v82, v20, v21
    v_mfma_f32_16x16x32_bf16 v[12:15], a[64:67], a[208:211], v[12:15]
    ds_read_b64_tr_b16 a[8:9], v241 offset:8192
    v_cvt_pk_bf16_f32 v83, v22, v23
    v_mfma_f32_16x16x32_bf16 v[12:15], a[68:71], v[60:63], v[12:15]
    ds_read_b64_tr_b16 a[10:11], v241 offset:10240
    v_mov_b32 v238, v82
    v_mfma_f32_16x16x32_bf16 v[12:15], a[72:75], a[224:227], v[12:15]
    ds_read_b64_tr_b16 a[12:13], v241 offset:12288
    v_mov_b32 v237, v83
    v_mfma_f32_16x16x32_bf16 v[12:15], a[76:79], a[240:243], v[12:15]
    ds_read_b64_tr_b16 a[14:15], v241 offset:14336
    v_mfma_f32_16x16x32_bf16 v[12:15], a[80:83], v[64:67], v[12:15]
    ds_read_b64_tr_b16 a[16:17], v241 offset:16384
    v_mfma_f32_16x16x32_bf16 v[12:15], a[84:87], v[220:223], v[12:15]
    ds_read_b64_tr_b16 a[18:19], v241 offset:18432
    v_mfma_f32_16x16x32_bf16 v[12:15], a[88:91], v[212:215], v[12:15]
    ds_read_b64_tr_b16 a[20:21], v241 offset:20480
    v_mfma_f32_16x16x32_bf16 v[12:15], a[92:95], v[96:99], v[12:15]
    ds_read_b64_tr_b16 a[22:23], v241 offset:22528
    v_mfma_f32_16x16x32_bf16 v[20:23], a[92:95], v[0:3], 0
    ds_read_b64_tr_b16 a[24:25], v241 offset:24576
    v_mfma_f32_16x16x32_bf16 v[20:23], a[88:91], v[40:43], v[20:23]
    ds_read_b64_tr_b16 a[26:27], v241 offset:26624
    v_mfma_f32_16x16x32_bf16 v[20:23], a[84:87], v[228:231], v[20:23]
    ds_read_b64_tr_b16 a[28:29], v241 offset:28672
    v_mfma_f32_16x16x32_bf16 v[20:23], a[80:83], v[168:171], v[20:23]
    ds_read_b64_tr_b16 a[30:31], v241 offset:30720
    v_cvt_pk_bf16_f32 v88, v12, v13
    v_mfma_f32_16x16x32_bf16 v[20:23], a[76:79], a[244:247], v[20:23]
    ds_read_b64_tr_b16 a[32:33], v241 offset:32768
    v_cvt_pk_bf16_f32 v89, v14, v15
    v_mfma_f32_16x16x32_bf16 v[20:23], a[72:75], a[228:231], v[20:23]
    ds_read_b64_tr_b16 a[34:35], v241 offset:34816
    v_mov_b32_dpp v84, v88 row_ror:8 row_mask:0xf bank_mask:0xc
    v_mfma_f32_16x16x32_bf16 v[20:23], a[68:71], v[124:127], v[20:23]
    ds_read_b64_tr_b16 a[36:37], v241 offset:36864
    v_mov_b32_dpp v85, v89 row_ror:8 row_mask:0xf bank_mask:0xc
    v_mfma_f32_16x16x32_bf16 v[20:23], a[64:67], a[212:215], v[20:23]
    ds_read_b64_tr_b16 a[38:39], v241 offset:38912
    v_mov_b32_dpp v88, v252 row_ror:8 row_mask:0xf bank_mask:0x3
    v_mfma_f32_16x16x32_bf16 v[20:23], a[60:63], a[196:199], v[20:23]
    ds_read_b64_tr_b16 a[40:41], v241 offset:40960
    v_mov_b32_dpp v89, v251 row_ror:8 row_mask:0xf bank_mask:0x3
    v_mfma_f32_16x16x32_bf16 v[20:23], a[56:59], v[8:11], v[20:23]
    ds_read_b64_tr_b16 a[42:43], v241 offset:43008
    v_mfma_f32_16x16x32_bf16 v[20:23], a[48:51], v[160:163], v[20:23]
    ds_read_b64_tr_b16 a[44:45], v241 offset:45056
    v_mfma_f32_16x16x32_bf16 v[20:23], a[52:55], v[108:111], v[20:23]
    ds_read_b64_tr_b16 a[46:47], v241 offset:47104
    v_mfma_f32_16x16x32_bf16 v[12:15], a[52:55], v[36:39], 0
    buffer_store_dwordx4 v[52:55], v253, s[56:59], s97 offen offset:384 nt
    v_mfma_f32_16x16x32_bf16 v[12:15], a[48:51], v[4:7], v[12:15]
    v_mfma_f32_16x16x32_bf16 v[12:15], a[56:59], v[24:27], v[12:15]
    v_mfma_f32_16x16x32_bf16 v[12:15], a[60:63], a[200:203], v[12:15]
    v_mfma_f32_16x16x32_bf16 v[12:15], a[64:67], a[216:219], v[12:15]
    v_mfma_f32_16x16x32_bf16 v[12:15], a[68:71], v[140:143], v[12:15]
    v_cvt_pk_bf16_f32 v52, v20, v21
    v_cvt_pk_bf16_f32 v53, v22, v23
    v_mfma_f32_16x16x32_bf16 v[12:15], a[72:75], a[232:235], v[12:15]
    v_mov_b32_dpp v28, v52 row_ror:8 row_mask:0xf bank_mask:0xc
    v_mov_b32_dpp v29, v53 row_ror:8 row_mask:0xf bank_mask:0xc
    v_mfma_f32_16x16x32_bf16 v[12:15], a[76:79], a[248:251], v[12:15]
    v_mov_b32_dpp v52, v254 row_ror:8 row_mask:0xf bank_mask:0x3
    v_mov_b32_dpp v53, v250 row_ror:8 row_mask:0xf bank_mask:0x3
    v_mfma_f32_16x16x32_bf16 v[12:15], a[80:83], v[180:183], v[12:15]
    v_mfma_f32_16x16x32_bf16 v[12:15], a[84:87], v[56:59], v[12:15]
    v_mfma_f32_16x16x32_bf16 v[12:15], a[88:91], v[104:107], v[12:15]
    v_mfma_f32_16x16x32_bf16 v[12:15], a[92:95], v[48:51], v[12:15]
    buffer_store_dwordx4 v[32:35], v253, s[56:59], s98 offen offset:384 nt
    v_mfma_f32_16x16x32_bf16 v[20:23], a[92:95], v[16:19], 0
    v_mfma_f32_16x16x32_bf16 v[20:23], a[88:91], v[68:71], v[20:23]
    v_mfma_f32_16x16x32_bf16 v[20:23], a[84:87], v[100:103], v[20:23]
    v_mfma_f32_16x16x32_bf16 v[20:23], a[80:83], v[184:187], v[20:23]
    v_mfma_f32_16x16x32_bf16 v[20:23], a[76:79], a[252:255], v[20:23]
    v_mfma_f32_16x16x32_bf16 v[20:23], a[72:75], a[236:239], v[20:23]
    v_mfma_f32_16x16x32_bf16 v[20:23], a[68:71], v[148:151], v[20:23]
    v_xor_b32 v254, 114688, v255
    v_cvt_pk_bf16_f32 v32, v12, v13
    v_mfma_f32_16x16x32_bf16 v[20:23], a[64:67], a[220:223], v[20:23]
    v_cvt_pk_bf16_f32 v33, v14, v15
    v_mov_b32_dpp v132, v32 row_ror:8 row_mask:0xf bank_mask:0xc
    v_mfma_f32_16x16x32_bf16 v[20:23], a[60:63], a[204:207], v[20:23]
    v_mov_b32_dpp v133, v33 row_ror:8 row_mask:0xf bank_mask:0xc
    v_mov_b32_dpp v32, v248 row_ror:8 row_mask:0xf bank_mask:0x3
    v_mfma_f32_16x16x32_bf16 v[20:23], a[56:59], v[72:75], v[20:23]
    v_mov_b32_dpp v33, v247 row_ror:8 row_mask:0xf bank_mask:0x3
    v_mfma_f32_16x16x32_bf16 v[20:23], a[48:51], v[120:123], v[20:23]
    v_mfma_f32_16x16x32_bf16 v[20:23], a[52:55], v[44:47], v[20:23]
    s_waitcnt vmcnt(9) lgkmcnt(0)
    s_barrier
    v_mfma_f32_16x16x32_bf16 v[12:15], a[4:7], v[76:79], 0
    ds_read_b64_tr_b16 a[48:49], v254 offset:0
    v_mfma_f32_16x16x32_bf16 v[12:15], a[0:3], v[116:119], v[12:15]
    ds_read_b64_tr_b16 a[50:51], v254 offset:2048
    v_mfma_f32_16x16x32_bf16 v[12:15], a[8:11], v[128:131], v[12:15]
    ds_read_b64_tr_b16 a[52:53], v254 offset:4096
    v_cvt_pk_bf16_f32 v92, v20, v21
    v_mfma_f32_16x16x32_bf16 v[12:15], a[12:15], a[192:195], v[12:15]
    ds_read_b64_tr_b16 a[54:55], v254 offset:6144
    v_cvt_pk_bf16_f32 v93, v22, v23
    v_mfma_f32_16x16x32_bf16 v[12:15], a[16:19], a[208:211], v[12:15]
    ds_read_b64_tr_b16 a[56:57], v254 offset:8192
    v_mov_b32_dpp v80, v92 row_ror:8 row_mask:0xf bank_mask:0xc
    v_mfma_f32_16x16x32_bf16 v[12:15], a[20:23], v[60:63], v[12:15]
    ds_read_b64_tr_b16 a[58:59], v254 offset:10240
    v_mov_b32_dpp v81, v93 row_ror:8 row_mask:0xf bank_mask:0xc
    v_mfma_f32_16x16x32_bf16 v[12:15], a[24:27], a[224:227], v[12:15]
    ds_read_b64_tr_b16 a[60:61], v254 offset:12288
    v_mov_b32_dpp v92, v246 row_ror:8 row_mask:0xf bank_mask:0x3
    v_mfma_f32_16x16x32_bf16 v[12:15], a[28:31], a[240:243], v[12:15]
    ds_read_b64_tr_b16 a[62:63], v254 offset:14336
    v_mov_b32_dpp v93, v245 row_ror:8 row_mask:0xf bank_mask:0x3
    v_mfma_f32_16x16x32_bf16 v[12:15], a[32:35], v[64:67], v[12:15]
    ds_read_b64_tr_b16 a[64:65], v254 offset:16384
    v_mfma_f32_16x16x32_bf16 v[12:15], a[36:39], v[220:223], v[12:15]
    ds_read_b64_tr_b16 a[66:67], v254 offset:18432
    v_mfma_f32_16x16x32_bf16 v[12:15], a[40:43], v[212:215], v[12:15]
    ds_read_b64_tr_b16 a[68:69], v254 offset:20480
    v_mfma_f32_16x16x32_bf16 v[12:15], a[44:47], v[96:99], v[12:15]
    ds_read_b64_tr_b16 a[70:71], v254 offset:22528
    v_mfma_f32_16x16x32_bf16 v[20:23], a[44:47], v[0:3], 0
    ds_read_b64_tr_b16 a[72:73], v254 offset:24576
    v_mfma_f32_16x16x32_bf16 v[20:23], a[40:43], v[40:43], v[20:23]
    ds_read_b64_tr_b16 a[74:75], v254 offset:26624
    v_mfma_f32_16x16x32_bf16 v[20:23], a[36:39], v[228:231], v[20:23]
    ds_read_b64_tr_b16 a[76:77], v254 offset:28672
    v_mfma_f32_16x16x32_bf16 v[20:23], a[32:35], v[168:171], v[20:23]
    ds_read_b64_tr_b16 a[78:79], v254 offset:30720
    v_cvt_pk_bf16_f32 v90, v12, v13
    v_mfma_f32_16x16x32_bf16 v[20:23], a[28:31], a[244:247], v[20:23]
    ds_read_b64_tr_b16 a[80:81], v254 offset:32768
    v_cvt_pk_bf16_f32 v91, v14, v15
    v_mfma_f32_16x16x32_bf16 v[20:23], a[24:27], a[228:231], v[20:23]
    ds_read_b64_tr_b16 a[82:83], v254 offset:34816
    v_mov_b32_dpp v86, v90 row_ror:8 row_mask:0xf bank_mask:0xc
    v_mfma_f32_16x16x32_bf16 v[20:23], a[20:23], v[124:127], v[20:23]
    ds_read_b64_tr_b16 a[84:85], v254 offset:36864
    v_mov_b32_dpp v87, v91 row_ror:8 row_mask:0xf bank_mask:0xc
    v_mfma_f32_16x16x32_bf16 v[20:23], a[16:19], a[212:215], v[20:23]
    ds_read_b64_tr_b16 a[86:87], v254 offset:38912
    v_mov_b32_dpp v90, v244 row_ror:8 row_mask:0xf bank_mask:0x3
    v_mfma_f32_16x16x32_bf16 v[20:23], a[12:15], a[196:199], v[20:23]
    ds_read_b64_tr_b16 a[88:89], v254 offset:40960
    v_mov_b32_dpp v91, v243 row_ror:8 row_mask:0xf bank_mask:0x3
    v_mfma_f32_16x16x32_bf16 v[20:23], a[8:11], v[8:11], v[20:23]
    ds_read_b64_tr_b16 a[90:91], v254 offset:43008
    v_mfma_f32_16x16x32_bf16 v[20:23], a[0:3], v[160:163], v[20:23]
    ds_read_b64_tr_b16 a[92:93], v254 offset:45056
    v_mfma_f32_16x16x32_bf16 v[20:23], a[4:7], v[108:111], v[20:23]
    ds_read_b64_tr_b16 a[94:95], v254 offset:47104
    v_mfma_f32_16x16x32_bf16 v[12:15], a[4:7], v[36:39], 0
    buffer_store_dwordx4 v[112:115], v253, s[56:59], s99 offen offset:384 nt
    v_mfma_f32_16x16x32_bf16 v[12:15], a[0:3], v[4:7], v[12:15]
    v_mfma_f32_16x16x32_bf16 v[12:15], a[8:11], v[24:27], v[12:15]
    v_mfma_f32_16x16x32_bf16 v[12:15], a[12:15], a[200:203], v[12:15]
    v_mfma_f32_16x16x32_bf16 v[12:15], a[16:19], a[216:219], v[12:15]
    v_mfma_f32_16x16x32_bf16 v[12:15], a[20:23], v[140:143], v[12:15]
    v_cvt_pk_bf16_f32 v54, v20, v21
    v_cvt_pk_bf16_f32 v55, v22, v23
    v_mfma_f32_16x16x32_bf16 v[12:15], a[24:27], a[232:235], v[12:15]
    v_mov_b32_dpp v30, v54 row_ror:8 row_mask:0xf bank_mask:0xc
    v_mov_b32_dpp v31, v55 row_ror:8 row_mask:0xf bank_mask:0xc
    v_mfma_f32_16x16x32_bf16 v[12:15], a[28:31], a[248:251], v[12:15]
    v_mov_b32_dpp v54, v249 row_ror:8 row_mask:0xf bank_mask:0x3
    v_mov_b32_dpp v55, v242 row_ror:8 row_mask:0xf bank_mask:0x3
    v_mfma_f32_16x16x32_bf16 v[12:15], a[32:35], v[180:183], v[12:15]
    v_mfma_f32_16x16x32_bf16 v[12:15], a[36:39], v[56:59], v[12:15]
    v_mfma_f32_16x16x32_bf16 v[12:15], a[40:43], v[104:107], v[12:15]
    v_mfma_f32_16x16x32_bf16 v[12:15], a[44:47], v[48:51], v[12:15]
    v_mbcnt_lo_u32_b32 v254, -1, 0
    v_mbcnt_hi_u32_b32 v252, -1, v254
    v_mfma_f32_16x16x32_bf16 v[20:23], a[44:47], v[16:19], 0
    v_and_b32 v251, 7, v252
    v_bfe_u32 v250, v252, 3, 1
    v_mfma_f32_16x16x32_bf16 v[20:23], a[40:43], v[68:71], v[20:23]
    v_add_u32 v254, s34, v251
    v_add_u32 v249, s33, v250
    v_mfma_f32_16x16x32_bf16 v[20:23], a[36:39], v[100:103], v[20:23]
    v_cvt_pk_bf16_f32 v34, v12, v13
    v_cvt_pk_bf16_f32 v35, v14, v15
    v_mfma_f32_16x16x32_bf16 v[20:23], a[32:35], v[184:187], v[20:23]
    v_and_b32 v251, 255, v254
    v_add_u32 v250, 0, v249
    v_mfma_f32_16x16x32_bf16 v[20:23], a[28:31], a[252:255], v[20:23]
    v_add_u32 v248, 2, v249
    v_add_u32 v254, 4, v249
    v_mfma_f32_16x16x32_bf16 v[20:23], a[24:27], a[236:239], v[20:23]
    v_add_u32 v247, 6, v249
    v_mul_u32_u24 v246, 768, v251
    v_mfma_f32_16x16x32_bf16 v[20:23], a[20:23], v[148:151], v[20:23]
    v_xor_b32 v245, 114696, v255
    v_lshrrev_b32 v249, 4, v252
    v_mfma_f32_16x16x32_bf16 v[20:23], a[16:19], a[220:223], v[20:23]
    v_and_b32 v251, 255, v250
    v_and_b32 v244, 255, v248
    v_mfma_f32_16x16x32_bf16 v[20:23], a[12:15], a[204:207], v[20:23]
    v_and_b32 v252, 255, v254
    v_and_b32 v250, 255, v247
    v_mfma_f32_16x16x32_bf16 v[20:23], a[8:11], v[72:75], v[20:23]
    v_mov_b32_dpp v134, v34 row_ror:8 row_mask:0xf bank_mask:0xc
    v_mov_b32_dpp v135, v35 row_ror:8 row_mask:0xf bank_mask:0xc
    v_mfma_f32_16x16x32_bf16 v[20:23], a[0:3], v[120:123], v[20:23]
    v_lshl_add_u32 v254, v249, 4, v246
    v_mul_u32_u24 v248, 768, v251
    v_mfma_f32_16x16x32_bf16 v[20:23], a[4:7], v[44:47], v[20:23]
    s_waitcnt lgkmcnt(0)
    v_mul_u32_u24 v249, 768, v244
    v_mul_u32_u24 v251, 768, v252
    v_mfma_f32_16x16x32_bf16 v[12:15], a[48:51], v[76:79], 0
    ds_read_b64_tr_b16 a[0:1], v245 offset:0
    v_mul_u32_u24 v247, 768, v250
    v_mfma_f32_16x16x32_bf16 v[12:15], a[52:55], v[116:119], v[12:15]
    ds_read_b64_tr_b16 a[2:3], v245 offset:2048
    v_cvt_pk_bf16_f32 v94, v20, v21
    v_mfma_f32_16x16x32_bf16 v[12:15], a[56:59], v[128:131], v[12:15]
    ds_read_b64_tr_b16 a[4:5], v245 offset:4096
G_21:
    s_cbranch_vccnz R_ret1
    v_cvt_pk_bf16_f32 v95, v22, v23
    v_mfma_f32_16x16x32_bf16 v[12:15], a[60:63], a[192:195], v[12:15]
    ds_read_b64_tr_b16 a[6:7], v245 offset:6144
    v_mov_b32_dpp v82, v94 row_ror:8 row_mask:0xf bank_mask:0xc
    v_mfma_f32_16x16x32_bf16 v[12:15], a[64:67], a[208:211], v[12:15]
    ds_read_b64_tr_b16 a[8:9], v245 offset:8192
    v_mov_b32_dpp v83, v95 row_ror:8 row_mask:0xf bank_mask:0xc
    v_mfma_f32_16x16x32_bf16 v[12:15], a[68:71], v[60:63], v[12:15]
    ds_read_b64_tr_b16 a[10:11], v245 offset:10240
    v_mov_b32_dpp v34, v240 row_ror:8 row_mask:0xf bank_mask:0x3
    v_mfma_f32_16x16x32_bf16 v[12:15], a[72:75], a[224:227], v[12:15]
    ds_read_b64_tr_b16 a[12:13], v245 offset:12288
    v_mov_b32_dpp v35, v239 row_ror:8 row_mask:0xf bank_mask:0x3
    v_mfma_f32_16x16x32_bf16 v[12:15], a[76:79], a[240:243], v[12:15]
    ds_read_b64_tr_b16 a[14:15], v245 offset:14336
    v_mov_b32_dpp v94, v238 row_ror:8 row_mask:0xf bank_mask:0x3
    v_mfma_f32_16x16x32_bf16 v[12:15], a[80:83], v[64:67], v[12:15]
    ds_read_b64_tr_b16 a[16:17], v245 offset:16384
    v_mov_b32_dpp v95, v237 row_ror:8 row_mask:0xf bank_mask:0x3
    v_mfma_f32_16x16x32_bf16 v[12:15], a[84:87], v[220:223], v[12:15]
    ds_read_b64_tr_b16 a[18:19], v245 offset:18432
    v_lshl_add_u32 v252, v248, 8, v254
    v_mfma_f32_16x16x32_bf16 v[12:15], a[88:91], v[212:215], v[12:15]
    ds_read_b64_tr_b16 a[20:21], v245 offset:20480
    v_lshl_add_u32 v250, v249, 8, v254
    v_mfma_f32_16x16x32_bf16 v[12:15], a[92:95], v[96:99], v[12:15]
    ds_read_b64_tr_b16 a[22:23], v245 offset:22528
    v_lshl_add_u32 v248, v251, 8, v254
    v_mfma_f32_16x16x32_bf16 v[20:23], a[92:95], v[0:3], 0
    ds_read_b64_tr_b16 a[24:25], v245 offset:24576
    v_lshl_add_u32 v249, v247, 8, v254
    v_mfma_f32_16x16x32_bf16 v[20:23], a[88:91], v[40:43], v[20:23]
    ds_read_b64_tr_b16 a[26:27], v245 offset:26624
    v_mfma_f32_16x16x32_bf16 v[20:23], a[84:87], v[228:231], v[20:23]
    ds_read_b64_tr_b16 a[28:29], v245 offset:28672
    v_cvt_pk_bf16_f32 v112, v12, v13
    v_mfma_f32_16x16x32_bf16 v[20:23], a[80:83], v[168:171], v[20:23]
    ds_read_b64_tr_b16 a[30:31], v245 offset:30720
    v_cvt_pk_bf16_f32 v113, v14, v15
    v_mfma_f32_16x16x32_bf16 v[20:23], a[76:79], a[244:247], v[20:23]
    ds_read_b64_tr_b16 a[32:33], v245 offset:32768
    v_mfma_f32_16x16x32_bf16 v[20:23], a[72:75], a[228:231], v[20:23]
    ds_read_b64_tr_b16 a[34:35], v245 offset:34816
    v_mfma_f32_16x16x32_bf16 v[20:23], a[68:71], v[124:127], v[20:23]
    ds_read_b64_tr_b16 a[36:37], v245 offset:36864
    v_mfma_f32_16x16x32_bf16 v[20:23], a[64:67], a[212:215], v[20:23]
    ds_read_b64_tr_b16 a[38:39], v245 offset:38912
    v_mfma_f32_16x16x32_bf16 v[20:23], a[60:63], a[196:199], v[20:23]
    ds_read_b64_tr_b16 a[40:41], v245 offset:40960
    v_mfma_f32_16x16x32_bf16 v[20:23], a[56:59], v[8:11], v[20:23]
    ds_read_b64_tr_b16 a[42:43], v245 offset:43008
    v_mfma_f32_16x16x32_bf16 v[20:23], a[52:55], v[160:163], v[20:23]
    ds_read_b64_tr_b16 a[44:45], v245 offset:45056
    v_mfma_f32_16x16x32_bf16 v[20:23], a[48:51], v[108:111], v[20:23]
    ds_read_b64_tr_b16 a[46:47], v245 offset:47104
    v_mfma_f32_16x16x32_bf16 v[12:15], a[48:51], v[36:39], 0
    buffer_store_dwordx4 v[84:87], v253, s[56:59], s92 offen offset:512 nt
    v_mfma_f32_16x16x32_bf16 v[12:15], a[52:55], v[4:7], v[12:15]
    buffer_store_dwordx4 v[88:91], v253, s[56:59], s93 offen offset:512 nt
    v_mfma_f32_16x16x32_bf16 v[12:15], a[56:59], v[24:27], v[12:15]
    v_mfma_f32_16x16x32_bf16 v[12:15], a[60:63], a[200:203], v[12:15]
    v_mfma_f32_16x16x32_bf16 v[12:15], a[64:67], a[216:219], v[12:15]
    v_cvt_pk_bf16_f32 v84, v20, v21
    v_cvt_pk_bf16_f32 v85, v22, v23
    v_mfma_f32_16x16x32_bf16 v[12:15], a[68:71], v[140:143], v[12:15]
    v_mfma_f32_16x16x32_bf16 v[12:15], a[72:75], a[232:235], v[12:15]
    v_mfma_f32_16x16x32_bf16 v[12:15], a[76:79], a[248:251], v[12:15]
    v_mfma_f32_16x16x32_bf16 v[12:15], a[80:83], v[180:183], v[12:15]
    v_mfma_f32_16x16x32_bf16 v[12:15], a[84:87], v[56:59], v[12:15]
    v_mfma_f32_16x16x32_bf16 v[12:15], a[88:91], v[104:107], v[12:15]
    v_mfma_f32_16x16x32_bf16 v[12:15], a[92:95], v[48:51], v[12:15]
    v_mfma_f32_16x16x32_bf16 v[20:23], a[92:95], v[16:19], 0
    v_mfma_f32_16x16x32_bf16 v[20:23], a[88:91], v[68:71], v[20:23]
    v_mfma_f32_16x16x32_bf16 v[20:23], a[84:87], v[100:103], v[20:23]
    v_mfma_f32_16x16x32_bf16 v[20:23], a[80:83], v[184:187], v[20:23]
    v_mfma_f32_16x16x32_bf16 v[20:23], a[76:79], a[252:255], v[20:23]
    v_mfma_f32_16x16x32_bf16 v[20:23], a[72:75], a[236:239], v[20:23]
    v_mfma_f32_16x16x32_bf16 v[20:23], a[68:71], v[148:151], v[20:23]
    v_xor_b32 v254, 114752, v255
    v_cvt_pk_bf16_f32 v88, v12, v13
    v_mfma_f32_16x16x32_bf16 v[20:23], a[64:67], a[220:223], v[20:23]
    v_cvt_pk_bf16_f32 v89, v14, v15
    v_mfma_f32_16x16x32_bf16 v[20:23], a[60:63], a[204:207], v[20:23]
    buffer_store_dwordx4 v[28:31], v253, s[56:59], s94 offen offset:512 nt
    v_mfma_f32_16x16x32_bf16 v[20:23], a[56:59], v[72:75], v[20:23]
    v_mfma_f32_16x16x32_bf16 v[20:23], a[52:55], v[120:123], v[20:23]
    v_mfma_f32_16x16x32_bf16 v[20:23], a[48:51], v[44:47], v[20:23]
    s_waitcnt lgkmcnt(0)
    v_mfma_f32_16x16x32_bf16 v[12:15], a[0:3], v[76:79], 0
    ds_read_b64_tr_b16 a[52:53], v254 offset:0
    v_mfma_f32_16x16x32_bf16 v[12:15], a[4:7], v[116:119], v[12:15]
    ds_read_b64_tr_b16 a[54:55], v254 offset:2048
    v_mfma_f32_16x16x32_bf16 v[12:15], a[8:11], v[128:131], v[12:15]
    ds_read_b64_tr_b16 a[48:49], v254 offset:4096
    v_mfma_f32_16x16x32_bf16 v[12:15], a[12:15], a[192:195], v[12:15]
    ds_read_b64_tr_b16 a[50:51], v254 offset:6144
    v_cvt_pk_bf16_f32 v28, v20, v21
    v_mfma_f32_16x16x32_bf16 v[12:15], a[16:19], a[208:211], v[12:15]
    ds_read_b64_tr_b16 a[56:57], v254 offset:8192
    v_cvt_pk_bf16_f32 v29, v22, v23
    v_mfma_f32_16x16x32_bf16 v[12:15], a[20:23], v[60:63], v[12:15]
    ds_read_b64_tr_b16 a[58:59], v254 offset:10240
    v_mfma_f32_16x16x32_bf16 v[12:15], a[24:27], a[224:227], v[12:15]
    ds_read_b64_tr_b16 a[60:61], v254 offset:12288
    v_mfma_f32_16x16x32_bf16 v[12:15], a[28:31], a[240:243], v[12:15]
    ds_read_b64_tr_b16 a[62:63], v254 offset:14336
    v_mfma_f32_16x16x32_bf16 v[12:15], a[32:35], v[64:67], v[12:15]
    ds_read_b64_tr_b16 a[64:65], v254 offset:16384
    v_mfma_f32_16x16x32_bf16 v[12:15], a[36:39], v[220:223], v[12:15]
    ds_read_b64_tr_b16 a[66:67], v254 offset:18432
    v_mfma_f32_16x16x32_bf16 v[12:15], a[40:43], v[212:215], v[12:15]
    ds_read_b64_tr_b16 a[68:69], v254 offset:20480
    v_mfma_f32_16x16x32_bf16 v[12:15], a[44:47], v[96:99], v[12:15]
    ds_read_b64_tr_b16 a[70:71], v254 offset:22528
    v_mfma_f32_16x16x32_bf16 v[20:23], a[44:47], v[0:3], 0
    ds_read_b64_tr_b16 a[72:73], v254 offset:24576
    v_mfma_f32_16x16x32_bf16 v[20:23], a[40:43], v[40:43], v[20:23]
    ds_read_b64_tr_b16 a[74:75], v254 offset:26624
    v_mfma_f32_16x16x32_bf16 v[20:23], a[36:39], v[228:231], v[20:23]
    ds_read_b64_tr_b16 a[76:77], v254 offset:28672
    v_mfma_f32_16x16x32_bf16 v[20:23], a[32:35], v[168:171], v[20:23]
    ds_read_b64_tr_b16 a[78:79], v254 offset:30720
    v_cvt_pk_bf16_f32 v114, v12, v13
    v_mfma_f32_16x16x32_bf16 v[20:23], a[28:31], a[244:247], v[20:23]
    ds_read_b64_tr_b16 a[80:81], v254 offset:32768
    v_cvt_pk_bf16_f32 v115, v14, v15
    v_mfma_f32_16x16x32_bf16 v[20:23], a[24:27], a[228:231], v[20:23]
    ds_read_b64_tr_b16 a[82:83], v254 offset:34816
    v_mfma_f32_16x16x32_bf16 v[20:23], a[20:23], v[124:127], v[20:23]
    ds_read_b64_tr_b16 a[84:85], v254 offset:36864
    v_mfma_f32_16x16x32_bf16 v[20:23], a[16:19], a[212:215], v[20:23]
    ds_read_b64_tr_b16 a[86:87], v254 offset:38912
    v_mfma_f32_16x16x32_bf16 v[20:23], a[12:15], a[196:199], v[20:23]
    ds_read_b64_tr_b16 a[88:89], v254 offset:40960
    v_mfma_f32_16x16x32_bf16 v[20:23], a[8:11], v[8:11], v[20:23]
    ds_read_b64_tr_b16 a[90:91], v254 offset:43008
    v_mfma_f32_16x16x32_bf16 v[20:23], a[4:7], v[160:163], v[20:23]
    ds_read_b64_tr_b16 a[92:93], v254 offset:45056
    v_mfma_f32_16x16x32_bf16 v[20:23], a[0:3], v[108:111], v[20:23]
    ds_read_b64_tr_b16 a[94:95], v254 offset:47104
    v_mfma_f32_16x16x32_bf16 v[12:15], a[0:3], v[36:39], 0
    buffer_store_dwordx4 v[52:55], v253, s[56:59], s95 offen offset:512 nt
    v_mfma_f32_16x16x32_bf16 v[12:15], a[4:7], v[4:7], v[12:15]
    buffer_store_dwordx4 v[112:115], v252, s[56:59], 0 offen offset:640 nt
    v_mfma_f32_16x16x32_bf16 v[12:15], a[8:11], v[24:27], v[12:15]
    v_mfma_f32_16x16x32_bf16 v[12:15], a[12:15], a[200:203], v[12:15]
    v_mfma_f32_16x16x32_bf16 v[12:15], a[16:19], a[216:219], v[12:15]
    v_cvt_pk_bf16_f32 v86, v20, v21
    v_cvt_pk_bf16_f32 v87, v22, v23
    v_mfma_f32_16x16x32_bf16 v[12:15], a[20:23], v[140:143], v[12:15]
    buffer_store_dwordx4 v[84:87], v250, s[56:59], 0 offen offset:640 nt
    v_mfma_f32_16x16x32_bf16 v[12:15], a[24:27], a[232:235], v[12:15]
    v_mfma_f32_16x16x32_bf16 v[12:15], a[28:31], a[248:251], v[12:15]
    v_mfma_f32_16x16x32_bf16 v[12:15], a[32:35], v[180:183], v[12:15]
    v_mfma_f32_16x16x32_bf16 v[12:15], a[36:39], v[56:59], v[12:15]
    v_mfma_f32_16x16x32_bf16 v[12:15], a[40:43], v[104:107], v[12:15]
    v_mfma_f32_16x16x32_bf16 v[12:15], a[44:47], v[48:51], v[12:15]
    v_mfma_f32_16x16x32_bf16 v[20:23], a[44:47], v[16:19], 0
    v_mfma_f32_16x16x32_bf16 v[20:23], a[40:43], v[68:71], v[20:23]
    v_mfma_f32_16x16x32_bf16 v[20:23], a[36:39], v[100:103], v[20:23]
    v_mfma_f32_16x16x32_bf16 v[20:23], a[32:35], v[184:187], v[20:23]
    buffer_store_dwordx4 v[132:135], v253, s[56:59], s96 offen offset:512 nt
    v_mfma_f32_16x16x32_bf16 v[20:23], a[28:31], a[252:255], v[20:23]
    v_mfma_f32_16x16x32_bf16 v[20:23], a[24:27], a[236:239], v[20:23]
    v_mfma_f32_16x16x32_bf16 v[20:23], a[20:23], v[148:151], v[20:23]
    v_xor_b32 v254, 114760, v255
    v_cvt_pk_bf16_f32 v90, v12, v13
    v_mfma_f32_16x16x32_bf16 v[20:23], a[16:19], a[220:223], v[20:23]
    v_cvt_pk_bf16_f32 v91, v14, v15
    v_mfma_f32_16x16x32_bf16 v[20:23], a[12:15], a[204:207], v[20:23]
    buffer_store_dwordx4 v[88:91], v248, s[56:59], 0 offen offset:640 nt
    v_mfma_f32_16x16x32_bf16 v[20:23], a[8:11], v[72:75], v[20:23]
    v_mfma_f32_16x16x32_bf16 v[20:23], a[4:7], v[120:123], v[20:23]
    v_mfma_f32_16x16x32_bf16 v[20:23], a[0:3], v[44:47], v[20:23]
    s_waitcnt lgkmcnt(0)
    v_mfma_f32_16x16x32_bf16 v[12:15], a[52:55], v[76:79], 0
    ds_read_b64_tr_b16 a[4:5], v254 offset:0
    v_mfma_f32_16x16x32_bf16 v[12:15], a[48:51], v[116:119], v[12:15]
    ds_read_b64_tr_b16 a[6:7], v254 offset:2048
    v_mfma_f32_16x16x32_bf16 v[12:15], a[56:59], v[128:131], v[12:15]
    ds_read_b64_tr_b16 a[0:1], v254 offset:4096
    v_mfma_f32_16x16x32_bf16 v[12:15], a[60:63], a[192:195], v[12:15]
    ds_read_b64_tr_b16 a[2:3], v254 offset:6144
    v_cvt_pk_bf16_f32 v30, v20, v21
    v_mfma_f32_16x16x32_bf16 v[12:15], a[64:67], a[208:211], v[12:15]
    ds_read_b64_tr_b16 a[8:9], v254 offset:8192
    v_cvt_pk_bf16_f32 v31, v22, v23
    v_mfma_f32_16x16x32_bf16 v[12:15], a[68:71], v[60:63], v[12:15]
    ds_read_b64_tr_b16 a[10:11], v254 offset:10240
    v_mfma_f32_16x16x32_bf16 v[12:15], a[72:75], a[224:227], v[12:15]
    ds_read_b64_tr_b16 a[12:13], v254 offset:12288
    v_mfma_f32_16x16x32_bf16 v[12:15], a[76:79], a[240:243], v[12:15]
    ds_read_b64_tr_b16 a[14:15], v254 offset:14336
    v_mfma_f32_16x16x32_bf16 v[12:15], a[80:83], v[64:67], v[12:15]
    ds_read_b64_tr_b16 a[16:17], v254 offset:16384
    v_mfma_f32_16x16x32_bf16 v[12:15], a[84:87], v[220:223], v[12:15]
    ds_read_b64_tr_b16 a[18:19], v254 offset:18432
    v_mfma_f32_16x16x32_bf16 v[12:15], a[88:91], v[212:215], v[12:15]
    ds_read_b64_tr_b16 a[20:21], v254 offset:20480
    v_mfma_f32_16x16x32_bf16 v[12:15], a[92:95], v[96:99], v[12:15]
    ds_read_b64_tr_b16 a[22:23], v254 offset:22528
    v_mfma_f32_16x16x32_bf16 v[20:23], a[92:95], v[0:3], 0
    ds_read_b64_tr_b16 a[24:25], v254 offset:24576
    v_mfma_f32_16x16x32_bf16 v[20:23], a[88:91], v[40:43], v[20:23]
    ds_read_b64_tr_b16 a[26:27], v254 offset:26624
    v_mfma_f32_16x16x32_bf16 v[20:23], a[84:87], v[228:231], v[20:23]
    ds_read_b64_tr_b16 a[28:29], v254 offset:28672
    v_mfma_f32_16x16x32_bf16 v[20:23], a[80:83], v[168:171], v[20:23]
    ds_read_b64_tr_b16 a[30:31], v254 offset:30720
    v_cvt_pk_bf16_f32 v52, v12, v13
    v_mfma_f32_16x16x32_bf16 v[20:23], a[76:79], a[244:247], v[20:23]
    ds_read_b64_tr_b16 a[32:33], v254 offset:32768
    v_cvt_pk_bf16_f32 v53, v14, v15
    v_mfma_f32_16x16x32_bf16 v[20:23], a[72:75], a[228:231], v[20:23]
    ds_read_b64_tr_b16 a[34:35], v254 offset:34816
    v_mfma_f32_16x16x32_bf16 v[20:23], a[68:71], v[124:127], v[20:23]
    ds_read_b64_tr_b16 a[36:37], v254 offset:36864
    v_mfma_f32_16x16x32_bf16 v[20:23], a[64:67], a[212:215], v[20:23]
    ds_read_b64_tr_b16 a[38:39], v254 offset:38912
    v_mfma_f32_16x16x32_bf16 v[20:23], a[60:63], a[196:199], v[20:23]
    ds_read_b64_tr_b16 a[40:41], v254 offset:40960
    v_mfma_f32_16x16x32_bf16 v[20:23], a[56:59], v[8:11], v[20:23]
    ds_read_b64_tr_b16 a[42:43], v254 offset:43008
    v_mfma_f32_16x16x32_bf16 v[20:23], a[48:51], v[160:163], v[20:23]
    ds_read_b64_tr_b16 a[44:45], v254 offset:45056
    v_mfma_f32_16x16x32_bf16 v[20:23], a[52:55], v[108:111], v[20:23]
    ds_read_b64_tr_b16 a[46:47], v254 offset:47104
    v_mfma_f32_16x16x32_bf16 v[12:15], a[52:55], v[36:39], 0
    buffer_store_dwordx4 v[32:35], v253, s[56:59], s97 offen offset:512 nt
    v_mfma_f32_16x16x32_bf16 v[12:15], a[48:51], v[4:7], v[12:15]
    buffer_store_dwordx4 v[28:31], v249, s[56:59], 0 offen offset:640 nt
    v_mfma_f32_16x16x32_bf16 v[12:15], a[56:59], v[24:27], v[12:15]
    v_mfma_f32_16x16x32_bf16 v[12:15], a[60:63], a[200:203], v[12:15]
    v_mfma_f32_16x16x32_bf16 v[12:15], a[64:67], a[216:219], v[12:15]
    v_cvt_pk_bf16_f32 v28, v20, v21
    v_cvt_pk_bf16_f32 v29, v22, v23
    v_mfma_f32_16x16x32_bf16 v[12:15], a[68:71], v[140:143], v[12:15]
    v_mfma_f32_16x16x32_bf16 v[12:15], a[72:75], a[232:235], v[12:15]
    v_mfma_f32_16x16x32_bf16 v[12:15], a[76:79], a[248:251], v[12:15]
    v_mfma_f32_16x16x32_bf16 v[12:15], a[80:83], v[180:183], v[12:15]
    v_mfma_f32_16x16x32_bf16 v[12:15], a[84:87], v[56:59], v[12:15]
    v_mfma_f32_16x16x32_bf16 v[12:15], a[88:91], v[104:107], v[12:15]
    v_mfma_f32_16x16x32_bf16 v[12:15], a[92:95], v[48:51], v[12:15]
    buffer_store_dwordx4 v[80:83], v253, s[56:59], s98 offen offset:512 nt
    v_mfma_f32_16x16x32_bf16 v[20:23], a[92:95], v[16:19], 0
    v_mfma_f32_16x16x32_bf16 v[20:23], a[88:91], v[68:71], v[20:23]
    v_mfma_f32_16x16x32_bf16 v[20:23], a[84:87], v[100:103], v[20:23]
    v_mfma_f32_16x16x32_bf16 v[20:23], a[80:83], v[184:187], v[20:23]
    v_mfma_f32_16x16x32_bf16 v[20:23], a[76:79], a[252:255], v[20:23]
    v_mfma_f32_16x16x32_bf16 v[20:23], a[72:75], a[236:239], v[20:23]
    v_mfma_f32_16x16x32_bf16 v[20:23], a[68:71], v[148:151], v[20:23]
    v_cvt_pk_bf16_f32 v32, v12, v13
    v_cvt_pk_bf16_f32 v33, v14, v15
    v_mfma_f32_16x16x32_bf16 v[20:23], a[64:67], a[220:223], v[20:23]
    v_mfma_f32_16x16x32_bf16 v[20:23], a[60:63], a[204:207], v[20:23]
    v_mfma_f32_16x16x32_bf16 v[20:23], a[56:59], v[72:75], v[20:23]
    v_mfma_f32_16x16x32_bf16 v[20:23], a[48:51], v[120:123], v[20:23]
    v_mfma_f32_16x16x32_bf16 v[20:23], a[52:55], v[44:47], v[20:23]
    s_waitcnt lgkmcnt(0)
    v_mfma_f32_16x16x32_bf16 v[12:15], a[4:7], v[76:79], 0
    v_mfma_f32_16x16x32_bf16 v[12:15], a[0:3], v[116:119], v[12:15]
    v_mfma_f32_16x16x32_bf16 v[12:15], a[8:11], v[128:131], v[12:15]
    v_mfma_f32_16x16x32_bf16 v[12:15], a[12:15], a[192:195], v[12:15]
    v_mfma_f32_16x16x32_bf16 v[12:15], a[16:19], a[208:211], v[12:15]
    v_mfma_f32_16x16x32_bf16 v[12:15], a[20:23], v[60:63], v[12:15]
    v_mfma_f32_16x16x32_bf16 v[12:15], a[24:27], a[224:227], v[12:15]
    v_cvt_pk_bf16_f32 v76, v20, v21
    v_cvt_pk_bf16_f32 v77, v22, v23
    v_mfma_f32_16x16x32_bf16 v[12:15], a[28:31], a[240:243], v[12:15]
    v_mfma_f32_16x16x32_bf16 v[12:15], a[32:35], v[64:67], v[12:15]
    v_mfma_f32_16x16x32_bf16 v[12:15], a[36:39], v[220:223], v[12:15]
    buffer_store_dwordx4 v[92:95], v253, s[56:59], s99 offen offset:512 nt
    v_mfma_f32_16x16x32_bf16 v[12:15], a[40:43], v[212:215], v[12:15]
    v_mfma_f32_16x16x32_bf16 v[12:15], a[44:47], v[96:99], v[12:15]
    v_mfma_f32_16x16x32_bf16 v[20:23], a[44:47], v[0:3], 0
    v_mfma_f32_16x16x32_bf16 v[20:23], a[40:43], v[40:43], v[20:23]
    v_mfma_f32_16x16x32_bf16 v[20:23], a[36:39], v[228:231], v[20:23]
    v_mfma_f32_16x16x32_bf16 v[20:23], a[32:35], v[168:171], v[20:23]
    v_mfma_f32_16x16x32_bf16 v[20:23], a[28:31], a[244:247], v[20:23]
    v_mfma_f32_16x16x32_bf16 v[20:23], a[24:27], a[228:231], v[20:23]
    v_mfma_f32_16x16x32_bf16 v[20:23], a[20:23], v[124:127], v[20:23]
    v_mfma_f32_16x16x32_bf16 v[20:23], a[16:19], a[212:215], v[20:23]
    v_cvt_pk_bf16_f32 v54, v12, v13
    v_cvt_pk_bf16_f32 v55, v14, v15
    v_mfma_f32_16x16x32_bf16 v[20:23], a[12:15], a[196:199], v[20:23]
    buffer_store_dwordx4 v[52:55], v252, s[56:59], 0 offen offset:704 nt
    v_mfma_f32_16x16x32_bf16 v[20:23], a[8:11], v[8:11], v[20:23]
    v_mfma_f32_16x16x32_bf16 v[20:23], a[0:3], v[160:163], v[20:23]
    v_mfma_f32_16x16x32_bf16 v[20:23], a[4:7], v[108:111], v[20:23]
    v_mfma_f32_16x16x32_bf16 v[0:3], a[4:7], v[36:39], 0
    v_mfma_f32_16x16x32_bf16 v[0:3], a[0:3], v[4:7], v[0:3]
    v_mfma_f32_16x16x32_bf16 v[0:3], a[8:11], v[24:27], v[0:3]
    v_mfma_f32_16x16x32_bf16 v[0:3], a[12:15], a[200:203], v[0:3]
    v_mfma_f32_16x16x32_bf16 v[0:3], a[16:19], a[216:219], v[0:3]
    v_mfma_f32_16x16x32_bf16 v[0:3], a[20:23], v[140:143], v[0:3]
    v_mfma_f32_16x16x32_bf16 v[0:3], a[24:27], a[232:235], v[0:3]
    v_mfma_f32_16x16x32_bf16 v[0:3], a[28:31], a[248:251], v[0:3]
    v_cvt_pk_bf16_f32 v30, v20, v21
    v_cvt_pk_bf16_f32 v31, v22, v23
    v_mfma_f32_16x16x32_bf16 v[0:3], a[32:35], v[180:183], v[0:3]
    buffer_store_dwordx4 v[28:31], v250, s[56:59], 0 offen offset:704 nt
    v_mfma_f32_16x16x32_bf16 v[0:3], a[36:39], v[56:59], v[0:3]
    v_mfma_f32_16x16x32_bf16 v[0:3], a[40:43], v[104:107], v[0:3]
    v_mfma_f32_16x16x32_bf16 v[0:3], a[44:47], v[48:51], v[0:3]
    v_mfma_f32_16x16x32_bf16 v[4:7], a[44:47], v[16:19], 0
    v_mfma_f32_16x16x32_bf16 v[4:7], a[40:43], v[68:71], v[4:7]
    v_mfma_f32_16x16x32_bf16 v[4:7], a[36:39], v[100:103], v[4:7]
    v_mfma_f32_16x16x32_bf16 v[4:7], a[32:35], v[184:187], v[4:7]
    v_mfma_f32_16x16x32_bf16 v[4:7], a[28:31], a[252:255], v[4:7]
    v_mfma_f32_16x16x32_bf16 v[4:7], a[24:27], a[236:239], v[4:7]
    v_mfma_f32_16x16x32_bf16 v[4:7], a[20:23], v[148:151], v[4:7]
    v_mfma_f32_16x16x32_bf16 v[4:7], a[16:19], a[220:223], v[4:7]
    v_cvt_pk_bf16_f32 v34, v0, v1
    v_cvt_pk_bf16_f32 v35, v2, v3
    v_mfma_f32_16x16x32_bf16 v[4:7], a[12:15], a[204:207], v[4:7]
    buffer_store_dwordx4 v[32:35], v248, s[56:59], 0 offen offset:704 nt
    v_mfma_f32_16x16x32_bf16 v[4:7], a[8:11], v[72:75], v[4:7]
    v_mfma_f32_16x16x32_bf16 v[4:7], a[0:3], v[120:123], v[4:7]
    v_mfma_f32_16x16x32_bf16 v[4:7], a[4:7], v[44:47], v[4:7]
    s_nop 7
    v_cvt_pk_bf16_f32 v78, v4, v5
    v_cvt_pk_bf16_f32 v79, v6, v7
    buffer_store_dwordx4 v[76:79], v249, s[56:59], 0 offen offset:704 nt
L_end:

s_endpgm
L_code_end:
.section .rodata,"a"
.p2align 6
.amdhsa_kernel standalone__window_attn_swin__vision_kernel
  .amdhsa_next_free_vgpr 512
  .amdhsa_next_free_sgpr 102
  .amdhsa_accum_offset 256
  .amdhsa_group_segment_fixed_size 0
  .amdhsa_kernarg_size 72
  .amdhsa_user_sgpr_count 2
  .amdhsa_user_sgpr_kernarg_segment_ptr 1
  .amdhsa_system_sgpr_workgroup_id_x 1
  .amdhsa_float_denorm_mode_32 3
.end_amdhsa_kernel
```
